```python
import torch

def _softmax(x, axis=-1):
    return torch.softmax(x, dim=axis)
def _gelu(x):
    return torch.nn.functional.gelu(x, approximate="tanh")
def _silu(x):
    return torch.nn.functional.silu(x)
def _sigmoid(x):
    return torch.sigmoid(x)
def _layernorm(x, axis=-1, eps=1e-5):
    m = x.mean(dim=axis, keepdim=True)
    v = x.var(dim=axis, keepdim=True, unbiased=False)
    return (x - m) / torch.sqrt(v + eps)
def _scatter_add(tgt, idx, src, axis=0):
    return tgt.clone().index_add_(axis, idx, src)
def _segment_sum(src, seg, n):
    out = torch.zeros((n,) + src.shape[1:], dtype=src.dtype)
    return out.index_add_(0, seg, src)
def _pad(x, pw):
    flat = tuple(v for pair in reversed(pw) for v in pair)
    return torch.nn.functional.pad(x, flat)

kernel_name = 'parallel_sum__mha_block__glu_gated_swiglu__prompt'

def setup_inputs():

    _w = (lambda a: (lambda t: t.to(torch.bfloat16) if t.is_floating_point() else t)(torch.as_tensor(a)))
    def _A_setup():
        B, S, D, H = 1, 2048, 1024, 32
        return {
            "x": _w((lambda *s: torch.randn(*s, dtype=torch.bfloat16) * 0.05)(B, S, D)),
            "wqkv": _w((lambda *s: torch.randn(*s, dtype=torch.bfloat16) * 0.05)(D, 3 * D)),
            "wo": _w((lambda *s: torch.randn(*s, dtype=torch.bfloat16) * 0.05)(D, D)),
        }
    _A_in = _A_setup()

    def _B_setup():
        B, S, D, F = 1, 2048, 1024, 3584
        return {
            "x": _w((lambda *s: torch.randn(*s, dtype=torch.bfloat16) * 0.05)(B, S, D)),
            "w1": _w((lambda *s: torch.randn(*s, dtype=torch.bfloat16) * 0.8)(D, F) * (2.0 / D) ** 0.5),
            "w3": _w((lambda *s: torch.randn(*s, dtype=torch.bfloat16) * 0.8)(D, F) * (2.0 / D) ** 0.5),
            "w2": _w((lambda *s: torch.randn(*s, dtype=torch.bfloat16) * 0.8)(F, D) * (2.0 / F) ** 0.5),
        }
    _B_in = _B_setup()

    return {
        "A_x": _A_in["x"],
        "A_wqkv": _A_in["wqkv"],
        "A_wo": _A_in["wo"],
        "B_x": _B_in["x"],
        "B_w1": _B_in["w1"],
        "B_w3": _B_in["w3"],
        "B_w2": _B_in["w2"],
    }

def reference(A_x, A_wqkv, A_wo, B_x, B_w1, B_w3, B_w2):
    def _A_ref(x, wqkv, wo):
        B, S, D = x.shape
        H = 32
        Dh = D // H
        qkv = (lambda x, *d: x.permute(*d))((x @ wqkv).reshape(B, S, 3, H, Dh), 2, 0, 3, 1, 4)
        q, k, v = qkv[0], qkv[1], qkv[2]
        scores = torch.einsum("bhqd,bhkd->bhqk", q, k) * (Dh ** -0.5)
        p = _softmax(scores, axis=-1)
        o = torch.einsum("bhqk,bhkd->bhqd", p, v)
        return (lambda x, *d: x.permute(*d))(o, 0, 2, 1, 3).reshape(B, S, D) @ wo

    def _B_ref(x, w1, w3, w2):
        gate = torch.einsum("bsd,df->bsf", x, w1)
        up = torch.einsum("bsd,df->bsf", x, w3)
        h = _silu(gate) * up
        out = torch.einsum("bsf,fd->bsd", h, w2)
        return out

    x = A_x
    xn = _layernorm(x, axis=-1)
    return x + _A_ref(xn, A_wqkv, A_wo) + _B_ref(xn, B_w1, B_w3, B_w2)
```

```asm
; @launch kernel=gemm1_kernel grid=(256,1,1) block=(512,1,1) lds=153600
; @launch kernel=fused_kernel grid=(256,1,1) block=(1024,1,1) lds=163840
.amdgcn_target "amdgcn-amd-amdhsa--gfx950"
.text
.globl gemm1_kernel
.p2align 8
.type gemm1_kernel,@function
gemm1_kernel:
  s_cmp_ge_u32 s2, 256
  s_cbranch_scc1 gemm1_kernel_end
  s_load_dwordx2 s[4:5], s[0:1], 8
  s_load_dwordx2 s[6:7], s[0:1], 32
  s_load_dwordx2 s[8:9], s[0:1], 40
  s_load_dwordx2 s[60:61], s[0:1], 0
  s_load_dwordx2 s[12:13], s[0:1], 72
  s_load_dwordx2 s[68:69], s[0:1], 64
  s_load_dwordx2 s[98:99], s[0:1], 48
  s_load_dwordx2 s[100:101], s[0:1], 16
  v_lshrrev_b32 v1, 6, v0
  v_and_b32 v2, 63, v0
  v_readfirstlane_b32 s28, v1
  s_and_b32 s47, s2, 7
  s_lshr_b32 s48, s2, 3
  s_and_b32 s32, s48, 7
  s_lshr_b32 s48, s48, 3
  s_lshl_b32 s31, s47, 1
  s_and_b32 s49, s48, 1
  s_add_u32 s31, s31, s49
  s_lshr_b32 s48, s48, 1
  s_and_b32 s48, s48, 1
  s_lshl_b32 s49, s31, 1
  s_add_u32 s50, s31, 32
  s_mul_i32 s51, s31, 3
  s_add_u32 s51, s51, 46
  s_lshl_b32 s52, s31, 2
  s_add_u32 s52, s52, 95
  s_cmp_eq_u32 s48, 0
  s_cselect_b32 s31, s49, s50
  s_cselect_b32 s3, s51, s52
  s_cselect_b32 s96, 2, 1
  s_and_b32 s29, s28, 1
  s_lshr_b32 s30, s28, 1
  s_mov_b32 s46, 0x3f803f80

  v_lshrrev_b32 v3, 3, v2
  v_lshrrev_b32 v4, 1, v3
  v_and_b32 v5, 7, v2
  v_xor_b32 v4, v4, v5
  v_lshlrev_b32 v4, 4, v4
  v_lshl_add_u32 v11, v3, 11, v4
  s_lshl_b32 s47, s32, 3
  s_add_u32 s47, s47, s28
  s_lshl_b32 s47, s47, 16
  v_add_u32 v11, s47, v11
  v_xor_b32 v12, 64, v11
  v_add_u32 v12, 16384, v12
  s_lshl_b32 s39, s28, 13
  s_add_u32 s39, s39, 81920
  s_mov_b32 s41, 0
  s_mov_b32 s42, 32768
  v_lshrrev_b32 v3, 2, v2
  v_lshrrev_b32 v4, 5, v2
  v_bfe_u32 v5, v2, 1, 1
  v_xor_b32 v4, v4, v5
  v_lshlrev_b32 v4, 5, v4
  v_and_b32 v5, 1, v2
  v_lshl_add_u32 v4, v5, 4, v4
  s_mov_b32 s14, 268435456
  s_mov_b32 s15, 0x20000
  s_mov_b32 s62, 4194304
  s_mov_b32 s63, 0x20000
  s_mov_b32 s70, 256
  s_mov_b32 s71, 0x20000
  s_add_u32 s47, s28, 0
  s_cmp_ge_u32 s47, 10
  s_cselect_b32 s48, 1, 0
  s_mul_i32 s49, s48, 10
  s_sub_u32 s47, s47, s49
  s_cmp_ge_u32 s47, 5
  s_cselect_b32 s49, 1, 0
  s_mul_i32 s50, s49, 5
  s_sub_u32 s47, s47, s50
  s_add_u32 s36, s28, 0
  s_lshl_b32 s36, s36, 10
  s_add_u32 s47, s47, 0
  s_cmp_lt_u32 s47, s96
  s_cselect_b32 s50, s31, s3
  s_add_u32 s50, s50, s47
  s_add_u32 s51, s49, 1
  s_lshl_b32 s53, s50, 7
  s_lshl_b32 s54, s49, 6
  s_add_u32 s53, s53, s54
  s_sub_u32 s54, s50, 48
  s_lshl_b32 s54, s54, 6
  s_cmp_ge_u32 s50, 48
  s_cselect_b32 s56, s51, 0
  s_mov_b32 s51, 7340032
  s_cselect_b32 s18, s51, 6291456
  s_mov_b32 s19, 0x20000
  s_cselect_b32 s53, s54, s53
  s_mov_b32 s51, 7168
  s_cselect_b32 s51, s51, 6144
  s_lshl_b32 s54, s51, 4
  s_mul_i32 s54, s54, s48
  s_add_u32 s33, s53, s54
  s_lshl_b32 s43, s51, 5
  v_mul_lo_u32 v8, v3, s51
  v_add_u32 v8, v8, v4

  s_waitcnt lgkmcnt(0)
  s_cmp_ge_u32 s2, 256
  s_cbranch_scc1 gemm1_kernel_end
  s_add_u32 m0, s39, 0
  s_nop 0
  buffer_load_dwordx4 v11, s[60:63], s41 offen lds
  s_add_u32 m0, s39, 1024
  s_nop 0
  buffer_load_dwordx4 v12, s[60:63], s41 offen lds
  s_add_u32 m0, s39, 2048
  s_nop 0
  buffer_load_dwordx4 v11, s[60:63], s42 offen lds
  s_add_u32 m0, s39, 3072
  s_nop 0
  buffer_load_dwordx4 v12, s[60:63], s42 offen lds
  s_add_u32 s41, s41, 128
  s_add_u32 s42, s42, 128
  s_cmp_eq_u32 s56, 1
  s_cselect_b64 s[10:11], s[6:7], s[8:9]
  s_cmp_eq_u32 s56, 0
  s_cselect_b64 s[16:17], s[4:5], s[10:11]
  s_add_u32 m0, s36, 0
  s_nop 0
  buffer_load_dwordx4 v8, s[16:19], s33 offen lds
  s_add_u32 s33, s33, s43
  s_add_u32 s47, s28, 8
  s_cmp_ge_u32 s47, 10
  s_cselect_b32 s48, 1, 0
  s_mul_i32 s49, s48, 10
  s_sub_u32 s47, s47, s49
  s_cmp_ge_u32 s47, 5
  s_cselect_b32 s49, 1, 0
  s_mul_i32 s50, s49, 5
  s_sub_u32 s47, s47, s50
  s_add_u32 s37, s28, 8
  s_lshl_b32 s37, s37, 10
  s_add_u32 s47, s47, 0
  s_cmp_lt_u32 s47, s96
  s_cselect_b32 s50, s31, s3
  s_add_u32 s50, s50, s47
  s_add_u32 s51, s49, 1
  s_lshl_b32 s53, s50, 7
  s_lshl_b32 s54, s49, 6
  s_add_u32 s53, s53, s54
  s_sub_u32 s54, s50, 48
  s_lshl_b32 s54, s54, 6
  s_cmp_ge_u32 s50, 48
  s_cselect_b32 s57, s51, 0
  s_mov_b32 s51, 7340032
  s_cselect_b32 s22, s51, 6291456
  s_mov_b32 s23, 0x20000
  s_cselect_b32 s53, s54, s53
  s_mov_b32 s51, 7168
  s_cselect_b32 s51, s51, 6144
  s_lshl_b32 s54, s51, 4
  s_mul_i32 s54, s54, s48
  s_add_u32 s34, s53, s54
  s_lshl_b32 s44, s51, 5
  v_mul_lo_u32 v9, v3, s51
  v_add_u32 v9, v9, v4

  s_cmp_eq_u32 s57, 1
  s_cselect_b64 s[10:11], s[6:7], s[8:9]
  s_cmp_eq_u32 s57, 0
  s_cselect_b64 s[20:21], s[4:5], s[10:11]
  s_add_u32 m0, s37, 0
  s_nop 0
  buffer_load_dwordx4 v9, s[20:23], s34 offen lds
  s_add_u32 s34, s34, s44
  s_add_u32 s47, s28, 16
  s_cmp_ge_u32 s47, 10
  s_cselect_b32 s48, 1, 0
  s_mul_i32 s49, s48, 10
  s_sub_u32 s47, s47, s49
  s_cmp_ge_u32 s47, 5
  s_cselect_b32 s49, 1, 0
  s_mul_i32 s50, s49, 5
  s_sub_u32 s47, s47, s50
  s_add_u32 s38, s28, 16
  s_lshl_b32 s38, s38, 10
  s_add_u32 s47, s47, 0
  s_cmp_lt_u32 s47, s96
  s_cselect_b32 s50, s31, s3
  s_add_u32 s50, s50, s47
  s_add_u32 s51, s49, 1
  s_lshl_b32 s53, s50, 7
  s_lshl_b32 s54, s49, 6
  s_add_u32 s53, s53, s54
  s_sub_u32 s54, s50, 48
  s_lshl_b32 s54, s54, 6
  s_cmp_ge_u32 s50, 48
  s_cselect_b32 s59, s51, 0
  s_mov_b32 s51, 7340032
  s_cselect_b32 s26, s51, 6291456
  s_mov_b32 s27, 0x20000
  s_cselect_b32 s53, s54, s53
  s_mov_b32 s51, 7168
  s_cselect_b32 s51, s51, 6144
  s_lshl_b32 s54, s51, 4
  s_mul_i32 s54, s54, s48
  s_add_u32 s35, s53, s54
  s_lshl_b32 s45, s51, 5
  v_mul_lo_u32 v10, v3, s51
  v_add_u32 v10, v10, v4

  s_cmp_eq_u32 s59, 1
  s_cselect_b64 s[10:11], s[6:7], s[8:9]
  s_cmp_eq_u32 s59, 0
  s_cselect_b64 s[24:25], s[4:5], s[10:11]
  s_cmp_ge_u32 s28, 4
  s_cbranch_scc1 gemm1_kernel_sk1
  s_add_u32 m0, s38, 0
  s_nop 0
  buffer_load_dwordx4 v10, s[24:27], s35 offen lds
  s_add_u32 s35, s35, s45
  gemm1_kernel_sk1:
  s_lshl_b32 s55, s2, 3
  s_add_u32 s55, s55, s28
  s_lshl_b32 s58, s55, 11
  v_lshlrev_b32 v90, 4, v2
  buffer_load_dwordx4 v[224:227], v90, s[60:63], s58 offen
  buffer_load_dwordx4 v[228:231], v90, s[60:63], s58 offen offset:1024
  v_lshrrev_b32 v3, 5, v2
  v_mul_u32_u24 v13, 10240, v3
  v_bfe_u32 v3, v2, 4, 1
  v_lshl_add_u32 v13, v3, 9, v13
  v_xor_b32 v3, s29, v3
  v_lshl_add_u32 v13, v3, 5, v13
  v_bfe_u32 v3, v2, 2, 2
  v_lshl_add_u32 v13, v3, 6, v13
  v_and_b32 v3, 3, v2
  v_lshl_add_u32 v13, v3, 3, v13
  v_add_u32 v14, 40960, v13
  v_and_b32 v3, 15, v2
  v_lshlrev_b32 v4, 7, v3
  v_lshrrev_b32 v3, 1, v3
  v_lshrrev_b32 v5, 4, v2
  v_xor_b32 v3, v3, v5
  v_lshl_add_u32 v4, v3, 4, v4
  s_lshl_b32 s47, s30, 14
  s_add_u32 s47, s47, 81920
  s_lshl_b32 s48, s29, 13
  s_add_u32 s48, s47, s48
  s_xor_b32 s49, s29, 1
  s_lshl_b32 s49, s49, 13
  s_add_u32 s49, s47, s49
  v_add_u32 v5, s49, v4
  v_add_u32 v4, s48, v4
  v_xor_b32 v6, 64, v4
  v_xor_b32 v7, 64, v5
  v_mov_b32 v15, 0

  v_mov_b32 v64, s46
  v_mov_b32 v65, s46
  v_mov_b32 v66, s46
  v_mov_b32 v67, s46
  s_mov_b32 s47, 7168
  s_cmp_eq_u32 s28, 0
  s_cselect_b32 s64, s4, s6
  s_cselect_b32 s65, s5, s7
  s_cselect_b32 s47, 6144, s47
  s_cmp_eq_u32 s28, 2
  s_cselect_b32 s64, s8, s64
  s_cselect_b32 s65, s9, s65
  s_cmp_eq_u32 s28, 3
  s_cselect_b32 s64, s98, s64
  s_cselect_b32 s65, s99, s65
  s_lshl_b32 s66, s47, 10
  s_cmp_ge_u32 s28, 4
  s_cselect_b32 s64, s100, s64
  s_cselect_b32 s65, s101, s65
  s_cselect_b32 s66, 2097152, s66
  s_cmp_ge_u32 s28, 5
  s_cselect_b32 s66, 0, s66
  s_mov_b32 s67, 0x20000
  s_cmp_ge_u32 s28, 3
  s_cselect_b32 s47, 8192, s47
  s_cselect_b32 s48, 0, 256
  s_add_u32 s48, s48, s2
  s_lshl_b32 s98, s47, 7
  s_lshr_b32 s47, s47, 1
  s_mul_i32 s97, s47, s48
  s_cmp_ge_u32 s28, 3
  s_cselect_b32 s48, 8388608, 0
  s_sub_u32 s97, s97, s48
  v_lshlrev_b32 v89, 6, v2

  s_waitcnt vmcnt(2)
  s_barrier
  ds_read_b64_tr_b16 v[16:17], v13 offset:0
  ds_read_b64_tr_b16 v[18:19], v13 offset:256
  ds_read_b128 v[32:35], v4 offset:0
  ds_read_b128 v[36:39], v4 offset:2048
  ds_read_b128 v[40:43], v5 offset:0
  ds_read_b128 v[44:47], v5 offset:2048
  ds_read_b64_tr_b16 v[20:21], v13 offset:5120
  ds_read_b64_tr_b16 v[22:23], v13 offset:5376
  ds_read_b64_tr_b16 v[24:25], v13 offset:1024
  ds_read_b64_tr_b16 v[26:27], v13 offset:1280
  s_mov_b32 s40, 6
  s_cmp_eq_u32 s30, 1
  s_cbranch_scc1 gemm1_kernel_p1_1
  s_cmp_eq_u32 s30, 2
  s_cbranch_scc1 gemm1_kernel_p1_2
  s_cmp_eq_u32 s30, 3
  s_cbranch_scc1 gemm1_kernel_p1_3
gemm1_kernel_p1_0:
  s_waitcnt lgkmcnt(4)
  v_mfma_f32_16x16x32_bf16 v[96:99], v[16:19], v[32:35], 0
  ds_read_b64_tr_b16 v[28:29], v13 offset:6144
  ds_read_b64_tr_b16 v[30:31], v13 offset:6400
  s_waitcnt vmcnt(0)
  s_mov_b32 s47, 0xffff0000
  v_lshlrev_b32 v232, 16, v224
  v_and_b32 v233, s47, v224
  v_mfma_f32_16x16x32_bf16 v[100:103], v[16:19], v[36:39], 0
  s_add_u32 m0, s36, 20480
  s_nop 0
  buffer_load_dwordx4 v8, s[16:19], s33 offen lds
  s_add_u32 s33, s33, s43
  v_lshlrev_b32 v234, 16, v225
  v_and_b32 v235, s47, v225
  v_lshlrev_b32 v236, 16, v226
  v_mfma_f32_16x16x32_bf16 v[104:107], v[16:19], v[40:43], 0
  v_and_b32 v237, s47, v226
  v_lshlrev_b32 v238, 16, v227
  v_and_b32 v239, s47, v227
  v_mfma_f32_16x16x32_bf16 v[108:111], v[16:19], v[44:47], 0
  s_add_u32 m0, s37, 20480
  s_nop 0
  buffer_load_dwordx4 v9, s[20:23], s34 offen lds
  s_add_u32 s34, s34, s44
  v_mfma_f32_16x16x32_bf16 v[68:71], v[16:19], v[64:67], 0
  v_lshlrev_b32 v240, 16, v228
  v_and_b32 v241, s47, v228
  v_lshlrev_b32 v242, 16, v229
  s_waitcnt lgkmcnt(4)
  v_mfma_f32_16x16x32_bf16 v[112:115], v[20:23], v[32:35], 0
  ds_read_b64_tr_b16 v[16:17], v13 offset:2048
  ds_read_b64_tr_b16 v[18:19], v13 offset:2304
  v_and_b32 v243, s47, v229
  v_lshlrev_b32 v244, 16, v230
  v_and_b32 v245, s47, v230
  v_mfma_f32_16x16x32_bf16 v[116:119], v[20:23], v[36:39], 0
  s_cmp_ge_u32 s28, 4
  s_cbranch_scc1 gemm1_kernel_sk2
  s_add_u32 m0, s38, 20480
  s_nop 0
  buffer_load_dwordx4 v10, s[24:27], s35 offen lds
  s_add_u32 s35, s35, s45
  gemm1_kernel_sk2:
  v_lshlrev_b32 v246, 16, v231
  v_and_b32 v247, s47, v231
  v_add_f32 v248, v232, v233
  v_mfma_f32_16x16x32_bf16 v[120:123], v[20:23], v[40:43], 0
  v_add_f32 v249, v234, v235
  v_add_f32 v248, v248, v236
  v_add_f32 v249, v249, v237
  v_mfma_f32_16x16x32_bf16 v[124:127], v[20:23], v[44:47], 0
  s_add_u32 m0, s39, 4096
  s_nop 0
  buffer_load_dwordx4 v11, s[60:63], s41 offen lds
  v_add_f32 v248, v248, v238
  v_add_f32 v249, v249, v239
  v_add_f32 v248, v248, v240
  s_waitcnt lgkmcnt(4)
  v_mfma_f32_16x16x32_bf16 v[128:131], v[24:27], v[32:35], 0
  ds_read_b64_tr_b16 v[20:21], v13 offset:7168
  ds_read_b64_tr_b16 v[22:23], v13 offset:7424
  v_add_f32 v249, v249, v241
  v_add_f32 v248, v248, v242
  v_add_f32 v249, v249, v243
  v_mfma_f32_16x16x32_bf16 v[132:135], v[24:27], v[36:39], 0
  s_add_u32 m0, s39, 5120
  s_nop 0
  buffer_load_dwordx4 v12, s[60:63], s41 offen lds
  v_add_f32 v248, v248, v244
  v_add_f32 v249, v249, v245
  v_add_f32 v248, v248, v246
  v_mfma_f32_16x16x32_bf16 v[136:139], v[24:27], v[40:43], 0
  v_add_f32 v249, v249, v247
  v_add_f32 v248, v248, v249
  s_nop 1
  v_add_f32_dpp v248, v248, v248 quad_perm:[1,0,3,2] row_mask:0xf bank_mask:0xf
  v_mfma_f32_16x16x32_bf16 v[140:143], v[24:27], v[44:47], 0
  s_add_u32 m0, s39, 6144
  s_nop 0
  buffer_load_dwordx4 v11, s[60:63], s42 offen lds
  s_nop 1
  v_add_f32_dpp v248, v248, v248 quad_perm:[2,3,0,1] row_mask:0xf bank_mask:0xf
  s_nop 1
  v_add_f32_dpp v248, v248, v248 row_half_mirror row_mask:0xf bank_mask:0xf
  s_nop 1
  v_add_f32_dpp v248, v248, v248 row_mirror row_mask:0xf bank_mask:0xf
  s_waitcnt lgkmcnt(4)
  v_mfma_f32_16x16x32_bf16 v[144:147], v[28:31], v[32:35], 0
  ds_read_b64_tr_b16 v[24:25], v13 offset:3072
  ds_read_b64_tr_b16 v[26:27], v13 offset:3328
  v_mov_b32 v250, v248
  s_nop 1
  v_permlane16_swap_b32 v250, v248
  s_nop 0
  v_add_f32 v248, v248, v250
  v_mfma_f32_16x16x32_bf16 v[148:151], v[28:31], v[36:39], 0
  s_add_u32 m0, s39, 7168
  s_nop 0
  buffer_load_dwordx4 v12, s[60:63], s42 offen lds
  s_add_u32 s41, s41, 128
  s_add_u32 s42, s42, 128
  v_mov_b32 v250, v248
  s_nop 1
  v_permlane32_swap_b32 v250, v248
  s_nop 0
  v_add_f32 v248, v248, v250
  v_mfma_f32_16x16x32_bf16 v[152:155], v[28:31], v[40:43], 0
  v_mul_f32 v248, 0xba800000, v248
  v_add_f32 v232, v232, v248
  v_add_f32 v233, v233, v248
  v_mfma_f32_16x16x32_bf16 v[156:159], v[28:31], v[44:47], 0
  s_add_u32 m0, s36, 40960
  s_nop 0
  buffer_load_dwordx4 v8, s[16:19], s33 offen lds
  s_add_u32 s33, s33, s43
  v_add_f32 v234, v234, v248
  v_add_f32 v235, v235, v248
  v_add_f32 v236, v236, v248
  s_waitcnt lgkmcnt(4)
  v_mfma_f32_16x16x32_bf16 v[160:163], v[16:19], v[32:35], 0
  ds_read_b64_tr_b16 v[28:29], v13 offset:8192
  ds_read_b64_tr_b16 v[30:31], v13 offset:8448
  v_add_f32 v237, v237, v248
  v_add_f32 v238, v238, v248
  v_add_f32 v239, v239, v248
  v_mfma_f32_16x16x32_bf16 v[164:167], v[16:19], v[36:39], 0
  s_add_u32 m0, s37, 40960
  s_nop 0
  buffer_load_dwordx4 v9, s[20:23], s34 offen lds
  s_add_u32 s34, s34, s44
  v_add_f32 v240, v240, v248
  v_add_f32 v241, v241, v248
  v_add_f32 v242, v242, v248
  v_mfma_f32_16x16x32_bf16 v[168:171], v[16:19], v[40:43], 0
  v_add_f32 v243, v243, v248
  v_add_f32 v244, v244, v248
  v_add_f32 v245, v245, v248
  v_mfma_f32_16x16x32_bf16 v[172:175], v[16:19], v[44:47], 0
  s_cmp_ge_u32 s28, 4
  s_cbranch_scc1 gemm1_kernel_sk3
  s_add_u32 m0, s38, 40960
  s_nop 0
  buffer_load_dwordx4 v10, s[24:27], s35 offen lds
  s_add_u32 s35, s35, s45
  gemm1_kernel_sk3:
  v_mfma_f32_16x16x32_bf16 v[72:75], v[16:19], v[64:67], 0
  v_add_f32 v246, v246, v248
  v_add_f32 v247, v247, v248
  v_mul_f32 v249, v232, v232
  s_waitcnt lgkmcnt(4)
  v_mfma_f32_16x16x32_bf16 v[176:179], v[20:23], v[32:35], 0
  ds_read_b64_tr_b16 v[16:17], v13 offset:4096
  ds_read_b64_tr_b16 v[18:19], v13 offset:4352
  v_mul_f32 v250, v233, v233
  v_fmac_f32 v249, v234, v234
  v_fmac_f32 v250, v235, v235
  v_mfma_f32_16x16x32_bf16 v[180:183], v[20:23], v[36:39], 0
  buffer_load_dword v88, v89, s[64:67], s97 offen
  s_add_u32 s97, s97, s98
  v_fmac_f32 v249, v236, v236
  v_fmac_f32 v250, v237, v237
  v_fmac_f32 v249, v238, v238
  v_mfma_f32_16x16x32_bf16 v[184:187], v[20:23], v[40:43], 0
  v_fmac_f32 v250, v239, v239
  v_fmac_f32 v249, v240, v240
  v_fmac_f32 v250, v241, v241
  v_mfma_f32_16x16x32_bf16 v[188:191], v[20:23], v[44:47], 0
  v_fmac_f32 v249, v242, v242
  v_fmac_f32 v250, v243, v243
  v_fmac_f32 v249, v244, v244
  s_waitcnt lgkmcnt(4)
  v_mfma_f32_16x16x32_bf16 v[192:195], v[24:27], v[32:35], 0
  ds_read_b64_tr_b16 v[20:21], v13 offset:9216
  ds_read_b64_tr_b16 v[22:23], v13 offset:9472
  v_fmac_f32 v250, v245, v245
  v_fmac_f32 v249, v246, v246
  v_fmac_f32 v250, v247, v247
  v_mfma_f32_16x16x32_bf16 v[196:199], v[24:27], v[36:39], 0
  v_add_f32 v249, v249, v250
  s_nop 1
  v_add_f32_dpp v249, v249, v249 quad_perm:[1,0,3,2] row_mask:0xf bank_mask:0xf
  s_nop 1
  v_add_f32_dpp v249, v249, v249 quad_perm:[2,3,0,1] row_mask:0xf bank_mask:0xf
  v_mfma_f32_16x16x32_bf16 v[200:203], v[24:27], v[40:43], 0
  s_nop 1
  v_add_f32_dpp v249, v249, v249 row_half_mirror row_mask:0xf bank_mask:0xf
  s_nop 1
  v_add_f32_dpp v249, v249, v249 row_mirror row_mask:0xf bank_mask:0xf
  v_mov_b32 v250, v249
  v_mfma_f32_16x16x32_bf16 v[204:207], v[24:27], v[44:47], 0
  s_nop 1
  v_permlane16_swap_b32 v250, v249
  s_nop 0
  v_add_f32 v249, v249, v250
  v_mov_b32 v250, v249
  s_waitcnt vmcnt(7) lgkmcnt(4)
  s_barrier
  v_mfma_f32_16x16x32_bf16 v[208:211], v[28:31], v[32:35], 0
  ds_read_b64_tr_b16 v[24:25], v13 offset:20480
  ds_read_b64_tr_b16 v[26:27], v13 offset:20736
  s_nop 1
  v_permlane32_swap_b32 v250, v249
  s_nop 0
  v_add_f32 v249, v249, v250
  v_mov_b32 v250, 0x3727c5ac
  v_mfma_f32_16x16x32_bf16 v[212:215], v[28:31], v[36:39], 0
  ds_read_b128 v[48:51], v6 offset:0
  s_add_u32 m0, s36, 61440
  s_nop 0
  buffer_load_dwordx4 v8, s[16:19], s33 offen lds
  s_add_u32 s33, s33, s43
  v_fmac_f32 v250, 0x3a800000, v249
  v_mov_b32 v249, v250
  s_lshl_b32 s47, s55, 3
  s_add_u32 s47, s47, 41943040
  s_lshl_b32 s48, s2, 2
  s_add_u32 s48, s48, 42008576
  s_mov_b64 exec, 1
  buffer_store_dwordx2 v[248:249], v15, s[12:15], s47 offen sc1
  buffer_store_dword v15, v15, s[12:15], s48 offen
  s_mov_b64 exec, -1
  s_nop 3
  v_mfma_f32_16x16x32_bf16 v[216:219], v[28:31], v[40:43], 0
  ds_read_b128 v[52:55], v6 offset:2048
  v_mfma_f32_16x16x32_bf16 v[220:223], v[28:31], v[44:47], 0
  s_waitcnt lgkmcnt(6)
  v_mfma_f32_16x16x32_bf16 v[224:227], v[16:19], v[32:35], 0
  ds_read_b64_tr_b16 v[28:29], v13 offset:25600
  ds_read_b64_tr_b16 v[30:31], v13 offset:25856
  v_mfma_f32_16x16x32_bf16 v[228:231], v[16:19], v[36:39], 0
  ds_read_b128 v[56:59], v7 offset:0
  v_mfma_f32_16x16x32_bf16 v[232:235], v[16:19], v[40:43], 0
  ds_read_b128 v[60:63], v7 offset:2048
  s_add_u32 m0, s37, 61440
  s_nop 0
  buffer_load_dwordx4 v9, s[20:23], s34 offen lds
  s_add_u32 s34, s34, s44
  v_mfma_f32_16x16x32_bf16 v[236:239], v[16:19], v[44:47], 0
  v_mfma_f32_16x16x32_bf16 v[76:79], v[16:19], v[64:67], 0
  s_waitcnt lgkmcnt(8)
  v_mfma_f32_16x16x32_bf16 v[240:243], v[20:23], v[32:35], 0
  ds_read_b64_tr_b16 v[16:17], v13 offset:21504
  ds_read_b64_tr_b16 v[18:19], v13 offset:21760
  v_mfma_f32_16x16x32_bf16 v[244:247], v[20:23], v[36:39], 0
  v_mfma_f32_16x16x32_bf16 v[248:251], v[20:23], v[40:43], 0
  v_mfma_f32_16x16x32_bf16 v[252:255], v[20:23], v[44:47], 0
  s_cmp_ge_u32 s28, 4
  s_cbranch_scc1 gemm1_kernel_sk4
  s_add_u32 m0, s38, 61440
  s_nop 0
  buffer_load_dwordx4 v10, s[24:27], s35 offen lds
  s_add_u32 s35, s35, s45
  gemm1_kernel_sk4:
  s_waitcnt lgkmcnt(2)
  v_mfma_f32_16x16x32_bf16 v[96:99], v[24:27], v[48:51], v[96:99]
  ds_read_b64_tr_b16 v[20:21], v13 offset:26624
  ds_read_b64_tr_b16 v[22:23], v13 offset:26880
  v_mfma_f32_16x16x32_bf16 v[100:103], v[24:27], v[52:55], v[100:103]
  v_mfma_f32_16x16x32_bf16 v[104:107], v[24:27], v[56:59], v[104:107]
  v_mfma_f32_16x16x32_bf16 v[108:111], v[24:27], v[60:63], v[108:111]
  v_mfma_f32_16x16x32_bf16 v[68:71], v[24:27], v[64:67], v[68:71]
  s_waitcnt lgkmcnt(4)
  v_mfma_f32_16x16x32_bf16 v[112:115], v[28:31], v[48:51], v[112:115]
  ds_read_b64_tr_b16 v[24:25], v13 offset:22528
  ds_read_b64_tr_b16 v[26:27], v13 offset:22784
  buffer_load_dword v88, v89, s[64:67], s97 offen
  s_add_u32 s97, s97, s98
  v_mfma_f32_16x16x32_bf16 v[116:119], v[28:31], v[52:55], v[116:119]
  v_mfma_f32_16x16x32_bf16 v[120:123], v[28:31], v[56:59], v[120:123]
  v_mfma_f32_16x16x32_bf16 v[124:127], v[28:31], v[60:63], v[124:127]
  s_waitcnt lgkmcnt(4)
  v_mfma_f32_16x16x32_bf16 v[128:131], v[16:19], v[48:51], v[128:131]
  ds_read_b64_tr_b16 v[28:29], v13 offset:27648
  ds_read_b64_tr_b16 v[30:31], v13 offset:27904
  v_mfma_f32_16x16x32_bf16 v[132:135], v[16:19], v[52:55], v[132:135]
  v_mfma_f32_16x16x32_bf16 v[136:139], v[16:19], v[56:59], v[136:139]
  v_mfma_f32_16x16x32_bf16 v[140:143], v[16:19], v[60:63], v[140:143]
  s_waitcnt lgkmcnt(4)
  v_mfma_f32_16x16x32_bf16 v[144:147], v[20:23], v[48:51], v[144:147]
  ds_read_b64_tr_b16 v[16:17], v13 offset:23552
  ds_read_b64_tr_b16 v[18:19], v13 offset:23808
  v_mfma_f32_16x16x32_bf16 v[148:151], v[20:23], v[52:55], v[148:151]
  v_mfma_f32_16x16x32_bf16 v[152:155], v[20:23], v[56:59], v[152:155]
  v_mfma_f32_16x16x32_bf16 v[156:159], v[20:23], v[60:63], v[156:159]
  s_waitcnt lgkmcnt(4)
  v_mfma_f32_16x16x32_bf16 v[160:163], v[24:27], v[48:51], v[160:163]
  ds_read_b64_tr_b16 v[20:21], v13 offset:28672
  ds_read_b64_tr_b16 v[22:23], v13 offset:28928
  v_mfma_f32_16x16x32_bf16 v[164:167], v[24:27], v[52:55], v[164:167]
  v_mfma_f32_16x16x32_bf16 v[168:171], v[24:27], v[56:59], v[168:171]
  v_mfma_f32_16x16x32_bf16 v[172:175], v[24:27], v[60:63], v[172:175]
  v_mfma_f32_16x16x32_bf16 v[72:75], v[24:27], v[64:67], v[72:75]
  s_waitcnt lgkmcnt(4)
  v_mfma_f32_16x16x32_bf16 v[176:179], v[28:31], v[48:51], v[176:179]
  ds_read_b64_tr_b16 v[24:25], v13 offset:24576
  ds_read_b64_tr_b16 v[26:27], v13 offset:24832
  v_mfma_f32_16x16x32_bf16 v[180:183], v[28:31], v[52:55], v[180:183]
  v_mfma_f32_16x16x32_bf16 v[184:187], v[28:31], v[56:59], v[184:187]
  v_mfma_f32_16x16x32_bf16 v[188:191], v[28:31], v[60:63], v[188:191]
  s_waitcnt lgkmcnt(4)
  v_mfma_f32_16x16x32_bf16 v[192:195], v[16:19], v[48:51], v[192:195]
  ds_read_b64_tr_b16 v[28:29], v13 offset:29696
  ds_read_b64_tr_b16 v[30:31], v13 offset:29952
  v_mfma_f32_16x16x32_bf16 v[196:199], v[16:19], v[52:55], v[196:199]
  v_mfma_f32_16x16x32_bf16 v[200:203], v[16:19], v[56:59], v[200:203]
  v_mfma_f32_16x16x32_bf16 v[204:207], v[16:19], v[60:63], v[204:207]
  s_waitcnt vmcnt(6) lgkmcnt(4)
  s_barrier
  v_mfma_f32_16x16x32_bf16 v[208:211], v[20:23], v[48:51], v[208:211]
  ds_read_b64_tr_b16 v[16:17], v14 offset:0
  ds_read_b64_tr_b16 v[18:19], v14 offset:256
  v_mfma_f32_16x16x32_bf16 v[212:215], v[20:23], v[52:55], v[212:215]
  ds_read_b128 v[32:35], v4 offset:4096
  s_add_u32 m0, s36, 0
  s_nop 0
  buffer_load_dwordx4 v8, s[16:19], s33 offen lds
  s_add_u32 s33, s33, s43
  v_mfma_f32_16x16x32_bf16 v[216:219], v[20:23], v[56:59], v[216:219]
  ds_read_b128 v[36:39], v4 offset:6144
  v_mfma_f32_16x16x32_bf16 v[220:223], v[20:23], v[60:63], v[220:223]
  s_waitcnt lgkmcnt(6)
  v_mfma_f32_16x16x32_bf16 v[224:227], v[24:27], v[48:51], v[224:227]
  ds_read_b64_tr_b16 v[20:21], v14 offset:5120
  ds_read_b64_tr_b16 v[22:23], v14 offset:5376
  v_mfma_f32_16x16x32_bf16 v[228:231], v[24:27], v[52:55], v[228:231]
  ds_read_b128 v[40:43], v5 offset:4096
  v_mfma_f32_16x16x32_bf16 v[232:235], v[24:27], v[56:59], v[232:235]
  ds_read_b128 v[44:47], v5 offset:6144
  s_add_u32 m0, s37, 0
  s_nop 0
  buffer_load_dwordx4 v9, s[20:23], s34 offen lds
  s_add_u32 s34, s34, s44
  v_mfma_f32_16x16x32_bf16 v[236:239], v[24:27], v[60:63], v[236:239]
  v_mfma_f32_16x16x32_bf16 v[76:79], v[24:27], v[64:67], v[76:79]
  s_waitcnt lgkmcnt(8)
  v_mfma_f32_16x16x32_bf16 v[240:243], v[28:31], v[48:51], v[240:243]
  ds_read_b64_tr_b16 v[24:25], v14 offset:1024
  ds_read_b64_tr_b16 v[26:27], v14 offset:1280
  v_mfma_f32_16x16x32_bf16 v[244:247], v[28:31], v[52:55], v[244:247]
  v_mfma_f32_16x16x32_bf16 v[248:251], v[28:31], v[56:59], v[248:251]
  v_mfma_f32_16x16x32_bf16 v[252:255], v[28:31], v[60:63], v[252:255]
  s_cmp_ge_u32 s28, 4
  s_cbranch_scc1 gemm1_kernel_sk5
  s_add_u32 m0, s38, 0
  s_nop 0
  buffer_load_dwordx4 v10, s[24:27], s35 offen lds
  s_add_u32 s35, s35, s45
  gemm1_kernel_sk5:
  s_waitcnt lgkmcnt(2)
  v_mfma_f32_16x16x32_bf16 v[96:99], v[16:19], v[32:35], v[96:99]
  ds_read_b64_tr_b16 v[28:29], v14 offset:6144
  ds_read_b64_tr_b16 v[30:31], v14 offset:6400
  v_mfma_f32_16x16x32_bf16 v[100:103], v[16:19], v[36:39], v[100:103]
  v_mfma_f32_16x16x32_bf16 v[104:107], v[16:19], v[40:43], v[104:107]
  v_mfma_f32_16x16x32_bf16 v[108:111], v[16:19], v[44:47], v[108:111]
  v_mfma_f32_16x16x32_bf16 v[68:71], v[16:19], v[64:67], v[68:71]
  s_waitcnt lgkmcnt(4)
  v_mfma_f32_16x16x32_bf16 v[112:115], v[20:23], v[32:35], v[112:115]
  ds_read_b64_tr_b16 v[16:17], v14 offset:2048
  ds_read_b64_tr_b16 v[18:19], v14 offset:2304
  s_add_u32 m0, s39, 0
  s_nop 0
  buffer_load_dwordx4 v11, s[60:63], s41 offen lds
  v_mfma_f32_16x16x32_bf16 v[116:119], v[20:23], v[36:39], v[116:119]
  v_mfma_f32_16x16x32_bf16 v[120:123], v[20:23], v[40:43], v[120:123]
  v_mfma_f32_16x16x32_bf16 v[124:127], v[20:23], v[44:47], v[124:127]
  s_waitcnt lgkmcnt(4)
  v_mfma_f32_16x16x32_bf16 v[128:131], v[24:27], v[32:35], v[128:131]
  ds_read_b64_tr_b16 v[20:21], v14 offset:7168
  ds_read_b64_tr_b16 v[22:23], v14 offset:7424
  v_mfma_f32_16x16x32_bf16 v[132:135], v[24:27], v[36:39], v[132:135]
  s_add_u32 m0, s39, 1024
  s_nop 0
  buffer_load_dwordx4 v12, s[60:63], s41 offen lds
  v_mfma_f32_16x16x32_bf16 v[136:139], v[24:27], v[40:43], v[136:139]
  v_mfma_f32_16x16x32_bf16 v[140:143], v[24:27], v[44:47], v[140:143]
  s_waitcnt lgkmcnt(4)
  v_mfma_f32_16x16x32_bf16 v[144:147], v[28:31], v[32:35], v[144:147]
  ds_read_b64_tr_b16 v[24:25], v14 offset:3072
  ds_read_b64_tr_b16 v[26:27], v14 offset:3328
  v_mfma_f32_16x16x32_bf16 v[148:151], v[28:31], v[36:39], v[148:151]
  v_mfma_f32_16x16x32_bf16 v[152:155], v[28:31], v[40:43], v[152:155]
  s_add_u32 m0, s39, 2048
  s_nop 0
  buffer_load_dwordx4 v11, s[60:63], s42 offen lds
  v_mfma_f32_16x16x32_bf16 v[156:159], v[28:31], v[44:47], v[156:159]
  s_waitcnt lgkmcnt(4)
  v_mfma_f32_16x16x32_bf16 v[160:163], v[16:19], v[32:35], v[160:163]
  ds_read_b64_tr_b16 v[28:29], v14 offset:8192
  ds_read_b64_tr_b16 v[30:31], v14 offset:8448
  v_mfma_f32_16x16x32_bf16 v[164:167], v[16:19], v[36:39], v[164:167]
  v_mfma_f32_16x16x32_bf16 v[168:171], v[16:19], v[40:43], v[168:171]
  v_mfma_f32_16x16x32_bf16 v[172:175], v[16:19], v[44:47], v[172:175]
  s_add_u32 m0, s39, 3072
  s_nop 0
  buffer_load_dwordx4 v12, s[60:63], s42 offen lds
  s_add_u32 s41, s41, 128
  s_add_u32 s42, s42, 128
  v_mfma_f32_16x16x32_bf16 v[72:75], v[16:19], v[64:67], v[72:75]
  s_waitcnt lgkmcnt(4)
  v_mfma_f32_16x16x32_bf16 v[176:179], v[20:23], v[32:35], v[176:179]
  ds_read_b64_tr_b16 v[16:17], v14 offset:4096
  ds_read_b64_tr_b16 v[18:19], v14 offset:4352
  v_mfma_f32_16x16x32_bf16 v[180:183], v[20:23], v[36:39], v[180:183]
  v_mfma_f32_16x16x32_bf16 v[184:187], v[20:23], v[40:43], v[184:187]
  v_mfma_f32_16x16x32_bf16 v[188:191], v[20:23], v[44:47], v[188:191]
  s_waitcnt lgkmcnt(4)
  v_mfma_f32_16x16x32_bf16 v[192:195], v[24:27], v[32:35], v[192:195]
  ds_read_b64_tr_b16 v[20:21], v14 offset:9216
  ds_read_b64_tr_b16 v[22:23], v14 offset:9472
  v_mfma_f32_16x16x32_bf16 v[196:199], v[24:27], v[36:39], v[196:199]
  v_mfma_f32_16x16x32_bf16 v[200:203], v[24:27], v[40:43], v[200:203]
  v_mfma_f32_16x16x32_bf16 v[204:207], v[24:27], v[44:47], v[204:207]
  s_waitcnt vmcnt(7) lgkmcnt(4)
  s_barrier
  v_mfma_f32_16x16x32_bf16 v[208:211], v[28:31], v[32:35], v[208:211]
  ds_read_b64_tr_b16 v[24:25], v14 offset:20480
  ds_read_b64_tr_b16 v[26:27], v14 offset:20736
  v_mfma_f32_16x16x32_bf16 v[212:215], v[28:31], v[36:39], v[212:215]
  ds_read_b128 v[48:51], v6 offset:4096
  s_add_u32 m0, s36, 20480
  s_nop 0
  buffer_load_dwordx4 v8, s[16:19], s33 offen lds
  s_add_u32 s33, s33, s43
  v_mfma_f32_16x16x32_bf16 v[216:219], v[28:31], v[40:43], v[216:219]
  ds_read_b128 v[52:55], v6 offset:6144
  v_mfma_f32_16x16x32_bf16 v[220:223], v[28:31], v[44:47], v[220:223]
  s_waitcnt lgkmcnt(6)
  v_mfma_f32_16x16x32_bf16 v[224:227], v[16:19], v[32:35], v[224:227]
  ds_read_b64_tr_b16 v[28:29], v14 offset:25600
  ds_read_b64_tr_b16 v[30:31], v14 offset:25856
  v_mfma_f32_16x16x32_bf16 v[228:231], v[16:19], v[36:39], v[228:231]
  ds_read_b128 v[56:59], v7 offset:4096
  v_mfma_f32_16x16x32_bf16 v[232:235], v[16:19], v[40:43], v[232:235]
  ds_read_b128 v[60:63], v7 offset:6144
  s_add_u32 m0, s37, 20480
  s_nop 0
  buffer_load_dwordx4 v9, s[20:23], s34 offen lds
  s_add_u32 s34, s34, s44
  v_mfma_f32_16x16x32_bf16 v[236:239], v[16:19], v[44:47], v[236:239]
  v_mfma_f32_16x16x32_bf16 v[76:79], v[16:19], v[64:67], v[76:79]
  s_waitcnt lgkmcnt(8)
  v_mfma_f32_16x16x32_bf16 v[240:243], v[20:23], v[32:35], v[240:243]
  ds_read_b64_tr_b16 v[16:17], v14 offset:21504
  ds_read_b64_tr_b16 v[18:19], v14 offset:21760
  v_mfma_f32_16x16x32_bf16 v[244:247], v[20:23], v[36:39], v[244:247]
  v_mfma_f32_16x16x32_bf16 v[248:251], v[20:23], v[40:43], v[248:251]
  v_mfma_f32_16x16x32_bf16 v[252:255], v[20:23], v[44:47], v[252:255]
  s_cmp_ge_u32 s28, 4
  s_cbranch_scc1 gemm1_kernel_sk6
  s_add_u32 m0, s38, 20480
  s_nop 0
  buffer_load_dwordx4 v10, s[24:27], s35 offen lds
  s_add_u32 s35, s35, s45
  gemm1_kernel_sk6:
  s_waitcnt lgkmcnt(2)
  v_mfma_f32_16x16x32_bf16 v[96:99], v[24:27], v[48:51], v[96:99]
  ds_read_b64_tr_b16 v[20:21], v14 offset:26624
  ds_read_b64_tr_b16 v[22:23], v14 offset:26880
  v_mfma_f32_16x16x32_bf16 v[100:103], v[24:27], v[52:55], v[100:103]
  v_mfma_f32_16x16x32_bf16 v[104:107], v[24:27], v[56:59], v[104:107]
  v_mfma_f32_16x16x32_bf16 v[108:111], v[24:27], v[60:63], v[108:111]
  v_mfma_f32_16x16x32_bf16 v[68:71], v[24:27], v[64:67], v[68:71]
  s_waitcnt lgkmcnt(4)
  v_mfma_f32_16x16x32_bf16 v[112:115], v[28:31], v[48:51], v[112:115]
  ds_read_b64_tr_b16 v[24:25], v14 offset:22528
  ds_read_b64_tr_b16 v[26:27], v14 offset:22784
  buffer_load_dword v88, v89, s[64:67], s97 offen
  s_add_u32 s97, s97, s98
  v_mfma_f32_16x16x32_bf16 v[116:119], v[28:31], v[52:55], v[116:119]
  v_mfma_f32_16x16x32_bf16 v[120:123], v[28:31], v[56:59], v[120:123]
  v_mfma_f32_16x16x32_bf16 v[124:127], v[28:31], v[60:63], v[124:127]
  s_waitcnt lgkmcnt(4)
  v_mfma_f32_16x16x32_bf16 v[128:131], v[16:19], v[48:51], v[128:131]
  ds_read_b64_tr_b16 v[28:29], v14 offset:27648
  ds_read_b64_tr_b16 v[30:31], v14 offset:27904
  v_mfma_f32_16x16x32_bf16 v[132:135], v[16:19], v[52:55], v[132:135]
  v_mfma_f32_16x16x32_bf16 v[136:139], v[16:19], v[56:59], v[136:139]
  v_mfma_f32_16x16x32_bf16 v[140:143], v[16:19], v[60:63], v[140:143]
  s_waitcnt lgkmcnt(4)
  v_mfma_f32_16x16x32_bf16 v[144:147], v[20:23], v[48:51], v[144:147]
  ds_read_b64_tr_b16 v[16:17], v14 offset:23552
  ds_read_b64_tr_b16 v[18:19], v14 offset:23808
  v_mfma_f32_16x16x32_bf16 v[148:151], v[20:23], v[52:55], v[148:151]
  v_mfma_f32_16x16x32_bf16 v[152:155], v[20:23], v[56:59], v[152:155]
  v_mfma_f32_16x16x32_bf16 v[156:159], v[20:23], v[60:63], v[156:159]
  s_waitcnt lgkmcnt(4)
  v_mfma_f32_16x16x32_bf16 v[160:163], v[24:27], v[48:51], v[160:163]
  ds_read_b64_tr_b16 v[20:21], v14 offset:28672
  ds_read_b64_tr_b16 v[22:23], v14 offset:28928
  v_mfma_f32_16x16x32_bf16 v[164:167], v[24:27], v[52:55], v[164:167]
  v_mfma_f32_16x16x32_bf16 v[168:171], v[24:27], v[56:59], v[168:171]
  v_mfma_f32_16x16x32_bf16 v[172:175], v[24:27], v[60:63], v[172:175]
  v_mfma_f32_16x16x32_bf16 v[72:75], v[24:27], v[64:67], v[72:75]
  s_waitcnt lgkmcnt(4)
  v_mfma_f32_16x16x32_bf16 v[176:179], v[28:31], v[48:51], v[176:179]
  ds_read_b64_tr_b16 v[24:25], v14 offset:24576
  ds_read_b64_tr_b16 v[26:27], v14 offset:24832
  v_mfma_f32_16x16x32_bf16 v[180:183], v[28:31], v[52:55], v[180:183]
  v_mfma_f32_16x16x32_bf16 v[184:187], v[28:31], v[56:59], v[184:187]
  v_mfma_f32_16x16x32_bf16 v[188:191], v[28:31], v[60:63], v[188:191]
  s_waitcnt lgkmcnt(4)
  v_mfma_f32_16x16x32_bf16 v[192:195], v[16:19], v[48:51], v[192:195]
  ds_read_b64_tr_b16 v[28:29], v14 offset:29696
  ds_read_b64_tr_b16 v[30:31], v14 offset:29952
  v_mfma_f32_16x16x32_bf16 v[196:199], v[16:19], v[52:55], v[196:199]
  v_mfma_f32_16x16x32_bf16 v[200:203], v[16:19], v[56:59], v[200:203]
  v_mfma_f32_16x16x32_bf16 v[204:207], v[16:19], v[60:63], v[204:207]
  s_waitcnt vmcnt(3) lgkmcnt(4)
  s_barrier
  v_mfma_f32_16x16x32_bf16 v[208:211], v[20:23], v[48:51], v[208:211]
  ds_read_b64_tr_b16 v[16:17], v13 offset:0
  ds_read_b64_tr_b16 v[18:19], v13 offset:256
  v_mfma_f32_16x16x32_bf16 v[212:215], v[20:23], v[52:55], v[212:215]
  ds_read_b128 v[32:35], v4 offset:0
  s_add_u32 m0, s36, 40960
  s_nop 0
  buffer_load_dwordx4 v8, s[16:19], s33 offen lds
  s_add_u32 s33, s33, s43
  v_mfma_f32_16x16x32_bf16 v[216:219], v[20:23], v[56:59], v[216:219]
  ds_read_b128 v[36:39], v4 offset:2048
  v_mfma_f32_16x16x32_bf16 v[220:223], v[20:23], v[60:63], v[220:223]
  s_waitcnt lgkmcnt(6)
  v_mfma_f32_16x16x32_bf16 v[224:227], v[24:27], v[48:51], v[224:227]
  ds_read_b64_tr_b16 v[20:21], v13 offset:5120
  ds_read_b64_tr_b16 v[22:23], v13 offset:5376
  v_mfma_f32_16x16x32_bf16 v[228:231], v[24:27], v[52:55], v[228:231]
  ds_read_b128 v[40:43], v5 offset:0
  v_mfma_f32_16x16x32_bf16 v[232:235], v[24:27], v[56:59], v[232:235]
  ds_read_b128 v[44:47], v5 offset:2048
  s_add_u32 m0, s37, 40960
  s_nop 0
  buffer_load_dwordx4 v9, s[20:23], s34 offen lds
  s_add_u32 s34, s34, s44
  v_mfma_f32_16x16x32_bf16 v[236:239], v[24:27], v[60:63], v[236:239]
  v_mfma_f32_16x16x32_bf16 v[76:79], v[24:27], v[64:67], v[76:79]
  s_waitcnt lgkmcnt(8)
  v_mfma_f32_16x16x32_bf16 v[240:243], v[28:31], v[48:51], v[240:243]
  ds_read_b64_tr_b16 v[24:25], v13 offset:1024
  ds_read_b64_tr_b16 v[26:27], v13 offset:1280
  v_mfma_f32_16x16x32_bf16 v[244:247], v[28:31], v[52:55], v[244:247]
  v_mfma_f32_16x16x32_bf16 v[248:251], v[28:31], v[56:59], v[248:251]
  v_mfma_f32_16x16x32_bf16 v[252:255], v[28:31], v[60:63], v[252:255]
  s_cmp_ge_u32 s28, 4
  s_cbranch_scc1 gemm1_kernel_sk7
  s_add_u32 m0, s38, 40960
  s_nop 0
  buffer_load_dwordx4 v10, s[24:27], s35 offen lds
  s_add_u32 s35, s35, s45
  gemm1_kernel_sk7:
gemm1_kernel_loop0:
  s_waitcnt lgkmcnt(2)
  v_mfma_f32_16x16x32_bf16 v[96:99], v[16:19], v[32:35], v[96:99]
  ds_read_b64_tr_b16 v[28:29], v13 offset:6144
  ds_read_b64_tr_b16 v[30:31], v13 offset:6400
  v_mfma_f32_16x16x32_bf16 v[100:103], v[16:19], v[36:39], v[100:103]
  v_mfma_f32_16x16x32_bf16 v[104:107], v[16:19], v[40:43], v[104:107]
  v_mfma_f32_16x16x32_bf16 v[108:111], v[16:19], v[44:47], v[108:111]
  v_mfma_f32_16x16x32_bf16 v[68:71], v[16:19], v[64:67], v[68:71]
  s_waitcnt lgkmcnt(4)
  v_mfma_f32_16x16x32_bf16 v[112:115], v[20:23], v[32:35], v[112:115]
  ds_read_b64_tr_b16 v[16:17], v13 offset:2048
  ds_read_b64_tr_b16 v[18:19], v13 offset:2304
  s_add_u32 m0, s39, 4096
  s_nop 0
  buffer_load_dwordx4 v11, s[60:63], s41 offen lds
  v_mfma_f32_16x16x32_bf16 v[116:119], v[20:23], v[36:39], v[116:119]
  v_mfma_f32_16x16x32_bf16 v[120:123], v[20:23], v[40:43], v[120:123]
  v_mfma_f32_16x16x32_bf16 v[124:127], v[20:23], v[44:47], v[124:127]
  s_waitcnt lgkmcnt(4)
  v_mfma_f32_16x16x32_bf16 v[128:131], v[24:27], v[32:35], v[128:131]
  ds_read_b64_tr_b16 v[20:21], v13 offset:7168
  ds_read_b64_tr_b16 v[22:23], v13 offset:7424
  v_mfma_f32_16x16x32_bf16 v[132:135], v[24:27], v[36:39], v[132:135]
  s_add_u32 m0, s39, 5120
  s_nop 0
  buffer_load_dwordx4 v12, s[60:63], s41 offen lds
  v_mfma_f32_16x16x32_bf16 v[136:139], v[24:27], v[40:43], v[136:139]
  v_mfma_f32_16x16x32_bf16 v[140:143], v[24:27], v[44:47], v[140:143]
  s_waitcnt lgkmcnt(4)
  v_mfma_f32_16x16x32_bf16 v[144:147], v[28:31], v[32:35], v[144:147]
  ds_read_b64_tr_b16 v[24:25], v13 offset:3072
  ds_read_b64_tr_b16 v[26:27], v13 offset:3328
  v_mfma_f32_16x16x32_bf16 v[148:151], v[28:31], v[36:39], v[148:151]
  v_mfma_f32_16x16x32_bf16 v[152:155], v[28:31], v[40:43], v[152:155]
  s_add_u32 m0, s39, 6144
  s_nop 0
  buffer_load_dwordx4 v11, s[60:63], s42 offen lds
  v_mfma_f32_16x16x32_bf16 v[156:159], v[28:31], v[44:47], v[156:159]
  s_waitcnt lgkmcnt(4)
  v_mfma_f32_16x16x32_bf16 v[160:163], v[16:19], v[32:35], v[160:163]
  ds_read_b64_tr_b16 v[28:29], v13 offset:8192
  ds_read_b64_tr_b16 v[30:31], v13 offset:8448
  v_mfma_f32_16x16x32_bf16 v[164:167], v[16:19], v[36:39], v[164:167]
  v_mfma_f32_16x16x32_bf16 v[168:171], v[16:19], v[40:43], v[168:171]
  v_mfma_f32_16x16x32_bf16 v[172:175], v[16:19], v[44:47], v[172:175]
  s_add_u32 m0, s39, 7168
  s_nop 0
  buffer_load_dwordx4 v12, s[60:63], s42 offen lds
  s_add_u32 s41, s41, 128
  s_add_u32 s42, s42, 128
  v_mfma_f32_16x16x32_bf16 v[72:75], v[16:19], v[64:67], v[72:75]
  s_waitcnt lgkmcnt(4)
  v_mfma_f32_16x16x32_bf16 v[176:179], v[20:23], v[32:35], v[176:179]
  ds_read_b64_tr_b16 v[16:17], v13 offset:4096
  ds_read_b64_tr_b16 v[18:19], v13 offset:4352
  v_mfma_f32_16x16x32_bf16 v[180:183], v[20:23], v[36:39], v[180:183]
  v_mfma_f32_16x16x32_bf16 v[184:187], v[20:23], v[40:43], v[184:187]
  v_mfma_f32_16x16x32_bf16 v[188:191], v[20:23], v[44:47], v[188:191]
  s_waitcnt lgkmcnt(4)
  v_mfma_f32_16x16x32_bf16 v[192:195], v[24:27], v[32:35], v[192:195]
  ds_read_b64_tr_b16 v[20:21], v13 offset:9216
  ds_read_b64_tr_b16 v[22:23], v13 offset:9472
  v_mfma_f32_16x16x32_bf16 v[196:199], v[24:27], v[36:39], v[196:199]
  v_mfma_f32_16x16x32_bf16 v[200:203], v[24:27], v[40:43], v[200:203]
  v_mfma_f32_16x16x32_bf16 v[204:207], v[24:27], v[44:47], v[204:207]
  s_waitcnt vmcnt(7) lgkmcnt(4)
  s_barrier
  v_mfma_f32_16x16x32_bf16 v[208:211], v[28:31], v[32:35], v[208:211]
  ds_read_b64_tr_b16 v[24:25], v13 offset:20480
  ds_read_b64_tr_b16 v[26:27], v13 offset:20736
  v_mfma_f32_16x16x32_bf16 v[212:215], v[28:31], v[36:39], v[212:215]
  ds_read_b128 v[48:51], v6 offset:0
  s_add_u32 m0, s36, 61440
  s_nop 0
  buffer_load_dwordx4 v8, s[16:19], s33 offen lds
  s_add_u32 s33, s33, s43
  v_mfma_f32_16x16x32_bf16 v[216:219], v[28:31], v[40:43], v[216:219]
  ds_read_b128 v[52:55], v6 offset:2048
  v_mfma_f32_16x16x32_bf16 v[220:223], v[28:31], v[44:47], v[220:223]
  s_waitcnt lgkmcnt(6)
  v_mfma_f32_16x16x32_bf16 v[224:227], v[16:19], v[32:35], v[224:227]
  ds_read_b64_tr_b16 v[28:29], v13 offset:25600
  ds_read_b64_tr_b16 v[30:31], v13 offset:25856
  v_mfma_f32_16x16x32_bf16 v[228:231], v[16:19], v[36:39], v[228:231]
  ds_read_b128 v[56:59], v7 offset:0
  v_mfma_f32_16x16x32_bf16 v[232:235], v[16:19], v[40:43], v[232:235]
  ds_read_b128 v[60:63], v7 offset:2048
  s_add_u32 m0, s37, 61440
  s_nop 0
  buffer_load_dwordx4 v9, s[20:23], s34 offen lds
  s_add_u32 s34, s34, s44
  v_mfma_f32_16x16x32_bf16 v[236:239], v[16:19], v[44:47], v[236:239]
  v_mfma_f32_16x16x32_bf16 v[76:79], v[16:19], v[64:67], v[76:79]
  s_waitcnt lgkmcnt(8)
  v_mfma_f32_16x16x32_bf16 v[240:243], v[20:23], v[32:35], v[240:243]
  ds_read_b64_tr_b16 v[16:17], v13 offset:21504
  ds_read_b64_tr_b16 v[18:19], v13 offset:21760
  v_mfma_f32_16x16x32_bf16 v[244:247], v[20:23], v[36:39], v[244:247]
  v_mfma_f32_16x16x32_bf16 v[248:251], v[20:23], v[40:43], v[248:251]
  v_mfma_f32_16x16x32_bf16 v[252:255], v[20:23], v[44:47], v[252:255]
  s_cmp_ge_u32 s28, 4
  s_cbranch_scc1 gemm1_kernel_sk8
  s_add_u32 m0, s38, 61440
  s_nop 0
  buffer_load_dwordx4 v10, s[24:27], s35 offen lds
  s_add_u32 s35, s35, s45
  gemm1_kernel_sk8:
  s_waitcnt lgkmcnt(2)
  v_mfma_f32_16x16x32_bf16 v[96:99], v[24:27], v[48:51], v[96:99]
  ds_read_b64_tr_b16 v[20:21], v13 offset:26624
  ds_read_b64_tr_b16 v[22:23], v13 offset:26880
  v_mfma_f32_16x16x32_bf16 v[100:103], v[24:27], v[52:55], v[100:103]
  v_mfma_f32_16x16x32_bf16 v[104:107], v[24:27], v[56:59], v[104:107]
  v_mfma_f32_16x16x32_bf16 v[108:111], v[24:27], v[60:63], v[108:111]
  v_mfma_f32_16x16x32_bf16 v[68:71], v[24:27], v[64:67], v[68:71]
  s_waitcnt lgkmcnt(4)
  v_mfma_f32_16x16x32_bf16 v[112:115], v[28:31], v[48:51], v[112:115]
  ds_read_b64_tr_b16 v[24:25], v13 offset:22528
  ds_read_b64_tr_b16 v[26:27], v13 offset:22784
  buffer_load_dword v88, v89, s[64:67], s97 offen
  s_add_u32 s97, s97, s98
  v_mfma_f32_16x16x32_bf16 v[116:119], v[28:31], v[52:55], v[116:119]
  v_mfma_f32_16x16x32_bf16 v[120:123], v[28:31], v[56:59], v[120:123]
  v_mfma_f32_16x16x32_bf16 v[124:127], v[28:31], v[60:63], v[124:127]
  s_waitcnt lgkmcnt(4)
  v_mfma_f32_16x16x32_bf16 v[128:131], v[16:19], v[48:51], v[128:131]
  ds_read_b64_tr_b16 v[28:29], v13 offset:27648
  ds_read_b64_tr_b16 v[30:31], v13 offset:27904
  v_mfma_f32_16x16x32_bf16 v[132:135], v[16:19], v[52:55], v[132:135]
  v_mfma_f32_16x16x32_bf16 v[136:139], v[16:19], v[56:59], v[136:139]
  v_mfma_f32_16x16x32_bf16 v[140:143], v[16:19], v[60:63], v[140:143]
  s_waitcnt lgkmcnt(4)
  v_mfma_f32_16x16x32_bf16 v[144:147], v[20:23], v[48:51], v[144:147]
  ds_read_b64_tr_b16 v[16:17], v13 offset:23552
  ds_read_b64_tr_b16 v[18:19], v13 offset:23808
  v_mfma_f32_16x16x32_bf16 v[148:151], v[20:23], v[52:55], v[148:151]
  v_mfma_f32_16x16x32_bf16 v[152:155], v[20:23], v[56:59], v[152:155]
  v_mfma_f32_16x16x32_bf16 v[156:159], v[20:23], v[60:63], v[156:159]
  s_waitcnt lgkmcnt(4)
  v_mfma_f32_16x16x32_bf16 v[160:163], v[24:27], v[48:51], v[160:163]
  ds_read_b64_tr_b16 v[20:21], v13 offset:28672
  ds_read_b64_tr_b16 v[22:23], v13 offset:28928
  v_mfma_f32_16x16x32_bf16 v[164:167], v[24:27], v[52:55], v[164:167]
  v_mfma_f32_16x16x32_bf16 v[168:171], v[24:27], v[56:59], v[168:171]
  v_mfma_f32_16x16x32_bf16 v[172:175], v[24:27], v[60:63], v[172:175]
  v_mfma_f32_16x16x32_bf16 v[72:75], v[24:27], v[64:67], v[72:75]
  s_waitcnt lgkmcnt(4)
  v_mfma_f32_16x16x32_bf16 v[176:179], v[28:31], v[48:51], v[176:179]
  ds_read_b64_tr_b16 v[24:25], v13 offset:24576
  ds_read_b64_tr_b16 v[26:27], v13 offset:24832
  v_mfma_f32_16x16x32_bf16 v[180:183], v[28:31], v[52:55], v[180:183]
  v_mfma_f32_16x16x32_bf16 v[184:187], v[28:31], v[56:59], v[184:187]
  v_mfma_f32_16x16x32_bf16 v[188:191], v[28:31], v[60:63], v[188:191]
  s_waitcnt lgkmcnt(4)
  v_mfma_f32_16x16x32_bf16 v[192:195], v[16:19], v[48:51], v[192:195]
  ds_read_b64_tr_b16 v[28:29], v13 offset:29696
  ds_read_b64_tr_b16 v[30:31], v13 offset:29952
  v_mfma_f32_16x16x32_bf16 v[196:199], v[16:19], v[52:55], v[196:199]
  v_mfma_f32_16x16x32_bf16 v[200:203], v[16:19], v[56:59], v[200:203]
  v_mfma_f32_16x16x32_bf16 v[204:207], v[16:19], v[60:63], v[204:207]
  s_waitcnt vmcnt(3) lgkmcnt(4)
  s_barrier
  v_mfma_f32_16x16x32_bf16 v[208:211], v[20:23], v[48:51], v[208:211]
  ds_read_b64_tr_b16 v[16:17], v14 offset:0
  ds_read_b64_tr_b16 v[18:19], v14 offset:256
  v_mfma_f32_16x16x32_bf16 v[212:215], v[20:23], v[52:55], v[212:215]
  ds_read_b128 v[32:35], v4 offset:4096
  s_add_u32 m0, s36, 0
  s_nop 0
  buffer_load_dwordx4 v8, s[16:19], s33 offen lds
  s_add_u32 s33, s33, s43
  v_mfma_f32_16x16x32_bf16 v[216:219], v[20:23], v[56:59], v[216:219]
  ds_read_b128 v[36:39], v4 offset:6144
  v_mfma_f32_16x16x32_bf16 v[220:223], v[20:23], v[60:63], v[220:223]
  s_waitcnt lgkmcnt(6)
  v_mfma_f32_16x16x32_bf16 v[224:227], v[24:27], v[48:51], v[224:227]
  ds_read_b64_tr_b16 v[20:21], v14 offset:5120
  ds_read_b64_tr_b16 v[22:23], v14 offset:5376
  v_mfma_f32_16x16x32_bf16 v[228:231], v[24:27], v[52:55], v[228:231]
  ds_read_b128 v[40:43], v5 offset:4096
  v_mfma_f32_16x16x32_bf16 v[232:235], v[24:27], v[56:59], v[232:235]
  ds_read_b128 v[44:47], v5 offset:6144
  s_add_u32 m0, s37, 0
  s_nop 0
  buffer_load_dwordx4 v9, s[20:23], s34 offen lds
  s_add_u32 s34, s34, s44
  v_mfma_f32_16x16x32_bf16 v[236:239], v[24:27], v[60:63], v[236:239]
  v_mfma_f32_16x16x32_bf16 v[76:79], v[24:27], v[64:67], v[76:79]
  s_waitcnt lgkmcnt(8)
  v_mfma_f32_16x16x32_bf16 v[240:243], v[28:31], v[48:51], v[240:243]
  ds_read_b64_tr_b16 v[24:25], v14 offset:1024
  ds_read_b64_tr_b16 v[26:27], v14 offset:1280
  v_mfma_f32_16x16x32_bf16 v[244:247], v[28:31], v[52:55], v[244:247]
  v_mfma_f32_16x16x32_bf16 v[248:251], v[28:31], v[56:59], v[248:251]
  s_cmp_lg_u32 s40, 6
  s_cbranch_scc1 gemm1_kernel_sk9
  s_cmp_lg_u32 s28, 0
  s_cbranch_scc1 gemm1_kernel_sk9
  s_lshr_b32 s47, s2, 5
  s_lshl_b32 s47, s47, 2
  v_mov_b32 v1, 1
  s_mov_b64 exec, 1
  buffer_atomic_add v1, v15, s[68:71], s47 offen sc1
  s_mov_b64 exec, -1
  s_nop 3
  gemm1_kernel_sk9:
  v_mfma_f32_16x16x32_bf16 v[252:255], v[28:31], v[60:63], v[252:255]
  s_cmp_ge_u32 s28, 4
  s_cbranch_scc1 gemm1_kernel_sk10
  s_add_u32 m0, s38, 0
  s_nop 0
  buffer_load_dwordx4 v10, s[24:27], s35 offen lds
  s_add_u32 s35, s35, s45
  gemm1_kernel_sk10:
  s_waitcnt lgkmcnt(2)
  v_mfma_f32_16x16x32_bf16 v[96:99], v[16:19], v[32:35], v[96:99]
  ds_read_b64_tr_b16 v[28:29], v14 offset:6144
  ds_read_b64_tr_b16 v[30:31], v14 offset:6400
  v_mfma_f32_16x16x32_bf16 v[100:103], v[16:19], v[36:39], v[100:103]
  v_mfma_f32_16x16x32_bf16 v[104:107], v[16:19], v[40:43], v[104:107]
  v_mfma_f32_16x16x32_bf16 v[108:111], v[16:19], v[44:47], v[108:111]
  v_mfma_f32_16x16x32_bf16 v[68:71], v[16:19], v[64:67], v[68:71]
  s_waitcnt lgkmcnt(4)
  v_mfma_f32_16x16x32_bf16 v[112:115], v[20:23], v[32:35], v[112:115]
  ds_read_b64_tr_b16 v[16:17], v14 offset:2048
  ds_read_b64_tr_b16 v[18:19], v14 offset:2304
  s_add_u32 m0, s39, 0
  s_nop 0
  buffer_load_dwordx4 v11, s[60:63], s41 offen lds
  v_mfma_f32_16x16x32_bf16 v[116:119], v[20:23], v[36:39], v[116:119]
  v_mfma_f32_16x16x32_bf16 v[120:123], v[20:23], v[40:43], v[120:123]
  v_mfma_f32_16x16x32_bf16 v[124:127], v[20:23], v[44:47], v[124:127]
  s_waitcnt lgkmcnt(4)
  v_mfma_f32_16x16x32_bf16 v[128:131], v[24:27], v[32:35], v[128:131]
  ds_read_b64_tr_b16 v[20:21], v14 offset:7168
  ds_read_b64_tr_b16 v[22:23], v14 offset:7424
  v_mfma_f32_16x16x32_bf16 v[132:135], v[24:27], v[36:39], v[132:135]
  s_add_u32 m0, s39, 1024
  s_nop 0
  buffer_load_dwordx4 v12, s[60:63], s41 offen lds
  v_mfma_f32_16x16x32_bf16 v[136:139], v[24:27], v[40:43], v[136:139]
  v_mfma_f32_16x16x32_bf16 v[140:143], v[24:27], v[44:47], v[140:143]
  s_waitcnt lgkmcnt(4)
  v_mfma_f32_16x16x32_bf16 v[144:147], v[28:31], v[32:35], v[144:147]
  ds_read_b64_tr_b16 v[24:25], v14 offset:3072
  ds_read_b64_tr_b16 v[26:27], v14 offset:3328
  v_mfma_f32_16x16x32_bf16 v[148:151], v[28:31], v[36:39], v[148:151]
  v_mfma_f32_16x16x32_bf16 v[152:155], v[28:31], v[40:43], v[152:155]
  s_add_u32 m0, s39, 2048
  s_nop 0
  buffer_load_dwordx4 v11, s[60:63], s42 offen lds
  v_mfma_f32_16x16x32_bf16 v[156:159], v[28:31], v[44:47], v[156:159]
  s_waitcnt lgkmcnt(4)
  v_mfma_f32_16x16x32_bf16 v[160:163], v[16:19], v[32:35], v[160:163]
  ds_read_b64_tr_b16 v[28:29], v14 offset:8192
  ds_read_b64_tr_b16 v[30:31], v14 offset:8448
  v_mfma_f32_16x16x32_bf16 v[164:167], v[16:19], v[36:39], v[164:167]
  v_mfma_f32_16x16x32_bf16 v[168:171], v[16:19], v[40:43], v[168:171]
  v_mfma_f32_16x16x32_bf16 v[172:175], v[16:19], v[44:47], v[172:175]
  s_add_u32 m0, s39, 3072
  s_nop 0
  buffer_load_dwordx4 v12, s[60:63], s42 offen lds
  s_add_u32 s41, s41, 128
  s_add_u32 s42, s42, 128
  v_mfma_f32_16x16x32_bf16 v[72:75], v[16:19], v[64:67], v[72:75]
  s_waitcnt lgkmcnt(4)
  v_mfma_f32_16x16x32_bf16 v[176:179], v[20:23], v[32:35], v[176:179]
  ds_read_b64_tr_b16 v[16:17], v14 offset:4096
  ds_read_b64_tr_b16 v[18:19], v14 offset:4352
  v_mfma_f32_16x16x32_bf16 v[180:183], v[20:23], v[36:39], v[180:183]
  v_mfma_f32_16x16x32_bf16 v[184:187], v[20:23], v[40:43], v[184:187]
  v_mfma_f32_16x16x32_bf16 v[188:191], v[20:23], v[44:47], v[188:191]
  s_waitcnt lgkmcnt(4)
  v_mfma_f32_16x16x32_bf16 v[192:195], v[24:27], v[32:35], v[192:195]
  ds_read_b64_tr_b16 v[20:21], v14 offset:9216
  ds_read_b64_tr_b16 v[22:23], v14 offset:9472
  v_mfma_f32_16x16x32_bf16 v[196:199], v[24:27], v[36:39], v[196:199]
  v_mfma_f32_16x16x32_bf16 v[200:203], v[24:27], v[40:43], v[200:203]
  v_mfma_f32_16x16x32_bf16 v[204:207], v[24:27], v[44:47], v[204:207]
  s_waitcnt vmcnt(7) lgkmcnt(4)
  s_barrier
  v_mfma_f32_16x16x32_bf16 v[208:211], v[28:31], v[32:35], v[208:211]
  ds_read_b64_tr_b16 v[24:25], v14 offset:20480
  ds_read_b64_tr_b16 v[26:27], v14 offset:20736
  v_mfma_f32_16x16x32_bf16 v[212:215], v[28:31], v[36:39], v[212:215]
  ds_read_b128 v[48:51], v6 offset:4096
  s_add_u32 m0, s36, 20480
  s_nop 0
  buffer_load_dwordx4 v8, s[16:19], s33 offen lds
  s_add_u32 s33, s33, s43
  v_mfma_f32_16x16x32_bf16 v[216:219], v[28:31], v[40:43], v[216:219]
  ds_read_b128 v[52:55], v6 offset:6144
  v_mfma_f32_16x16x32_bf16 v[220:223], v[28:31], v[44:47], v[220:223]
  s_waitcnt lgkmcnt(6)
  v_mfma_f32_16x16x32_bf16 v[224:227], v[16:19], v[32:35], v[224:227]
  ds_read_b64_tr_b16 v[28:29], v14 offset:25600
  ds_read_b64_tr_b16 v[30:31], v14 offset:25856
  v_mfma_f32_16x16x32_bf16 v[228:231], v[16:19], v[36:39], v[228:231]
  ds_read_b128 v[56:59], v7 offset:4096
  v_mfma_f32_16x16x32_bf16 v[232:235], v[16:19], v[40:43], v[232:235]
  ds_read_b128 v[60:63], v7 offset:6144
  s_add_u32 m0, s37, 20480
  s_nop 0
  buffer_load_dwordx4 v9, s[20:23], s34 offen lds
  s_add_u32 s34, s34, s44
  v_mfma_f32_16x16x32_bf16 v[236:239], v[16:19], v[44:47], v[236:239]
  v_mfma_f32_16x16x32_bf16 v[76:79], v[16:19], v[64:67], v[76:79]
  s_waitcnt lgkmcnt(8)
  v_mfma_f32_16x16x32_bf16 v[240:243], v[20:23], v[32:35], v[240:243]
  ds_read_b64_tr_b16 v[16:17], v14 offset:21504
  ds_read_b64_tr_b16 v[18:19], v14 offset:21760
  v_mfma_f32_16x16x32_bf16 v[244:247], v[20:23], v[36:39], v[244:247]
  v_mfma_f32_16x16x32_bf16 v[248:251], v[20:23], v[40:43], v[248:251]
  v_mfma_f32_16x16x32_bf16 v[252:255], v[20:23], v[44:47], v[252:255]
  s_cmp_ge_u32 s28, 4
  s_cbranch_scc1 gemm1_kernel_sk11
  s_add_u32 m0, s38, 20480
  s_nop 0
  buffer_load_dwordx4 v10, s[24:27], s35 offen lds
  s_add_u32 s35, s35, s45
  gemm1_kernel_sk11:
  s_waitcnt lgkmcnt(2)
  v_mfma_f32_16x16x32_bf16 v[96:99], v[24:27], v[48:51], v[96:99]
  ds_read_b64_tr_b16 v[20:21], v14 offset:26624
  ds_read_b64_tr_b16 v[22:23], v14 offset:26880
  v_mfma_f32_16x16x32_bf16 v[100:103], v[24:27], v[52:55], v[100:103]
  v_mfma_f32_16x16x32_bf16 v[104:107], v[24:27], v[56:59], v[104:107]
  v_mfma_f32_16x16x32_bf16 v[108:111], v[24:27], v[60:63], v[108:111]
  v_mfma_f32_16x16x32_bf16 v[68:71], v[24:27], v[64:67], v[68:71]
  s_waitcnt lgkmcnt(4)
  v_mfma_f32_16x16x32_bf16 v[112:115], v[28:31], v[48:51], v[112:115]
  ds_read_b64_tr_b16 v[24:25], v14 offset:22528
  ds_read_b64_tr_b16 v[26:27], v14 offset:22784
  buffer_load_dword v88, v89, s[64:67], s97 offen
  s_add_u32 s97, s97, s98
  v_mfma_f32_16x16x32_bf16 v[116:119], v[28:31], v[52:55], v[116:119]
  v_mfma_f32_16x16x32_bf16 v[120:123], v[28:31], v[56:59], v[120:123]
  v_mfma_f32_16x16x32_bf16 v[124:127], v[28:31], v[60:63], v[124:127]
  s_waitcnt lgkmcnt(4)
  v_mfma_f32_16x16x32_bf16 v[128:131], v[16:19], v[48:51], v[128:131]
  ds_read_b64_tr_b16 v[28:29], v14 offset:27648
  ds_read_b64_tr_b16 v[30:31], v14 offset:27904
  v_mfma_f32_16x16x32_bf16 v[132:135], v[16:19], v[52:55], v[132:135]
  v_mfma_f32_16x16x32_bf16 v[136:139], v[16:19], v[56:59], v[136:139]
  v_mfma_f32_16x16x32_bf16 v[140:143], v[16:19], v[60:63], v[140:143]
  s_waitcnt lgkmcnt(4)
  v_mfma_f32_16x16x32_bf16 v[144:147], v[20:23], v[48:51], v[144:147]
  ds_read_b64_tr_b16 v[16:17], v14 offset:23552
  ds_read_b64_tr_b16 v[18:19], v14 offset:23808
  v_mfma_f32_16x16x32_bf16 v[148:151], v[20:23], v[52:55], v[148:151]
  v_mfma_f32_16x16x32_bf16 v[152:155], v[20:23], v[56:59], v[152:155]
  v_mfma_f32_16x16x32_bf16 v[156:159], v[20:23], v[60:63], v[156:159]
  s_waitcnt lgkmcnt(4)
  v_mfma_f32_16x16x32_bf16 v[160:163], v[24:27], v[48:51], v[160:163]
  ds_read_b64_tr_b16 v[20:21], v14 offset:28672
  ds_read_b64_tr_b16 v[22:23], v14 offset:28928
  v_mfma_f32_16x16x32_bf16 v[164:167], v[24:27], v[52:55], v[164:167]
  v_mfma_f32_16x16x32_bf16 v[168:171], v[24:27], v[56:59], v[168:171]
  v_mfma_f32_16x16x32_bf16 v[172:175], v[24:27], v[60:63], v[172:175]
  v_mfma_f32_16x16x32_bf16 v[72:75], v[24:27], v[64:67], v[72:75]
  s_waitcnt lgkmcnt(4)
  v_mfma_f32_16x16x32_bf16 v[176:179], v[28:31], v[48:51], v[176:179]
  ds_read_b64_tr_b16 v[24:25], v14 offset:24576
  ds_read_b64_tr_b16 v[26:27], v14 offset:24832
  v_mfma_f32_16x16x32_bf16 v[180:183], v[28:31], v[52:55], v[180:183]
  v_mfma_f32_16x16x32_bf16 v[184:187], v[28:31], v[56:59], v[184:187]
  v_mfma_f32_16x16x32_bf16 v[188:191], v[28:31], v[60:63], v[188:191]
  s_waitcnt lgkmcnt(4)
  v_mfma_f32_16x16x32_bf16 v[192:195], v[16:19], v[48:51], v[192:195]
  ds_read_b64_tr_b16 v[28:29], v14 offset:29696
  ds_read_b64_tr_b16 v[30:31], v14 offset:29952
  v_mfma_f32_16x16x32_bf16 v[196:199], v[16:19], v[52:55], v[196:199]
  v_mfma_f32_16x16x32_bf16 v[200:203], v[16:19], v[56:59], v[200:203]
  v_mfma_f32_16x16x32_bf16 v[204:207], v[16:19], v[60:63], v[204:207]
  s_waitcnt vmcnt(3) lgkmcnt(4)
  s_barrier
  v_mfma_f32_16x16x32_bf16 v[208:211], v[20:23], v[48:51], v[208:211]
  ds_read_b64_tr_b16 v[16:17], v13 offset:0
  ds_read_b64_tr_b16 v[18:19], v13 offset:256
  v_mfma_f32_16x16x32_bf16 v[212:215], v[20:23], v[52:55], v[212:215]
  ds_read_b128 v[32:35], v4 offset:0
  s_add_u32 m0, s36, 40960
  s_nop 0
  buffer_load_dwordx4 v8, s[16:19], s33 offen lds
  s_add_u32 s33, s33, s43
  v_mfma_f32_16x16x32_bf16 v[216:219], v[20:23], v[56:59], v[216:219]
  ds_read_b128 v[36:39], v4 offset:2048
  v_mfma_f32_16x16x32_bf16 v[220:223], v[20:23], v[60:63], v[220:223]
  s_waitcnt lgkmcnt(6)
  v_mfma_f32_16x16x32_bf16 v[224:227], v[24:27], v[48:51], v[224:227]
  ds_read_b64_tr_b16 v[20:21], v13 offset:5120
  ds_read_b64_tr_b16 v[22:23], v13 offset:5376
  v_mfma_f32_16x16x32_bf16 v[228:231], v[24:27], v[52:55], v[228:231]
  ds_read_b128 v[40:43], v5 offset:0
  v_mfma_f32_16x16x32_bf16 v[232:235], v[24:27], v[56:59], v[232:235]
  ds_read_b128 v[44:47], v5 offset:2048
  s_add_u32 m0, s37, 40960
  s_nop 0
  buffer_load_dwordx4 v9, s[20:23], s34 offen lds
  s_add_u32 s34, s34, s44
  v_mfma_f32_16x16x32_bf16 v[236:239], v[24:27], v[60:63], v[236:239]
  v_mfma_f32_16x16x32_bf16 v[76:79], v[24:27], v[64:67], v[76:79]
  s_waitcnt lgkmcnt(8)
  v_mfma_f32_16x16x32_bf16 v[240:243], v[28:31], v[48:51], v[240:243]
  ds_read_b64_tr_b16 v[24:25], v13 offset:1024
  ds_read_b64_tr_b16 v[26:27], v13 offset:1280
  v_mfma_f32_16x16x32_bf16 v[244:247], v[28:31], v[52:55], v[244:247]
  v_mfma_f32_16x16x32_bf16 v[248:251], v[28:31], v[56:59], v[248:251]
  v_mfma_f32_16x16x32_bf16 v[252:255], v[28:31], v[60:63], v[252:255]
  s_cmp_ge_u32 s28, 4
  s_cbranch_scc1 gemm1_kernel_sk12
  s_add_u32 m0, s38, 40960
  s_nop 0
  buffer_load_dwordx4 v10, s[24:27], s35 offen lds
  s_add_u32 s35, s35, s45
  gemm1_kernel_sk12:
  s_sub_u32 s40, s40, 1
  s_cmp_lg_u32 s40, 0
  s_cbranch_scc1 gemm1_kernel_loop0
  s_lshl_b32 s55, s32, 2
  buffer_load_dword v1, v15, s[68:71], s55 offen sc1
  s_lshl_b32 s47, s32, 11
  s_lshl_b32 s48, s30, 9
  s_add_u32 s47, s47, s48
  s_lshl_b32 s48, s29, 8
  s_add_u32 s47, s47, s48
  s_add_u32 s47, s47, 41943040
  v_and_b32 v94, 15, v2
  v_lshlrev_b32 v94, 3, v94
  v_add_u32 v94, s47, v94
  v_xor_b32 v95, 256, v94
  s_waitcnt lgkmcnt(2)
  v_mfma_f32_16x16x32_bf16 v[96:99], v[16:19], v[32:35], v[96:99]
  ds_read_b64_tr_b16 v[28:29], v13 offset:6144
  ds_read_b64_tr_b16 v[30:31], v13 offset:6400
  v_mfma_f32_16x16x32_bf16 v[100:103], v[16:19], v[36:39], v[100:103]
  v_mfma_f32_16x16x32_bf16 v[104:107], v[16:19], v[40:43], v[104:107]
  v_mfma_f32_16x16x32_bf16 v[108:111], v[16:19], v[44:47], v[108:111]
  v_mfma_f32_16x16x32_bf16 v[68:71], v[16:19], v[64:67], v[68:71]
  s_waitcnt lgkmcnt(4)
  v_mfma_f32_16x16x32_bf16 v[112:115], v[20:23], v[32:35], v[112:115]
  ds_read_b64_tr_b16 v[16:17], v13 offset:2048
  ds_read_b64_tr_b16 v[18:19], v13 offset:2304
  s_add_u32 m0, s39, 4096
  s_nop 0
  buffer_load_dwordx4 v11, s[60:63], s41 offen lds
  v_mfma_f32_16x16x32_bf16 v[116:119], v[20:23], v[36:39], v[116:119]
  v_mfma_f32_16x16x32_bf16 v[120:123], v[20:23], v[40:43], v[120:123]
  v_mfma_f32_16x16x32_bf16 v[124:127], v[20:23], v[44:47], v[124:127]
  s_waitcnt lgkmcnt(4)
  v_mfma_f32_16x16x32_bf16 v[128:131], v[24:27], v[32:35], v[128:131]
  ds_read_b64_tr_b16 v[20:21], v13 offset:7168
  ds_read_b64_tr_b16 v[22:23], v13 offset:7424
  v_mfma_f32_16x16x32_bf16 v[132:135], v[24:27], v[36:39], v[132:135]
  s_add_u32 m0, s39, 5120
  s_nop 0
  buffer_load_dwordx4 v12, s[60:63], s41 offen lds
  v_mfma_f32_16x16x32_bf16 v[136:139], v[24:27], v[40:43], v[136:139]
  v_mfma_f32_16x16x32_bf16 v[140:143], v[24:27], v[44:47], v[140:143]
  s_waitcnt lgkmcnt(4)
  v_mfma_f32_16x16x32_bf16 v[144:147], v[28:31], v[32:35], v[144:147]
  ds_read_b64_tr_b16 v[24:25], v13 offset:3072
  ds_read_b64_tr_b16 v[26:27], v13 offset:3328
  v_mfma_f32_16x16x32_bf16 v[148:151], v[28:31], v[36:39], v[148:151]
  v_mfma_f32_16x16x32_bf16 v[152:155], v[28:31], v[40:43], v[152:155]
  s_add_u32 m0, s39, 6144
  s_nop 0
  buffer_load_dwordx4 v11, s[60:63], s42 offen lds
  v_mfma_f32_16x16x32_bf16 v[156:159], v[28:31], v[44:47], v[156:159]
  s_waitcnt lgkmcnt(4)
  v_mfma_f32_16x16x32_bf16 v[160:163], v[16:19], v[32:35], v[160:163]
  ds_read_b64_tr_b16 v[28:29], v13 offset:8192
  ds_read_b64_tr_b16 v[30:31], v13 offset:8448
  v_mfma_f32_16x16x32_bf16 v[164:167], v[16:19], v[36:39], v[164:167]
  v_mfma_f32_16x16x32_bf16 v[168:171], v[16:19], v[40:43], v[168:171]
  v_mfma_f32_16x16x32_bf16 v[172:175], v[16:19], v[44:47], v[172:175]
  s_add_u32 m0, s39, 7168
  s_nop 0
  buffer_load_dwordx4 v12, s[60:63], s42 offen lds
  s_add_u32 s41, s41, 128
  s_add_u32 s42, s42, 128
  v_mfma_f32_16x16x32_bf16 v[72:75], v[16:19], v[64:67], v[72:75]
  s_waitcnt lgkmcnt(4)
  v_mfma_f32_16x16x32_bf16 v[176:179], v[20:23], v[32:35], v[176:179]
  ds_read_b64_tr_b16 v[16:17], v13 offset:4096
  ds_read_b64_tr_b16 v[18:19], v13 offset:4352
  v_mfma_f32_16x16x32_bf16 v[180:183], v[20:23], v[36:39], v[180:183]
  v_mfma_f32_16x16x32_bf16 v[184:187], v[20:23], v[40:43], v[184:187]
  v_mfma_f32_16x16x32_bf16 v[188:191], v[20:23], v[44:47], v[188:191]
  s_waitcnt lgkmcnt(4)
  v_mfma_f32_16x16x32_bf16 v[192:195], v[24:27], v[32:35], v[192:195]
  ds_read_b64_tr_b16 v[20:21], v13 offset:9216
  ds_read_b64_tr_b16 v[22:23], v13 offset:9472
  v_mfma_f32_16x16x32_bf16 v[196:199], v[24:27], v[36:39], v[196:199]
  v_mfma_f32_16x16x32_bf16 v[200:203], v[24:27], v[40:43], v[200:203]
  v_mfma_f32_16x16x32_bf16 v[204:207], v[24:27], v[44:47], v[204:207]
  s_waitcnt vmcnt(8) lgkmcnt(4)
  s_barrier
  v_mfma_f32_16x16x32_bf16 v[208:211], v[28:31], v[32:35], v[208:211]
  ds_read_b64_tr_b16 v[24:25], v13 offset:20480
  ds_read_b64_tr_b16 v[26:27], v13 offset:20736
  v_mfma_f32_16x16x32_bf16 v[212:215], v[28:31], v[36:39], v[212:215]
  ds_read_b128 v[48:51], v6 offset:0
  s_add_u32 m0, s36, 61440
  s_nop 0
  buffer_load_dwordx4 v8, s[16:19], s33 offen lds
  s_add_u32 s33, s33, s43
  v_mfma_f32_16x16x32_bf16 v[216:219], v[28:31], v[40:43], v[216:219]
  ds_read_b128 v[52:55], v6 offset:2048
  v_mfma_f32_16x16x32_bf16 v[220:223], v[28:31], v[44:47], v[220:223]
  s_waitcnt lgkmcnt(6)
  v_mfma_f32_16x16x32_bf16 v[224:227], v[16:19], v[32:35], v[224:227]
  ds_read_b64_tr_b16 v[28:29], v13 offset:25600
  ds_read_b64_tr_b16 v[30:31], v13 offset:25856
  v_mfma_f32_16x16x32_bf16 v[228:231], v[16:19], v[36:39], v[228:231]
  ds_read_b128 v[56:59], v7 offset:0
  v_mfma_f32_16x16x32_bf16 v[232:235], v[16:19], v[40:43], v[232:235]
  ds_read_b128 v[60:63], v7 offset:2048
  s_add_u32 m0, s37, 61440
  s_nop 0
  buffer_load_dwordx4 v9, s[20:23], s34 offen lds
  s_add_u32 s34, s34, s44
  v_mfma_f32_16x16x32_bf16 v[236:239], v[16:19], v[44:47], v[236:239]
  v_mfma_f32_16x16x32_bf16 v[76:79], v[16:19], v[64:67], v[76:79]
  s_waitcnt lgkmcnt(8)
  v_mfma_f32_16x16x32_bf16 v[240:243], v[20:23], v[32:35], v[240:243]
  ds_read_b64_tr_b16 v[16:17], v13 offset:21504
  ds_read_b64_tr_b16 v[18:19], v13 offset:21760
  v_mfma_f32_16x16x32_bf16 v[244:247], v[20:23], v[36:39], v[244:247]
  v_mfma_f32_16x16x32_bf16 v[248:251], v[20:23], v[40:43], v[248:251]
  v_mfma_f32_16x16x32_bf16 v[252:255], v[20:23], v[44:47], v[252:255]
  s_cmp_ge_u32 s28, 4
  s_cbranch_scc1 gemm1_kernel_sk13
  s_add_u32 m0, s38, 61440
  s_nop 0
  buffer_load_dwordx4 v10, s[24:27], s35 offen lds
  s_add_u32 s35, s35, s45
  gemm1_kernel_sk13:
  s_waitcnt lgkmcnt(2)
  v_mfma_f32_16x16x32_bf16 v[96:99], v[24:27], v[48:51], v[96:99]
  ds_read_b64_tr_b16 v[20:21], v13 offset:26624
  ds_read_b64_tr_b16 v[22:23], v13 offset:26880
  v_mfma_f32_16x16x32_bf16 v[100:103], v[24:27], v[52:55], v[100:103]
  v_mfma_f32_16x16x32_bf16 v[104:107], v[24:27], v[56:59], v[104:107]
  v_mfma_f32_16x16x32_bf16 v[108:111], v[24:27], v[60:63], v[108:111]
  v_mfma_f32_16x16x32_bf16 v[68:71], v[24:27], v[64:67], v[68:71]
  s_waitcnt lgkmcnt(4)
  v_mfma_f32_16x16x32_bf16 v[112:115], v[28:31], v[48:51], v[112:115]
  ds_read_b64_tr_b16 v[24:25], v13 offset:22528
  ds_read_b64_tr_b16 v[26:27], v13 offset:22784
  v_mfma_f32_16x16x32_bf16 v[116:119], v[28:31], v[52:55], v[116:119]
  v_mfma_f32_16x16x32_bf16 v[120:123], v[28:31], v[56:59], v[120:123]
  v_mfma_f32_16x16x32_bf16 v[124:127], v[28:31], v[60:63], v[124:127]
  s_waitcnt lgkmcnt(4)
  v_mfma_f32_16x16x32_bf16 v[128:131], v[16:19], v[48:51], v[128:131]
  ds_read_b64_tr_b16 v[28:29], v13 offset:27648
  ds_read_b64_tr_b16 v[30:31], v13 offset:27904
  v_mfma_f32_16x16x32_bf16 v[132:135], v[16:19], v[52:55], v[132:135]
  v_mfma_f32_16x16x32_bf16 v[136:139], v[16:19], v[56:59], v[136:139]
  v_mfma_f32_16x16x32_bf16 v[140:143], v[16:19], v[60:63], v[140:143]
  s_waitcnt lgkmcnt(4)
  v_mfma_f32_16x16x32_bf16 v[144:147], v[20:23], v[48:51], v[144:147]
  ds_read_b64_tr_b16 v[16:17], v13 offset:23552
  ds_read_b64_tr_b16 v[18:19], v13 offset:23808
  v_mfma_f32_16x16x32_bf16 v[148:151], v[20:23], v[52:55], v[148:151]
  v_mfma_f32_16x16x32_bf16 v[152:155], v[20:23], v[56:59], v[152:155]
  v_mfma_f32_16x16x32_bf16 v[156:159], v[20:23], v[60:63], v[156:159]
  s_waitcnt lgkmcnt(4)
  v_mfma_f32_16x16x32_bf16 v[160:163], v[24:27], v[48:51], v[160:163]
  ds_read_b64_tr_b16 v[20:21], v13 offset:28672
  ds_read_b64_tr_b16 v[22:23], v13 offset:28928
  v_mfma_f32_16x16x32_bf16 v[164:167], v[24:27], v[52:55], v[164:167]
  v_mfma_f32_16x16x32_bf16 v[168:171], v[24:27], v[56:59], v[168:171]
  v_mfma_f32_16x16x32_bf16 v[172:175], v[24:27], v[60:63], v[172:175]
  v_mfma_f32_16x16x32_bf16 v[72:75], v[24:27], v[64:67], v[72:75]
  s_waitcnt lgkmcnt(4)
  v_mfma_f32_16x16x32_bf16 v[176:179], v[28:31], v[48:51], v[176:179]
  ds_read_b64_tr_b16 v[24:25], v13 offset:24576
  ds_read_b64_tr_b16 v[26:27], v13 offset:24832
  v_mfma_f32_16x16x32_bf16 v[180:183], v[28:31], v[52:55], v[180:183]
  v_mfma_f32_16x16x32_bf16 v[184:187], v[28:31], v[56:59], v[184:187]
  v_mfma_f32_16x16x32_bf16 v[188:191], v[28:31], v[60:63], v[188:191]
  s_waitcnt lgkmcnt(4)
  v_mfma_f32_16x16x32_bf16 v[192:195], v[16:19], v[48:51], v[192:195]
  ds_read_b64_tr_b16 v[28:29], v13 offset:29696
  ds_read_b64_tr_b16 v[30:31], v13 offset:29952
  v_mfma_f32_16x16x32_bf16 v[196:199], v[16:19], v[52:55], v[196:199]
  v_mfma_f32_16x16x32_bf16 v[200:203], v[16:19], v[56:59], v[200:203]
  v_mfma_f32_16x16x32_bf16 v[204:207], v[16:19], v[60:63], v[204:207]
  s_waitcnt vmcnt(2) lgkmcnt(4)
  s_barrier
  v_mfma_f32_16x16x32_bf16 v[208:211], v[20:23], v[48:51], v[208:211]
  ds_read_b64_tr_b16 v[16:17], v14 offset:0
  ds_read_b64_tr_b16 v[18:19], v14 offset:256
  v_mfma_f32_16x16x32_bf16 v[212:215], v[20:23], v[52:55], v[212:215]
  ds_read_b128 v[32:35], v4 offset:4096
  v_mfma_f32_16x16x32_bf16 v[216:219], v[20:23], v[56:59], v[216:219]
  ds_read_b128 v[36:39], v4 offset:6144
  v_mfma_f32_16x16x32_bf16 v[220:223], v[20:23], v[60:63], v[220:223]
  s_waitcnt lgkmcnt(6)
  v_mfma_f32_16x16x32_bf16 v[224:227], v[24:27], v[48:51], v[224:227]
  ds_read_b64_tr_b16 v[20:21], v14 offset:5120
  ds_read_b64_tr_b16 v[22:23], v14 offset:5376
  v_mfma_f32_16x16x32_bf16 v[228:231], v[24:27], v[52:55], v[228:231]
  ds_read_b128 v[40:43], v5 offset:4096
  v_mfma_f32_16x16x32_bf16 v[232:235], v[24:27], v[56:59], v[232:235]
  ds_read_b128 v[44:47], v5 offset:6144
  v_mfma_f32_16x16x32_bf16 v[236:239], v[24:27], v[60:63], v[236:239]
  v_mfma_f32_16x16x32_bf16 v[76:79], v[24:27], v[64:67], v[76:79]
  s_waitcnt lgkmcnt(8)
  v_mfma_f32_16x16x32_bf16 v[240:243], v[28:31], v[48:51], v[240:243]
  ds_read_b64_tr_b16 v[24:25], v14 offset:1024
  ds_read_b64_tr_b16 v[26:27], v14 offset:1280
  v_mfma_f32_16x16x32_bf16 v[244:247], v[28:31], v[52:55], v[244:247]
  v_mfma_f32_16x16x32_bf16 v[248:251], v[28:31], v[56:59], v[248:251]
  v_mfma_f32_16x16x32_bf16 v[252:255], v[28:31], v[60:63], v[252:255]
  s_waitcnt vmcnt(6)
  v_readfirstlane_b32 s58, v1
  buffer_load_dwordx2 v[80:81], v94, s[12:15], 0 offen offset:0 sc1
  buffer_load_dwordx2 v[82:83], v94, s[12:15], 0 offen offset:128 sc1
  buffer_load_dwordx2 v[84:85], v95, s[12:15], 0 offen offset:0 sc1
  buffer_load_dwordx2 v[86:87], v95, s[12:15], 0 offen offset:128 sc1
  s_waitcnt lgkmcnt(2)
  v_mfma_f32_16x16x32_bf16 v[96:99], v[16:19], v[32:35], v[96:99]
  ds_read_b64_tr_b16 v[28:29], v14 offset:6144
  ds_read_b64_tr_b16 v[30:31], v14 offset:6400
  v_mfma_f32_16x16x32_bf16 v[100:103], v[16:19], v[36:39], v[100:103]
  v_mfma_f32_16x16x32_bf16 v[104:107], v[16:19], v[40:43], v[104:107]
  v_mfma_f32_16x16x32_bf16 v[108:111], v[16:19], v[44:47], v[108:111]
  v_mfma_f32_16x16x32_bf16 v[68:71], v[16:19], v[64:67], v[68:71]
  s_waitcnt lgkmcnt(4)
  v_mfma_f32_16x16x32_bf16 v[112:115], v[20:23], v[32:35], v[112:115]
  ds_read_b64_tr_b16 v[16:17], v14 offset:2048
  ds_read_b64_tr_b16 v[18:19], v14 offset:2304
  v_mfma_f32_16x16x32_bf16 v[116:119], v[20:23], v[36:39], v[116:119]
  v_mfma_f32_16x16x32_bf16 v[120:123], v[20:23], v[40:43], v[120:123]
  v_mfma_f32_16x16x32_bf16 v[124:127], v[20:23], v[44:47], v[124:127]
  s_waitcnt lgkmcnt(4)
  v_mfma_f32_16x16x32_bf16 v[128:131], v[24:27], v[32:35], v[128:131]
  ds_read_b64_tr_b16 v[20:21], v14 offset:7168
  ds_read_b64_tr_b16 v[22:23], v14 offset:7424
  v_mfma_f32_16x16x32_bf16 v[132:135], v[24:27], v[36:39], v[132:135]
  v_mfma_f32_16x16x32_bf16 v[136:139], v[24:27], v[40:43], v[136:139]
  v_mfma_f32_16x16x32_bf16 v[140:143], v[24:27], v[44:47], v[140:143]
  s_waitcnt lgkmcnt(4)
  v_mfma_f32_16x16x32_bf16 v[144:147], v[28:31], v[32:35], v[144:147]
  ds_read_b64_tr_b16 v[24:25], v14 offset:3072
  ds_read_b64_tr_b16 v[26:27], v14 offset:3328
  v_mfma_f32_16x16x32_bf16 v[148:151], v[28:31], v[36:39], v[148:151]
  v_mfma_f32_16x16x32_bf16 v[152:155], v[28:31], v[40:43], v[152:155]
  v_mfma_f32_16x16x32_bf16 v[156:159], v[28:31], v[44:47], v[156:159]
  s_waitcnt lgkmcnt(4)
  v_mfma_f32_16x16x32_bf16 v[160:163], v[16:19], v[32:35], v[160:163]
  ds_read_b64_tr_b16 v[28:29], v14 offset:8192
  ds_read_b64_tr_b16 v[30:31], v14 offset:8448
  v_mfma_f32_16x16x32_bf16 v[164:167], v[16:19], v[36:39], v[164:167]
  v_mfma_f32_16x16x32_bf16 v[168:171], v[16:19], v[40:43], v[168:171]
  v_mfma_f32_16x16x32_bf16 v[172:175], v[16:19], v[44:47], v[172:175]
  v_mfma_f32_16x16x32_bf16 v[72:75], v[16:19], v[64:67], v[72:75]
  s_waitcnt lgkmcnt(4)
  v_mfma_f32_16x16x32_bf16 v[176:179], v[20:23], v[32:35], v[176:179]
  ds_read_b64_tr_b16 v[16:17], v14 offset:4096
  ds_read_b64_tr_b16 v[18:19], v14 offset:4352
  v_mfma_f32_16x16x32_bf16 v[180:183], v[20:23], v[36:39], v[180:183]
  v_mfma_f32_16x16x32_bf16 v[184:187], v[20:23], v[40:43], v[184:187]
  v_mfma_f32_16x16x32_bf16 v[188:191], v[20:23], v[44:47], v[188:191]
  s_waitcnt lgkmcnt(4)
  v_mfma_f32_16x16x32_bf16 v[192:195], v[24:27], v[32:35], v[192:195]
  ds_read_b64_tr_b16 v[20:21], v14 offset:9216
  ds_read_b64_tr_b16 v[22:23], v14 offset:9472
  v_mfma_f32_16x16x32_bf16 v[196:199], v[24:27], v[36:39], v[196:199]
  v_mfma_f32_16x16x32_bf16 v[200:203], v[24:27], v[40:43], v[200:203]
  v_mfma_f32_16x16x32_bf16 v[204:207], v[24:27], v[44:47], v[204:207]
  s_waitcnt vmcnt(4) lgkmcnt(4)
  s_barrier
  v_mfma_f32_16x16x32_bf16 v[208:211], v[28:31], v[32:35], v[208:211]
  ds_read_b64_tr_b16 v[24:25], v14 offset:20480
  ds_read_b64_tr_b16 v[26:27], v14 offset:20736
  v_mfma_f32_16x16x32_bf16 v[212:215], v[28:31], v[36:39], v[212:215]
  ds_read_b128 v[48:51], v6 offset:4096
  v_mfma_f32_16x16x32_bf16 v[216:219], v[28:31], v[40:43], v[216:219]
  ds_read_b128 v[52:55], v6 offset:6144
  v_mfma_f32_16x16x32_bf16 v[220:223], v[28:31], v[44:47], v[220:223]
  s_waitcnt lgkmcnt(6)
  v_mfma_f32_16x16x32_bf16 v[224:227], v[16:19], v[32:35], v[224:227]
  ds_read_b64_tr_b16 v[28:29], v14 offset:25600
  ds_read_b64_tr_b16 v[30:31], v14 offset:25856
  v_mfma_f32_16x16x32_bf16 v[228:231], v[16:19], v[36:39], v[228:231]
  ds_read_b128 v[56:59], v7 offset:4096
  v_mfma_f32_16x16x32_bf16 v[232:235], v[16:19], v[40:43], v[232:235]
  ds_read_b128 v[60:63], v7 offset:6144
  v_mfma_f32_16x16x32_bf16 v[236:239], v[16:19], v[44:47], v[236:239]
  v_mfma_f32_16x16x32_bf16 v[76:79], v[16:19], v[64:67], v[76:79]
  s_waitcnt lgkmcnt(8)
  v_mfma_f32_16x16x32_bf16 v[240:243], v[20:23], v[32:35], v[240:243]
  ds_read_b64_tr_b16 v[16:17], v14 offset:21504
  ds_read_b64_tr_b16 v[18:19], v14 offset:21760
  v_mfma_f32_16x16x32_bf16 v[244:247], v[20:23], v[36:39], v[244:247]
  v_mfma_f32_16x16x32_bf16 v[248:251], v[20:23], v[40:43], v[248:251]
  v_mfma_f32_16x16x32_bf16 v[252:255], v[20:23], v[44:47], v[252:255]
  s_waitcnt lgkmcnt(2)
  v_mfma_f32_16x16x32_bf16 v[96:99], v[24:27], v[48:51], v[96:99]
  ds_read_b64_tr_b16 v[20:21], v14 offset:26624
  ds_read_b64_tr_b16 v[22:23], v14 offset:26880
  v_mfma_f32_16x16x32_bf16 v[100:103], v[24:27], v[52:55], v[100:103]
  v_mfma_f32_16x16x32_bf16 v[104:107], v[24:27], v[56:59], v[104:107]
  v_mfma_f32_16x16x32_bf16 v[108:111], v[24:27], v[60:63], v[108:111]
  v_mfma_f32_16x16x32_bf16 v[68:71], v[24:27], v[64:67], v[68:71]
  s_waitcnt lgkmcnt(4)
  v_mfma_f32_16x16x32_bf16 v[112:115], v[28:31], v[48:51], v[112:115]
  ds_read_b64_tr_b16 v[24:25], v14 offset:22528
  ds_read_b64_tr_b16 v[26:27], v14 offset:22784
  v_mfma_f32_16x16x32_bf16 v[116:119], v[28:31], v[52:55], v[116:119]
  v_mfma_f32_16x16x32_bf16 v[120:123], v[28:31], v[56:59], v[120:123]
  v_mfma_f32_16x16x32_bf16 v[124:127], v[28:31], v[60:63], v[124:127]
  s_waitcnt lgkmcnt(4)
  v_mfma_f32_16x16x32_bf16 v[128:131], v[16:19], v[48:51], v[128:131]
  ds_read_b64_tr_b16 v[28:29], v14 offset:27648
  ds_read_b64_tr_b16 v[30:31], v14 offset:27904
  v_mfma_f32_16x16x32_bf16 v[132:135], v[16:19], v[52:55], v[132:135]
  v_mfma_f32_16x16x32_bf16 v[136:139], v[16:19], v[56:59], v[136:139]
  v_mfma_f32_16x16x32_bf16 v[140:143], v[16:19], v[60:63], v[140:143]
  s_waitcnt lgkmcnt(4)
  v_mfma_f32_16x16x32_bf16 v[144:147], v[20:23], v[48:51], v[144:147]
  ds_read_b64_tr_b16 v[16:17], v14 offset:23552
  ds_read_b64_tr_b16 v[18:19], v14 offset:23808
  v_mfma_f32_16x16x32_bf16 v[148:151], v[20:23], v[52:55], v[148:151]
  v_mfma_f32_16x16x32_bf16 v[152:155], v[20:23], v[56:59], v[152:155]
  v_mfma_f32_16x16x32_bf16 v[156:159], v[20:23], v[60:63], v[156:159]
  s_waitcnt lgkmcnt(4)
  v_mfma_f32_16x16x32_bf16 v[160:163], v[24:27], v[48:51], v[160:163]
  ds_read_b64_tr_b16 v[20:21], v14 offset:28672
  ds_read_b64_tr_b16 v[22:23], v14 offset:28928
  v_mfma_f32_16x16x32_bf16 v[164:167], v[24:27], v[52:55], v[164:167]
  v_mfma_f32_16x16x32_bf16 v[168:171], v[24:27], v[56:59], v[168:171]
  v_mfma_f32_16x16x32_bf16 v[172:175], v[24:27], v[60:63], v[172:175]
  v_mfma_f32_16x16x32_bf16 v[72:75], v[24:27], v[64:67], v[72:75]
  s_waitcnt lgkmcnt(4)
  v_mfma_f32_16x16x32_bf16 v[176:179], v[28:31], v[48:51], v[176:179]
  ds_read_b64_tr_b16 v[24:25], v14 offset:24576
  ds_read_b64_tr_b16 v[26:27], v14 offset:24832
  v_mfma_f32_16x16x32_bf16 v[180:183], v[28:31], v[52:55], v[180:183]
  v_mfma_f32_16x16x32_bf16 v[184:187], v[28:31], v[56:59], v[184:187]
  v_mfma_f32_16x16x32_bf16 v[188:191], v[28:31], v[60:63], v[188:191]
  s_waitcnt lgkmcnt(4)
  v_mfma_f32_16x16x32_bf16 v[192:195], v[16:19], v[48:51], v[192:195]
  ds_read_b64_tr_b16 v[28:29], v14 offset:29696
  ds_read_b64_tr_b16 v[30:31], v14 offset:29952
  v_mfma_f32_16x16x32_bf16 v[196:199], v[16:19], v[52:55], v[196:199]
  v_mfma_f32_16x16x32_bf16 v[200:203], v[16:19], v[56:59], v[200:203]
  v_mfma_f32_16x16x32_bf16 v[204:207], v[16:19], v[60:63], v[204:207]
  s_waitcnt lgkmcnt(4)
  v_mfma_f32_16x16x32_bf16 v[208:211], v[20:23], v[48:51], v[208:211]
  v_mfma_f32_16x16x32_bf16 v[212:215], v[20:23], v[52:55], v[212:215]
  v_mfma_f32_16x16x32_bf16 v[216:219], v[20:23], v[56:59], v[216:219]
  v_mfma_f32_16x16x32_bf16 v[220:223], v[20:23], v[60:63], v[220:223]
  s_waitcnt lgkmcnt(2)
  v_mfma_f32_16x16x32_bf16 v[224:227], v[24:27], v[48:51], v[224:227]
  v_mfma_f32_16x16x32_bf16 v[228:231], v[24:27], v[52:55], v[228:231]
  v_mfma_f32_16x16x32_bf16 v[232:235], v[24:27], v[56:59], v[232:235]
  v_mfma_f32_16x16x32_bf16 v[236:239], v[24:27], v[60:63], v[236:239]
  v_mfma_f32_16x16x32_bf16 v[76:79], v[24:27], v[64:67], v[76:79]
  s_waitcnt lgkmcnt(0)
  v_mfma_f32_16x16x32_bf16 v[240:243], v[28:31], v[48:51], v[240:243]
  v_mfma_f32_16x16x32_bf16 v[244:247], v[28:31], v[52:55], v[244:247]
  v_mfma_f32_16x16x32_bf16 v[248:251], v[28:31], v[56:59], v[248:251]
  v_mfma_f32_16x16x32_bf16 v[252:255], v[28:31], v[60:63], v[252:255]
  v_lshrrev_b32 v3, 4, v2
  s_mul_i32 s47, s29, 640
  s_add_u32 s47, s47, 147456
  v_lshlrev_b32 v10, 4, v3
  v_add_u32 v10, s47, v10
  s_nop 7

  ds_write_b128 v10, v[68:71] offset:0
  ds_write_b128 v10, v[72:75] offset:256
  ds_write_b128 v10, v[76:79] offset:512
  s_branch gemm1_kernel_epi
gemm1_kernel_p1_1:
  s_waitcnt lgkmcnt(4)
  v_mfma_f32_16x16x32_bf16 v[96:99], v[16:19], v[32:35], 0
  ds_read_b64_tr_b16 v[28:29], v13 offset:6144
  ds_read_b64_tr_b16 v[30:31], v13 offset:6400
  s_waitcnt vmcnt(0)
  s_mov_b32 s47, 0xffff0000
  v_lshlrev_b32 v232, 16, v224
  v_and_b32 v233, s47, v224
  v_mfma_f32_16x16x32_bf16 v[100:103], v[16:19], v[36:39], 0
  s_add_u32 m0, s36, 20480
  s_nop 0
  buffer_load_dwordx4 v8, s[16:19], s33 offen lds
  s_add_u32 s33, s33, s43
  v_lshlrev_b32 v234, 16, v225
  v_and_b32 v235, s47, v225
  v_lshlrev_b32 v236, 16, v226
  v_mfma_f32_16x16x32_bf16 v[104:107], v[16:19], v[40:43], 0
  v_and_b32 v237, s47, v226
  v_lshlrev_b32 v238, 16, v227
  v_and_b32 v239, s47, v227
  v_mfma_f32_16x16x32_bf16 v[108:111], v[16:19], v[44:47], 0
  s_add_u32 m0, s37, 20480
  s_nop 0
  buffer_load_dwordx4 v9, s[20:23], s34 offen lds
  s_add_u32 s34, s34, s44
  v_lshlrev_b32 v240, 16, v228
  v_and_b32 v241, s47, v228
  v_lshlrev_b32 v242, 16, v229
  s_waitcnt lgkmcnt(4)
  v_mfma_f32_16x16x32_bf16 v[112:115], v[20:23], v[32:35], 0
  ds_read_b64_tr_b16 v[16:17], v13 offset:2048
  ds_read_b64_tr_b16 v[18:19], v13 offset:2304
  v_and_b32 v243, s47, v229
  v_lshlrev_b32 v244, 16, v230
  v_and_b32 v245, s47, v230
  v_mfma_f32_16x16x32_bf16 v[116:119], v[20:23], v[36:39], 0
  s_cmp_ge_u32 s28, 4
  s_cbranch_scc1 gemm1_kernel_sk14
  s_add_u32 m0, s38, 20480
  s_nop 0
  buffer_load_dwordx4 v10, s[24:27], s35 offen lds
  s_add_u32 s35, s35, s45
  gemm1_kernel_sk14:
  v_lshlrev_b32 v246, 16, v231
  v_and_b32 v247, s47, v231
  v_add_f32 v248, v232, v233
  v_mfma_f32_16x16x32_bf16 v[120:123], v[20:23], v[40:43], 0
  v_add_f32 v249, v234, v235
  v_add_f32 v248, v248, v236
  v_add_f32 v249, v249, v237
  v_mfma_f32_16x16x32_bf16 v[124:127], v[20:23], v[44:47], 0
  s_add_u32 m0, s39, 4096
  s_nop 0
  buffer_load_dwordx4 v11, s[60:63], s41 offen lds
  v_mfma_f32_16x16x32_bf16 v[68:71], v[20:23], v[64:67], 0
  v_add_f32 v248, v248, v238
  v_add_f32 v249, v249, v239
  v_add_f32 v248, v248, v240
  s_waitcnt lgkmcnt(4)
  v_mfma_f32_16x16x32_bf16 v[128:131], v[24:27], v[32:35], 0
  ds_read_b64_tr_b16 v[20:21], v13 offset:7168
  ds_read_b64_tr_b16 v[22:23], v13 offset:7424
  v_add_f32 v249, v249, v241
  v_add_f32 v248, v248, v242
  v_add_f32 v249, v249, v243
  v_mfma_f32_16x16x32_bf16 v[132:135], v[24:27], v[36:39], 0
  s_add_u32 m0, s39, 5120
  s_nop 0
  buffer_load_dwordx4 v12, s[60:63], s41 offen lds
  v_add_f32 v248, v248, v244
  v_add_f32 v249, v249, v245
  v_add_f32 v248, v248, v246
  v_mfma_f32_16x16x32_bf16 v[136:139], v[24:27], v[40:43], 0
  v_add_f32 v249, v249, v247
  v_add_f32 v248, v248, v249
  s_nop 1
  v_add_f32_dpp v248, v248, v248 quad_perm:[1,0,3,2] row_mask:0xf bank_mask:0xf
  v_mfma_f32_16x16x32_bf16 v[140:143], v[24:27], v[44:47], 0
  s_add_u32 m0, s39, 6144
  s_nop 0
  buffer_load_dwordx4 v11, s[60:63], s42 offen lds
  s_nop 1
  v_add_f32_dpp v248, v248, v248 quad_perm:[2,3,0,1] row_mask:0xf bank_mask:0xf
  s_nop 1
  v_add_f32_dpp v248, v248, v248 row_half_mirror row_mask:0xf bank_mask:0xf
  s_nop 1
  v_add_f32_dpp v248, v248, v248 row_mirror row_mask:0xf bank_mask:0xf
  s_waitcnt lgkmcnt(4)
  v_mfma_f32_16x16x32_bf16 v[144:147], v[28:31], v[32:35], 0
  ds_read_b64_tr_b16 v[24:25], v13 offset:3072
  ds_read_b64_tr_b16 v[26:27], v13 offset:3328
  v_mov_b32 v250, v248
  s_nop 1
  v_permlane16_swap_b32 v250, v248
  s_nop 0
  v_add_f32 v248, v248, v250
  v_mfma_f32_16x16x32_bf16 v[148:151], v[28:31], v[36:39], 0
  s_add_u32 m0, s39, 7168
  s_nop 0
  buffer_load_dwordx4 v12, s[60:63], s42 offen lds
  s_add_u32 s41, s41, 128
  s_add_u32 s42, s42, 128
  v_mov_b32 v250, v248
  s_nop 1
  v_permlane32_swap_b32 v250, v248
  s_nop 0
  v_add_f32 v248, v248, v250
  v_mfma_f32_16x16x32_bf16 v[152:155], v[28:31], v[40:43], 0
  v_mul_f32 v248, 0xba800000, v248
  v_add_f32 v232, v232, v248
  v_add_f32 v233, v233, v248
  v_mfma_f32_16x16x32_bf16 v[156:159], v[28:31], v[44:47], 0
  s_add_u32 m0, s36, 40960
  s_nop 0
  buffer_load_dwordx4 v8, s[16:19], s33 offen lds
  s_add_u32 s33, s33, s43
  v_add_f32 v234, v234, v248
  v_add_f32 v235, v235, v248
  v_add_f32 v236, v236, v248
  s_waitcnt lgkmcnt(4)
  v_mfma_f32_16x16x32_bf16 v[160:163], v[16:19], v[32:35], 0
  ds_read_b64_tr_b16 v[28:29], v13 offset:8192
  ds_read_b64_tr_b16 v[30:31], v13 offset:8448
  v_add_f32 v237, v237, v248
  v_add_f32 v238, v238, v248
  v_add_f32 v239, v239, v248
  v_mfma_f32_16x16x32_bf16 v[164:167], v[16:19], v[36:39], 0
  s_add_u32 m0, s37, 40960
  s_nop 0
  buffer_load_dwordx4 v9, s[20:23], s34 offen lds
  s_add_u32 s34, s34, s44
  v_add_f32 v240, v240, v248
  v_add_f32 v241, v241, v248
  v_add_f32 v242, v242, v248
  v_mfma_f32_16x16x32_bf16 v[168:171], v[16:19], v[40:43], 0
  v_add_f32 v243, v243, v248
  v_add_f32 v244, v244, v248
  v_add_f32 v245, v245, v248
  v_mfma_f32_16x16x32_bf16 v[172:175], v[16:19], v[44:47], 0
  s_cmp_ge_u32 s28, 4
  s_cbranch_scc1 gemm1_kernel_sk15
  s_add_u32 m0, s38, 40960
  s_nop 0
  buffer_load_dwordx4 v10, s[24:27], s35 offen lds
  s_add_u32 s35, s35, s45
  gemm1_kernel_sk15:
  v_add_f32 v246, v246, v248
  v_add_f32 v247, v247, v248
  v_mul_f32 v249, v232, v232
  s_waitcnt lgkmcnt(4)
  v_mfma_f32_16x16x32_bf16 v[176:179], v[20:23], v[32:35], 0
  ds_read_b64_tr_b16 v[16:17], v13 offset:4096
  ds_read_b64_tr_b16 v[18:19], v13 offset:4352
  v_mul_f32 v250, v233, v233
  v_fmac_f32 v249, v234, v234
  v_fmac_f32 v250, v235, v235
  v_mfma_f32_16x16x32_bf16 v[180:183], v[20:23], v[36:39], 0
  buffer_load_dword v88, v89, s[64:67], s97 offen
  s_add_u32 s97, s97, s98
  v_fmac_f32 v249, v236, v236
  v_fmac_f32 v250, v237, v237
  v_fmac_f32 v249, v238, v238
  v_mfma_f32_16x16x32_bf16 v[184:187], v[20:23], v[40:43], 0
  v_fmac_f32 v250, v239, v239
  v_fmac_f32 v249, v240, v240
  v_fmac_f32 v250, v241, v241
  v_mfma_f32_16x16x32_bf16 v[188:191], v[20:23], v[44:47], 0
  v_mfma_f32_16x16x32_bf16 v[72:75], v[20:23], v[64:67], 0
  v_fmac_f32 v249, v242, v242
  v_fmac_f32 v250, v243, v243
  v_fmac_f32 v249, v244, v244
  s_waitcnt lgkmcnt(4)
  v_mfma_f32_16x16x32_bf16 v[192:195], v[24:27], v[32:35], 0
  ds_read_b64_tr_b16 v[20:21], v13 offset:9216
  ds_read_b64_tr_b16 v[22:23], v13 offset:9472
  v_fmac_f32 v250, v245, v245
  v_fmac_f32 v249, v246, v246
  v_fmac_f32 v250, v247, v247
  v_mfma_f32_16x16x32_bf16 v[196:199], v[24:27], v[36:39], 0
  v_add_f32 v249, v249, v250
  s_nop 1
  v_add_f32_dpp v249, v249, v249 quad_perm:[1,0,3,2] row_mask:0xf bank_mask:0xf
  s_nop 1
  v_add_f32_dpp v249, v249, v249 quad_perm:[2,3,0,1] row_mask:0xf bank_mask:0xf
  v_mfma_f32_16x16x32_bf16 v[200:203], v[24:27], v[40:43], 0
  s_nop 1
  v_add_f32_dpp v249, v249, v249 row_half_mirror row_mask:0xf bank_mask:0xf
  s_nop 1
  v_add_f32_dpp v249, v249, v249 row_mirror row_mask:0xf bank_mask:0xf
  v_mov_b32 v250, v249
  v_mfma_f32_16x16x32_bf16 v[204:207], v[24:27], v[44:47], 0
  s_nop 1
  v_permlane16_swap_b32 v250, v249
  s_nop 0
  v_add_f32 v249, v249, v250
  v_mov_b32 v250, v249
  s_waitcnt vmcnt(7) lgkmcnt(4)
  s_barrier
  v_mfma_f32_16x16x32_bf16 v[208:211], v[28:31], v[32:35], 0
  ds_read_b64_tr_b16 v[24:25], v13 offset:20480
  ds_read_b64_tr_b16 v[26:27], v13 offset:20736
  s_nop 1
  v_permlane32_swap_b32 v250, v249
  s_nop 0
  v_add_f32 v249, v249, v250
  v_mov_b32 v250, 0x3727c5ac
  v_mfma_f32_16x16x32_bf16 v[212:215], v[28:31], v[36:39], 0
  ds_read_b128 v[48:51], v6 offset:0
  v_fmac_f32 v250, 0x3a800000, v249
  v_mov_b32 v249, v250
  s_lshl_b32 s47, s55, 3
  s_add_u32 s47, s47, 41943040
  s_lshl_b32 s48, s2, 2
  s_add_u32 s48, s48, 42008576
  s_mov_b64 exec, 1
  buffer_store_dwordx2 v[248:249], v15, s[12:15], s47 offen sc1
  buffer_store_dword v15, v15, s[12:15], s48 offen
  s_mov_b64 exec, -1
  s_nop 3
  v_mfma_f32_16x16x32_bf16 v[216:219], v[28:31], v[40:43], 0
  ds_read_b128 v[52:55], v6 offset:2048
  s_add_u32 m0, s36, 61440
  s_nop 0
  buffer_load_dwordx4 v8, s[16:19], s33 offen lds
  s_add_u32 s33, s33, s43
  v_mfma_f32_16x16x32_bf16 v[220:223], v[28:31], v[44:47], 0
  s_waitcnt lgkmcnt(6)
  v_mfma_f32_16x16x32_bf16 v[224:227], v[16:19], v[32:35], 0
  ds_read_b64_tr_b16 v[28:29], v13 offset:25600
  ds_read_b64_tr_b16 v[30:31], v13 offset:25856
  v_mfma_f32_16x16x32_bf16 v[228:231], v[16:19], v[36:39], 0
  ds_read_b128 v[56:59], v7 offset:0
  v_mfma_f32_16x16x32_bf16 v[232:235], v[16:19], v[40:43], 0
  ds_read_b128 v[60:63], v7 offset:2048
  v_mfma_f32_16x16x32_bf16 v[236:239], v[16:19], v[44:47], 0
  s_add_u32 m0, s37, 61440
  s_nop 0
  buffer_load_dwordx4 v9, s[20:23], s34 offen lds
  s_add_u32 s34, s34, s44
  s_waitcnt lgkmcnt(8)
  v_mfma_f32_16x16x32_bf16 v[240:243], v[20:23], v[32:35], 0
  ds_read_b64_tr_b16 v[16:17], v13 offset:21504
  ds_read_b64_tr_b16 v[18:19], v13 offset:21760
  v_mfma_f32_16x16x32_bf16 v[244:247], v[20:23], v[36:39], 0
  v_mfma_f32_16x16x32_bf16 v[248:251], v[20:23], v[40:43], 0
  v_mfma_f32_16x16x32_bf16 v[252:255], v[20:23], v[44:47], 0
  v_mfma_f32_16x16x32_bf16 v[76:79], v[20:23], v[64:67], 0
  s_waitcnt lgkmcnt(2)
  v_mfma_f32_16x16x32_bf16 v[96:99], v[24:27], v[48:51], v[96:99]
  ds_read_b64_tr_b16 v[20:21], v13 offset:26624
  ds_read_b64_tr_b16 v[22:23], v13 offset:26880
  s_cmp_ge_u32 s28, 4
  s_cbranch_scc1 gemm1_kernel_sk16
  s_add_u32 m0, s38, 61440
  s_nop 0
  buffer_load_dwordx4 v10, s[24:27], s35 offen lds
  s_add_u32 s35, s35, s45
  gemm1_kernel_sk16:
  v_mfma_f32_16x16x32_bf16 v[100:103], v[24:27], v[52:55], v[100:103]
  v_mfma_f32_16x16x32_bf16 v[104:107], v[24:27], v[56:59], v[104:107]
  v_mfma_f32_16x16x32_bf16 v[108:111], v[24:27], v[60:63], v[108:111]
  s_waitcnt lgkmcnt(4)
  v_mfma_f32_16x16x32_bf16 v[112:115], v[28:31], v[48:51], v[112:115]
  ds_read_b64_tr_b16 v[24:25], v13 offset:22528
  ds_read_b64_tr_b16 v[26:27], v13 offset:22784
  v_mfma_f32_16x16x32_bf16 v[116:119], v[28:31], v[52:55], v[116:119]
  buffer_load_dword v88, v89, s[64:67], s97 offen
  s_add_u32 s97, s97, s98
  v_mfma_f32_16x16x32_bf16 v[120:123], v[28:31], v[56:59], v[120:123]
  v_mfma_f32_16x16x32_bf16 v[124:127], v[28:31], v[60:63], v[124:127]
  v_mfma_f32_16x16x32_bf16 v[68:71], v[28:31], v[64:67], v[68:71]
  s_waitcnt lgkmcnt(4)
  v_mfma_f32_16x16x32_bf16 v[128:131], v[16:19], v[48:51], v[128:131]
  ds_read_b64_tr_b16 v[28:29], v13 offset:27648
  ds_read_b64_tr_b16 v[30:31], v13 offset:27904
  v_mfma_f32_16x16x32_bf16 v[132:135], v[16:19], v[52:55], v[132:135]
  v_mfma_f32_16x16x32_bf16 v[136:139], v[16:19], v[56:59], v[136:139]
  v_mfma_f32_16x16x32_bf16 v[140:143], v[16:19], v[60:63], v[140:143]
  s_waitcnt lgkmcnt(4)
  v_mfma_f32_16x16x32_bf16 v[144:147], v[20:23], v[48:51], v[144:147]
  ds_read_b64_tr_b16 v[16:17], v13 offset:23552
  ds_read_b64_tr_b16 v[18:19], v13 offset:23808
  v_mfma_f32_16x16x32_bf16 v[148:151], v[20:23], v[52:55], v[148:151]
  v_mfma_f32_16x16x32_bf16 v[152:155], v[20:23], v[56:59], v[152:155]
  v_mfma_f32_16x16x32_bf16 v[156:159], v[20:23], v[60:63], v[156:159]
  s_waitcnt lgkmcnt(4)
  v_mfma_f32_16x16x32_bf16 v[160:163], v[24:27], v[48:51], v[160:163]
  ds_read_b64_tr_b16 v[20:21], v13 offset:28672
  ds_read_b64_tr_b16 v[22:23], v13 offset:28928
  v_mfma_f32_16x16x32_bf16 v[164:167], v[24:27], v[52:55], v[164:167]
  v_mfma_f32_16x16x32_bf16 v[168:171], v[24:27], v[56:59], v[168:171]
  v_mfma_f32_16x16x32_bf16 v[172:175], v[24:27], v[60:63], v[172:175]
  s_waitcnt lgkmcnt(4)
  v_mfma_f32_16x16x32_bf16 v[176:179], v[28:31], v[48:51], v[176:179]
  ds_read_b64_tr_b16 v[24:25], v13 offset:24576
  ds_read_b64_tr_b16 v[26:27], v13 offset:24832
  v_mfma_f32_16x16x32_bf16 v[180:183], v[28:31], v[52:55], v[180:183]
  v_mfma_f32_16x16x32_bf16 v[184:187], v[28:31], v[56:59], v[184:187]
  v_mfma_f32_16x16x32_bf16 v[188:191], v[28:31], v[60:63], v[188:191]
  v_mfma_f32_16x16x32_bf16 v[72:75], v[28:31], v[64:67], v[72:75]
  s_waitcnt lgkmcnt(4)
  v_mfma_f32_16x16x32_bf16 v[192:195], v[16:19], v[48:51], v[192:195]
  ds_read_b64_tr_b16 v[28:29], v13 offset:29696
  ds_read_b64_tr_b16 v[30:31], v13 offset:29952
  v_mfma_f32_16x16x32_bf16 v[196:199], v[16:19], v[52:55], v[196:199]
  v_mfma_f32_16x16x32_bf16 v[200:203], v[16:19], v[56:59], v[200:203]
  v_mfma_f32_16x16x32_bf16 v[204:207], v[16:19], v[60:63], v[204:207]
  s_waitcnt vmcnt(6) lgkmcnt(4)
  s_barrier
  v_mfma_f32_16x16x32_bf16 v[208:211], v[20:23], v[48:51], v[208:211]
  ds_read_b64_tr_b16 v[16:17], v14 offset:0
  ds_read_b64_tr_b16 v[18:19], v14 offset:256
  v_mfma_f32_16x16x32_bf16 v[212:215], v[20:23], v[52:55], v[212:215]
  ds_read_b128 v[32:35], v4 offset:4096
  v_mfma_f32_16x16x32_bf16 v[216:219], v[20:23], v[56:59], v[216:219]
  ds_read_b128 v[36:39], v4 offset:6144
  s_add_u32 m0, s36, 0
  s_nop 0
  buffer_load_dwordx4 v8, s[16:19], s33 offen lds
  s_add_u32 s33, s33, s43
  v_mfma_f32_16x16x32_bf16 v[220:223], v[20:23], v[60:63], v[220:223]
  s_waitcnt lgkmcnt(6)
  v_mfma_f32_16x16x32_bf16 v[224:227], v[24:27], v[48:51], v[224:227]
  ds_read_b64_tr_b16 v[20:21], v14 offset:5120
  ds_read_b64_tr_b16 v[22:23], v14 offset:5376
  v_mfma_f32_16x16x32_bf16 v[228:231], v[24:27], v[52:55], v[228:231]
  ds_read_b128 v[40:43], v5 offset:4096
  v_mfma_f32_16x16x32_bf16 v[232:235], v[24:27], v[56:59], v[232:235]
  ds_read_b128 v[44:47], v5 offset:6144
  v_mfma_f32_16x16x32_bf16 v[236:239], v[24:27], v[60:63], v[236:239]
  s_add_u32 m0, s37, 0
  s_nop 0
  buffer_load_dwordx4 v9, s[20:23], s34 offen lds
  s_add_u32 s34, s34, s44
  s_waitcnt lgkmcnt(8)
  v_mfma_f32_16x16x32_bf16 v[240:243], v[28:31], v[48:51], v[240:243]
  ds_read_b64_tr_b16 v[24:25], v14 offset:1024
  ds_read_b64_tr_b16 v[26:27], v14 offset:1280
  v_mfma_f32_16x16x32_bf16 v[244:247], v[28:31], v[52:55], v[244:247]
  v_mfma_f32_16x16x32_bf16 v[248:251], v[28:31], v[56:59], v[248:251]
  v_mfma_f32_16x16x32_bf16 v[252:255], v[28:31], v[60:63], v[252:255]
  v_mfma_f32_16x16x32_bf16 v[76:79], v[28:31], v[64:67], v[76:79]
  s_waitcnt lgkmcnt(2)
  v_mfma_f32_16x16x32_bf16 v[96:99], v[16:19], v[32:35], v[96:99]
  ds_read_b64_tr_b16 v[28:29], v14 offset:6144
  ds_read_b64_tr_b16 v[30:31], v14 offset:6400
  s_cmp_ge_u32 s28, 4
  s_cbranch_scc1 gemm1_kernel_sk17
  s_add_u32 m0, s38, 0
  s_nop 0
  buffer_load_dwordx4 v10, s[24:27], s35 offen lds
  s_add_u32 s35, s35, s45
  gemm1_kernel_sk17:
  v_mfma_f32_16x16x32_bf16 v[100:103], v[16:19], v[36:39], v[100:103]
  v_mfma_f32_16x16x32_bf16 v[104:107], v[16:19], v[40:43], v[104:107]
  v_mfma_f32_16x16x32_bf16 v[108:111], v[16:19], v[44:47], v[108:111]
  s_waitcnt lgkmcnt(4)
  v_mfma_f32_16x16x32_bf16 v[112:115], v[20:23], v[32:35], v[112:115]
  ds_read_b64_tr_b16 v[16:17], v14 offset:2048
  ds_read_b64_tr_b16 v[18:19], v14 offset:2304
  v_mfma_f32_16x16x32_bf16 v[116:119], v[20:23], v[36:39], v[116:119]
  s_add_u32 m0, s39, 0
  s_nop 0
  buffer_load_dwordx4 v11, s[60:63], s41 offen lds
  v_mfma_f32_16x16x32_bf16 v[120:123], v[20:23], v[40:43], v[120:123]
  v_mfma_f32_16x16x32_bf16 v[124:127], v[20:23], v[44:47], v[124:127]
  v_mfma_f32_16x16x32_bf16 v[68:71], v[20:23], v[64:67], v[68:71]
  s_waitcnt lgkmcnt(4)
  v_mfma_f32_16x16x32_bf16 v[128:131], v[24:27], v[32:35], v[128:131]
  ds_read_b64_tr_b16 v[20:21], v14 offset:7168
  ds_read_b64_tr_b16 v[22:23], v14 offset:7424
  v_mfma_f32_16x16x32_bf16 v[132:135], v[24:27], v[36:39], v[132:135]
  v_mfma_f32_16x16x32_bf16 v[136:139], v[24:27], v[40:43], v[136:139]
  s_add_u32 m0, s39, 1024
  s_nop 0
  buffer_load_dwordx4 v12, s[60:63], s41 offen lds
  v_mfma_f32_16x16x32_bf16 v[140:143], v[24:27], v[44:47], v[140:143]
  s_waitcnt lgkmcnt(4)
  v_mfma_f32_16x16x32_bf16 v[144:147], v[28:31], v[32:35], v[144:147]
  ds_read_b64_tr_b16 v[24:25], v14 offset:3072
  ds_read_b64_tr_b16 v[26:27], v14 offset:3328
  v_mfma_f32_16x16x32_bf16 v[148:151], v[28:31], v[36:39], v[148:151]
  v_mfma_f32_16x16x32_bf16 v[152:155], v[28:31], v[40:43], v[152:155]
  v_mfma_f32_16x16x32_bf16 v[156:159], v[28:31], v[44:47], v[156:159]
  s_add_u32 m0, s39, 2048
  s_nop 0
  buffer_load_dwordx4 v11, s[60:63], s42 offen lds
  s_waitcnt lgkmcnt(4)
  v_mfma_f32_16x16x32_bf16 v[160:163], v[16:19], v[32:35], v[160:163]
  ds_read_b64_tr_b16 v[28:29], v14 offset:8192
  ds_read_b64_tr_b16 v[30:31], v14 offset:8448
  v_mfma_f32_16x16x32_bf16 v[164:167], v[16:19], v[36:39], v[164:167]
  v_mfma_f32_16x16x32_bf16 v[168:171], v[16:19], v[40:43], v[168:171]
  v_mfma_f32_16x16x32_bf16 v[172:175], v[16:19], v[44:47], v[172:175]
  s_waitcnt lgkmcnt(4)
  v_mfma_f32_16x16x32_bf16 v[176:179], v[20:23], v[32:35], v[176:179]
  ds_read_b64_tr_b16 v[16:17], v14 offset:4096
  ds_read_b64_tr_b16 v[18:19], v14 offset:4352
  s_add_u32 m0, s39, 3072
  s_nop 0
  buffer_load_dwordx4 v12, s[60:63], s42 offen lds
  s_add_u32 s41, s41, 128
  s_add_u32 s42, s42, 128
  v_mfma_f32_16x16x32_bf16 v[180:183], v[20:23], v[36:39], v[180:183]
  v_mfma_f32_16x16x32_bf16 v[184:187], v[20:23], v[40:43], v[184:187]
  v_mfma_f32_16x16x32_bf16 v[188:191], v[20:23], v[44:47], v[188:191]
  v_mfma_f32_16x16x32_bf16 v[72:75], v[20:23], v[64:67], v[72:75]
  s_waitcnt lgkmcnt(4)
  v_mfma_f32_16x16x32_bf16 v[192:195], v[24:27], v[32:35], v[192:195]
  ds_read_b64_tr_b16 v[20:21], v14 offset:9216
  ds_read_b64_tr_b16 v[22:23], v14 offset:9472
  v_mfma_f32_16x16x32_bf16 v[196:199], v[24:27], v[36:39], v[196:199]
  v_mfma_f32_16x16x32_bf16 v[200:203], v[24:27], v[40:43], v[200:203]
  v_mfma_f32_16x16x32_bf16 v[204:207], v[24:27], v[44:47], v[204:207]
  s_waitcnt vmcnt(7) lgkmcnt(4)
  s_barrier
  v_mfma_f32_16x16x32_bf16 v[208:211], v[28:31], v[32:35], v[208:211]
  ds_read_b64_tr_b16 v[24:25], v14 offset:20480
  ds_read_b64_tr_b16 v[26:27], v14 offset:20736
  v_mfma_f32_16x16x32_bf16 v[212:215], v[28:31], v[36:39], v[212:215]
  ds_read_b128 v[48:51], v6 offset:4096
  v_mfma_f32_16x16x32_bf16 v[216:219], v[28:31], v[40:43], v[216:219]
  ds_read_b128 v[52:55], v6 offset:6144
  s_add_u32 m0, s36, 20480
  s_nop 0
  buffer_load_dwordx4 v8, s[16:19], s33 offen lds
  s_add_u32 s33, s33, s43
  v_mfma_f32_16x16x32_bf16 v[220:223], v[28:31], v[44:47], v[220:223]
  s_waitcnt lgkmcnt(6)
  v_mfma_f32_16x16x32_bf16 v[224:227], v[16:19], v[32:35], v[224:227]
  ds_read_b64_tr_b16 v[28:29], v14 offset:25600
  ds_read_b64_tr_b16 v[30:31], v14 offset:25856
  v_mfma_f32_16x16x32_bf16 v[228:231], v[16:19], v[36:39], v[228:231]
  ds_read_b128 v[56:59], v7 offset:4096
  v_mfma_f32_16x16x32_bf16 v[232:235], v[16:19], v[40:43], v[232:235]
  ds_read_b128 v[60:63], v7 offset:6144
  v_mfma_f32_16x16x32_bf16 v[236:239], v[16:19], v[44:47], v[236:239]
  s_add_u32 m0, s37, 20480
  s_nop 0
  buffer_load_dwordx4 v9, s[20:23], s34 offen lds
  s_add_u32 s34, s34, s44
  s_waitcnt lgkmcnt(8)
  v_mfma_f32_16x16x32_bf16 v[240:243], v[20:23], v[32:35], v[240:243]
  ds_read_b64_tr_b16 v[16:17], v14 offset:21504
  ds_read_b64_tr_b16 v[18:19], v14 offset:21760
  v_mfma_f32_16x16x32_bf16 v[244:247], v[20:23], v[36:39], v[244:247]
  v_mfma_f32_16x16x32_bf16 v[248:251], v[20:23], v[40:43], v[248:251]
  v_mfma_f32_16x16x32_bf16 v[252:255], v[20:23], v[44:47], v[252:255]
  v_mfma_f32_16x16x32_bf16 v[76:79], v[20:23], v[64:67], v[76:79]
  s_waitcnt lgkmcnt(2)
  v_mfma_f32_16x16x32_bf16 v[96:99], v[24:27], v[48:51], v[96:99]
  ds_read_b64_tr_b16 v[20:21], v14 offset:26624
  ds_read_b64_tr_b16 v[22:23], v14 offset:26880
  s_cmp_ge_u32 s28, 4
  s_cbranch_scc1 gemm1_kernel_sk18
  s_add_u32 m0, s38, 20480
  s_nop 0
  buffer_load_dwordx4 v10, s[24:27], s35 offen lds
  s_add_u32 s35, s35, s45
  gemm1_kernel_sk18:
  v_mfma_f32_16x16x32_bf16 v[100:103], v[24:27], v[52:55], v[100:103]
  v_mfma_f32_16x16x32_bf16 v[104:107], v[24:27], v[56:59], v[104:107]
  v_mfma_f32_16x16x32_bf16 v[108:111], v[24:27], v[60:63], v[108:111]
  s_waitcnt lgkmcnt(4)
  v_mfma_f32_16x16x32_bf16 v[112:115], v[28:31], v[48:51], v[112:115]
  ds_read_b64_tr_b16 v[24:25], v14 offset:22528
  ds_read_b64_tr_b16 v[26:27], v14 offset:22784
  v_mfma_f32_16x16x32_bf16 v[116:119], v[28:31], v[52:55], v[116:119]
  buffer_load_dword v88, v89, s[64:67], s97 offen
  s_add_u32 s97, s97, s98
  v_mfma_f32_16x16x32_bf16 v[120:123], v[28:31], v[56:59], v[120:123]
  v_mfma_f32_16x16x32_bf16 v[124:127], v[28:31], v[60:63], v[124:127]
  v_mfma_f32_16x16x32_bf16 v[68:71], v[28:31], v[64:67], v[68:71]
  s_waitcnt lgkmcnt(4)
  v_mfma_f32_16x16x32_bf16 v[128:131], v[16:19], v[48:51], v[128:131]
  ds_read_b64_tr_b16 v[28:29], v14 offset:27648
  ds_read_b64_tr_b16 v[30:31], v14 offset:27904
  v_mfma_f32_16x16x32_bf16 v[132:135], v[16:19], v[52:55], v[132:135]
  v_mfma_f32_16x16x32_bf16 v[136:139], v[16:19], v[56:59], v[136:139]
  v_mfma_f32_16x16x32_bf16 v[140:143], v[16:19], v[60:63], v[140:143]
  s_waitcnt lgkmcnt(4)
  v_mfma_f32_16x16x32_bf16 v[144:147], v[20:23], v[48:51], v[144:147]
  ds_read_b64_tr_b16 v[16:17], v14 offset:23552
  ds_read_b64_tr_b16 v[18:19], v14 offset:23808
  v_mfma_f32_16x16x32_bf16 v[148:151], v[20:23], v[52:55], v[148:151]
  v_mfma_f32_16x16x32_bf16 v[152:155], v[20:23], v[56:59], v[152:155]
  v_mfma_f32_16x16x32_bf16 v[156:159], v[20:23], v[60:63], v[156:159]
  s_waitcnt lgkmcnt(4)
  v_mfma_f32_16x16x32_bf16 v[160:163], v[24:27], v[48:51], v[160:163]
  ds_read_b64_tr_b16 v[20:21], v14 offset:28672
  ds_read_b64_tr_b16 v[22:23], v14 offset:28928
  v_mfma_f32_16x16x32_bf16 v[164:167], v[24:27], v[52:55], v[164:167]
  v_mfma_f32_16x16x32_bf16 v[168:171], v[24:27], v[56:59], v[168:171]
  v_mfma_f32_16x16x32_bf16 v[172:175], v[24:27], v[60:63], v[172:175]
  s_waitcnt lgkmcnt(4)
  v_mfma_f32_16x16x32_bf16 v[176:179], v[28:31], v[48:51], v[176:179]
  ds_read_b64_tr_b16 v[24:25], v14 offset:24576
  ds_read_b64_tr_b16 v[26:27], v14 offset:24832
  v_mfma_f32_16x16x32_bf16 v[180:183], v[28:31], v[52:55], v[180:183]
  v_mfma_f32_16x16x32_bf16 v[184:187], v[28:31], v[56:59], v[184:187]
  v_mfma_f32_16x16x32_bf16 v[188:191], v[28:31], v[60:63], v[188:191]
  v_mfma_f32_16x16x32_bf16 v[72:75], v[28:31], v[64:67], v[72:75]
  s_waitcnt lgkmcnt(4)
  v_mfma_f32_16x16x32_bf16 v[192:195], v[16:19], v[48:51], v[192:195]
  ds_read_b64_tr_b16 v[28:29], v14 offset:29696
  ds_read_b64_tr_b16 v[30:31], v14 offset:29952
  v_mfma_f32_16x16x32_bf16 v[196:199], v[16:19], v[52:55], v[196:199]
  v_mfma_f32_16x16x32_bf16 v[200:203], v[16:19], v[56:59], v[200:203]
  v_mfma_f32_16x16x32_bf16 v[204:207], v[16:19], v[60:63], v[204:207]
  s_waitcnt vmcnt(3) lgkmcnt(4)
  s_barrier
  v_mfma_f32_16x16x32_bf16 v[208:211], v[20:23], v[48:51], v[208:211]
  ds_read_b64_tr_b16 v[16:17], v13 offset:0
  ds_read_b64_tr_b16 v[18:19], v13 offset:256
  v_mfma_f32_16x16x32_bf16 v[212:215], v[20:23], v[52:55], v[212:215]
  ds_read_b128 v[32:35], v4 offset:0
  v_mfma_f32_16x16x32_bf16 v[216:219], v[20:23], v[56:59], v[216:219]
  ds_read_b128 v[36:39], v4 offset:2048
  s_add_u32 m0, s36, 40960
  s_nop 0
  buffer_load_dwordx4 v8, s[16:19], s33 offen lds
  s_add_u32 s33, s33, s43
  v_mfma_f32_16x16x32_bf16 v[220:223], v[20:23], v[60:63], v[220:223]
  s_waitcnt lgkmcnt(6)
  v_mfma_f32_16x16x32_bf16 v[224:227], v[24:27], v[48:51], v[224:227]
  ds_read_b64_tr_b16 v[20:21], v13 offset:5120
  ds_read_b64_tr_b16 v[22:23], v13 offset:5376
  v_mfma_f32_16x16x32_bf16 v[228:231], v[24:27], v[52:55], v[228:231]
  ds_read_b128 v[40:43], v5 offset:0
  v_mfma_f32_16x16x32_bf16 v[232:235], v[24:27], v[56:59], v[232:235]
  ds_read_b128 v[44:47], v5 offset:2048
  v_mfma_f32_16x16x32_bf16 v[236:239], v[24:27], v[60:63], v[236:239]
  s_add_u32 m0, s37, 40960
  s_nop 0
  buffer_load_dwordx4 v9, s[20:23], s34 offen lds
  s_add_u32 s34, s34, s44
  s_waitcnt lgkmcnt(8)
  v_mfma_f32_16x16x32_bf16 v[240:243], v[28:31], v[48:51], v[240:243]
  ds_read_b64_tr_b16 v[24:25], v13 offset:1024
  ds_read_b64_tr_b16 v[26:27], v13 offset:1280
  v_mfma_f32_16x16x32_bf16 v[244:247], v[28:31], v[52:55], v[244:247]
  v_mfma_f32_16x16x32_bf16 v[248:251], v[28:31], v[56:59], v[248:251]
  v_mfma_f32_16x16x32_bf16 v[252:255], v[28:31], v[60:63], v[252:255]
  v_mfma_f32_16x16x32_bf16 v[76:79], v[28:31], v[64:67], v[76:79]
gemm1_kernel_loop1:
  s_waitcnt lgkmcnt(2)
  v_mfma_f32_16x16x32_bf16 v[96:99], v[16:19], v[32:35], v[96:99]
  ds_read_b64_tr_b16 v[28:29], v13 offset:6144
  ds_read_b64_tr_b16 v[30:31], v13 offset:6400
  s_cmp_ge_u32 s28, 4
  s_cbranch_scc1 gemm1_kernel_sk19
  s_add_u32 m0, s38, 40960
  s_nop 0
  buffer_load_dwordx4 v10, s[24:27], s35 offen lds
  s_add_u32 s35, s35, s45
  gemm1_kernel_sk19:
  v_mfma_f32_16x16x32_bf16 v[100:103], v[16:19], v[36:39], v[100:103]
  v_mfma_f32_16x16x32_bf16 v[104:107], v[16:19], v[40:43], v[104:107]
  v_mfma_f32_16x16x32_bf16 v[108:111], v[16:19], v[44:47], v[108:111]
  s_waitcnt lgkmcnt(4)
  v_mfma_f32_16x16x32_bf16 v[112:115], v[20:23], v[32:35], v[112:115]
  ds_read_b64_tr_b16 v[16:17], v13 offset:2048
  ds_read_b64_tr_b16 v[18:19], v13 offset:2304
  v_mfma_f32_16x16x32_bf16 v[116:119], v[20:23], v[36:39], v[116:119]
  s_add_u32 m0, s39, 4096
  s_nop 0
  buffer_load_dwordx4 v11, s[60:63], s41 offen lds
  v_mfma_f32_16x16x32_bf16 v[120:123], v[20:23], v[40:43], v[120:123]
  v_mfma_f32_16x16x32_bf16 v[124:127], v[20:23], v[44:47], v[124:127]
  v_mfma_f32_16x16x32_bf16 v[68:71], v[20:23], v[64:67], v[68:71]
  s_waitcnt lgkmcnt(4)
  v_mfma_f32_16x16x32_bf16 v[128:131], v[24:27], v[32:35], v[128:131]
  ds_read_b64_tr_b16 v[20:21], v13 offset:7168
  ds_read_b64_tr_b16 v[22:23], v13 offset:7424
  v_mfma_f32_16x16x32_bf16 v[132:135], v[24:27], v[36:39], v[132:135]
  v_mfma_f32_16x16x32_bf16 v[136:139], v[24:27], v[40:43], v[136:139]
  s_add_u32 m0, s39, 5120
  s_nop 0
  buffer_load_dwordx4 v12, s[60:63], s41 offen lds
  v_mfma_f32_16x16x32_bf16 v[140:143], v[24:27], v[44:47], v[140:143]
  s_waitcnt lgkmcnt(4)
  v_mfma_f32_16x16x32_bf16 v[144:147], v[28:31], v[32:35], v[144:147]
  ds_read_b64_tr_b16 v[24:25], v13 offset:3072
  ds_read_b64_tr_b16 v[26:27], v13 offset:3328
  v_mfma_f32_16x16x32_bf16 v[148:151], v[28:31], v[36:39], v[148:151]
  v_mfma_f32_16x16x32_bf16 v[152:155], v[28:31], v[40:43], v[152:155]
  v_mfma_f32_16x16x32_bf16 v[156:159], v[28:31], v[44:47], v[156:159]
  s_add_u32 m0, s39, 6144
  s_nop 0
  buffer_load_dwordx4 v11, s[60:63], s42 offen lds
  s_waitcnt lgkmcnt(4)
  v_mfma_f32_16x16x32_bf16 v[160:163], v[16:19], v[32:35], v[160:163]
  ds_read_b64_tr_b16 v[28:29], v13 offset:8192
  ds_read_b64_tr_b16 v[30:31], v13 offset:8448
  v_mfma_f32_16x16x32_bf16 v[164:167], v[16:19], v[36:39], v[164:167]
  v_mfma_f32_16x16x32_bf16 v[168:171], v[16:19], v[40:43], v[168:171]
  v_mfma_f32_16x16x32_bf16 v[172:175], v[16:19], v[44:47], v[172:175]
  s_waitcnt lgkmcnt(4)
  v_mfma_f32_16x16x32_bf16 v[176:179], v[20:23], v[32:35], v[176:179]
  ds_read_b64_tr_b16 v[16:17], v13 offset:4096
  ds_read_b64_tr_b16 v[18:19], v13 offset:4352
  s_add_u32 m0, s39, 7168
  s_nop 0
  buffer_load_dwordx4 v12, s[60:63], s42 offen lds
  s_add_u32 s41, s41, 128
  s_add_u32 s42, s42, 128
  v_mfma_f32_16x16x32_bf16 v[180:183], v[20:23], v[36:39], v[180:183]
  v_mfma_f32_16x16x32_bf16 v[184:187], v[20:23], v[40:43], v[184:187]
  v_mfma_f32_16x16x32_bf16 v[188:191], v[20:23], v[44:47], v[188:191]
  v_mfma_f32_16x16x32_bf16 v[72:75], v[20:23], v[64:67], v[72:75]
  s_waitcnt lgkmcnt(4)
  v_mfma_f32_16x16x32_bf16 v[192:195], v[24:27], v[32:35], v[192:195]
  ds_read_b64_tr_b16 v[20:21], v13 offset:9216
  ds_read_b64_tr_b16 v[22:23], v13 offset:9472
  v_mfma_f32_16x16x32_bf16 v[196:199], v[24:27], v[36:39], v[196:199]
  v_mfma_f32_16x16x32_bf16 v[200:203], v[24:27], v[40:43], v[200:203]
  v_mfma_f32_16x16x32_bf16 v[204:207], v[24:27], v[44:47], v[204:207]
  s_waitcnt vmcnt(7) lgkmcnt(4)
  s_barrier
  v_mfma_f32_16x16x32_bf16 v[208:211], v[28:31], v[32:35], v[208:211]
  ds_read_b64_tr_b16 v[24:25], v13 offset:20480
  ds_read_b64_tr_b16 v[26:27], v13 offset:20736
  v_mfma_f32_16x16x32_bf16 v[212:215], v[28:31], v[36:39], v[212:215]
  ds_read_b128 v[48:51], v6 offset:0
  v_mfma_f32_16x16x32_bf16 v[216:219], v[28:31], v[40:43], v[216:219]
  ds_read_b128 v[52:55], v6 offset:2048
  s_add_u32 m0, s36, 61440
  s_nop 0
  buffer_load_dwordx4 v8, s[16:19], s33 offen lds
  s_add_u32 s33, s33, s43
  v_mfma_f32_16x16x32_bf16 v[220:223], v[28:31], v[44:47], v[220:223]
  s_waitcnt lgkmcnt(6)
  v_mfma_f32_16x16x32_bf16 v[224:227], v[16:19], v[32:35], v[224:227]
  ds_read_b64_tr_b16 v[28:29], v13 offset:25600
  ds_read_b64_tr_b16 v[30:31], v13 offset:25856
  v_mfma_f32_16x16x32_bf16 v[228:231], v[16:19], v[36:39], v[228:231]
  ds_read_b128 v[56:59], v7 offset:0
  v_mfma_f32_16x16x32_bf16 v[232:235], v[16:19], v[40:43], v[232:235]
  ds_read_b128 v[60:63], v7 offset:2048
  v_mfma_f32_16x16x32_bf16 v[236:239], v[16:19], v[44:47], v[236:239]
  s_add_u32 m0, s37, 61440
  s_nop 0
  buffer_load_dwordx4 v9, s[20:23], s34 offen lds
  s_add_u32 s34, s34, s44
  s_waitcnt lgkmcnt(8)
  v_mfma_f32_16x16x32_bf16 v[240:243], v[20:23], v[32:35], v[240:243]
  ds_read_b64_tr_b16 v[16:17], v13 offset:21504
  ds_read_b64_tr_b16 v[18:19], v13 offset:21760
  v_mfma_f32_16x16x32_bf16 v[244:247], v[20:23], v[36:39], v[244:247]
  v_mfma_f32_16x16x32_bf16 v[248:251], v[20:23], v[40:43], v[248:251]
  v_mfma_f32_16x16x32_bf16 v[252:255], v[20:23], v[44:47], v[252:255]
  v_mfma_f32_16x16x32_bf16 v[76:79], v[20:23], v[64:67], v[76:79]
  s_waitcnt lgkmcnt(2)
  v_mfma_f32_16x16x32_bf16 v[96:99], v[24:27], v[48:51], v[96:99]
  ds_read_b64_tr_b16 v[20:21], v13 offset:26624
  ds_read_b64_tr_b16 v[22:23], v13 offset:26880
  s_cmp_ge_u32 s28, 4
  s_cbranch_scc1 gemm1_kernel_sk20
  s_add_u32 m0, s38, 61440
  s_nop 0
  buffer_load_dwordx4 v10, s[24:27], s35 offen lds
  s_add_u32 s35, s35, s45
  gemm1_kernel_sk20:
  v_mfma_f32_16x16x32_bf16 v[100:103], v[24:27], v[52:55], v[100:103]
  v_mfma_f32_16x16x32_bf16 v[104:107], v[24:27], v[56:59], v[104:107]
  v_mfma_f32_16x16x32_bf16 v[108:111], v[24:27], v[60:63], v[108:111]
  s_waitcnt lgkmcnt(4)
  v_mfma_f32_16x16x32_bf16 v[112:115], v[28:31], v[48:51], v[112:115]
  ds_read_b64_tr_b16 v[24:25], v13 offset:22528
  ds_read_b64_tr_b16 v[26:27], v13 offset:22784
  v_mfma_f32_16x16x32_bf16 v[116:119], v[28:31], v[52:55], v[116:119]
  buffer_load_dword v88, v89, s[64:67], s97 offen
  s_add_u32 s97, s97, s98
  v_mfma_f32_16x16x32_bf16 v[120:123], v[28:31], v[56:59], v[120:123]
  v_mfma_f32_16x16x32_bf16 v[124:127], v[28:31], v[60:63], v[124:127]
  v_mfma_f32_16x16x32_bf16 v[68:71], v[28:31], v[64:67], v[68:71]
  s_waitcnt lgkmcnt(4)
  v_mfma_f32_16x16x32_bf16 v[128:131], v[16:19], v[48:51], v[128:131]
  ds_read_b64_tr_b16 v[28:29], v13 offset:27648
  ds_read_b64_tr_b16 v[30:31], v13 offset:27904
  v_mfma_f32_16x16x32_bf16 v[132:135], v[16:19], v[52:55], v[132:135]
  v_mfma_f32_16x16x32_bf16 v[136:139], v[16:19], v[56:59], v[136:139]
  v_mfma_f32_16x16x32_bf16 v[140:143], v[16:19], v[60:63], v[140:143]
  s_waitcnt lgkmcnt(4)
  v_mfma_f32_16x16x32_bf16 v[144:147], v[20:23], v[48:51], v[144:147]
  ds_read_b64_tr_b16 v[16:17], v13 offset:23552
  ds_read_b64_tr_b16 v[18:19], v13 offset:23808
  v_mfma_f32_16x16x32_bf16 v[148:151], v[20:23], v[52:55], v[148:151]
  v_mfma_f32_16x16x32_bf16 v[152:155], v[20:23], v[56:59], v[152:155]
  v_mfma_f32_16x16x32_bf16 v[156:159], v[20:23], v[60:63], v[156:159]
  s_waitcnt lgkmcnt(4)
  v_mfma_f32_16x16x32_bf16 v[160:163], v[24:27], v[48:51], v[160:163]
  ds_read_b64_tr_b16 v[20:21], v13 offset:28672
  ds_read_b64_tr_b16 v[22:23], v13 offset:28928
  v_mfma_f32_16x16x32_bf16 v[164:167], v[24:27], v[52:55], v[164:167]
  v_mfma_f32_16x16x32_bf16 v[168:171], v[24:27], v[56:59], v[168:171]
  v_mfma_f32_16x16x32_bf16 v[172:175], v[24:27], v[60:63], v[172:175]
  s_waitcnt lgkmcnt(4)
  v_mfma_f32_16x16x32_bf16 v[176:179], v[28:31], v[48:51], v[176:179]
  ds_read_b64_tr_b16 v[24:25], v13 offset:24576
  ds_read_b64_tr_b16 v[26:27], v13 offset:24832
  v_mfma_f32_16x16x32_bf16 v[180:183], v[28:31], v[52:55], v[180:183]
  v_mfma_f32_16x16x32_bf16 v[184:187], v[28:31], v[56:59], v[184:187]
  v_mfma_f32_16x16x32_bf16 v[188:191], v[28:31], v[60:63], v[188:191]
  v_mfma_f32_16x16x32_bf16 v[72:75], v[28:31], v[64:67], v[72:75]
  s_waitcnt lgkmcnt(4)
  v_mfma_f32_16x16x32_bf16 v[192:195], v[16:19], v[48:51], v[192:195]
  ds_read_b64_tr_b16 v[28:29], v13 offset:29696
  ds_read_b64_tr_b16 v[30:31], v13 offset:29952
  v_mfma_f32_16x16x32_bf16 v[196:199], v[16:19], v[52:55], v[196:199]
  v_mfma_f32_16x16x32_bf16 v[200:203], v[16:19], v[56:59], v[200:203]
  v_mfma_f32_16x16x32_bf16 v[204:207], v[16:19], v[60:63], v[204:207]
  s_waitcnt vmcnt(3) lgkmcnt(4)
  s_barrier
  v_mfma_f32_16x16x32_bf16 v[208:211], v[20:23], v[48:51], v[208:211]
  ds_read_b64_tr_b16 v[16:17], v14 offset:0
  ds_read_b64_tr_b16 v[18:19], v14 offset:256
  v_mfma_f32_16x16x32_bf16 v[212:215], v[20:23], v[52:55], v[212:215]
  ds_read_b128 v[32:35], v4 offset:4096
  v_mfma_f32_16x16x32_bf16 v[216:219], v[20:23], v[56:59], v[216:219]
  ds_read_b128 v[36:39], v4 offset:6144
  s_add_u32 m0, s36, 0
  s_nop 0
  buffer_load_dwordx4 v8, s[16:19], s33 offen lds
  s_add_u32 s33, s33, s43
  v_mfma_f32_16x16x32_bf16 v[220:223], v[20:23], v[60:63], v[220:223]
  s_waitcnt lgkmcnt(6)
  v_mfma_f32_16x16x32_bf16 v[224:227], v[24:27], v[48:51], v[224:227]
  ds_read_b64_tr_b16 v[20:21], v14 offset:5120
  ds_read_b64_tr_b16 v[22:23], v14 offset:5376
  v_mfma_f32_16x16x32_bf16 v[228:231], v[24:27], v[52:55], v[228:231]
  ds_read_b128 v[40:43], v5 offset:4096
  v_mfma_f32_16x16x32_bf16 v[232:235], v[24:27], v[56:59], v[232:235]
  ds_read_b128 v[44:47], v5 offset:6144
  v_mfma_f32_16x16x32_bf16 v[236:239], v[24:27], v[60:63], v[236:239]
  s_add_u32 m0, s37, 0
  s_nop 0
  buffer_load_dwordx4 v9, s[20:23], s34 offen lds
  s_add_u32 s34, s34, s44
  s_waitcnt lgkmcnt(8)
  v_mfma_f32_16x16x32_bf16 v[240:243], v[28:31], v[48:51], v[240:243]
  ds_read_b64_tr_b16 v[24:25], v14 offset:1024
  ds_read_b64_tr_b16 v[26:27], v14 offset:1280
  v_mfma_f32_16x16x32_bf16 v[244:247], v[28:31], v[52:55], v[244:247]
  v_mfma_f32_16x16x32_bf16 v[248:251], v[28:31], v[56:59], v[248:251]
  v_mfma_f32_16x16x32_bf16 v[252:255], v[28:31], v[60:63], v[252:255]
  v_mfma_f32_16x16x32_bf16 v[76:79], v[28:31], v[64:67], v[76:79]
  s_waitcnt lgkmcnt(2)
  v_mfma_f32_16x16x32_bf16 v[96:99], v[16:19], v[32:35], v[96:99]
  ds_read_b64_tr_b16 v[28:29], v14 offset:6144
  ds_read_b64_tr_b16 v[30:31], v14 offset:6400
  s_cmp_ge_u32 s28, 4
  s_cbranch_scc1 gemm1_kernel_sk21
  s_add_u32 m0, s38, 0
  s_nop 0
  buffer_load_dwordx4 v10, s[24:27], s35 offen lds
  s_add_u32 s35, s35, s45
  gemm1_kernel_sk21:
  v_mfma_f32_16x16x32_bf16 v[100:103], v[16:19], v[36:39], v[100:103]
  v_mfma_f32_16x16x32_bf16 v[104:107], v[16:19], v[40:43], v[104:107]
  v_mfma_f32_16x16x32_bf16 v[108:111], v[16:19], v[44:47], v[108:111]
  s_waitcnt lgkmcnt(4)
  v_mfma_f32_16x16x32_bf16 v[112:115], v[20:23], v[32:35], v[112:115]
  ds_read_b64_tr_b16 v[16:17], v14 offset:2048
  ds_read_b64_tr_b16 v[18:19], v14 offset:2304
  v_mfma_f32_16x16x32_bf16 v[116:119], v[20:23], v[36:39], v[116:119]
  s_add_u32 m0, s39, 0
  s_nop 0
  buffer_load_dwordx4 v11, s[60:63], s41 offen lds
  v_mfma_f32_16x16x32_bf16 v[120:123], v[20:23], v[40:43], v[120:123]
  v_mfma_f32_16x16x32_bf16 v[124:127], v[20:23], v[44:47], v[124:127]
  v_mfma_f32_16x16x32_bf16 v[68:71], v[20:23], v[64:67], v[68:71]
  s_waitcnt lgkmcnt(4)
  v_mfma_f32_16x16x32_bf16 v[128:131], v[24:27], v[32:35], v[128:131]
  ds_read_b64_tr_b16 v[20:21], v14 offset:7168
  ds_read_b64_tr_b16 v[22:23], v14 offset:7424
  v_mfma_f32_16x16x32_bf16 v[132:135], v[24:27], v[36:39], v[132:135]
  v_mfma_f32_16x16x32_bf16 v[136:139], v[24:27], v[40:43], v[136:139]
  s_add_u32 m0, s39, 1024
  s_nop 0
  buffer_load_dwordx4 v12, s[60:63], s41 offen lds
  v_mfma_f32_16x16x32_bf16 v[140:143], v[24:27], v[44:47], v[140:143]
  s_waitcnt lgkmcnt(4)
  v_mfma_f32_16x16x32_bf16 v[144:147], v[28:31], v[32:35], v[144:147]
  ds_read_b64_tr_b16 v[24:25], v14 offset:3072
  ds_read_b64_tr_b16 v[26:27], v14 offset:3328
  v_mfma_f32_16x16x32_bf16 v[148:151], v[28:31], v[36:39], v[148:151]
  v_mfma_f32_16x16x32_bf16 v[152:155], v[28:31], v[40:43], v[152:155]
  v_mfma_f32_16x16x32_bf16 v[156:159], v[28:31], v[44:47], v[156:159]
  s_add_u32 m0, s39, 2048
  s_nop 0
  buffer_load_dwordx4 v11, s[60:63], s42 offen lds
  s_waitcnt lgkmcnt(4)
  v_mfma_f32_16x16x32_bf16 v[160:163], v[16:19], v[32:35], v[160:163]
  ds_read_b64_tr_b16 v[28:29], v14 offset:8192
  ds_read_b64_tr_b16 v[30:31], v14 offset:8448
  v_mfma_f32_16x16x32_bf16 v[164:167], v[16:19], v[36:39], v[164:167]
  v_mfma_f32_16x16x32_bf16 v[168:171], v[16:19], v[40:43], v[168:171]
  v_mfma_f32_16x16x32_bf16 v[172:175], v[16:19], v[44:47], v[172:175]
  s_waitcnt lgkmcnt(4)
  v_mfma_f32_16x16x32_bf16 v[176:179], v[20:23], v[32:35], v[176:179]
  ds_read_b64_tr_b16 v[16:17], v14 offset:4096
  ds_read_b64_tr_b16 v[18:19], v14 offset:4352
  s_add_u32 m0, s39, 3072
  s_nop 0
  buffer_load_dwordx4 v12, s[60:63], s42 offen lds
  s_add_u32 s41, s41, 128
  s_add_u32 s42, s42, 128
  v_mfma_f32_16x16x32_bf16 v[180:183], v[20:23], v[36:39], v[180:183]
  v_mfma_f32_16x16x32_bf16 v[184:187], v[20:23], v[40:43], v[184:187]
  v_mfma_f32_16x16x32_bf16 v[188:191], v[20:23], v[44:47], v[188:191]
  v_mfma_f32_16x16x32_bf16 v[72:75], v[20:23], v[64:67], v[72:75]
  s_waitcnt lgkmcnt(4)
  v_mfma_f32_16x16x32_bf16 v[192:195], v[24:27], v[32:35], v[192:195]
  ds_read_b64_tr_b16 v[20:21], v14 offset:9216
  ds_read_b64_tr_b16 v[22:23], v14 offset:9472
  v_mfma_f32_16x16x32_bf16 v[196:199], v[24:27], v[36:39], v[196:199]
  v_mfma_f32_16x16x32_bf16 v[200:203], v[24:27], v[40:43], v[200:203]
  v_mfma_f32_16x16x32_bf16 v[204:207], v[24:27], v[44:47], v[204:207]
  s_waitcnt vmcnt(7) lgkmcnt(4)
  s_barrier
  v_mfma_f32_16x16x32_bf16 v[208:211], v[28:31], v[32:35], v[208:211]
  ds_read_b64_tr_b16 v[24:25], v14 offset:20480
  ds_read_b64_tr_b16 v[26:27], v14 offset:20736
  v_mfma_f32_16x16x32_bf16 v[212:215], v[28:31], v[36:39], v[212:215]
  ds_read_b128 v[48:51], v6 offset:4096
  v_mfma_f32_16x16x32_bf16 v[216:219], v[28:31], v[40:43], v[216:219]
  ds_read_b128 v[52:55], v6 offset:6144
  s_add_u32 m0, s36, 20480
  s_nop 0
  buffer_load_dwordx4 v8, s[16:19], s33 offen lds
  s_add_u32 s33, s33, s43
  v_mfma_f32_16x16x32_bf16 v[220:223], v[28:31], v[44:47], v[220:223]
  s_waitcnt lgkmcnt(6)
  v_mfma_f32_16x16x32_bf16 v[224:227], v[16:19], v[32:35], v[224:227]
  ds_read_b64_tr_b16 v[28:29], v14 offset:25600
  ds_read_b64_tr_b16 v[30:31], v14 offset:25856
  v_mfma_f32_16x16x32_bf16 v[228:231], v[16:19], v[36:39], v[228:231]
  ds_read_b128 v[56:59], v7 offset:4096
  v_mfma_f32_16x16x32_bf16 v[232:235], v[16:19], v[40:43], v[232:235]
  ds_read_b128 v[60:63], v7 offset:6144
  v_mfma_f32_16x16x32_bf16 v[236:239], v[16:19], v[44:47], v[236:239]
  s_add_u32 m0, s37, 20480
  s_nop 0
  buffer_load_dwordx4 v9, s[20:23], s34 offen lds
  s_add_u32 s34, s34, s44
  s_waitcnt lgkmcnt(8)
  v_mfma_f32_16x16x32_bf16 v[240:243], v[20:23], v[32:35], v[240:243]
  ds_read_b64_tr_b16 v[16:17], v14 offset:21504
  ds_read_b64_tr_b16 v[18:19], v14 offset:21760
  v_mfma_f32_16x16x32_bf16 v[244:247], v[20:23], v[36:39], v[244:247]
  v_mfma_f32_16x16x32_bf16 v[248:251], v[20:23], v[40:43], v[248:251]
  v_mfma_f32_16x16x32_bf16 v[252:255], v[20:23], v[44:47], v[252:255]
  v_mfma_f32_16x16x32_bf16 v[76:79], v[20:23], v[64:67], v[76:79]
  s_waitcnt lgkmcnt(2)
  v_mfma_f32_16x16x32_bf16 v[96:99], v[24:27], v[48:51], v[96:99]
  ds_read_b64_tr_b16 v[20:21], v14 offset:26624
  ds_read_b64_tr_b16 v[22:23], v14 offset:26880
  s_cmp_ge_u32 s28, 4
  s_cbranch_scc1 gemm1_kernel_sk22
  s_add_u32 m0, s38, 20480
  s_nop 0
  buffer_load_dwordx4 v10, s[24:27], s35 offen lds
  s_add_u32 s35, s35, s45
  gemm1_kernel_sk22:
  v_mfma_f32_16x16x32_bf16 v[100:103], v[24:27], v[52:55], v[100:103]
  v_mfma_f32_16x16x32_bf16 v[104:107], v[24:27], v[56:59], v[104:107]
  v_mfma_f32_16x16x32_bf16 v[108:111], v[24:27], v[60:63], v[108:111]
  s_waitcnt lgkmcnt(4)
  v_mfma_f32_16x16x32_bf16 v[112:115], v[28:31], v[48:51], v[112:115]
  ds_read_b64_tr_b16 v[24:25], v14 offset:22528
  ds_read_b64_tr_b16 v[26:27], v14 offset:22784
  v_mfma_f32_16x16x32_bf16 v[116:119], v[28:31], v[52:55], v[116:119]
  buffer_load_dword v88, v89, s[64:67], s97 offen
  s_add_u32 s97, s97, s98
  v_mfma_f32_16x16x32_bf16 v[120:123], v[28:31], v[56:59], v[120:123]
  v_mfma_f32_16x16x32_bf16 v[124:127], v[28:31], v[60:63], v[124:127]
  v_mfma_f32_16x16x32_bf16 v[68:71], v[28:31], v[64:67], v[68:71]
  s_waitcnt lgkmcnt(4)
  v_mfma_f32_16x16x32_bf16 v[128:131], v[16:19], v[48:51], v[128:131]
  ds_read_b64_tr_b16 v[28:29], v14 offset:27648
  ds_read_b64_tr_b16 v[30:31], v14 offset:27904
  v_mfma_f32_16x16x32_bf16 v[132:135], v[16:19], v[52:55], v[132:135]
  v_mfma_f32_16x16x32_bf16 v[136:139], v[16:19], v[56:59], v[136:139]
  v_mfma_f32_16x16x32_bf16 v[140:143], v[16:19], v[60:63], v[140:143]
  s_waitcnt lgkmcnt(4)
  v_mfma_f32_16x16x32_bf16 v[144:147], v[20:23], v[48:51], v[144:147]
  ds_read_b64_tr_b16 v[16:17], v14 offset:23552
  ds_read_b64_tr_b16 v[18:19], v14 offset:23808
  v_mfma_f32_16x16x32_bf16 v[148:151], v[20:23], v[52:55], v[148:151]
  v_mfma_f32_16x16x32_bf16 v[152:155], v[20:23], v[56:59], v[152:155]
  v_mfma_f32_16x16x32_bf16 v[156:159], v[20:23], v[60:63], v[156:159]
  s_waitcnt lgkmcnt(4)
  v_mfma_f32_16x16x32_bf16 v[160:163], v[24:27], v[48:51], v[160:163]
  ds_read_b64_tr_b16 v[20:21], v14 offset:28672
  ds_read_b64_tr_b16 v[22:23], v14 offset:28928
  v_mfma_f32_16x16x32_bf16 v[164:167], v[24:27], v[52:55], v[164:167]
  v_mfma_f32_16x16x32_bf16 v[168:171], v[24:27], v[56:59], v[168:171]
  v_mfma_f32_16x16x32_bf16 v[172:175], v[24:27], v[60:63], v[172:175]
  s_waitcnt lgkmcnt(4)
  v_mfma_f32_16x16x32_bf16 v[176:179], v[28:31], v[48:51], v[176:179]
  ds_read_b64_tr_b16 v[24:25], v14 offset:24576
  ds_read_b64_tr_b16 v[26:27], v14 offset:24832
  v_mfma_f32_16x16x32_bf16 v[180:183], v[28:31], v[52:55], v[180:183]
  v_mfma_f32_16x16x32_bf16 v[184:187], v[28:31], v[56:59], v[184:187]
  v_mfma_f32_16x16x32_bf16 v[188:191], v[28:31], v[60:63], v[188:191]
  v_mfma_f32_16x16x32_bf16 v[72:75], v[28:31], v[64:67], v[72:75]
  s_waitcnt lgkmcnt(4)
  v_mfma_f32_16x16x32_bf16 v[192:195], v[16:19], v[48:51], v[192:195]
  ds_read_b64_tr_b16 v[28:29], v14 offset:29696
  ds_read_b64_tr_b16 v[30:31], v14 offset:29952
  v_mfma_f32_16x16x32_bf16 v[196:199], v[16:19], v[52:55], v[196:199]
  v_mfma_f32_16x16x32_bf16 v[200:203], v[16:19], v[56:59], v[200:203]
  v_mfma_f32_16x16x32_bf16 v[204:207], v[16:19], v[60:63], v[204:207]
  s_waitcnt vmcnt(3) lgkmcnt(4)
  s_barrier
  v_mfma_f32_16x16x32_bf16 v[208:211], v[20:23], v[48:51], v[208:211]
  ds_read_b64_tr_b16 v[16:17], v13 offset:0
  ds_read_b64_tr_b16 v[18:19], v13 offset:256
  v_mfma_f32_16x16x32_bf16 v[212:215], v[20:23], v[52:55], v[212:215]
  ds_read_b128 v[32:35], v4 offset:0
  v_mfma_f32_16x16x32_bf16 v[216:219], v[20:23], v[56:59], v[216:219]
  ds_read_b128 v[36:39], v4 offset:2048
  s_add_u32 m0, s36, 40960
  s_nop 0
  buffer_load_dwordx4 v8, s[16:19], s33 offen lds
  s_add_u32 s33, s33, s43
  v_mfma_f32_16x16x32_bf16 v[220:223], v[20:23], v[60:63], v[220:223]
  s_waitcnt lgkmcnt(6)
  v_mfma_f32_16x16x32_bf16 v[224:227], v[24:27], v[48:51], v[224:227]
  ds_read_b64_tr_b16 v[20:21], v13 offset:5120
  ds_read_b64_tr_b16 v[22:23], v13 offset:5376
  v_mfma_f32_16x16x32_bf16 v[228:231], v[24:27], v[52:55], v[228:231]
  ds_read_b128 v[40:43], v5 offset:0
  v_mfma_f32_16x16x32_bf16 v[232:235], v[24:27], v[56:59], v[232:235]
  ds_read_b128 v[44:47], v5 offset:2048
  v_mfma_f32_16x16x32_bf16 v[236:239], v[24:27], v[60:63], v[236:239]
  s_add_u32 m0, s37, 40960
  s_nop 0
  buffer_load_dwordx4 v9, s[20:23], s34 offen lds
  s_add_u32 s34, s34, s44
  s_waitcnt lgkmcnt(8)
  v_mfma_f32_16x16x32_bf16 v[240:243], v[28:31], v[48:51], v[240:243]
  ds_read_b64_tr_b16 v[24:25], v13 offset:1024
  ds_read_b64_tr_b16 v[26:27], v13 offset:1280
  v_mfma_f32_16x16x32_bf16 v[244:247], v[28:31], v[52:55], v[244:247]
  v_mfma_f32_16x16x32_bf16 v[248:251], v[28:31], v[56:59], v[248:251]
  v_mfma_f32_16x16x32_bf16 v[252:255], v[28:31], v[60:63], v[252:255]
  v_mfma_f32_16x16x32_bf16 v[76:79], v[28:31], v[64:67], v[76:79]
  s_sub_u32 s40, s40, 1
  s_cmp_lg_u32 s40, 0
  s_cbranch_scc1 gemm1_kernel_loop1
  s_lshl_b32 s55, s32, 2
  buffer_load_dword v1, v15, s[68:71], s55 offen sc1
  s_lshl_b32 s47, s32, 11
  s_lshl_b32 s48, s30, 9
  s_add_u32 s47, s47, s48
  s_lshl_b32 s48, s29, 8
  s_add_u32 s47, s47, s48
  s_add_u32 s47, s47, 41943040
  v_and_b32 v94, 15, v2
  v_lshlrev_b32 v94, 3, v94
  v_add_u32 v94, s47, v94
  v_xor_b32 v95, 256, v94
  s_waitcnt lgkmcnt(2)
  v_mfma_f32_16x16x32_bf16 v[96:99], v[16:19], v[32:35], v[96:99]
  ds_read_b64_tr_b16 v[28:29], v13 offset:6144
  ds_read_b64_tr_b16 v[30:31], v13 offset:6400
  s_cmp_ge_u32 s28, 4
  s_cbranch_scc1 gemm1_kernel_sk23
  s_add_u32 m0, s38, 40960
  s_nop 0
  buffer_load_dwordx4 v10, s[24:27], s35 offen lds
  s_add_u32 s35, s35, s45
  gemm1_kernel_sk23:
  v_mfma_f32_16x16x32_bf16 v[100:103], v[16:19], v[36:39], v[100:103]
  v_mfma_f32_16x16x32_bf16 v[104:107], v[16:19], v[40:43], v[104:107]
  v_mfma_f32_16x16x32_bf16 v[108:111], v[16:19], v[44:47], v[108:111]
  s_waitcnt lgkmcnt(4)
  v_mfma_f32_16x16x32_bf16 v[112:115], v[20:23], v[32:35], v[112:115]
  ds_read_b64_tr_b16 v[16:17], v13 offset:2048
  ds_read_b64_tr_b16 v[18:19], v13 offset:2304
  v_mfma_f32_16x16x32_bf16 v[116:119], v[20:23], v[36:39], v[116:119]
  s_add_u32 m0, s39, 4096
  s_nop 0
  buffer_load_dwordx4 v11, s[60:63], s41 offen lds
  v_mfma_f32_16x16x32_bf16 v[120:123], v[20:23], v[40:43], v[120:123]
  v_mfma_f32_16x16x32_bf16 v[124:127], v[20:23], v[44:47], v[124:127]
  v_mfma_f32_16x16x32_bf16 v[68:71], v[20:23], v[64:67], v[68:71]
  s_waitcnt lgkmcnt(4)
  v_mfma_f32_16x16x32_bf16 v[128:131], v[24:27], v[32:35], v[128:131]
  ds_read_b64_tr_b16 v[20:21], v13 offset:7168
  ds_read_b64_tr_b16 v[22:23], v13 offset:7424
  v_mfma_f32_16x16x32_bf16 v[132:135], v[24:27], v[36:39], v[132:135]
  v_mfma_f32_16x16x32_bf16 v[136:139], v[24:27], v[40:43], v[136:139]
  s_add_u32 m0, s39, 5120
  s_nop 0
  buffer_load_dwordx4 v12, s[60:63], s41 offen lds
  v_mfma_f32_16x16x32_bf16 v[140:143], v[24:27], v[44:47], v[140:143]
  s_waitcnt lgkmcnt(4)
  v_mfma_f32_16x16x32_bf16 v[144:147], v[28:31], v[32:35], v[144:147]
  ds_read_b64_tr_b16 v[24:25], v13 offset:3072
  ds_read_b64_tr_b16 v[26:27], v13 offset:3328
  v_mfma_f32_16x16x32_bf16 v[148:151], v[28:31], v[36:39], v[148:151]
  v_mfma_f32_16x16x32_bf16 v[152:155], v[28:31], v[40:43], v[152:155]
  v_mfma_f32_16x16x32_bf16 v[156:159], v[28:31], v[44:47], v[156:159]
  s_add_u32 m0, s39, 6144
  s_nop 0
  buffer_load_dwordx4 v11, s[60:63], s42 offen lds
  s_waitcnt lgkmcnt(4)
  v_mfma_f32_16x16x32_bf16 v[160:163], v[16:19], v[32:35], v[160:163]
  ds_read_b64_tr_b16 v[28:29], v13 offset:8192
  ds_read_b64_tr_b16 v[30:31], v13 offset:8448
  v_mfma_f32_16x16x32_bf16 v[164:167], v[16:19], v[36:39], v[164:167]
  v_mfma_f32_16x16x32_bf16 v[168:171], v[16:19], v[40:43], v[168:171]
  v_mfma_f32_16x16x32_bf16 v[172:175], v[16:19], v[44:47], v[172:175]
  s_waitcnt lgkmcnt(4)
  v_mfma_f32_16x16x32_bf16 v[176:179], v[20:23], v[32:35], v[176:179]
  ds_read_b64_tr_b16 v[16:17], v13 offset:4096
  ds_read_b64_tr_b16 v[18:19], v13 offset:4352
  s_add_u32 m0, s39, 7168
  s_nop 0
  buffer_load_dwordx4 v12, s[60:63], s42 offen lds
  s_add_u32 s41, s41, 128
  s_add_u32 s42, s42, 128
  v_mfma_f32_16x16x32_bf16 v[180:183], v[20:23], v[36:39], v[180:183]
  v_mfma_f32_16x16x32_bf16 v[184:187], v[20:23], v[40:43], v[184:187]
  v_mfma_f32_16x16x32_bf16 v[188:191], v[20:23], v[44:47], v[188:191]
  v_mfma_f32_16x16x32_bf16 v[72:75], v[20:23], v[64:67], v[72:75]
  s_waitcnt lgkmcnt(4)
  v_mfma_f32_16x16x32_bf16 v[192:195], v[24:27], v[32:35], v[192:195]
  ds_read_b64_tr_b16 v[20:21], v13 offset:9216
  ds_read_b64_tr_b16 v[22:23], v13 offset:9472
  v_mfma_f32_16x16x32_bf16 v[196:199], v[24:27], v[36:39], v[196:199]
  v_mfma_f32_16x16x32_bf16 v[200:203], v[24:27], v[40:43], v[200:203]
  v_mfma_f32_16x16x32_bf16 v[204:207], v[24:27], v[44:47], v[204:207]
  s_waitcnt vmcnt(8) lgkmcnt(4)
  s_barrier
  v_mfma_f32_16x16x32_bf16 v[208:211], v[28:31], v[32:35], v[208:211]
  ds_read_b64_tr_b16 v[24:25], v13 offset:20480
  ds_read_b64_tr_b16 v[26:27], v13 offset:20736
  v_mfma_f32_16x16x32_bf16 v[212:215], v[28:31], v[36:39], v[212:215]
  ds_read_b128 v[48:51], v6 offset:0
  v_mfma_f32_16x16x32_bf16 v[216:219], v[28:31], v[40:43], v[216:219]
  ds_read_b128 v[52:55], v6 offset:2048
  s_add_u32 m0, s36, 61440
  s_nop 0
  buffer_load_dwordx4 v8, s[16:19], s33 offen lds
  s_add_u32 s33, s33, s43
  v_mfma_f32_16x16x32_bf16 v[220:223], v[28:31], v[44:47], v[220:223]
  s_waitcnt lgkmcnt(6)
  v_mfma_f32_16x16x32_bf16 v[224:227], v[16:19], v[32:35], v[224:227]
  ds_read_b64_tr_b16 v[28:29], v13 offset:25600
  ds_read_b64_tr_b16 v[30:31], v13 offset:25856
  v_mfma_f32_16x16x32_bf16 v[228:231], v[16:19], v[36:39], v[228:231]
  ds_read_b128 v[56:59], v7 offset:0
  v_mfma_f32_16x16x32_bf16 v[232:235], v[16:19], v[40:43], v[232:235]
  ds_read_b128 v[60:63], v7 offset:2048
  v_mfma_f32_16x16x32_bf16 v[236:239], v[16:19], v[44:47], v[236:239]
  s_add_u32 m0, s37, 61440
  s_nop 0
  buffer_load_dwordx4 v9, s[20:23], s34 offen lds
  s_add_u32 s34, s34, s44
  s_waitcnt lgkmcnt(8)
  v_mfma_f32_16x16x32_bf16 v[240:243], v[20:23], v[32:35], v[240:243]
  ds_read_b64_tr_b16 v[16:17], v13 offset:21504
  ds_read_b64_tr_b16 v[18:19], v13 offset:21760
  v_mfma_f32_16x16x32_bf16 v[244:247], v[20:23], v[36:39], v[244:247]
  v_mfma_f32_16x16x32_bf16 v[248:251], v[20:23], v[40:43], v[248:251]
  v_mfma_f32_16x16x32_bf16 v[252:255], v[20:23], v[44:47], v[252:255]
  v_mfma_f32_16x16x32_bf16 v[76:79], v[20:23], v[64:67], v[76:79]
  s_waitcnt lgkmcnt(2)
  v_mfma_f32_16x16x32_bf16 v[96:99], v[24:27], v[48:51], v[96:99]
  ds_read_b64_tr_b16 v[20:21], v13 offset:26624
  ds_read_b64_tr_b16 v[22:23], v13 offset:26880
  s_cmp_ge_u32 s28, 4
  s_cbranch_scc1 gemm1_kernel_sk24
  s_add_u32 m0, s38, 61440
  s_nop 0
  buffer_load_dwordx4 v10, s[24:27], s35 offen lds
  s_add_u32 s35, s35, s45
  gemm1_kernel_sk24:
  v_mfma_f32_16x16x32_bf16 v[100:103], v[24:27], v[52:55], v[100:103]
  v_mfma_f32_16x16x32_bf16 v[104:107], v[24:27], v[56:59], v[104:107]
  v_mfma_f32_16x16x32_bf16 v[108:111], v[24:27], v[60:63], v[108:111]
  s_waitcnt lgkmcnt(4)
  v_mfma_f32_16x16x32_bf16 v[112:115], v[28:31], v[48:51], v[112:115]
  ds_read_b64_tr_b16 v[24:25], v13 offset:22528
  ds_read_b64_tr_b16 v[26:27], v13 offset:22784
  v_mfma_f32_16x16x32_bf16 v[116:119], v[28:31], v[52:55], v[116:119]
  v_mfma_f32_16x16x32_bf16 v[120:123], v[28:31], v[56:59], v[120:123]
  v_mfma_f32_16x16x32_bf16 v[124:127], v[28:31], v[60:63], v[124:127]
  v_mfma_f32_16x16x32_bf16 v[68:71], v[28:31], v[64:67], v[68:71]
  s_waitcnt lgkmcnt(4)
  v_mfma_f32_16x16x32_bf16 v[128:131], v[16:19], v[48:51], v[128:131]
  ds_read_b64_tr_b16 v[28:29], v13 offset:27648
  ds_read_b64_tr_b16 v[30:31], v13 offset:27904
  v_mfma_f32_16x16x32_bf16 v[132:135], v[16:19], v[52:55], v[132:135]
  v_mfma_f32_16x16x32_bf16 v[136:139], v[16:19], v[56:59], v[136:139]
  v_mfma_f32_16x16x32_bf16 v[140:143], v[16:19], v[60:63], v[140:143]
  s_waitcnt lgkmcnt(4)
  v_mfma_f32_16x16x32_bf16 v[144:147], v[20:23], v[48:51], v[144:147]
  ds_read_b64_tr_b16 v[16:17], v13 offset:23552
  ds_read_b64_tr_b16 v[18:19], v13 offset:23808
  v_mfma_f32_16x16x32_bf16 v[148:151], v[20:23], v[52:55], v[148:151]
  v_mfma_f32_16x16x32_bf16 v[152:155], v[20:23], v[56:59], v[152:155]
  v_mfma_f32_16x16x32_bf16 v[156:159], v[20:23], v[60:63], v[156:159]
  s_waitcnt lgkmcnt(4)
  v_mfma_f32_16x16x32_bf16 v[160:163], v[24:27], v[48:51], v[160:163]
  ds_read_b64_tr_b16 v[20:21], v13 offset:28672
  ds_read_b64_tr_b16 v[22:23], v13 offset:28928
  v_mfma_f32_16x16x32_bf16 v[164:167], v[24:27], v[52:55], v[164:167]
  v_mfma_f32_16x16x32_bf16 v[168:171], v[24:27], v[56:59], v[168:171]
  v_mfma_f32_16x16x32_bf16 v[172:175], v[24:27], v[60:63], v[172:175]
  s_waitcnt lgkmcnt(4)
  v_mfma_f32_16x16x32_bf16 v[176:179], v[28:31], v[48:51], v[176:179]
  ds_read_b64_tr_b16 v[24:25], v13 offset:24576
  ds_read_b64_tr_b16 v[26:27], v13 offset:24832
  v_mfma_f32_16x16x32_bf16 v[180:183], v[28:31], v[52:55], v[180:183]
  v_mfma_f32_16x16x32_bf16 v[184:187], v[28:31], v[56:59], v[184:187]
  v_mfma_f32_16x16x32_bf16 v[188:191], v[28:31], v[60:63], v[188:191]
  v_mfma_f32_16x16x32_bf16 v[72:75], v[28:31], v[64:67], v[72:75]
  s_waitcnt lgkmcnt(4)
  v_mfma_f32_16x16x32_bf16 v[192:195], v[16:19], v[48:51], v[192:195]
  ds_read_b64_tr_b16 v[28:29], v13 offset:29696
  ds_read_b64_tr_b16 v[30:31], v13 offset:29952
  v_mfma_f32_16x16x32_bf16 v[196:199], v[16:19], v[52:55], v[196:199]
  v_mfma_f32_16x16x32_bf16 v[200:203], v[16:19], v[56:59], v[200:203]
  v_mfma_f32_16x16x32_bf16 v[204:207], v[16:19], v[60:63], v[204:207]
  s_waitcnt vmcnt(2) lgkmcnt(4)
  s_barrier
  v_mfma_f32_16x16x32_bf16 v[208:211], v[20:23], v[48:51], v[208:211]
  ds_read_b64_tr_b16 v[16:17], v14 offset:0
  ds_read_b64_tr_b16 v[18:19], v14 offset:256
  v_mfma_f32_16x16x32_bf16 v[212:215], v[20:23], v[52:55], v[212:215]
  ds_read_b128 v[32:35], v4 offset:4096
  v_mfma_f32_16x16x32_bf16 v[216:219], v[20:23], v[56:59], v[216:219]
  ds_read_b128 v[36:39], v4 offset:6144
  v_mfma_f32_16x16x32_bf16 v[220:223], v[20:23], v[60:63], v[220:223]
  s_waitcnt lgkmcnt(6)
  v_mfma_f32_16x16x32_bf16 v[224:227], v[24:27], v[48:51], v[224:227]
  ds_read_b64_tr_b16 v[20:21], v14 offset:5120
  ds_read_b64_tr_b16 v[22:23], v14 offset:5376
  v_mfma_f32_16x16x32_bf16 v[228:231], v[24:27], v[52:55], v[228:231]
  ds_read_b128 v[40:43], v5 offset:4096
  v_mfma_f32_16x16x32_bf16 v[232:235], v[24:27], v[56:59], v[232:235]
  ds_read_b128 v[44:47], v5 offset:6144
  v_mfma_f32_16x16x32_bf16 v[236:239], v[24:27], v[60:63], v[236:239]
  s_waitcnt lgkmcnt(8)
  v_mfma_f32_16x16x32_bf16 v[240:243], v[28:31], v[48:51], v[240:243]
  ds_read_b64_tr_b16 v[24:25], v14 offset:1024
  ds_read_b64_tr_b16 v[26:27], v14 offset:1280
  v_mfma_f32_16x16x32_bf16 v[244:247], v[28:31], v[52:55], v[244:247]
  v_mfma_f32_16x16x32_bf16 v[248:251], v[28:31], v[56:59], v[248:251]
  v_mfma_f32_16x16x32_bf16 v[252:255], v[28:31], v[60:63], v[252:255]
  v_mfma_f32_16x16x32_bf16 v[76:79], v[28:31], v[64:67], v[76:79]
  s_waitcnt vmcnt(6)
  v_readfirstlane_b32 s58, v1
  buffer_load_dwordx2 v[80:81], v94, s[12:15], 0 offen offset:0 sc1
  buffer_load_dwordx2 v[82:83], v94, s[12:15], 0 offen offset:128 sc1
  buffer_load_dwordx2 v[84:85], v95, s[12:15], 0 offen offset:0 sc1
  buffer_load_dwordx2 v[86:87], v95, s[12:15], 0 offen offset:128 sc1
  s_waitcnt lgkmcnt(2)
  v_mfma_f32_16x16x32_bf16 v[96:99], v[16:19], v[32:35], v[96:99]
  ds_read_b64_tr_b16 v[28:29], v14 offset:6144
  ds_read_b64_tr_b16 v[30:31], v14 offset:6400
  v_mfma_f32_16x16x32_bf16 v[100:103], v[16:19], v[36:39], v[100:103]
  v_mfma_f32_16x16x32_bf16 v[104:107], v[16:19], v[40:43], v[104:107]
  v_mfma_f32_16x16x32_bf16 v[108:111], v[16:19], v[44:47], v[108:111]
  s_waitcnt lgkmcnt(4)
  v_mfma_f32_16x16x32_bf16 v[112:115], v[20:23], v[32:35], v[112:115]
  ds_read_b64_tr_b16 v[16:17], v14 offset:2048
  ds_read_b64_tr_b16 v[18:19], v14 offset:2304
  v_mfma_f32_16x16x32_bf16 v[116:119], v[20:23], v[36:39], v[116:119]
  v_mfma_f32_16x16x32_bf16 v[120:123], v[20:23], v[40:43], v[120:123]
  v_mfma_f32_16x16x32_bf16 v[124:127], v[20:23], v[44:47], v[124:127]
  v_mfma_f32_16x16x32_bf16 v[68:71], v[20:23], v[64:67], v[68:71]
  s_waitcnt lgkmcnt(4)
  v_mfma_f32_16x16x32_bf16 v[128:131], v[24:27], v[32:35], v[128:131]
  ds_read_b64_tr_b16 v[20:21], v14 offset:7168
  ds_read_b64_tr_b16 v[22:23], v14 offset:7424
  v_mfma_f32_16x16x32_bf16 v[132:135], v[24:27], v[36:39], v[132:135]
  v_mfma_f32_16x16x32_bf16 v[136:139], v[24:27], v[40:43], v[136:139]
  v_mfma_f32_16x16x32_bf16 v[140:143], v[24:27], v[44:47], v[140:143]
  s_waitcnt lgkmcnt(4)
  v_mfma_f32_16x16x32_bf16 v[144:147], v[28:31], v[32:35], v[144:147]
  ds_read_b64_tr_b16 v[24:25], v14 offset:3072
  ds_read_b64_tr_b16 v[26:27], v14 offset:3328
  v_mfma_f32_16x16x32_bf16 v[148:151], v[28:31], v[36:39], v[148:151]
  v_mfma_f32_16x16x32_bf16 v[152:155], v[28:31], v[40:43], v[152:155]
  v_mfma_f32_16x16x32_bf16 v[156:159], v[28:31], v[44:47], v[156:159]
  s_waitcnt lgkmcnt(4)
  v_mfma_f32_16x16x32_bf16 v[160:163], v[16:19], v[32:35], v[160:163]
  ds_read_b64_tr_b16 v[28:29], v14 offset:8192
  ds_read_b64_tr_b16 v[30:31], v14 offset:8448
  v_mfma_f32_16x16x32_bf16 v[164:167], v[16:19], v[36:39], v[164:167]
  v_mfma_f32_16x16x32_bf16 v[168:171], v[16:19], v[40:43], v[168:171]
  v_mfma_f32_16x16x32_bf16 v[172:175], v[16:19], v[44:47], v[172:175]
  s_waitcnt lgkmcnt(4)
  v_mfma_f32_16x16x32_bf16 v[176:179], v[20:23], v[32:35], v[176:179]
  ds_read_b64_tr_b16 v[16:17], v14 offset:4096
  ds_read_b64_tr_b16 v[18:19], v14 offset:4352
  v_mfma_f32_16x16x32_bf16 v[180:183], v[20:23], v[36:39], v[180:183]
  v_mfma_f32_16x16x32_bf16 v[184:187], v[20:23], v[40:43], v[184:187]
  v_mfma_f32_16x16x32_bf16 v[188:191], v[20:23], v[44:47], v[188:191]
  v_mfma_f32_16x16x32_bf16 v[72:75], v[20:23], v[64:67], v[72:75]
  s_waitcnt lgkmcnt(4)
  v_mfma_f32_16x16x32_bf16 v[192:195], v[24:27], v[32:35], v[192:195]
  ds_read_b64_tr_b16 v[20:21], v14 offset:9216
  ds_read_b64_tr_b16 v[22:23], v14 offset:9472
  v_mfma_f32_16x16x32_bf16 v[196:199], v[24:27], v[36:39], v[196:199]
  v_mfma_f32_16x16x32_bf16 v[200:203], v[24:27], v[40:43], v[200:203]
  v_mfma_f32_16x16x32_bf16 v[204:207], v[24:27], v[44:47], v[204:207]
  s_waitcnt vmcnt(4) lgkmcnt(4)
  s_barrier
  v_mfma_f32_16x16x32_bf16 v[208:211], v[28:31], v[32:35], v[208:211]
  ds_read_b64_tr_b16 v[24:25], v14 offset:20480
  ds_read_b64_tr_b16 v[26:27], v14 offset:20736
  v_mfma_f32_16x16x32_bf16 v[212:215], v[28:31], v[36:39], v[212:215]
  ds_read_b128 v[48:51], v6 offset:4096
  v_mfma_f32_16x16x32_bf16 v[216:219], v[28:31], v[40:43], v[216:219]
  ds_read_b128 v[52:55], v6 offset:6144
  v_mfma_f32_16x16x32_bf16 v[220:223], v[28:31], v[44:47], v[220:223]
  s_waitcnt lgkmcnt(6)
  v_mfma_f32_16x16x32_bf16 v[224:227], v[16:19], v[32:35], v[224:227]
  ds_read_b64_tr_b16 v[28:29], v14 offset:25600
  ds_read_b64_tr_b16 v[30:31], v14 offset:25856
  v_mfma_f32_16x16x32_bf16 v[228:231], v[16:19], v[36:39], v[228:231]
  ds_read_b128 v[56:59], v7 offset:4096
  v_mfma_f32_16x16x32_bf16 v[232:235], v[16:19], v[40:43], v[232:235]
  ds_read_b128 v[60:63], v7 offset:6144
  v_mfma_f32_16x16x32_bf16 v[236:239], v[16:19], v[44:47], v[236:239]
  s_waitcnt lgkmcnt(8)
  v_mfma_f32_16x16x32_bf16 v[240:243], v[20:23], v[32:35], v[240:243]
  ds_read_b64_tr_b16 v[16:17], v14 offset:21504
  ds_read_b64_tr_b16 v[18:19], v14 offset:21760
  v_mfma_f32_16x16x32_bf16 v[244:247], v[20:23], v[36:39], v[244:247]
  v_mfma_f32_16x16x32_bf16 v[248:251], v[20:23], v[40:43], v[248:251]
  v_mfma_f32_16x16x32_bf16 v[252:255], v[20:23], v[44:47], v[252:255]
  v_mfma_f32_16x16x32_bf16 v[76:79], v[20:23], v[64:67], v[76:79]
  s_waitcnt lgkmcnt(2)
  v_mfma_f32_16x16x32_bf16 v[96:99], v[24:27], v[48:51], v[96:99]
  ds_read_b64_tr_b16 v[20:21], v14 offset:26624
  ds_read_b64_tr_b16 v[22:23], v14 offset:26880
  v_mfma_f32_16x16x32_bf16 v[100:103], v[24:27], v[52:55], v[100:103]
  v_mfma_f32_16x16x32_bf16 v[104:107], v[24:27], v[56:59], v[104:107]
  v_mfma_f32_16x16x32_bf16 v[108:111], v[24:27], v[60:63], v[108:111]
  s_waitcnt lgkmcnt(4)
  v_mfma_f32_16x16x32_bf16 v[112:115], v[28:31], v[48:51], v[112:115]
  ds_read_b64_tr_b16 v[24:25], v14 offset:22528
  ds_read_b64_tr_b16 v[26:27], v14 offset:22784
  v_mfma_f32_16x16x32_bf16 v[116:119], v[28:31], v[52:55], v[116:119]
  v_mfma_f32_16x16x32_bf16 v[120:123], v[28:31], v[56:59], v[120:123]
  v_mfma_f32_16x16x32_bf16 v[124:127], v[28:31], v[60:63], v[124:127]
  v_mfma_f32_16x16x32_bf16 v[68:71], v[28:31], v[64:67], v[68:71]
  s_waitcnt lgkmcnt(4)
  v_mfma_f32_16x16x32_bf16 v[128:131], v[16:19], v[48:51], v[128:131]
  ds_read_b64_tr_b16 v[28:29], v14 offset:27648
  ds_read_b64_tr_b16 v[30:31], v14 offset:27904
  v_mfma_f32_16x16x32_bf16 v[132:135], v[16:19], v[52:55], v[132:135]
  v_mfma_f32_16x16x32_bf16 v[136:139], v[16:19], v[56:59], v[136:139]
  v_mfma_f32_16x16x32_bf16 v[140:143], v[16:19], v[60:63], v[140:143]
  s_waitcnt lgkmcnt(4)
  v_mfma_f32_16x16x32_bf16 v[144:147], v[20:23], v[48:51], v[144:147]
  ds_read_b64_tr_b16 v[16:17], v14 offset:23552
  ds_read_b64_tr_b16 v[18:19], v14 offset:23808
  v_mfma_f32_16x16x32_bf16 v[148:151], v[20:23], v[52:55], v[148:151]
  v_mfma_f32_16x16x32_bf16 v[152:155], v[20:23], v[56:59], v[152:155]
  v_mfma_f32_16x16x32_bf16 v[156:159], v[20:23], v[60:63], v[156:159]
  s_waitcnt lgkmcnt(4)
  v_mfma_f32_16x16x32_bf16 v[160:163], v[24:27], v[48:51], v[160:163]
  ds_read_b64_tr_b16 v[20:21], v14 offset:28672
  ds_read_b64_tr_b16 v[22:23], v14 offset:28928
  v_mfma_f32_16x16x32_bf16 v[164:167], v[24:27], v[52:55], v[164:167]
  v_mfma_f32_16x16x32_bf16 v[168:171], v[24:27], v[56:59], v[168:171]
  v_mfma_f32_16x16x32_bf16 v[172:175], v[24:27], v[60:63], v[172:175]
  s_waitcnt lgkmcnt(4)
  v_mfma_f32_16x16x32_bf16 v[176:179], v[28:31], v[48:51], v[176:179]
  ds_read_b64_tr_b16 v[24:25], v14 offset:24576
  ds_read_b64_tr_b16 v[26:27], v14 offset:24832
  v_mfma_f32_16x16x32_bf16 v[180:183], v[28:31], v[52:55], v[180:183]
  v_mfma_f32_16x16x32_bf16 v[184:187], v[28:31], v[56:59], v[184:187]
  v_mfma_f32_16x16x32_bf16 v[188:191], v[28:31], v[60:63], v[188:191]
  v_mfma_f32_16x16x32_bf16 v[72:75], v[28:31], v[64:67], v[72:75]
  s_waitcnt lgkmcnt(4)
  v_mfma_f32_16x16x32_bf16 v[192:195], v[16:19], v[48:51], v[192:195]
  ds_read_b64_tr_b16 v[28:29], v14 offset:29696
  ds_read_b64_tr_b16 v[30:31], v14 offset:29952
  v_mfma_f32_16x16x32_bf16 v[196:199], v[16:19], v[52:55], v[196:199]
  v_mfma_f32_16x16x32_bf16 v[200:203], v[16:19], v[56:59], v[200:203]
  v_mfma_f32_16x16x32_bf16 v[204:207], v[16:19], v[60:63], v[204:207]
  s_waitcnt lgkmcnt(4)
  v_mfma_f32_16x16x32_bf16 v[208:211], v[20:23], v[48:51], v[208:211]
  v_mfma_f32_16x16x32_bf16 v[212:215], v[20:23], v[52:55], v[212:215]
  v_mfma_f32_16x16x32_bf16 v[216:219], v[20:23], v[56:59], v[216:219]
  v_mfma_f32_16x16x32_bf16 v[220:223], v[20:23], v[60:63], v[220:223]
  s_waitcnt lgkmcnt(2)
  v_mfma_f32_16x16x32_bf16 v[224:227], v[24:27], v[48:51], v[224:227]
  v_mfma_f32_16x16x32_bf16 v[228:231], v[24:27], v[52:55], v[228:231]
  v_mfma_f32_16x16x32_bf16 v[232:235], v[24:27], v[56:59], v[232:235]
  v_mfma_f32_16x16x32_bf16 v[236:239], v[24:27], v[60:63], v[236:239]
  s_waitcnt lgkmcnt(0)
  v_mfma_f32_16x16x32_bf16 v[240:243], v[28:31], v[48:51], v[240:243]
  v_mfma_f32_16x16x32_bf16 v[244:247], v[28:31], v[52:55], v[244:247]
  v_mfma_f32_16x16x32_bf16 v[248:251], v[28:31], v[56:59], v[248:251]
  v_mfma_f32_16x16x32_bf16 v[252:255], v[28:31], v[60:63], v[252:255]
  v_mfma_f32_16x16x32_bf16 v[76:79], v[28:31], v[64:67], v[76:79]
  v_lshrrev_b32 v3, 4, v2
  s_mul_i32 s47, s29, 640
  s_add_u32 s47, s47, 147456
  v_lshlrev_b32 v10, 4, v3
  v_add_u32 v10, s47, v10
  s_nop 7

  ds_write_b128 v10, v[68:71] offset:64
  ds_write_b128 v10, v[72:75] offset:320
  ds_write_b128 v10, v[76:79] offset:576
  s_branch gemm1_kernel_epi
gemm1_kernel_p1_2:
  s_waitcnt lgkmcnt(4)
  v_mfma_f32_16x16x32_bf16 v[96:99], v[16:19], v[32:35], 0
  ds_read_b64_tr_b16 v[28:29], v13 offset:6144
  ds_read_b64_tr_b16 v[30:31], v13 offset:6400
  s_waitcnt vmcnt(0)
  s_mov_b32 s47, 0xffff0000
  v_lshlrev_b32 v232, 16, v224
  v_and_b32 v233, s47, v224
  v_mfma_f32_16x16x32_bf16 v[100:103], v[16:19], v[36:39], 0
  s_add_u32 m0, s36, 20480
  s_nop 0
  buffer_load_dwordx4 v8, s[16:19], s33 offen lds
  s_add_u32 s33, s33, s43
  v_lshlrev_b32 v234, 16, v225
  v_and_b32 v235, s47, v225
  v_lshlrev_b32 v236, 16, v226
  v_mfma_f32_16x16x32_bf16 v[104:107], v[16:19], v[40:43], 0
  v_and_b32 v237, s47, v226
  v_lshlrev_b32 v238, 16, v227
  v_and_b32 v239, s47, v227
  v_mfma_f32_16x16x32_bf16 v[108:111], v[16:19], v[44:47], 0
  s_add_u32 m0, s37, 20480
  s_nop 0
  buffer_load_dwordx4 v9, s[20:23], s34 offen lds
  s_add_u32 s34, s34, s44
  v_lshlrev_b32 v240, 16, v228
  v_and_b32 v241, s47, v228
  v_lshlrev_b32 v242, 16, v229
  s_waitcnt lgkmcnt(4)
  v_mfma_f32_16x16x32_bf16 v[112:115], v[20:23], v[32:35], 0
  ds_read_b64_tr_b16 v[16:17], v13 offset:2048
  ds_read_b64_tr_b16 v[18:19], v13 offset:2304
  v_and_b32 v243, s47, v229
  v_lshlrev_b32 v244, 16, v230
  v_and_b32 v245, s47, v230
  v_mfma_f32_16x16x32_bf16 v[116:119], v[20:23], v[36:39], 0
  s_cmp_ge_u32 s28, 4
  s_cbranch_scc1 gemm1_kernel_sk25
  s_add_u32 m0, s38, 20480
  s_nop 0
  buffer_load_dwordx4 v10, s[24:27], s35 offen lds
  s_add_u32 s35, s35, s45
  gemm1_kernel_sk25:
  v_lshlrev_b32 v246, 16, v231
  v_and_b32 v247, s47, v231
  v_add_f32 v248, v232, v233
  v_mfma_f32_16x16x32_bf16 v[120:123], v[20:23], v[40:43], 0
  v_add_f32 v249, v234, v235
  v_add_f32 v248, v248, v236
  v_add_f32 v249, v249, v237
  v_mfma_f32_16x16x32_bf16 v[124:127], v[20:23], v[44:47], 0
  s_add_u32 m0, s39, 4096
  s_nop 0
  buffer_load_dwordx4 v11, s[60:63], s41 offen lds
  v_add_f32 v248, v248, v238
  v_add_f32 v249, v249, v239
  v_add_f32 v248, v248, v240
  s_waitcnt lgkmcnt(4)
  v_mfma_f32_16x16x32_bf16 v[128:131], v[24:27], v[32:35], 0
  ds_read_b64_tr_b16 v[20:21], v13 offset:7168
  ds_read_b64_tr_b16 v[22:23], v13 offset:7424
  v_add_f32 v249, v249, v241
  v_add_f32 v248, v248, v242
  v_add_f32 v249, v249, v243
  v_mfma_f32_16x16x32_bf16 v[132:135], v[24:27], v[36:39], 0
  s_add_u32 m0, s39, 5120
  s_nop 0
  buffer_load_dwordx4 v12, s[60:63], s41 offen lds
  v_add_f32 v248, v248, v244
  v_add_f32 v249, v249, v245
  v_add_f32 v248, v248, v246
  v_mfma_f32_16x16x32_bf16 v[136:139], v[24:27], v[40:43], 0
  v_add_f32 v249, v249, v247
  v_add_f32 v248, v248, v249
  s_nop 1
  v_add_f32_dpp v248, v248, v248 quad_perm:[1,0,3,2] row_mask:0xf bank_mask:0xf
  v_mfma_f32_16x16x32_bf16 v[140:143], v[24:27], v[44:47], 0
  s_add_u32 m0, s39, 6144
  s_nop 0
  buffer_load_dwordx4 v11, s[60:63], s42 offen lds
  v_mfma_f32_16x16x32_bf16 v[68:71], v[24:27], v[64:67], 0
  s_nop 1
  v_add_f32_dpp v248, v248, v248 quad_perm:[2,3,0,1] row_mask:0xf bank_mask:0xf
  s_nop 1
  v_add_f32_dpp v248, v248, v248 row_half_mirror row_mask:0xf bank_mask:0xf
  s_nop 1
  v_add_f32_dpp v248, v248, v248 row_mirror row_mask:0xf bank_mask:0xf
  s_waitcnt lgkmcnt(4)
  v_mfma_f32_16x16x32_bf16 v[144:147], v[28:31], v[32:35], 0
  ds_read_b64_tr_b16 v[24:25], v13 offset:3072
  ds_read_b64_tr_b16 v[26:27], v13 offset:3328
  v_mov_b32 v250, v248
  s_nop 1
  v_permlane16_swap_b32 v250, v248
  s_nop 0
  v_add_f32 v248, v248, v250
  v_mfma_f32_16x16x32_bf16 v[148:151], v[28:31], v[36:39], 0
  s_add_u32 m0, s39, 7168
  s_nop 0
  buffer_load_dwordx4 v12, s[60:63], s42 offen lds
  s_add_u32 s41, s41, 128
  s_add_u32 s42, s42, 128
  v_mov_b32 v250, v248
  s_nop 1
  v_permlane32_swap_b32 v250, v248
  s_nop 0
  v_add_f32 v248, v248, v250
  v_mfma_f32_16x16x32_bf16 v[152:155], v[28:31], v[40:43], 0
  v_mul_f32 v248, 0xba800000, v248
  v_add_f32 v232, v232, v248
  v_add_f32 v233, v233, v248
  v_mfma_f32_16x16x32_bf16 v[156:159], v[28:31], v[44:47], 0
  s_add_u32 m0, s36, 40960
  s_nop 0
  buffer_load_dwordx4 v8, s[16:19], s33 offen lds
  s_add_u32 s33, s33, s43
  v_add_f32 v234, v234, v248
  v_add_f32 v235, v235, v248
  v_add_f32 v236, v236, v248
  s_waitcnt lgkmcnt(4)
  v_mfma_f32_16x16x32_bf16 v[160:163], v[16:19], v[32:35], 0
  ds_read_b64_tr_b16 v[28:29], v13 offset:8192
  ds_read_b64_tr_b16 v[30:31], v13 offset:8448
  v_add_f32 v237, v237, v248
  v_add_f32 v238, v238, v248
  v_add_f32 v239, v239, v248
  v_mfma_f32_16x16x32_bf16 v[164:167], v[16:19], v[36:39], 0
  s_add_u32 m0, s37, 40960
  s_nop 0
  buffer_load_dwordx4 v9, s[20:23], s34 offen lds
  s_add_u32 s34, s34, s44
  v_add_f32 v240, v240, v248
  v_add_f32 v241, v241, v248
  v_add_f32 v242, v242, v248
  v_mfma_f32_16x16x32_bf16 v[168:171], v[16:19], v[40:43], 0
  v_add_f32 v243, v243, v248
  v_add_f32 v244, v244, v248
  v_add_f32 v245, v245, v248
  v_mfma_f32_16x16x32_bf16 v[172:175], v[16:19], v[44:47], 0
  s_cmp_ge_u32 s28, 4
  s_cbranch_scc1 gemm1_kernel_sk26
  s_add_u32 m0, s38, 40960
  s_nop 0
  buffer_load_dwordx4 v10, s[24:27], s35 offen lds
  s_add_u32 s35, s35, s45
  gemm1_kernel_sk26:
  v_add_f32 v246, v246, v248
  v_add_f32 v247, v247, v248
  v_mul_f32 v249, v232, v232
  s_waitcnt lgkmcnt(4)
  v_mfma_f32_16x16x32_bf16 v[176:179], v[20:23], v[32:35], 0
  ds_read_b64_tr_b16 v[16:17], v13 offset:4096
  ds_read_b64_tr_b16 v[18:19], v13 offset:4352
  v_mul_f32 v250, v233, v233
  v_fmac_f32 v249, v234, v234
  v_fmac_f32 v250, v235, v235
  v_mfma_f32_16x16x32_bf16 v[180:183], v[20:23], v[36:39], 0
  buffer_load_dword v88, v89, s[64:67], s97 offen
  s_add_u32 s97, s97, s98
  v_fmac_f32 v249, v236, v236
  v_fmac_f32 v250, v237, v237
  v_fmac_f32 v249, v238, v238
  v_mfma_f32_16x16x32_bf16 v[184:187], v[20:23], v[40:43], 0
  v_fmac_f32 v250, v239, v239
  v_fmac_f32 v249, v240, v240
  v_fmac_f32 v250, v241, v241
  v_mfma_f32_16x16x32_bf16 v[188:191], v[20:23], v[44:47], 0
  v_fmac_f32 v249, v242, v242
  v_fmac_f32 v250, v243, v243
  v_fmac_f32 v249, v244, v244
  s_waitcnt lgkmcnt(4)
  v_mfma_f32_16x16x32_bf16 v[192:195], v[24:27], v[32:35], 0
  ds_read_b64_tr_b16 v[20:21], v13 offset:9216
  ds_read_b64_tr_b16 v[22:23], v13 offset:9472
  v_fmac_f32 v250, v245, v245
  v_fmac_f32 v249, v246, v246
  v_fmac_f32 v250, v247, v247
  v_mfma_f32_16x16x32_bf16 v[196:199], v[24:27], v[36:39], 0
  v_add_f32 v249, v249, v250
  s_nop 1
  v_add_f32_dpp v249, v249, v249 quad_perm:[1,0,3,2] row_mask:0xf bank_mask:0xf
  s_nop 1
  v_add_f32_dpp v249, v249, v249 quad_perm:[2,3,0,1] row_mask:0xf bank_mask:0xf
  v_mfma_f32_16x16x32_bf16 v[200:203], v[24:27], v[40:43], 0
  s_nop 1
  v_add_f32_dpp v249, v249, v249 row_half_mirror row_mask:0xf bank_mask:0xf
  s_nop 1
  v_add_f32_dpp v249, v249, v249 row_mirror row_mask:0xf bank_mask:0xf
  v_mov_b32 v250, v249
  v_mfma_f32_16x16x32_bf16 v[204:207], v[24:27], v[44:47], 0
  v_mfma_f32_16x16x32_bf16 v[72:75], v[24:27], v[64:67], 0
  s_nop 1
  v_permlane16_swap_b32 v250, v249
  s_nop 0
  v_add_f32 v249, v249, v250
  v_mov_b32 v250, v249
  s_waitcnt vmcnt(7) lgkmcnt(4)
  s_barrier
  v_mfma_f32_16x16x32_bf16 v[208:211], v[28:31], v[32:35], 0
  ds_read_b64_tr_b16 v[24:25], v13 offset:20480
  ds_read_b64_tr_b16 v[26:27], v13 offset:20736
  s_nop 1
  v_permlane32_swap_b32 v250, v249
  s_nop 0
  v_add_f32 v249, v249, v250
  v_mov_b32 v250, 0x3727c5ac
  v_mfma_f32_16x16x32_bf16 v[212:215], v[28:31], v[36:39], 0
  ds_read_b128 v[48:51], v6 offset:0
  v_fmac_f32 v250, 0x3a800000, v249
  v_mov_b32 v249, v250
  s_lshl_b32 s47, s55, 3
  s_add_u32 s47, s47, 41943040
  s_lshl_b32 s48, s2, 2
  s_add_u32 s48, s48, 42008576
  s_mov_b64 exec, 1
  buffer_store_dwordx2 v[248:249], v15, s[12:15], s47 offen sc1
  buffer_store_dword v15, v15, s[12:15], s48 offen
  s_mov_b64 exec, -1
  s_nop 3
  v_mfma_f32_16x16x32_bf16 v[216:219], v[28:31], v[40:43], 0
  ds_read_b128 v[52:55], v6 offset:2048
  v_mfma_f32_16x16x32_bf16 v[220:223], v[28:31], v[44:47], 0
  s_add_u32 m0, s36, 61440
  s_nop 0
  buffer_load_dwordx4 v8, s[16:19], s33 offen lds
  s_add_u32 s33, s33, s43
  s_waitcnt lgkmcnt(6)
  v_mfma_f32_16x16x32_bf16 v[224:227], v[16:19], v[32:35], 0
  ds_read_b64_tr_b16 v[28:29], v13 offset:25600
  ds_read_b64_tr_b16 v[30:31], v13 offset:25856
  v_mfma_f32_16x16x32_bf16 v[228:231], v[16:19], v[36:39], 0
  ds_read_b128 v[56:59], v7 offset:0
  v_mfma_f32_16x16x32_bf16 v[232:235], v[16:19], v[40:43], 0
  ds_read_b128 v[60:63], v7 offset:2048
  v_mfma_f32_16x16x32_bf16 v[236:239], v[16:19], v[44:47], 0
  s_waitcnt lgkmcnt(8)
  v_mfma_f32_16x16x32_bf16 v[240:243], v[20:23], v[32:35], 0
  ds_read_b64_tr_b16 v[16:17], v13 offset:21504
  ds_read_b64_tr_b16 v[18:19], v13 offset:21760
  s_add_u32 m0, s37, 61440
  s_nop 0
  buffer_load_dwordx4 v9, s[20:23], s34 offen lds
  s_add_u32 s34, s34, s44
  v_mfma_f32_16x16x32_bf16 v[244:247], v[20:23], v[36:39], 0
  v_mfma_f32_16x16x32_bf16 v[248:251], v[20:23], v[40:43], 0
  v_mfma_f32_16x16x32_bf16 v[252:255], v[20:23], v[44:47], 0
  s_waitcnt lgkmcnt(2)
  v_mfma_f32_16x16x32_bf16 v[96:99], v[24:27], v[48:51], v[96:99]
  ds_read_b64_tr_b16 v[20:21], v13 offset:26624
  ds_read_b64_tr_b16 v[22:23], v13 offset:26880
  v_mfma_f32_16x16x32_bf16 v[100:103], v[24:27], v[52:55], v[100:103]
  s_cmp_ge_u32 s28, 4
  s_cbranch_scc1 gemm1_kernel_sk27
  s_add_u32 m0, s38, 61440
  s_nop 0
  buffer_load_dwordx4 v10, s[24:27], s35 offen lds
  s_add_u32 s35, s35, s45
  gemm1_kernel_sk27:
  v_mfma_f32_16x16x32_bf16 v[104:107], v[24:27], v[56:59], v[104:107]
  v_mfma_f32_16x16x32_bf16 v[108:111], v[24:27], v[60:63], v[108:111]
  s_waitcnt lgkmcnt(4)
  v_mfma_f32_16x16x32_bf16 v[112:115], v[28:31], v[48:51], v[112:115]
  ds_read_b64_tr_b16 v[24:25], v13 offset:22528
  ds_read_b64_tr_b16 v[26:27], v13 offset:22784
  v_mfma_f32_16x16x32_bf16 v[116:119], v[28:31], v[52:55], v[116:119]
  v_mfma_f32_16x16x32_bf16 v[120:123], v[28:31], v[56:59], v[120:123]
  buffer_load_dword v88, v89, s[64:67], s97 offen
  s_add_u32 s97, s97, s98
  v_mfma_f32_16x16x32_bf16 v[124:127], v[28:31], v[60:63], v[124:127]
  s_waitcnt lgkmcnt(4)
  v_mfma_f32_16x16x32_bf16 v[128:131], v[16:19], v[48:51], v[128:131]
  ds_read_b64_tr_b16 v[28:29], v13 offset:27648
  ds_read_b64_tr_b16 v[30:31], v13 offset:27904
  v_mfma_f32_16x16x32_bf16 v[132:135], v[16:19], v[52:55], v[132:135]
  v_mfma_f32_16x16x32_bf16 v[136:139], v[16:19], v[56:59], v[136:139]
  v_mfma_f32_16x16x32_bf16 v[140:143], v[16:19], v[60:63], v[140:143]
  v_mfma_f32_16x16x32_bf16 v[68:71], v[16:19], v[64:67], v[68:71]
  s_waitcnt lgkmcnt(4)
  v_mfma_f32_16x16x32_bf16 v[144:147], v[20:23], v[48:51], v[144:147]
  ds_read_b64_tr_b16 v[16:17], v13 offset:23552
  ds_read_b64_tr_b16 v[18:19], v13 offset:23808
  v_mfma_f32_16x16x32_bf16 v[148:151], v[20:23], v[52:55], v[148:151]
  v_mfma_f32_16x16x32_bf16 v[152:155], v[20:23], v[56:59], v[152:155]
  v_mfma_f32_16x16x32_bf16 v[156:159], v[20:23], v[60:63], v[156:159]
  s_waitcnt lgkmcnt(4)
  v_mfma_f32_16x16x32_bf16 v[160:163], v[24:27], v[48:51], v[160:163]
  ds_read_b64_tr_b16 v[20:21], v13 offset:28672
  ds_read_b64_tr_b16 v[22:23], v13 offset:28928
  v_mfma_f32_16x16x32_bf16 v[164:167], v[24:27], v[52:55], v[164:167]
  v_mfma_f32_16x16x32_bf16 v[168:171], v[24:27], v[56:59], v[168:171]
  v_mfma_f32_16x16x32_bf16 v[172:175], v[24:27], v[60:63], v[172:175]
  s_waitcnt lgkmcnt(4)
  v_mfma_f32_16x16x32_bf16 v[176:179], v[28:31], v[48:51], v[176:179]
  ds_read_b64_tr_b16 v[24:25], v13 offset:24576
  ds_read_b64_tr_b16 v[26:27], v13 offset:24832
  v_mfma_f32_16x16x32_bf16 v[180:183], v[28:31], v[52:55], v[180:183]
  v_mfma_f32_16x16x32_bf16 v[184:187], v[28:31], v[56:59], v[184:187]
  v_mfma_f32_16x16x32_bf16 v[188:191], v[28:31], v[60:63], v[188:191]
  s_waitcnt lgkmcnt(4)
  v_mfma_f32_16x16x32_bf16 v[192:195], v[16:19], v[48:51], v[192:195]
  ds_read_b64_tr_b16 v[28:29], v13 offset:29696
  ds_read_b64_tr_b16 v[30:31], v13 offset:29952
  v_mfma_f32_16x16x32_bf16 v[196:199], v[16:19], v[52:55], v[196:199]
  v_mfma_f32_16x16x32_bf16 v[200:203], v[16:19], v[56:59], v[200:203]
  v_mfma_f32_16x16x32_bf16 v[204:207], v[16:19], v[60:63], v[204:207]
  v_mfma_f32_16x16x32_bf16 v[72:75], v[16:19], v[64:67], v[72:75]
  s_waitcnt vmcnt(6) lgkmcnt(4)
  s_barrier
  v_mfma_f32_16x16x32_bf16 v[208:211], v[20:23], v[48:51], v[208:211]
  ds_read_b64_tr_b16 v[16:17], v14 offset:0
  ds_read_b64_tr_b16 v[18:19], v14 offset:256
  v_mfma_f32_16x16x32_bf16 v[212:215], v[20:23], v[52:55], v[212:215]
  ds_read_b128 v[32:35], v4 offset:4096
  v_mfma_f32_16x16x32_bf16 v[216:219], v[20:23], v[56:59], v[216:219]
  ds_read_b128 v[36:39], v4 offset:6144
  v_mfma_f32_16x16x32_bf16 v[220:223], v[20:23], v[60:63], v[220:223]
  s_add_u32 m0, s36, 0
  s_nop 0
  buffer_load_dwordx4 v8, s[16:19], s33 offen lds
  s_add_u32 s33, s33, s43
  s_waitcnt lgkmcnt(6)
  v_mfma_f32_16x16x32_bf16 v[224:227], v[24:27], v[48:51], v[224:227]
  ds_read_b64_tr_b16 v[20:21], v14 offset:5120
  ds_read_b64_tr_b16 v[22:23], v14 offset:5376
  v_mfma_f32_16x16x32_bf16 v[228:231], v[24:27], v[52:55], v[228:231]
  ds_read_b128 v[40:43], v5 offset:4096
  v_mfma_f32_16x16x32_bf16 v[232:235], v[24:27], v[56:59], v[232:235]
  ds_read_b128 v[44:47], v5 offset:6144
  v_mfma_f32_16x16x32_bf16 v[236:239], v[24:27], v[60:63], v[236:239]
  s_waitcnt lgkmcnt(8)
  v_mfma_f32_16x16x32_bf16 v[240:243], v[28:31], v[48:51], v[240:243]
  ds_read_b64_tr_b16 v[24:25], v14 offset:1024
  ds_read_b64_tr_b16 v[26:27], v14 offset:1280
  s_add_u32 m0, s37, 0
  s_nop 0
  buffer_load_dwordx4 v9, s[20:23], s34 offen lds
  s_add_u32 s34, s34, s44
  v_mfma_f32_16x16x32_bf16 v[244:247], v[28:31], v[52:55], v[244:247]
  v_mfma_f32_16x16x32_bf16 v[248:251], v[28:31], v[56:59], v[248:251]
  v_mfma_f32_16x16x32_bf16 v[252:255], v[28:31], v[60:63], v[252:255]
  s_waitcnt lgkmcnt(2)
  v_mfma_f32_16x16x32_bf16 v[96:99], v[16:19], v[32:35], v[96:99]
  ds_read_b64_tr_b16 v[28:29], v14 offset:6144
  ds_read_b64_tr_b16 v[30:31], v14 offset:6400
  v_mfma_f32_16x16x32_bf16 v[100:103], v[16:19], v[36:39], v[100:103]
  s_cmp_ge_u32 s28, 4
  s_cbranch_scc1 gemm1_kernel_sk28
  s_add_u32 m0, s38, 0
  s_nop 0
  buffer_load_dwordx4 v10, s[24:27], s35 offen lds
  s_add_u32 s35, s35, s45
  gemm1_kernel_sk28:
  v_mfma_f32_16x16x32_bf16 v[104:107], v[16:19], v[40:43], v[104:107]
  v_mfma_f32_16x16x32_bf16 v[108:111], v[16:19], v[44:47], v[108:111]
  s_waitcnt lgkmcnt(4)
  v_mfma_f32_16x16x32_bf16 v[112:115], v[20:23], v[32:35], v[112:115]
  ds_read_b64_tr_b16 v[16:17], v14 offset:2048
  ds_read_b64_tr_b16 v[18:19], v14 offset:2304
  v_mfma_f32_16x16x32_bf16 v[116:119], v[20:23], v[36:39], v[116:119]
  v_mfma_f32_16x16x32_bf16 v[120:123], v[20:23], v[40:43], v[120:123]
  s_add_u32 m0, s39, 0
  s_nop 0
  buffer_load_dwordx4 v11, s[60:63], s41 offen lds
  v_mfma_f32_16x16x32_bf16 v[124:127], v[20:23], v[44:47], v[124:127]
  s_waitcnt lgkmcnt(4)
  v_mfma_f32_16x16x32_bf16 v[128:131], v[24:27], v[32:35], v[128:131]
  ds_read_b64_tr_b16 v[20:21], v14 offset:7168
  ds_read_b64_tr_b16 v[22:23], v14 offset:7424
  v_mfma_f32_16x16x32_bf16 v[132:135], v[24:27], v[36:39], v[132:135]
  v_mfma_f32_16x16x32_bf16 v[136:139], v[24:27], v[40:43], v[136:139]
  v_mfma_f32_16x16x32_bf16 v[140:143], v[24:27], v[44:47], v[140:143]
  s_add_u32 m0, s39, 1024
  s_nop 0
  buffer_load_dwordx4 v12, s[60:63], s41 offen lds
  v_mfma_f32_16x16x32_bf16 v[68:71], v[24:27], v[64:67], v[68:71]
  s_waitcnt lgkmcnt(4)
  v_mfma_f32_16x16x32_bf16 v[144:147], v[28:31], v[32:35], v[144:147]
  ds_read_b64_tr_b16 v[24:25], v14 offset:3072
  ds_read_b64_tr_b16 v[26:27], v14 offset:3328
  v_mfma_f32_16x16x32_bf16 v[148:151], v[28:31], v[36:39], v[148:151]
  v_mfma_f32_16x16x32_bf16 v[152:155], v[28:31], v[40:43], v[152:155]
  v_mfma_f32_16x16x32_bf16 v[156:159], v[28:31], v[44:47], v[156:159]
  s_waitcnt lgkmcnt(4)
  v_mfma_f32_16x16x32_bf16 v[160:163], v[16:19], v[32:35], v[160:163]
  ds_read_b64_tr_b16 v[28:29], v14 offset:8192
  ds_read_b64_tr_b16 v[30:31], v14 offset:8448
  s_add_u32 m0, s39, 2048
  s_nop 0
  buffer_load_dwordx4 v11, s[60:63], s42 offen lds
  v_mfma_f32_16x16x32_bf16 v[164:167], v[16:19], v[36:39], v[164:167]
  v_mfma_f32_16x16x32_bf16 v[168:171], v[16:19], v[40:43], v[168:171]
  v_mfma_f32_16x16x32_bf16 v[172:175], v[16:19], v[44:47], v[172:175]
  s_waitcnt lgkmcnt(4)
  v_mfma_f32_16x16x32_bf16 v[176:179], v[20:23], v[32:35], v[176:179]
  ds_read_b64_tr_b16 v[16:17], v14 offset:4096
  ds_read_b64_tr_b16 v[18:19], v14 offset:4352
  v_mfma_f32_16x16x32_bf16 v[180:183], v[20:23], v[36:39], v[180:183]
  s_add_u32 m0, s39, 3072
  s_nop 0
  buffer_load_dwordx4 v12, s[60:63], s42 offen lds
  s_add_u32 s41, s41, 128
  s_add_u32 s42, s42, 128
  v_mfma_f32_16x16x32_bf16 v[184:187], v[20:23], v[40:43], v[184:187]
  v_mfma_f32_16x16x32_bf16 v[188:191], v[20:23], v[44:47], v[188:191]
  s_waitcnt lgkmcnt(4)
  v_mfma_f32_16x16x32_bf16 v[192:195], v[24:27], v[32:35], v[192:195]
  ds_read_b64_tr_b16 v[20:21], v14 offset:9216
  ds_read_b64_tr_b16 v[22:23], v14 offset:9472
  v_mfma_f32_16x16x32_bf16 v[196:199], v[24:27], v[36:39], v[196:199]
  v_mfma_f32_16x16x32_bf16 v[200:203], v[24:27], v[40:43], v[200:203]
  v_mfma_f32_16x16x32_bf16 v[204:207], v[24:27], v[44:47], v[204:207]
  v_mfma_f32_16x16x32_bf16 v[72:75], v[24:27], v[64:67], v[72:75]
  s_waitcnt vmcnt(7) lgkmcnt(4)
  s_barrier
  v_mfma_f32_16x16x32_bf16 v[208:211], v[28:31], v[32:35], v[208:211]
  ds_read_b64_tr_b16 v[24:25], v14 offset:20480
  ds_read_b64_tr_b16 v[26:27], v14 offset:20736
  v_mfma_f32_16x16x32_bf16 v[212:215], v[28:31], v[36:39], v[212:215]
  ds_read_b128 v[48:51], v6 offset:4096
  v_mfma_f32_16x16x32_bf16 v[216:219], v[28:31], v[40:43], v[216:219]
  ds_read_b128 v[52:55], v6 offset:6144
  v_mfma_f32_16x16x32_bf16 v[220:223], v[28:31], v[44:47], v[220:223]
  s_add_u32 m0, s36, 20480
  s_nop 0
  buffer_load_dwordx4 v8, s[16:19], s33 offen lds
  s_add_u32 s33, s33, s43
  s_waitcnt lgkmcnt(6)
  v_mfma_f32_16x16x32_bf16 v[224:227], v[16:19], v[32:35], v[224:227]
  ds_read_b64_tr_b16 v[28:29], v14 offset:25600
  ds_read_b64_tr_b16 v[30:31], v14 offset:25856
  v_mfma_f32_16x16x32_bf16 v[228:231], v[16:19], v[36:39], v[228:231]
  ds_read_b128 v[56:59], v7 offset:4096
  v_mfma_f32_16x16x32_bf16 v[232:235], v[16:19], v[40:43], v[232:235]
  ds_read_b128 v[60:63], v7 offset:6144
  v_mfma_f32_16x16x32_bf16 v[236:239], v[16:19], v[44:47], v[236:239]
  s_waitcnt lgkmcnt(8)
  v_mfma_f32_16x16x32_bf16 v[240:243], v[20:23], v[32:35], v[240:243]
  ds_read_b64_tr_b16 v[16:17], v14 offset:21504
  ds_read_b64_tr_b16 v[18:19], v14 offset:21760
  s_add_u32 m0, s37, 20480
  s_nop 0
  buffer_load_dwordx4 v9, s[20:23], s34 offen lds
  s_add_u32 s34, s34, s44
  v_mfma_f32_16x16x32_bf16 v[244:247], v[20:23], v[36:39], v[244:247]
  v_mfma_f32_16x16x32_bf16 v[248:251], v[20:23], v[40:43], v[248:251]
  v_mfma_f32_16x16x32_bf16 v[252:255], v[20:23], v[44:47], v[252:255]
  s_waitcnt lgkmcnt(2)
  v_mfma_f32_16x16x32_bf16 v[96:99], v[24:27], v[48:51], v[96:99]
  ds_read_b64_tr_b16 v[20:21], v14 offset:26624
  ds_read_b64_tr_b16 v[22:23], v14 offset:26880
  v_mfma_f32_16x16x32_bf16 v[100:103], v[24:27], v[52:55], v[100:103]
  s_cmp_ge_u32 s28, 4
  s_cbranch_scc1 gemm1_kernel_sk29
  s_add_u32 m0, s38, 20480
  s_nop 0
  buffer_load_dwordx4 v10, s[24:27], s35 offen lds
  s_add_u32 s35, s35, s45
  gemm1_kernel_sk29:
  v_mfma_f32_16x16x32_bf16 v[104:107], v[24:27], v[56:59], v[104:107]
  v_mfma_f32_16x16x32_bf16 v[108:111], v[24:27], v[60:63], v[108:111]
  s_waitcnt lgkmcnt(4)
  v_mfma_f32_16x16x32_bf16 v[112:115], v[28:31], v[48:51], v[112:115]
  ds_read_b64_tr_b16 v[24:25], v14 offset:22528
  ds_read_b64_tr_b16 v[26:27], v14 offset:22784
  v_mfma_f32_16x16x32_bf16 v[116:119], v[28:31], v[52:55], v[116:119]
  v_mfma_f32_16x16x32_bf16 v[120:123], v[28:31], v[56:59], v[120:123]
  buffer_load_dword v88, v89, s[64:67], s97 offen
  s_add_u32 s97, s97, s98
  v_mfma_f32_16x16x32_bf16 v[124:127], v[28:31], v[60:63], v[124:127]
  s_waitcnt lgkmcnt(4)
  v_mfma_f32_16x16x32_bf16 v[128:131], v[16:19], v[48:51], v[128:131]
  ds_read_b64_tr_b16 v[28:29], v14 offset:27648
  ds_read_b64_tr_b16 v[30:31], v14 offset:27904
  v_mfma_f32_16x16x32_bf16 v[132:135], v[16:19], v[52:55], v[132:135]
  v_mfma_f32_16x16x32_bf16 v[136:139], v[16:19], v[56:59], v[136:139]
  v_mfma_f32_16x16x32_bf16 v[140:143], v[16:19], v[60:63], v[140:143]
  v_mfma_f32_16x16x32_bf16 v[68:71], v[16:19], v[64:67], v[68:71]
  s_waitcnt lgkmcnt(4)
  v_mfma_f32_16x16x32_bf16 v[144:147], v[20:23], v[48:51], v[144:147]
  ds_read_b64_tr_b16 v[16:17], v14 offset:23552
  ds_read_b64_tr_b16 v[18:19], v14 offset:23808
  v_mfma_f32_16x16x32_bf16 v[148:151], v[20:23], v[52:55], v[148:151]
  v_mfma_f32_16x16x32_bf16 v[152:155], v[20:23], v[56:59], v[152:155]
  v_mfma_f32_16x16x32_bf16 v[156:159], v[20:23], v[60:63], v[156:159]
  s_waitcnt lgkmcnt(4)
  v_mfma_f32_16x16x32_bf16 v[160:163], v[24:27], v[48:51], v[160:163]
  ds_read_b64_tr_b16 v[20:21], v14 offset:28672
  ds_read_b64_tr_b16 v[22:23], v14 offset:28928
  v_mfma_f32_16x16x32_bf16 v[164:167], v[24:27], v[52:55], v[164:167]
  v_mfma_f32_16x16x32_bf16 v[168:171], v[24:27], v[56:59], v[168:171]
  v_mfma_f32_16x16x32_bf16 v[172:175], v[24:27], v[60:63], v[172:175]
  s_waitcnt lgkmcnt(4)
  v_mfma_f32_16x16x32_bf16 v[176:179], v[28:31], v[48:51], v[176:179]
  ds_read_b64_tr_b16 v[24:25], v14 offset:24576
  ds_read_b64_tr_b16 v[26:27], v14 offset:24832
  v_mfma_f32_16x16x32_bf16 v[180:183], v[28:31], v[52:55], v[180:183]
  v_mfma_f32_16x16x32_bf16 v[184:187], v[28:31], v[56:59], v[184:187]
  v_mfma_f32_16x16x32_bf16 v[188:191], v[28:31], v[60:63], v[188:191]
  s_waitcnt lgkmcnt(4)
  v_mfma_f32_16x16x32_bf16 v[192:195], v[16:19], v[48:51], v[192:195]
  ds_read_b64_tr_b16 v[28:29], v14 offset:29696
  ds_read_b64_tr_b16 v[30:31], v14 offset:29952
  v_mfma_f32_16x16x32_bf16 v[196:199], v[16:19], v[52:55], v[196:199]
  v_mfma_f32_16x16x32_bf16 v[200:203], v[16:19], v[56:59], v[200:203]
  v_mfma_f32_16x16x32_bf16 v[204:207], v[16:19], v[60:63], v[204:207]
  v_mfma_f32_16x16x32_bf16 v[72:75], v[16:19], v[64:67], v[72:75]
  s_waitcnt vmcnt(3) lgkmcnt(4)
  s_barrier
  v_mfma_f32_16x16x32_bf16 v[208:211], v[20:23], v[48:51], v[208:211]
  ds_read_b64_tr_b16 v[16:17], v13 offset:0
  ds_read_b64_tr_b16 v[18:19], v13 offset:256
  v_mfma_f32_16x16x32_bf16 v[212:215], v[20:23], v[52:55], v[212:215]
  ds_read_b128 v[32:35], v4 offset:0
  v_mfma_f32_16x16x32_bf16 v[216:219], v[20:23], v[56:59], v[216:219]
  ds_read_b128 v[36:39], v4 offset:2048
  v_mfma_f32_16x16x32_bf16 v[220:223], v[20:23], v[60:63], v[220:223]
  s_add_u32 m0, s36, 40960
  s_nop 0
  buffer_load_dwordx4 v8, s[16:19], s33 offen lds
  s_add_u32 s33, s33, s43
  s_waitcnt lgkmcnt(6)
  v_mfma_f32_16x16x32_bf16 v[224:227], v[24:27], v[48:51], v[224:227]
  ds_read_b64_tr_b16 v[20:21], v13 offset:5120
  ds_read_b64_tr_b16 v[22:23], v13 offset:5376
  v_mfma_f32_16x16x32_bf16 v[228:231], v[24:27], v[52:55], v[228:231]
  ds_read_b128 v[40:43], v5 offset:0
  v_mfma_f32_16x16x32_bf16 v[232:235], v[24:27], v[56:59], v[232:235]
  ds_read_b128 v[44:47], v5 offset:2048
  v_mfma_f32_16x16x32_bf16 v[236:239], v[24:27], v[60:63], v[236:239]
  s_waitcnt lgkmcnt(8)
  v_mfma_f32_16x16x32_bf16 v[240:243], v[28:31], v[48:51], v[240:243]
  ds_read_b64_tr_b16 v[24:25], v13 offset:1024
  ds_read_b64_tr_b16 v[26:27], v13 offset:1280
  s_add_u32 m0, s37, 40960
  s_nop 0
  buffer_load_dwordx4 v9, s[20:23], s34 offen lds
  s_add_u32 s34, s34, s44
  v_mfma_f32_16x16x32_bf16 v[244:247], v[28:31], v[52:55], v[244:247]
  v_mfma_f32_16x16x32_bf16 v[248:251], v[28:31], v[56:59], v[248:251]
  v_mfma_f32_16x16x32_bf16 v[252:255], v[28:31], v[60:63], v[252:255]
gemm1_kernel_loop2:
  s_waitcnt lgkmcnt(2)
  v_mfma_f32_16x16x32_bf16 v[96:99], v[16:19], v[32:35], v[96:99]
  ds_read_b64_tr_b16 v[28:29], v13 offset:6144
  ds_read_b64_tr_b16 v[30:31], v13 offset:6400
  v_mfma_f32_16x16x32_bf16 v[100:103], v[16:19], v[36:39], v[100:103]
  s_cmp_ge_u32 s28, 4
  s_cbranch_scc1 gemm1_kernel_sk30
  s_add_u32 m0, s38, 40960
  s_nop 0
  buffer_load_dwordx4 v10, s[24:27], s35 offen lds
  s_add_u32 s35, s35, s45
  gemm1_kernel_sk30:
  v_mfma_f32_16x16x32_bf16 v[104:107], v[16:19], v[40:43], v[104:107]
  v_mfma_f32_16x16x32_bf16 v[108:111], v[16:19], v[44:47], v[108:111]
  s_waitcnt lgkmcnt(4)
  v_mfma_f32_16x16x32_bf16 v[112:115], v[20:23], v[32:35], v[112:115]
  ds_read_b64_tr_b16 v[16:17], v13 offset:2048
  ds_read_b64_tr_b16 v[18:19], v13 offset:2304
  v_mfma_f32_16x16x32_bf16 v[116:119], v[20:23], v[36:39], v[116:119]
  v_mfma_f32_16x16x32_bf16 v[120:123], v[20:23], v[40:43], v[120:123]
  s_add_u32 m0, s39, 4096
  s_nop 0
  buffer_load_dwordx4 v11, s[60:63], s41 offen lds
  v_mfma_f32_16x16x32_bf16 v[124:127], v[20:23], v[44:47], v[124:127]
  s_waitcnt lgkmcnt(4)
  v_mfma_f32_16x16x32_bf16 v[128:131], v[24:27], v[32:35], v[128:131]
  ds_read_b64_tr_b16 v[20:21], v13 offset:7168
  ds_read_b64_tr_b16 v[22:23], v13 offset:7424
  v_mfma_f32_16x16x32_bf16 v[132:135], v[24:27], v[36:39], v[132:135]
  v_mfma_f32_16x16x32_bf16 v[136:139], v[24:27], v[40:43], v[136:139]
  v_mfma_f32_16x16x32_bf16 v[140:143], v[24:27], v[44:47], v[140:143]
  s_add_u32 m0, s39, 5120
  s_nop 0
  buffer_load_dwordx4 v12, s[60:63], s41 offen lds
  v_mfma_f32_16x16x32_bf16 v[68:71], v[24:27], v[64:67], v[68:71]
  s_waitcnt lgkmcnt(4)
  v_mfma_f32_16x16x32_bf16 v[144:147], v[28:31], v[32:35], v[144:147]
  ds_read_b64_tr_b16 v[24:25], v13 offset:3072
  ds_read_b64_tr_b16 v[26:27], v13 offset:3328
  v_mfma_f32_16x16x32_bf16 v[148:151], v[28:31], v[36:39], v[148:151]
  v_mfma_f32_16x16x32_bf16 v[152:155], v[28:31], v[40:43], v[152:155]
  v_mfma_f32_16x16x32_bf16 v[156:159], v[28:31], v[44:47], v[156:159]
  s_waitcnt lgkmcnt(4)
  v_mfma_f32_16x16x32_bf16 v[160:163], v[16:19], v[32:35], v[160:163]
  ds_read_b64_tr_b16 v[28:29], v13 offset:8192
  ds_read_b64_tr_b16 v[30:31], v13 offset:8448
  s_add_u32 m0, s39, 6144
  s_nop 0
  buffer_load_dwordx4 v11, s[60:63], s42 offen lds
  v_mfma_f32_16x16x32_bf16 v[164:167], v[16:19], v[36:39], v[164:167]
  v_mfma_f32_16x16x32_bf16 v[168:171], v[16:19], v[40:43], v[168:171]
  v_mfma_f32_16x16x32_bf16 v[172:175], v[16:19], v[44:47], v[172:175]
  s_waitcnt lgkmcnt(4)
  v_mfma_f32_16x16x32_bf16 v[176:179], v[20:23], v[32:35], v[176:179]
  ds_read_b64_tr_b16 v[16:17], v13 offset:4096
  ds_read_b64_tr_b16 v[18:19], v13 offset:4352
  v_mfma_f32_16x16x32_bf16 v[180:183], v[20:23], v[36:39], v[180:183]
  s_add_u32 m0, s39, 7168
  s_nop 0
  buffer_load_dwordx4 v12, s[60:63], s42 offen lds
  s_add_u32 s41, s41, 128
  s_add_u32 s42, s42, 128
  v_mfma_f32_16x16x32_bf16 v[184:187], v[20:23], v[40:43], v[184:187]
  v_mfma_f32_16x16x32_bf16 v[188:191], v[20:23], v[44:47], v[188:191]
  s_waitcnt lgkmcnt(4)
  v_mfma_f32_16x16x32_bf16 v[192:195], v[24:27], v[32:35], v[192:195]
  ds_read_b64_tr_b16 v[20:21], v13 offset:9216
  ds_read_b64_tr_b16 v[22:23], v13 offset:9472
  v_mfma_f32_16x16x32_bf16 v[196:199], v[24:27], v[36:39], v[196:199]
  v_mfma_f32_16x16x32_bf16 v[200:203], v[24:27], v[40:43], v[200:203]
  v_mfma_f32_16x16x32_bf16 v[204:207], v[24:27], v[44:47], v[204:207]
  v_mfma_f32_16x16x32_bf16 v[72:75], v[24:27], v[64:67], v[72:75]
  s_waitcnt vmcnt(7) lgkmcnt(4)
  s_barrier
  v_mfma_f32_16x16x32_bf16 v[208:211], v[28:31], v[32:35], v[208:211]
  ds_read_b64_tr_b16 v[24:25], v13 offset:20480
  ds_read_b64_tr_b16 v[26:27], v13 offset:20736
  v_mfma_f32_16x16x32_bf16 v[212:215], v[28:31], v[36:39], v[212:215]
  ds_read_b128 v[48:51], v6 offset:0
  v_mfma_f32_16x16x32_bf16 v[216:219], v[28:31], v[40:43], v[216:219]
  ds_read_b128 v[52:55], v6 offset:2048
  v_mfma_f32_16x16x32_bf16 v[220:223], v[28:31], v[44:47], v[220:223]
  s_add_u32 m0, s36, 61440
  s_nop 0
  buffer_load_dwordx4 v8, s[16:19], s33 offen lds
  s_add_u32 s33, s33, s43
  s_waitcnt lgkmcnt(6)
  v_mfma_f32_16x16x32_bf16 v[224:227], v[16:19], v[32:35], v[224:227]
  ds_read_b64_tr_b16 v[28:29], v13 offset:25600
  ds_read_b64_tr_b16 v[30:31], v13 offset:25856
  v_mfma_f32_16x16x32_bf16 v[228:231], v[16:19], v[36:39], v[228:231]
  ds_read_b128 v[56:59], v7 offset:0
  v_mfma_f32_16x16x32_bf16 v[232:235], v[16:19], v[40:43], v[232:235]
  ds_read_b128 v[60:63], v7 offset:2048
  v_mfma_f32_16x16x32_bf16 v[236:239], v[16:19], v[44:47], v[236:239]
  s_waitcnt lgkmcnt(8)
  v_mfma_f32_16x16x32_bf16 v[240:243], v[20:23], v[32:35], v[240:243]
  ds_read_b64_tr_b16 v[16:17], v13 offset:21504
  ds_read_b64_tr_b16 v[18:19], v13 offset:21760
  s_add_u32 m0, s37, 61440
  s_nop 0
  buffer_load_dwordx4 v9, s[20:23], s34 offen lds
  s_add_u32 s34, s34, s44
  v_mfma_f32_16x16x32_bf16 v[244:247], v[20:23], v[36:39], v[244:247]
  v_mfma_f32_16x16x32_bf16 v[248:251], v[20:23], v[40:43], v[248:251]
  v_mfma_f32_16x16x32_bf16 v[252:255], v[20:23], v[44:47], v[252:255]
  s_waitcnt lgkmcnt(2)
  v_mfma_f32_16x16x32_bf16 v[96:99], v[24:27], v[48:51], v[96:99]
  ds_read_b64_tr_b16 v[20:21], v13 offset:26624
  ds_read_b64_tr_b16 v[22:23], v13 offset:26880
  v_mfma_f32_16x16x32_bf16 v[100:103], v[24:27], v[52:55], v[100:103]
  s_cmp_ge_u32 s28, 4
  s_cbranch_scc1 gemm1_kernel_sk31
  s_add_u32 m0, s38, 61440
  s_nop 0
  buffer_load_dwordx4 v10, s[24:27], s35 offen lds
  s_add_u32 s35, s35, s45
  gemm1_kernel_sk31:
  v_mfma_f32_16x16x32_bf16 v[104:107], v[24:27], v[56:59], v[104:107]
  v_mfma_f32_16x16x32_bf16 v[108:111], v[24:27], v[60:63], v[108:111]
  s_waitcnt lgkmcnt(4)
  v_mfma_f32_16x16x32_bf16 v[112:115], v[28:31], v[48:51], v[112:115]
  ds_read_b64_tr_b16 v[24:25], v13 offset:22528
  ds_read_b64_tr_b16 v[26:27], v13 offset:22784
  v_mfma_f32_16x16x32_bf16 v[116:119], v[28:31], v[52:55], v[116:119]
  v_mfma_f32_16x16x32_bf16 v[120:123], v[28:31], v[56:59], v[120:123]
  buffer_load_dword v88, v89, s[64:67], s97 offen
  s_add_u32 s97, s97, s98
  v_mfma_f32_16x16x32_bf16 v[124:127], v[28:31], v[60:63], v[124:127]
  s_waitcnt lgkmcnt(4)
  v_mfma_f32_16x16x32_bf16 v[128:131], v[16:19], v[48:51], v[128:131]
  ds_read_b64_tr_b16 v[28:29], v13 offset:27648
  ds_read_b64_tr_b16 v[30:31], v13 offset:27904
  v_mfma_f32_16x16x32_bf16 v[132:135], v[16:19], v[52:55], v[132:135]
  v_mfma_f32_16x16x32_bf16 v[136:139], v[16:19], v[56:59], v[136:139]
  v_mfma_f32_16x16x32_bf16 v[140:143], v[16:19], v[60:63], v[140:143]
  v_mfma_f32_16x16x32_bf16 v[68:71], v[16:19], v[64:67], v[68:71]
  s_waitcnt lgkmcnt(4)
  v_mfma_f32_16x16x32_bf16 v[144:147], v[20:23], v[48:51], v[144:147]
  ds_read_b64_tr_b16 v[16:17], v13 offset:23552
  ds_read_b64_tr_b16 v[18:19], v13 offset:23808
  v_mfma_f32_16x16x32_bf16 v[148:151], v[20:23], v[52:55], v[148:151]
  v_mfma_f32_16x16x32_bf16 v[152:155], v[20:23], v[56:59], v[152:155]
  v_mfma_f32_16x16x32_bf16 v[156:159], v[20:23], v[60:63], v[156:159]
  s_waitcnt lgkmcnt(4)
  v_mfma_f32_16x16x32_bf16 v[160:163], v[24:27], v[48:51], v[160:163]
  ds_read_b64_tr_b16 v[20:21], v13 offset:28672
  ds_read_b64_tr_b16 v[22:23], v13 offset:28928
  v_mfma_f32_16x16x32_bf16 v[164:167], v[24:27], v[52:55], v[164:167]
  v_mfma_f32_16x16x32_bf16 v[168:171], v[24:27], v[56:59], v[168:171]
  v_mfma_f32_16x16x32_bf16 v[172:175], v[24:27], v[60:63], v[172:175]
  s_waitcnt lgkmcnt(4)
  v_mfma_f32_16x16x32_bf16 v[176:179], v[28:31], v[48:51], v[176:179]
  ds_read_b64_tr_b16 v[24:25], v13 offset:24576
  ds_read_b64_tr_b16 v[26:27], v13 offset:24832
  v_mfma_f32_16x16x32_bf16 v[180:183], v[28:31], v[52:55], v[180:183]
  v_mfma_f32_16x16x32_bf16 v[184:187], v[28:31], v[56:59], v[184:187]
  v_mfma_f32_16x16x32_bf16 v[188:191], v[28:31], v[60:63], v[188:191]
  s_waitcnt lgkmcnt(4)
  v_mfma_f32_16x16x32_bf16 v[192:195], v[16:19], v[48:51], v[192:195]
  ds_read_b64_tr_b16 v[28:29], v13 offset:29696
  ds_read_b64_tr_b16 v[30:31], v13 offset:29952
  v_mfma_f32_16x16x32_bf16 v[196:199], v[16:19], v[52:55], v[196:199]
  v_mfma_f32_16x16x32_bf16 v[200:203], v[16:19], v[56:59], v[200:203]
  v_mfma_f32_16x16x32_bf16 v[204:207], v[16:19], v[60:63], v[204:207]
  v_mfma_f32_16x16x32_bf16 v[72:75], v[16:19], v[64:67], v[72:75]
  s_waitcnt vmcnt(3) lgkmcnt(4)
  s_barrier
  v_mfma_f32_16x16x32_bf16 v[208:211], v[20:23], v[48:51], v[208:211]
  ds_read_b64_tr_b16 v[16:17], v14 offset:0
  ds_read_b64_tr_b16 v[18:19], v14 offset:256
  v_mfma_f32_16x16x32_bf16 v[212:215], v[20:23], v[52:55], v[212:215]
  ds_read_b128 v[32:35], v4 offset:4096
  v_mfma_f32_16x16x32_bf16 v[216:219], v[20:23], v[56:59], v[216:219]
  ds_read_b128 v[36:39], v4 offset:6144
  v_mfma_f32_16x16x32_bf16 v[220:223], v[20:23], v[60:63], v[220:223]
  s_add_u32 m0, s36, 0
  s_nop 0
  buffer_load_dwordx4 v8, s[16:19], s33 offen lds
  s_add_u32 s33, s33, s43
  s_waitcnt lgkmcnt(6)
  v_mfma_f32_16x16x32_bf16 v[224:227], v[24:27], v[48:51], v[224:227]
  ds_read_b64_tr_b16 v[20:21], v14 offset:5120
  ds_read_b64_tr_b16 v[22:23], v14 offset:5376
  v_mfma_f32_16x16x32_bf16 v[228:231], v[24:27], v[52:55], v[228:231]
  ds_read_b128 v[40:43], v5 offset:4096
  v_mfma_f32_16x16x32_bf16 v[232:235], v[24:27], v[56:59], v[232:235]
  ds_read_b128 v[44:47], v5 offset:6144
  v_mfma_f32_16x16x32_bf16 v[236:239], v[24:27], v[60:63], v[236:239]
  s_waitcnt lgkmcnt(8)
  v_mfma_f32_16x16x32_bf16 v[240:243], v[28:31], v[48:51], v[240:243]
  ds_read_b64_tr_b16 v[24:25], v14 offset:1024
  ds_read_b64_tr_b16 v[26:27], v14 offset:1280
  s_add_u32 m0, s37, 0
  s_nop 0
  buffer_load_dwordx4 v9, s[20:23], s34 offen lds
  s_add_u32 s34, s34, s44
  v_mfma_f32_16x16x32_bf16 v[244:247], v[28:31], v[52:55], v[244:247]
  v_mfma_f32_16x16x32_bf16 v[248:251], v[28:31], v[56:59], v[248:251]
  v_mfma_f32_16x16x32_bf16 v[252:255], v[28:31], v[60:63], v[252:255]
  s_waitcnt lgkmcnt(2)
  v_mfma_f32_16x16x32_bf16 v[96:99], v[16:19], v[32:35], v[96:99]
  ds_read_b64_tr_b16 v[28:29], v14 offset:6144
  ds_read_b64_tr_b16 v[30:31], v14 offset:6400
  v_mfma_f32_16x16x32_bf16 v[100:103], v[16:19], v[36:39], v[100:103]
  s_cmp_ge_u32 s28, 4
  s_cbranch_scc1 gemm1_kernel_sk32
  s_add_u32 m0, s38, 0
  s_nop 0
  buffer_load_dwordx4 v10, s[24:27], s35 offen lds
  s_add_u32 s35, s35, s45
  gemm1_kernel_sk32:
  v_mfma_f32_16x16x32_bf16 v[104:107], v[16:19], v[40:43], v[104:107]
  v_mfma_f32_16x16x32_bf16 v[108:111], v[16:19], v[44:47], v[108:111]
  s_waitcnt lgkmcnt(4)
  v_mfma_f32_16x16x32_bf16 v[112:115], v[20:23], v[32:35], v[112:115]
  ds_read_b64_tr_b16 v[16:17], v14 offset:2048
  ds_read_b64_tr_b16 v[18:19], v14 offset:2304
  v_mfma_f32_16x16x32_bf16 v[116:119], v[20:23], v[36:39], v[116:119]
  v_mfma_f32_16x16x32_bf16 v[120:123], v[20:23], v[40:43], v[120:123]
  s_add_u32 m0, s39, 0
  s_nop 0
  buffer_load_dwordx4 v11, s[60:63], s41 offen lds
  v_mfma_f32_16x16x32_bf16 v[124:127], v[20:23], v[44:47], v[124:127]
  s_waitcnt lgkmcnt(4)
  v_mfma_f32_16x16x32_bf16 v[128:131], v[24:27], v[32:35], v[128:131]
  ds_read_b64_tr_b16 v[20:21], v14 offset:7168
  ds_read_b64_tr_b16 v[22:23], v14 offset:7424
  v_mfma_f32_16x16x32_bf16 v[132:135], v[24:27], v[36:39], v[132:135]
  v_mfma_f32_16x16x32_bf16 v[136:139], v[24:27], v[40:43], v[136:139]
  v_mfma_f32_16x16x32_bf16 v[140:143], v[24:27], v[44:47], v[140:143]
  s_add_u32 m0, s39, 1024
  s_nop 0
  buffer_load_dwordx4 v12, s[60:63], s41 offen lds
  v_mfma_f32_16x16x32_bf16 v[68:71], v[24:27], v[64:67], v[68:71]
  s_waitcnt lgkmcnt(4)
  v_mfma_f32_16x16x32_bf16 v[144:147], v[28:31], v[32:35], v[144:147]
  ds_read_b64_tr_b16 v[24:25], v14 offset:3072
  ds_read_b64_tr_b16 v[26:27], v14 offset:3328
  v_mfma_f32_16x16x32_bf16 v[148:151], v[28:31], v[36:39], v[148:151]
  v_mfma_f32_16x16x32_bf16 v[152:155], v[28:31], v[40:43], v[152:155]
  v_mfma_f32_16x16x32_bf16 v[156:159], v[28:31], v[44:47], v[156:159]
  s_waitcnt lgkmcnt(4)
  v_mfma_f32_16x16x32_bf16 v[160:163], v[16:19], v[32:35], v[160:163]
  ds_read_b64_tr_b16 v[28:29], v14 offset:8192
  ds_read_b64_tr_b16 v[30:31], v14 offset:8448
  s_add_u32 m0, s39, 2048
  s_nop 0
  buffer_load_dwordx4 v11, s[60:63], s42 offen lds
  v_mfma_f32_16x16x32_bf16 v[164:167], v[16:19], v[36:39], v[164:167]
  v_mfma_f32_16x16x32_bf16 v[168:171], v[16:19], v[40:43], v[168:171]
  v_mfma_f32_16x16x32_bf16 v[172:175], v[16:19], v[44:47], v[172:175]
  s_waitcnt lgkmcnt(4)
  v_mfma_f32_16x16x32_bf16 v[176:179], v[20:23], v[32:35], v[176:179]
  ds_read_b64_tr_b16 v[16:17], v14 offset:4096
  ds_read_b64_tr_b16 v[18:19], v14 offset:4352
  v_mfma_f32_16x16x32_bf16 v[180:183], v[20:23], v[36:39], v[180:183]
  s_add_u32 m0, s39, 3072
  s_nop 0
  buffer_load_dwordx4 v12, s[60:63], s42 offen lds
  s_add_u32 s41, s41, 128
  s_add_u32 s42, s42, 128
  v_mfma_f32_16x16x32_bf16 v[184:187], v[20:23], v[40:43], v[184:187]
  v_mfma_f32_16x16x32_bf16 v[188:191], v[20:23], v[44:47], v[188:191]
  s_waitcnt lgkmcnt(4)
  v_mfma_f32_16x16x32_bf16 v[192:195], v[24:27], v[32:35], v[192:195]
  ds_read_b64_tr_b16 v[20:21], v14 offset:9216
  ds_read_b64_tr_b16 v[22:23], v14 offset:9472
  v_mfma_f32_16x16x32_bf16 v[196:199], v[24:27], v[36:39], v[196:199]
  v_mfma_f32_16x16x32_bf16 v[200:203], v[24:27], v[40:43], v[200:203]
  v_mfma_f32_16x16x32_bf16 v[204:207], v[24:27], v[44:47], v[204:207]
  v_mfma_f32_16x16x32_bf16 v[72:75], v[24:27], v[64:67], v[72:75]
  s_waitcnt vmcnt(7) lgkmcnt(4)
  s_barrier
  v_mfma_f32_16x16x32_bf16 v[208:211], v[28:31], v[32:35], v[208:211]
  ds_read_b64_tr_b16 v[24:25], v14 offset:20480
  ds_read_b64_tr_b16 v[26:27], v14 offset:20736
  v_mfma_f32_16x16x32_bf16 v[212:215], v[28:31], v[36:39], v[212:215]
  ds_read_b128 v[48:51], v6 offset:4096
  v_mfma_f32_16x16x32_bf16 v[216:219], v[28:31], v[40:43], v[216:219]
  ds_read_b128 v[52:55], v6 offset:6144
  v_mfma_f32_16x16x32_bf16 v[220:223], v[28:31], v[44:47], v[220:223]
  s_add_u32 m0, s36, 20480
  s_nop 0
  buffer_load_dwordx4 v8, s[16:19], s33 offen lds
  s_add_u32 s33, s33, s43
  s_waitcnt lgkmcnt(6)
  v_mfma_f32_16x16x32_bf16 v[224:227], v[16:19], v[32:35], v[224:227]
  ds_read_b64_tr_b16 v[28:29], v14 offset:25600
  ds_read_b64_tr_b16 v[30:31], v14 offset:25856
  v_mfma_f32_16x16x32_bf16 v[228:231], v[16:19], v[36:39], v[228:231]
  ds_read_b128 v[56:59], v7 offset:4096
  v_mfma_f32_16x16x32_bf16 v[232:235], v[16:19], v[40:43], v[232:235]
  ds_read_b128 v[60:63], v7 offset:6144
  v_mfma_f32_16x16x32_bf16 v[236:239], v[16:19], v[44:47], v[236:239]
  s_waitcnt lgkmcnt(8)
  v_mfma_f32_16x16x32_bf16 v[240:243], v[20:23], v[32:35], v[240:243]
  ds_read_b64_tr_b16 v[16:17], v14 offset:21504
  ds_read_b64_tr_b16 v[18:19], v14 offset:21760
  s_add_u32 m0, s37, 20480
  s_nop 0
  buffer_load_dwordx4 v9, s[20:23], s34 offen lds
  s_add_u32 s34, s34, s44
  v_mfma_f32_16x16x32_bf16 v[244:247], v[20:23], v[36:39], v[244:247]
  v_mfma_f32_16x16x32_bf16 v[248:251], v[20:23], v[40:43], v[248:251]
  v_mfma_f32_16x16x32_bf16 v[252:255], v[20:23], v[44:47], v[252:255]
  s_waitcnt lgkmcnt(2)
  v_mfma_f32_16x16x32_bf16 v[96:99], v[24:27], v[48:51], v[96:99]
  ds_read_b64_tr_b16 v[20:21], v14 offset:26624
  ds_read_b64_tr_b16 v[22:23], v14 offset:26880
  v_mfma_f32_16x16x32_bf16 v[100:103], v[24:27], v[52:55], v[100:103]
  s_cmp_ge_u32 s28, 4
  s_cbranch_scc1 gemm1_kernel_sk33
  s_add_u32 m0, s38, 20480
  s_nop 0
  buffer_load_dwordx4 v10, s[24:27], s35 offen lds
  s_add_u32 s35, s35, s45
  gemm1_kernel_sk33:
  v_mfma_f32_16x16x32_bf16 v[104:107], v[24:27], v[56:59], v[104:107]
  v_mfma_f32_16x16x32_bf16 v[108:111], v[24:27], v[60:63], v[108:111]
  s_waitcnt lgkmcnt(4)
  v_mfma_f32_16x16x32_bf16 v[112:115], v[28:31], v[48:51], v[112:115]
  ds_read_b64_tr_b16 v[24:25], v14 offset:22528
  ds_read_b64_tr_b16 v[26:27], v14 offset:22784
  v_mfma_f32_16x16x32_bf16 v[116:119], v[28:31], v[52:55], v[116:119]
  v_mfma_f32_16x16x32_bf16 v[120:123], v[28:31], v[56:59], v[120:123]
  buffer_load_dword v88, v89, s[64:67], s97 offen
  s_add_u32 s97, s97, s98
  v_mfma_f32_16x16x32_bf16 v[124:127], v[28:31], v[60:63], v[124:127]
  s_waitcnt lgkmcnt(4)
  v_mfma_f32_16x16x32_bf16 v[128:131], v[16:19], v[48:51], v[128:131]
  ds_read_b64_tr_b16 v[28:29], v14 offset:27648
  ds_read_b64_tr_b16 v[30:31], v14 offset:27904
  v_mfma_f32_16x16x32_bf16 v[132:135], v[16:19], v[52:55], v[132:135]
  v_mfma_f32_16x16x32_bf16 v[136:139], v[16:19], v[56:59], v[136:139]
  v_mfma_f32_16x16x32_bf16 v[140:143], v[16:19], v[60:63], v[140:143]
  v_mfma_f32_16x16x32_bf16 v[68:71], v[16:19], v[64:67], v[68:71]
  s_waitcnt lgkmcnt(4)
  v_mfma_f32_16x16x32_bf16 v[144:147], v[20:23], v[48:51], v[144:147]
  ds_read_b64_tr_b16 v[16:17], v14 offset:23552
  ds_read_b64_tr_b16 v[18:19], v14 offset:23808
  v_mfma_f32_16x16x32_bf16 v[148:151], v[20:23], v[52:55], v[148:151]
  v_mfma_f32_16x16x32_bf16 v[152:155], v[20:23], v[56:59], v[152:155]
  v_mfma_f32_16x16x32_bf16 v[156:159], v[20:23], v[60:63], v[156:159]
  s_waitcnt lgkmcnt(4)
  v_mfma_f32_16x16x32_bf16 v[160:163], v[24:27], v[48:51], v[160:163]
  ds_read_b64_tr_b16 v[20:21], v14 offset:28672
  ds_read_b64_tr_b16 v[22:23], v14 offset:28928
  v_mfma_f32_16x16x32_bf16 v[164:167], v[24:27], v[52:55], v[164:167]
  v_mfma_f32_16x16x32_bf16 v[168:171], v[24:27], v[56:59], v[168:171]
  v_mfma_f32_16x16x32_bf16 v[172:175], v[24:27], v[60:63], v[172:175]
  s_waitcnt lgkmcnt(4)
  v_mfma_f32_16x16x32_bf16 v[176:179], v[28:31], v[48:51], v[176:179]
  ds_read_b64_tr_b16 v[24:25], v14 offset:24576
  ds_read_b64_tr_b16 v[26:27], v14 offset:24832
  v_mfma_f32_16x16x32_bf16 v[180:183], v[28:31], v[52:55], v[180:183]
  v_mfma_f32_16x16x32_bf16 v[184:187], v[28:31], v[56:59], v[184:187]
  v_mfma_f32_16x16x32_bf16 v[188:191], v[28:31], v[60:63], v[188:191]
  s_waitcnt lgkmcnt(4)
  v_mfma_f32_16x16x32_bf16 v[192:195], v[16:19], v[48:51], v[192:195]
  ds_read_b64_tr_b16 v[28:29], v14 offset:29696
  ds_read_b64_tr_b16 v[30:31], v14 offset:29952
  v_mfma_f32_16x16x32_bf16 v[196:199], v[16:19], v[52:55], v[196:199]
  v_mfma_f32_16x16x32_bf16 v[200:203], v[16:19], v[56:59], v[200:203]
  v_mfma_f32_16x16x32_bf16 v[204:207], v[16:19], v[60:63], v[204:207]
  v_mfma_f32_16x16x32_bf16 v[72:75], v[16:19], v[64:67], v[72:75]
  s_waitcnt vmcnt(3) lgkmcnt(4)
  s_barrier
  v_mfma_f32_16x16x32_bf16 v[208:211], v[20:23], v[48:51], v[208:211]
  ds_read_b64_tr_b16 v[16:17], v13 offset:0
  ds_read_b64_tr_b16 v[18:19], v13 offset:256
  v_mfma_f32_16x16x32_bf16 v[212:215], v[20:23], v[52:55], v[212:215]
  ds_read_b128 v[32:35], v4 offset:0
  v_mfma_f32_16x16x32_bf16 v[216:219], v[20:23], v[56:59], v[216:219]
  ds_read_b128 v[36:39], v4 offset:2048
  v_mfma_f32_16x16x32_bf16 v[220:223], v[20:23], v[60:63], v[220:223]
  s_add_u32 m0, s36, 40960
  s_nop 0
  buffer_load_dwordx4 v8, s[16:19], s33 offen lds
  s_add_u32 s33, s33, s43
  s_waitcnt lgkmcnt(6)
  v_mfma_f32_16x16x32_bf16 v[224:227], v[24:27], v[48:51], v[224:227]
  ds_read_b64_tr_b16 v[20:21], v13 offset:5120
  ds_read_b64_tr_b16 v[22:23], v13 offset:5376
  v_mfma_f32_16x16x32_bf16 v[228:231], v[24:27], v[52:55], v[228:231]
  ds_read_b128 v[40:43], v5 offset:0
  v_mfma_f32_16x16x32_bf16 v[232:235], v[24:27], v[56:59], v[232:235]
  ds_read_b128 v[44:47], v5 offset:2048
  v_mfma_f32_16x16x32_bf16 v[236:239], v[24:27], v[60:63], v[236:239]
  s_waitcnt lgkmcnt(8)
  v_mfma_f32_16x16x32_bf16 v[240:243], v[28:31], v[48:51], v[240:243]
  ds_read_b64_tr_b16 v[24:25], v13 offset:1024
  ds_read_b64_tr_b16 v[26:27], v13 offset:1280
  s_add_u32 m0, s37, 40960
  s_nop 0
  buffer_load_dwordx4 v9, s[20:23], s34 offen lds
  s_add_u32 s34, s34, s44
  v_mfma_f32_16x16x32_bf16 v[244:247], v[28:31], v[52:55], v[244:247]
  v_mfma_f32_16x16x32_bf16 v[248:251], v[28:31], v[56:59], v[248:251]
  v_mfma_f32_16x16x32_bf16 v[252:255], v[28:31], v[60:63], v[252:255]
  s_sub_u32 s40, s40, 1
  s_cmp_lg_u32 s40, 0
  s_cbranch_scc1 gemm1_kernel_loop2
  s_lshl_b32 s55, s32, 2
  buffer_load_dword v1, v15, s[68:71], s55 offen sc1
  s_lshl_b32 s47, s32, 11
  s_lshl_b32 s48, s30, 9
  s_add_u32 s47, s47, s48
  s_lshl_b32 s48, s29, 8
  s_add_u32 s47, s47, s48
  s_add_u32 s47, s47, 41943040
  v_and_b32 v94, 15, v2
  v_lshlrev_b32 v94, 3, v94
  v_add_u32 v94, s47, v94
  v_xor_b32 v95, 256, v94
  s_waitcnt lgkmcnt(2)
  v_mfma_f32_16x16x32_bf16 v[96:99], v[16:19], v[32:35], v[96:99]
  ds_read_b64_tr_b16 v[28:29], v13 offset:6144
  ds_read_b64_tr_b16 v[30:31], v13 offset:6400
  v_mfma_f32_16x16x32_bf16 v[100:103], v[16:19], v[36:39], v[100:103]
  s_cmp_ge_u32 s28, 4
  s_cbranch_scc1 gemm1_kernel_sk34
  s_add_u32 m0, s38, 40960
  s_nop 0
  buffer_load_dwordx4 v10, s[24:27], s35 offen lds
  s_add_u32 s35, s35, s45
  gemm1_kernel_sk34:
  v_mfma_f32_16x16x32_bf16 v[104:107], v[16:19], v[40:43], v[104:107]
  v_mfma_f32_16x16x32_bf16 v[108:111], v[16:19], v[44:47], v[108:111]
  s_waitcnt lgkmcnt(4)
  v_mfma_f32_16x16x32_bf16 v[112:115], v[20:23], v[32:35], v[112:115]
  ds_read_b64_tr_b16 v[16:17], v13 offset:2048
  ds_read_b64_tr_b16 v[18:19], v13 offset:2304
  v_mfma_f32_16x16x32_bf16 v[116:119], v[20:23], v[36:39], v[116:119]
  v_mfma_f32_16x16x32_bf16 v[120:123], v[20:23], v[40:43], v[120:123]
  s_add_u32 m0, s39, 4096
  s_nop 0
  buffer_load_dwordx4 v11, s[60:63], s41 offen lds
  v_mfma_f32_16x16x32_bf16 v[124:127], v[20:23], v[44:47], v[124:127]
  s_waitcnt lgkmcnt(4)
  v_mfma_f32_16x16x32_bf16 v[128:131], v[24:27], v[32:35], v[128:131]
  ds_read_b64_tr_b16 v[20:21], v13 offset:7168
  ds_read_b64_tr_b16 v[22:23], v13 offset:7424
  v_mfma_f32_16x16x32_bf16 v[132:135], v[24:27], v[36:39], v[132:135]
  v_mfma_f32_16x16x32_bf16 v[136:139], v[24:27], v[40:43], v[136:139]
  v_mfma_f32_16x16x32_bf16 v[140:143], v[24:27], v[44:47], v[140:143]
  s_add_u32 m0, s39, 5120
  s_nop 0
  buffer_load_dwordx4 v12, s[60:63], s41 offen lds
  v_mfma_f32_16x16x32_bf16 v[68:71], v[24:27], v[64:67], v[68:71]
  s_waitcnt lgkmcnt(4)
  v_mfma_f32_16x16x32_bf16 v[144:147], v[28:31], v[32:35], v[144:147]
  ds_read_b64_tr_b16 v[24:25], v13 offset:3072
  ds_read_b64_tr_b16 v[26:27], v13 offset:3328
  v_mfma_f32_16x16x32_bf16 v[148:151], v[28:31], v[36:39], v[148:151]
  v_mfma_f32_16x16x32_bf16 v[152:155], v[28:31], v[40:43], v[152:155]
  v_mfma_f32_16x16x32_bf16 v[156:159], v[28:31], v[44:47], v[156:159]
  s_waitcnt lgkmcnt(4)
  v_mfma_f32_16x16x32_bf16 v[160:163], v[16:19], v[32:35], v[160:163]
  ds_read_b64_tr_b16 v[28:29], v13 offset:8192
  ds_read_b64_tr_b16 v[30:31], v13 offset:8448
  s_add_u32 m0, s39, 6144
  s_nop 0
  buffer_load_dwordx4 v11, s[60:63], s42 offen lds
  v_mfma_f32_16x16x32_bf16 v[164:167], v[16:19], v[36:39], v[164:167]
  v_mfma_f32_16x16x32_bf16 v[168:171], v[16:19], v[40:43], v[168:171]
  v_mfma_f32_16x16x32_bf16 v[172:175], v[16:19], v[44:47], v[172:175]
  s_waitcnt lgkmcnt(4)
  v_mfma_f32_16x16x32_bf16 v[176:179], v[20:23], v[32:35], v[176:179]
  ds_read_b64_tr_b16 v[16:17], v13 offset:4096
  ds_read_b64_tr_b16 v[18:19], v13 offset:4352
  v_mfma_f32_16x16x32_bf16 v[180:183], v[20:23], v[36:39], v[180:183]
  s_add_u32 m0, s39, 7168
  s_nop 0
  buffer_load_dwordx4 v12, s[60:63], s42 offen lds
  s_add_u32 s41, s41, 128
  s_add_u32 s42, s42, 128
  v_mfma_f32_16x16x32_bf16 v[184:187], v[20:23], v[40:43], v[184:187]
  v_mfma_f32_16x16x32_bf16 v[188:191], v[20:23], v[44:47], v[188:191]
  s_waitcnt lgkmcnt(4)
  v_mfma_f32_16x16x32_bf16 v[192:195], v[24:27], v[32:35], v[192:195]
  ds_read_b64_tr_b16 v[20:21], v13 offset:9216
  ds_read_b64_tr_b16 v[22:23], v13 offset:9472
  v_mfma_f32_16x16x32_bf16 v[196:199], v[24:27], v[36:39], v[196:199]
  v_mfma_f32_16x16x32_bf16 v[200:203], v[24:27], v[40:43], v[200:203]
  v_mfma_f32_16x16x32_bf16 v[204:207], v[24:27], v[44:47], v[204:207]
  v_mfma_f32_16x16x32_bf16 v[72:75], v[24:27], v[64:67], v[72:75]
  s_waitcnt vmcnt(8) lgkmcnt(4)
  s_barrier
  v_mfma_f32_16x16x32_bf16 v[208:211], v[28:31], v[32:35], v[208:211]
  ds_read_b64_tr_b16 v[24:25], v13 offset:20480
  ds_read_b64_tr_b16 v[26:27], v13 offset:20736
  v_mfma_f32_16x16x32_bf16 v[212:215], v[28:31], v[36:39], v[212:215]
  ds_read_b128 v[48:51], v6 offset:0
  v_mfma_f32_16x16x32_bf16 v[216:219], v[28:31], v[40:43], v[216:219]
  ds_read_b128 v[52:55], v6 offset:2048
  v_mfma_f32_16x16x32_bf16 v[220:223], v[28:31], v[44:47], v[220:223]
  s_add_u32 m0, s36, 61440
  s_nop 0
  buffer_load_dwordx4 v8, s[16:19], s33 offen lds
  s_add_u32 s33, s33, s43
  s_waitcnt lgkmcnt(6)
  v_mfma_f32_16x16x32_bf16 v[224:227], v[16:19], v[32:35], v[224:227]
  ds_read_b64_tr_b16 v[28:29], v13 offset:25600
  ds_read_b64_tr_b16 v[30:31], v13 offset:25856
  v_mfma_f32_16x16x32_bf16 v[228:231], v[16:19], v[36:39], v[228:231]
  ds_read_b128 v[56:59], v7 offset:0
  v_mfma_f32_16x16x32_bf16 v[232:235], v[16:19], v[40:43], v[232:235]
  ds_read_b128 v[60:63], v7 offset:2048
  v_mfma_f32_16x16x32_bf16 v[236:239], v[16:19], v[44:47], v[236:239]
  s_waitcnt lgkmcnt(8)
  v_mfma_f32_16x16x32_bf16 v[240:243], v[20:23], v[32:35], v[240:243]
  ds_read_b64_tr_b16 v[16:17], v13 offset:21504
  ds_read_b64_tr_b16 v[18:19], v13 offset:21760
  s_add_u32 m0, s37, 61440
  s_nop 0
  buffer_load_dwordx4 v9, s[20:23], s34 offen lds
  s_add_u32 s34, s34, s44
  v_mfma_f32_16x16x32_bf16 v[244:247], v[20:23], v[36:39], v[244:247]
  v_mfma_f32_16x16x32_bf16 v[248:251], v[20:23], v[40:43], v[248:251]
  v_mfma_f32_16x16x32_bf16 v[252:255], v[20:23], v[44:47], v[252:255]
  s_waitcnt lgkmcnt(2)
  v_mfma_f32_16x16x32_bf16 v[96:99], v[24:27], v[48:51], v[96:99]
  ds_read_b64_tr_b16 v[20:21], v13 offset:26624
  ds_read_b64_tr_b16 v[22:23], v13 offset:26880
  v_mfma_f32_16x16x32_bf16 v[100:103], v[24:27], v[52:55], v[100:103]
  s_cmp_ge_u32 s28, 4
  s_cbranch_scc1 gemm1_kernel_sk35
  s_add_u32 m0, s38, 61440
  s_nop 0
  buffer_load_dwordx4 v10, s[24:27], s35 offen lds
  s_add_u32 s35, s35, s45
  gemm1_kernel_sk35:
  v_mfma_f32_16x16x32_bf16 v[104:107], v[24:27], v[56:59], v[104:107]
  v_mfma_f32_16x16x32_bf16 v[108:111], v[24:27], v[60:63], v[108:111]
  s_waitcnt lgkmcnt(4)
  v_mfma_f32_16x16x32_bf16 v[112:115], v[28:31], v[48:51], v[112:115]
  ds_read_b64_tr_b16 v[24:25], v13 offset:22528
  ds_read_b64_tr_b16 v[26:27], v13 offset:22784
  v_mfma_f32_16x16x32_bf16 v[116:119], v[28:31], v[52:55], v[116:119]
  v_mfma_f32_16x16x32_bf16 v[120:123], v[28:31], v[56:59], v[120:123]
  v_mfma_f32_16x16x32_bf16 v[124:127], v[28:31], v[60:63], v[124:127]
  s_waitcnt lgkmcnt(4)
  v_mfma_f32_16x16x32_bf16 v[128:131], v[16:19], v[48:51], v[128:131]
  ds_read_b64_tr_b16 v[28:29], v13 offset:27648
  ds_read_b64_tr_b16 v[30:31], v13 offset:27904
  v_mfma_f32_16x16x32_bf16 v[132:135], v[16:19], v[52:55], v[132:135]
  v_mfma_f32_16x16x32_bf16 v[136:139], v[16:19], v[56:59], v[136:139]
  v_mfma_f32_16x16x32_bf16 v[140:143], v[16:19], v[60:63], v[140:143]
  v_mfma_f32_16x16x32_bf16 v[68:71], v[16:19], v[64:67], v[68:71]
  s_waitcnt lgkmcnt(4)
  v_mfma_f32_16x16x32_bf16 v[144:147], v[20:23], v[48:51], v[144:147]
  ds_read_b64_tr_b16 v[16:17], v13 offset:23552
  ds_read_b64_tr_b16 v[18:19], v13 offset:23808
  v_mfma_f32_16x16x32_bf16 v[148:151], v[20:23], v[52:55], v[148:151]
  v_mfma_f32_16x16x32_bf16 v[152:155], v[20:23], v[56:59], v[152:155]
  v_mfma_f32_16x16x32_bf16 v[156:159], v[20:23], v[60:63], v[156:159]
  s_waitcnt lgkmcnt(4)
  v_mfma_f32_16x16x32_bf16 v[160:163], v[24:27], v[48:51], v[160:163]
  ds_read_b64_tr_b16 v[20:21], v13 offset:28672
  ds_read_b64_tr_b16 v[22:23], v13 offset:28928
  v_mfma_f32_16x16x32_bf16 v[164:167], v[24:27], v[52:55], v[164:167]
  v_mfma_f32_16x16x32_bf16 v[168:171], v[24:27], v[56:59], v[168:171]
  v_mfma_f32_16x16x32_bf16 v[172:175], v[24:27], v[60:63], v[172:175]
  s_waitcnt lgkmcnt(4)
  v_mfma_f32_16x16x32_bf16 v[176:179], v[28:31], v[48:51], v[176:179]
  ds_read_b64_tr_b16 v[24:25], v13 offset:24576
  ds_read_b64_tr_b16 v[26:27], v13 offset:24832
  v_mfma_f32_16x16x32_bf16 v[180:183], v[28:31], v[52:55], v[180:183]
  v_mfma_f32_16x16x32_bf16 v[184:187], v[28:31], v[56:59], v[184:187]
  v_mfma_f32_16x16x32_bf16 v[188:191], v[28:31], v[60:63], v[188:191]
  s_waitcnt lgkmcnt(4)
  v_mfma_f32_16x16x32_bf16 v[192:195], v[16:19], v[48:51], v[192:195]
  ds_read_b64_tr_b16 v[28:29], v13 offset:29696
  ds_read_b64_tr_b16 v[30:31], v13 offset:29952
  v_mfma_f32_16x16x32_bf16 v[196:199], v[16:19], v[52:55], v[196:199]
  v_mfma_f32_16x16x32_bf16 v[200:203], v[16:19], v[56:59], v[200:203]
  v_mfma_f32_16x16x32_bf16 v[204:207], v[16:19], v[60:63], v[204:207]
  v_mfma_f32_16x16x32_bf16 v[72:75], v[16:19], v[64:67], v[72:75]
  s_waitcnt vmcnt(2) lgkmcnt(4)
  s_barrier
  v_mfma_f32_16x16x32_bf16 v[208:211], v[20:23], v[48:51], v[208:211]
  ds_read_b64_tr_b16 v[16:17], v14 offset:0
  ds_read_b64_tr_b16 v[18:19], v14 offset:256
  v_mfma_f32_16x16x32_bf16 v[212:215], v[20:23], v[52:55], v[212:215]
  ds_read_b128 v[32:35], v4 offset:4096
  v_mfma_f32_16x16x32_bf16 v[216:219], v[20:23], v[56:59], v[216:219]
  ds_read_b128 v[36:39], v4 offset:6144
  v_mfma_f32_16x16x32_bf16 v[220:223], v[20:23], v[60:63], v[220:223]
  s_waitcnt lgkmcnt(6)
  v_mfma_f32_16x16x32_bf16 v[224:227], v[24:27], v[48:51], v[224:227]
  ds_read_b64_tr_b16 v[20:21], v14 offset:5120
  ds_read_b64_tr_b16 v[22:23], v14 offset:5376
  v_mfma_f32_16x16x32_bf16 v[228:231], v[24:27], v[52:55], v[228:231]
  ds_read_b128 v[40:43], v5 offset:4096
  v_mfma_f32_16x16x32_bf16 v[232:235], v[24:27], v[56:59], v[232:235]
  ds_read_b128 v[44:47], v5 offset:6144
  v_mfma_f32_16x16x32_bf16 v[236:239], v[24:27], v[60:63], v[236:239]
  s_waitcnt lgkmcnt(8)
  v_mfma_f32_16x16x32_bf16 v[240:243], v[28:31], v[48:51], v[240:243]
  ds_read_b64_tr_b16 v[24:25], v14 offset:1024
  ds_read_b64_tr_b16 v[26:27], v14 offset:1280
  v_mfma_f32_16x16x32_bf16 v[244:247], v[28:31], v[52:55], v[244:247]
  v_mfma_f32_16x16x32_bf16 v[248:251], v[28:31], v[56:59], v[248:251]
  v_mfma_f32_16x16x32_bf16 v[252:255], v[28:31], v[60:63], v[252:255]
  s_waitcnt vmcnt(6)
  v_readfirstlane_b32 s58, v1
  buffer_load_dwordx2 v[80:81], v94, s[12:15], 0 offen offset:0 sc1
  buffer_load_dwordx2 v[82:83], v94, s[12:15], 0 offen offset:128 sc1
  buffer_load_dwordx2 v[84:85], v95, s[12:15], 0 offen offset:0 sc1
  buffer_load_dwordx2 v[86:87], v95, s[12:15], 0 offen offset:128 sc1
  s_waitcnt lgkmcnt(2)
  v_mfma_f32_16x16x32_bf16 v[96:99], v[16:19], v[32:35], v[96:99]
  ds_read_b64_tr_b16 v[28:29], v14 offset:6144
  ds_read_b64_tr_b16 v[30:31], v14 offset:6400
  v_mfma_f32_16x16x32_bf16 v[100:103], v[16:19], v[36:39], v[100:103]
  v_mfma_f32_16x16x32_bf16 v[104:107], v[16:19], v[40:43], v[104:107]
  v_mfma_f32_16x16x32_bf16 v[108:111], v[16:19], v[44:47], v[108:111]
  s_waitcnt lgkmcnt(4)
  v_mfma_f32_16x16x32_bf16 v[112:115], v[20:23], v[32:35], v[112:115]
  ds_read_b64_tr_b16 v[16:17], v14 offset:2048
  ds_read_b64_tr_b16 v[18:19], v14 offset:2304
  v_mfma_f32_16x16x32_bf16 v[116:119], v[20:23], v[36:39], v[116:119]
  v_mfma_f32_16x16x32_bf16 v[120:123], v[20:23], v[40:43], v[120:123]
  v_mfma_f32_16x16x32_bf16 v[124:127], v[20:23], v[44:47], v[124:127]
  s_waitcnt lgkmcnt(4)
  v_mfma_f32_16x16x32_bf16 v[128:131], v[24:27], v[32:35], v[128:131]
  ds_read_b64_tr_b16 v[20:21], v14 offset:7168
  ds_read_b64_tr_b16 v[22:23], v14 offset:7424
  v_mfma_f32_16x16x32_bf16 v[132:135], v[24:27], v[36:39], v[132:135]
  v_mfma_f32_16x16x32_bf16 v[136:139], v[24:27], v[40:43], v[136:139]
  v_mfma_f32_16x16x32_bf16 v[140:143], v[24:27], v[44:47], v[140:143]
  v_mfma_f32_16x16x32_bf16 v[68:71], v[24:27], v[64:67], v[68:71]
  s_waitcnt lgkmcnt(4)
  v_mfma_f32_16x16x32_bf16 v[144:147], v[28:31], v[32:35], v[144:147]
  ds_read_b64_tr_b16 v[24:25], v14 offset:3072
  ds_read_b64_tr_b16 v[26:27], v14 offset:3328
  v_mfma_f32_16x16x32_bf16 v[148:151], v[28:31], v[36:39], v[148:151]
  v_mfma_f32_16x16x32_bf16 v[152:155], v[28:31], v[40:43], v[152:155]
  v_mfma_f32_16x16x32_bf16 v[156:159], v[28:31], v[44:47], v[156:159]
  s_waitcnt lgkmcnt(4)
  v_mfma_f32_16x16x32_bf16 v[160:163], v[16:19], v[32:35], v[160:163]
  ds_read_b64_tr_b16 v[28:29], v14 offset:8192
  ds_read_b64_tr_b16 v[30:31], v14 offset:8448
  v_mfma_f32_16x16x32_bf16 v[164:167], v[16:19], v[36:39], v[164:167]
  v_mfma_f32_16x16x32_bf16 v[168:171], v[16:19], v[40:43], v[168:171]
  v_mfma_f32_16x16x32_bf16 v[172:175], v[16:19], v[44:47], v[172:175]
  s_waitcnt lgkmcnt(4)
  v_mfma_f32_16x16x32_bf16 v[176:179], v[20:23], v[32:35], v[176:179]
  ds_read_b64_tr_b16 v[16:17], v14 offset:4096
  ds_read_b64_tr_b16 v[18:19], v14 offset:4352
  v_mfma_f32_16x16x32_bf16 v[180:183], v[20:23], v[36:39], v[180:183]
  v_mfma_f32_16x16x32_bf16 v[184:187], v[20:23], v[40:43], v[184:187]
  v_mfma_f32_16x16x32_bf16 v[188:191], v[20:23], v[44:47], v[188:191]
  s_waitcnt lgkmcnt(4)
  v_mfma_f32_16x16x32_bf16 v[192:195], v[24:27], v[32:35], v[192:195]
  ds_read_b64_tr_b16 v[20:21], v14 offset:9216
  ds_read_b64_tr_b16 v[22:23], v14 offset:9472
  v_mfma_f32_16x16x32_bf16 v[196:199], v[24:27], v[36:39], v[196:199]
  v_mfma_f32_16x16x32_bf16 v[200:203], v[24:27], v[40:43], v[200:203]
  v_mfma_f32_16x16x32_bf16 v[204:207], v[24:27], v[44:47], v[204:207]
  v_mfma_f32_16x16x32_bf16 v[72:75], v[24:27], v[64:67], v[72:75]
  s_waitcnt vmcnt(4) lgkmcnt(4)
  s_barrier
  v_mfma_f32_16x16x32_bf16 v[208:211], v[28:31], v[32:35], v[208:211]
  ds_read_b64_tr_b16 v[24:25], v14 offset:20480
  ds_read_b64_tr_b16 v[26:27], v14 offset:20736
  v_mfma_f32_16x16x32_bf16 v[212:215], v[28:31], v[36:39], v[212:215]
  ds_read_b128 v[48:51], v6 offset:4096
  v_mfma_f32_16x16x32_bf16 v[216:219], v[28:31], v[40:43], v[216:219]
  ds_read_b128 v[52:55], v6 offset:6144
  v_mfma_f32_16x16x32_bf16 v[220:223], v[28:31], v[44:47], v[220:223]
  s_waitcnt lgkmcnt(6)
  v_mfma_f32_16x16x32_bf16 v[224:227], v[16:19], v[32:35], v[224:227]
  ds_read_b64_tr_b16 v[28:29], v14 offset:25600
  ds_read_b64_tr_b16 v[30:31], v14 offset:25856
  v_mfma_f32_16x16x32_bf16 v[228:231], v[16:19], v[36:39], v[228:231]
  ds_read_b128 v[56:59], v7 offset:4096
  v_mfma_f32_16x16x32_bf16 v[232:235], v[16:19], v[40:43], v[232:235]
  ds_read_b128 v[60:63], v7 offset:6144
  v_mfma_f32_16x16x32_bf16 v[236:239], v[16:19], v[44:47], v[236:239]
  s_waitcnt lgkmcnt(8)
  v_mfma_f32_16x16x32_bf16 v[240:243], v[20:23], v[32:35], v[240:243]
  ds_read_b64_tr_b16 v[16:17], v14 offset:21504
  ds_read_b64_tr_b16 v[18:19], v14 offset:21760
  v_mfma_f32_16x16x32_bf16 v[244:247], v[20:23], v[36:39], v[244:247]
  v_mfma_f32_16x16x32_bf16 v[248:251], v[20:23], v[40:43], v[248:251]
  v_mfma_f32_16x16x32_bf16 v[252:255], v[20:23], v[44:47], v[252:255]
  s_waitcnt lgkmcnt(2)
  v_mfma_f32_16x16x32_bf16 v[96:99], v[24:27], v[48:51], v[96:99]
  ds_read_b64_tr_b16 v[20:21], v14 offset:26624
  ds_read_b64_tr_b16 v[22:23], v14 offset:26880
  v_mfma_f32_16x16x32_bf16 v[100:103], v[24:27], v[52:55], v[100:103]
  v_mfma_f32_16x16x32_bf16 v[104:107], v[24:27], v[56:59], v[104:107]
  v_mfma_f32_16x16x32_bf16 v[108:111], v[24:27], v[60:63], v[108:111]
  s_waitcnt lgkmcnt(4)
  v_mfma_f32_16x16x32_bf16 v[112:115], v[28:31], v[48:51], v[112:115]
  ds_read_b64_tr_b16 v[24:25], v14 offset:22528
  ds_read_b64_tr_b16 v[26:27], v14 offset:22784
  v_mfma_f32_16x16x32_bf16 v[116:119], v[28:31], v[52:55], v[116:119]
  v_mfma_f32_16x16x32_bf16 v[120:123], v[28:31], v[56:59], v[120:123]
  v_mfma_f32_16x16x32_bf16 v[124:127], v[28:31], v[60:63], v[124:127]
  s_waitcnt lgkmcnt(4)
  v_mfma_f32_16x16x32_bf16 v[128:131], v[16:19], v[48:51], v[128:131]
  ds_read_b64_tr_b16 v[28:29], v14 offset:27648
  ds_read_b64_tr_b16 v[30:31], v14 offset:27904
  v_mfma_f32_16x16x32_bf16 v[132:135], v[16:19], v[52:55], v[132:135]
  v_mfma_f32_16x16x32_bf16 v[136:139], v[16:19], v[56:59], v[136:139]
  v_mfma_f32_16x16x32_bf16 v[140:143], v[16:19], v[60:63], v[140:143]
  v_mfma_f32_16x16x32_bf16 v[68:71], v[16:19], v[64:67], v[68:71]
  s_waitcnt lgkmcnt(4)
  v_mfma_f32_16x16x32_bf16 v[144:147], v[20:23], v[48:51], v[144:147]
  ds_read_b64_tr_b16 v[16:17], v14 offset:23552
  ds_read_b64_tr_b16 v[18:19], v14 offset:23808
  v_mfma_f32_16x16x32_bf16 v[148:151], v[20:23], v[52:55], v[148:151]
  v_mfma_f32_16x16x32_bf16 v[152:155], v[20:23], v[56:59], v[152:155]
  v_mfma_f32_16x16x32_bf16 v[156:159], v[20:23], v[60:63], v[156:159]
  s_waitcnt lgkmcnt(4)
  v_mfma_f32_16x16x32_bf16 v[160:163], v[24:27], v[48:51], v[160:163]
  ds_read_b64_tr_b16 v[20:21], v14 offset:28672
  ds_read_b64_tr_b16 v[22:23], v14 offset:28928
  v_mfma_f32_16x16x32_bf16 v[164:167], v[24:27], v[52:55], v[164:167]
  v_mfma_f32_16x16x32_bf16 v[168:171], v[24:27], v[56:59], v[168:171]
  v_mfma_f32_16x16x32_bf16 v[172:175], v[24:27], v[60:63], v[172:175]
  s_waitcnt lgkmcnt(4)
  v_mfma_f32_16x16x32_bf16 v[176:179], v[28:31], v[48:51], v[176:179]
  ds_read_b64_tr_b16 v[24:25], v14 offset:24576
  ds_read_b64_tr_b16 v[26:27], v14 offset:24832
  v_mfma_f32_16x16x32_bf16 v[180:183], v[28:31], v[52:55], v[180:183]
  v_mfma_f32_16x16x32_bf16 v[184:187], v[28:31], v[56:59], v[184:187]
  v_mfma_f32_16x16x32_bf16 v[188:191], v[28:31], v[60:63], v[188:191]
  s_waitcnt lgkmcnt(4)
  v_mfma_f32_16x16x32_bf16 v[192:195], v[16:19], v[48:51], v[192:195]
  ds_read_b64_tr_b16 v[28:29], v14 offset:29696
  ds_read_b64_tr_b16 v[30:31], v14 offset:29952
  v_mfma_f32_16x16x32_bf16 v[196:199], v[16:19], v[52:55], v[196:199]
  v_mfma_f32_16x16x32_bf16 v[200:203], v[16:19], v[56:59], v[200:203]
  v_mfma_f32_16x16x32_bf16 v[204:207], v[16:19], v[60:63], v[204:207]
  v_mfma_f32_16x16x32_bf16 v[72:75], v[16:19], v[64:67], v[72:75]
  s_waitcnt lgkmcnt(4)
  v_mfma_f32_16x16x32_bf16 v[208:211], v[20:23], v[48:51], v[208:211]
  v_mfma_f32_16x16x32_bf16 v[212:215], v[20:23], v[52:55], v[212:215]
  v_mfma_f32_16x16x32_bf16 v[216:219], v[20:23], v[56:59], v[216:219]
  v_mfma_f32_16x16x32_bf16 v[220:223], v[20:23], v[60:63], v[220:223]
  s_waitcnt lgkmcnt(2)
  v_mfma_f32_16x16x32_bf16 v[224:227], v[24:27], v[48:51], v[224:227]
  v_mfma_f32_16x16x32_bf16 v[228:231], v[24:27], v[52:55], v[228:231]
  v_mfma_f32_16x16x32_bf16 v[232:235], v[24:27], v[56:59], v[232:235]
  v_mfma_f32_16x16x32_bf16 v[236:239], v[24:27], v[60:63], v[236:239]
  s_waitcnt lgkmcnt(0)
  v_mfma_f32_16x16x32_bf16 v[240:243], v[28:31], v[48:51], v[240:243]
  v_mfma_f32_16x16x32_bf16 v[244:247], v[28:31], v[52:55], v[244:247]
  v_mfma_f32_16x16x32_bf16 v[248:251], v[28:31], v[56:59], v[248:251]
  v_mfma_f32_16x16x32_bf16 v[252:255], v[28:31], v[60:63], v[252:255]
  v_lshrrev_b32 v3, 4, v2
  s_mul_i32 s47, s29, 640
  s_add_u32 s47, s47, 147456
  v_lshlrev_b32 v10, 4, v3
  v_add_u32 v10, s47, v10
  s_nop 7

  ds_write_b128 v10, v[68:71] offset:128
  ds_write_b128 v10, v[72:75] offset:384
  s_branch gemm1_kernel_epi
gemm1_kernel_p1_3:
  s_waitcnt lgkmcnt(4)
  v_mfma_f32_16x16x32_bf16 v[96:99], v[16:19], v[32:35], 0
  ds_read_b64_tr_b16 v[28:29], v13 offset:6144
  ds_read_b64_tr_b16 v[30:31], v13 offset:6400
  s_waitcnt vmcnt(0)
  s_mov_b32 s47, 0xffff0000
  v_lshlrev_b32 v232, 16, v224
  v_and_b32 v233, s47, v224
  v_mfma_f32_16x16x32_bf16 v[100:103], v[16:19], v[36:39], 0
  s_add_u32 m0, s36, 20480
  s_nop 0
  buffer_load_dwordx4 v8, s[16:19], s33 offen lds
  s_add_u32 s33, s33, s43
  v_lshlrev_b32 v234, 16, v225
  v_and_b32 v235, s47, v225
  v_lshlrev_b32 v236, 16, v226
  v_mfma_f32_16x16x32_bf16 v[104:107], v[16:19], v[40:43], 0
  v_and_b32 v237, s47, v226
  v_lshlrev_b32 v238, 16, v227
  v_and_b32 v239, s47, v227
  v_mfma_f32_16x16x32_bf16 v[108:111], v[16:19], v[44:47], 0
  s_add_u32 m0, s37, 20480
  s_nop 0
  buffer_load_dwordx4 v9, s[20:23], s34 offen lds
  s_add_u32 s34, s34, s44
  v_lshlrev_b32 v240, 16, v228
  v_and_b32 v241, s47, v228
  v_lshlrev_b32 v242, 16, v229
  s_waitcnt lgkmcnt(4)
  v_mfma_f32_16x16x32_bf16 v[112:115], v[20:23], v[32:35], 0
  ds_read_b64_tr_b16 v[16:17], v13 offset:2048
  ds_read_b64_tr_b16 v[18:19], v13 offset:2304
  v_and_b32 v243, s47, v229
  v_lshlrev_b32 v244, 16, v230
  v_and_b32 v245, s47, v230
  v_mfma_f32_16x16x32_bf16 v[116:119], v[20:23], v[36:39], 0
  s_cmp_ge_u32 s28, 4
  s_cbranch_scc1 gemm1_kernel_sk36
  s_add_u32 m0, s38, 20480
  s_nop 0
  buffer_load_dwordx4 v10, s[24:27], s35 offen lds
  s_add_u32 s35, s35, s45
  gemm1_kernel_sk36:
  v_lshlrev_b32 v246, 16, v231
  v_and_b32 v247, s47, v231
  v_add_f32 v248, v232, v233
  v_mfma_f32_16x16x32_bf16 v[120:123], v[20:23], v[40:43], 0
  v_add_f32 v249, v234, v235
  v_add_f32 v248, v248, v236
  v_add_f32 v249, v249, v237
  v_mfma_f32_16x16x32_bf16 v[124:127], v[20:23], v[44:47], 0
  s_add_u32 m0, s39, 4096
  s_nop 0
  buffer_load_dwordx4 v11, s[60:63], s41 offen lds
  v_add_f32 v248, v248, v238
  v_add_f32 v249, v249, v239
  v_add_f32 v248, v248, v240
  s_waitcnt lgkmcnt(4)
  v_mfma_f32_16x16x32_bf16 v[128:131], v[24:27], v[32:35], 0
  ds_read_b64_tr_b16 v[20:21], v13 offset:7168
  ds_read_b64_tr_b16 v[22:23], v13 offset:7424
  v_add_f32 v249, v249, v241
  v_add_f32 v248, v248, v242
  v_add_f32 v249, v249, v243
  v_mfma_f32_16x16x32_bf16 v[132:135], v[24:27], v[36:39], 0
  s_add_u32 m0, s39, 5120
  s_nop 0
  buffer_load_dwordx4 v12, s[60:63], s41 offen lds
  v_add_f32 v248, v248, v244
  v_add_f32 v249, v249, v245
  v_add_f32 v248, v248, v246
  v_mfma_f32_16x16x32_bf16 v[136:139], v[24:27], v[40:43], 0
  v_add_f32 v249, v249, v247
  v_add_f32 v248, v248, v249
  s_nop 1
  v_add_f32_dpp v248, v248, v248 quad_perm:[1,0,3,2] row_mask:0xf bank_mask:0xf
  v_mfma_f32_16x16x32_bf16 v[140:143], v[24:27], v[44:47], 0
  s_add_u32 m0, s39, 6144
  s_nop 0
  buffer_load_dwordx4 v11, s[60:63], s42 offen lds
  s_nop 1
  v_add_f32_dpp v248, v248, v248 quad_perm:[2,3,0,1] row_mask:0xf bank_mask:0xf
  s_nop 1
  v_add_f32_dpp v248, v248, v248 row_half_mirror row_mask:0xf bank_mask:0xf
  s_nop 1
  v_add_f32_dpp v248, v248, v248 row_mirror row_mask:0xf bank_mask:0xf
  s_waitcnt lgkmcnt(4)
  v_mfma_f32_16x16x32_bf16 v[144:147], v[28:31], v[32:35], 0
  ds_read_b64_tr_b16 v[24:25], v13 offset:3072
  ds_read_b64_tr_b16 v[26:27], v13 offset:3328
  v_mov_b32 v250, v248
  s_nop 1
  v_permlane16_swap_b32 v250, v248
  s_nop 0
  v_add_f32 v248, v248, v250
  v_mfma_f32_16x16x32_bf16 v[148:151], v[28:31], v[36:39], 0
  s_add_u32 m0, s39, 7168
  s_nop 0
  buffer_load_dwordx4 v12, s[60:63], s42 offen lds
  s_add_u32 s41, s41, 128
  s_add_u32 s42, s42, 128
  v_mov_b32 v250, v248
  s_nop 1
  v_permlane32_swap_b32 v250, v248
  s_nop 0
  v_add_f32 v248, v248, v250
  v_mfma_f32_16x16x32_bf16 v[152:155], v[28:31], v[40:43], 0
  v_mul_f32 v248, 0xba800000, v248
  v_add_f32 v232, v232, v248
  v_add_f32 v233, v233, v248
  v_mfma_f32_16x16x32_bf16 v[156:159], v[28:31], v[44:47], 0
  s_add_u32 m0, s36, 40960
  s_nop 0
  buffer_load_dwordx4 v8, s[16:19], s33 offen lds
  s_add_u32 s33, s33, s43
  v_mfma_f32_16x16x32_bf16 v[68:71], v[28:31], v[64:67], 0
  v_add_f32 v234, v234, v248
  v_add_f32 v235, v235, v248
  v_add_f32 v236, v236, v248
  s_waitcnt lgkmcnt(4)
  v_mfma_f32_16x16x32_bf16 v[160:163], v[16:19], v[32:35], 0
  ds_read_b64_tr_b16 v[28:29], v13 offset:8192
  ds_read_b64_tr_b16 v[30:31], v13 offset:8448
  v_add_f32 v237, v237, v248
  v_add_f32 v238, v238, v248
  v_add_f32 v239, v239, v248
  v_mfma_f32_16x16x32_bf16 v[164:167], v[16:19], v[36:39], 0
  s_add_u32 m0, s37, 40960
  s_nop 0
  buffer_load_dwordx4 v9, s[20:23], s34 offen lds
  s_add_u32 s34, s34, s44
  v_add_f32 v240, v240, v248
  v_add_f32 v241, v241, v248
  v_add_f32 v242, v242, v248
  v_mfma_f32_16x16x32_bf16 v[168:171], v[16:19], v[40:43], 0
  v_add_f32 v243, v243, v248
  v_add_f32 v244, v244, v248
  v_add_f32 v245, v245, v248
  v_mfma_f32_16x16x32_bf16 v[172:175], v[16:19], v[44:47], 0
  s_cmp_ge_u32 s28, 4
  s_cbranch_scc1 gemm1_kernel_sk37
  s_add_u32 m0, s38, 40960
  s_nop 0
  buffer_load_dwordx4 v10, s[24:27], s35 offen lds
  s_add_u32 s35, s35, s45
  gemm1_kernel_sk37:
  v_add_f32 v246, v246, v248
  v_add_f32 v247, v247, v248
  v_mul_f32 v249, v232, v232
  s_waitcnt lgkmcnt(4)
  v_mfma_f32_16x16x32_bf16 v[176:179], v[20:23], v[32:35], 0
  ds_read_b64_tr_b16 v[16:17], v13 offset:4096
  ds_read_b64_tr_b16 v[18:19], v13 offset:4352
  v_mul_f32 v250, v233, v233
  v_fmac_f32 v249, v234, v234
  v_fmac_f32 v250, v235, v235
  v_mfma_f32_16x16x32_bf16 v[180:183], v[20:23], v[36:39], 0
  buffer_load_dword v88, v89, s[64:67], s97 offen
  s_add_u32 s97, s97, s98
  v_fmac_f32 v249, v236, v236
  v_fmac_f32 v250, v237, v237
  v_fmac_f32 v249, v238, v238
  v_mfma_f32_16x16x32_bf16 v[184:187], v[20:23], v[40:43], 0
  v_fmac_f32 v250, v239, v239
  v_fmac_f32 v249, v240, v240
  v_fmac_f32 v250, v241, v241
  v_mfma_f32_16x16x32_bf16 v[188:191], v[20:23], v[44:47], 0
  v_fmac_f32 v249, v242, v242
  v_fmac_f32 v250, v243, v243
  v_fmac_f32 v249, v244, v244
  s_waitcnt lgkmcnt(4)
  v_mfma_f32_16x16x32_bf16 v[192:195], v[24:27], v[32:35], 0
  ds_read_b64_tr_b16 v[20:21], v13 offset:9216
  ds_read_b64_tr_b16 v[22:23], v13 offset:9472
  v_fmac_f32 v250, v245, v245
  v_fmac_f32 v249, v246, v246
  v_fmac_f32 v250, v247, v247
  v_mfma_f32_16x16x32_bf16 v[196:199], v[24:27], v[36:39], 0
  v_add_f32 v249, v249, v250
  s_nop 1
  v_add_f32_dpp v249, v249, v249 quad_perm:[1,0,3,2] row_mask:0xf bank_mask:0xf
  s_nop 1
  v_add_f32_dpp v249, v249, v249 quad_perm:[2,3,0,1] row_mask:0xf bank_mask:0xf
  v_mfma_f32_16x16x32_bf16 v[200:203], v[24:27], v[40:43], 0
  s_nop 1
  v_add_f32_dpp v249, v249, v249 row_half_mirror row_mask:0xf bank_mask:0xf
  s_nop 1
  v_add_f32_dpp v249, v249, v249 row_mirror row_mask:0xf bank_mask:0xf
  v_mov_b32 v250, v249
  v_mfma_f32_16x16x32_bf16 v[204:207], v[24:27], v[44:47], 0
  s_nop 1
  v_permlane16_swap_b32 v250, v249
  s_nop 0
  v_add_f32 v249, v249, v250
  v_mov_b32 v250, v249
  s_waitcnt vmcnt(7) lgkmcnt(4)
  s_barrier
  v_mfma_f32_16x16x32_bf16 v[208:211], v[28:31], v[32:35], 0
  ds_read_b64_tr_b16 v[24:25], v13 offset:20480
  ds_read_b64_tr_b16 v[26:27], v13 offset:20736
  s_nop 1
  v_permlane32_swap_b32 v250, v249
  s_nop 0
  v_add_f32 v249, v249, v250
  v_mov_b32 v250, 0x3727c5ac
  v_mfma_f32_16x16x32_bf16 v[212:215], v[28:31], v[36:39], 0
  ds_read_b128 v[48:51], v6 offset:0
  v_fmac_f32 v250, 0x3a800000, v249
  v_mov_b32 v249, v250
  s_lshl_b32 s47, s55, 3
  s_add_u32 s47, s47, 41943040
  s_lshl_b32 s48, s2, 2
  s_add_u32 s48, s48, 42008576
  s_mov_b64 exec, 1
  buffer_store_dwordx2 v[248:249], v15, s[12:15], s47 offen sc1
  buffer_store_dword v15, v15, s[12:15], s48 offen
  s_mov_b64 exec, -1
  s_nop 3
  v_mfma_f32_16x16x32_bf16 v[216:219], v[28:31], v[40:43], 0
  ds_read_b128 v[52:55], v6 offset:2048
  v_mfma_f32_16x16x32_bf16 v[220:223], v[28:31], v[44:47], 0
  v_mfma_f32_16x16x32_bf16 v[72:75], v[28:31], v[64:67], 0
  s_waitcnt lgkmcnt(6)
  v_mfma_f32_16x16x32_bf16 v[224:227], v[16:19], v[32:35], 0
  ds_read_b64_tr_b16 v[28:29], v13 offset:25600
  ds_read_b64_tr_b16 v[30:31], v13 offset:25856
  s_add_u32 m0, s36, 61440
  s_nop 0
  buffer_load_dwordx4 v8, s[16:19], s33 offen lds
  s_add_u32 s33, s33, s43
  v_mfma_f32_16x16x32_bf16 v[228:231], v[16:19], v[36:39], 0
  ds_read_b128 v[56:59], v7 offset:0
  v_mfma_f32_16x16x32_bf16 v[232:235], v[16:19], v[40:43], 0
  ds_read_b128 v[60:63], v7 offset:2048
  v_mfma_f32_16x16x32_bf16 v[236:239], v[16:19], v[44:47], 0
  s_waitcnt lgkmcnt(8)
  v_mfma_f32_16x16x32_bf16 v[240:243], v[20:23], v[32:35], 0
  ds_read_b64_tr_b16 v[16:17], v13 offset:21504
  ds_read_b64_tr_b16 v[18:19], v13 offset:21760
  v_mfma_f32_16x16x32_bf16 v[244:247], v[20:23], v[36:39], 0
  s_add_u32 m0, s37, 61440
  s_nop 0
  buffer_load_dwordx4 v9, s[20:23], s34 offen lds
  s_add_u32 s34, s34, s44
  v_mfma_f32_16x16x32_bf16 v[248:251], v[20:23], v[40:43], 0
  v_mfma_f32_16x16x32_bf16 v[252:255], v[20:23], v[44:47], 0
  s_waitcnt lgkmcnt(2)
  v_mfma_f32_16x16x32_bf16 v[96:99], v[24:27], v[48:51], v[96:99]
  ds_read_b64_tr_b16 v[20:21], v13 offset:26624
  ds_read_b64_tr_b16 v[22:23], v13 offset:26880
  v_mfma_f32_16x16x32_bf16 v[100:103], v[24:27], v[52:55], v[100:103]
  v_mfma_f32_16x16x32_bf16 v[104:107], v[24:27], v[56:59], v[104:107]
  s_cmp_ge_u32 s28, 4
  s_cbranch_scc1 gemm1_kernel_sk38
  s_add_u32 m0, s38, 61440
  s_nop 0
  buffer_load_dwordx4 v10, s[24:27], s35 offen lds
  s_add_u32 s35, s35, s45
  gemm1_kernel_sk38:
  v_mfma_f32_16x16x32_bf16 v[108:111], v[24:27], v[60:63], v[108:111]
  s_waitcnt lgkmcnt(4)
  v_mfma_f32_16x16x32_bf16 v[112:115], v[28:31], v[48:51], v[112:115]
  ds_read_b64_tr_b16 v[24:25], v13 offset:22528
  ds_read_b64_tr_b16 v[26:27], v13 offset:22784
  v_mfma_f32_16x16x32_bf16 v[116:119], v[28:31], v[52:55], v[116:119]
  v_mfma_f32_16x16x32_bf16 v[120:123], v[28:31], v[56:59], v[120:123]
  v_mfma_f32_16x16x32_bf16 v[124:127], v[28:31], v[60:63], v[124:127]
  buffer_load_dword v88, v89, s[64:67], s97 offen
  s_add_u32 s97, s97, s98
  s_waitcnt lgkmcnt(4)
  v_mfma_f32_16x16x32_bf16 v[128:131], v[16:19], v[48:51], v[128:131]
  ds_read_b64_tr_b16 v[28:29], v13 offset:27648
  ds_read_b64_tr_b16 v[30:31], v13 offset:27904
  v_mfma_f32_16x16x32_bf16 v[132:135], v[16:19], v[52:55], v[132:135]
  v_mfma_f32_16x16x32_bf16 v[136:139], v[16:19], v[56:59], v[136:139]
  v_mfma_f32_16x16x32_bf16 v[140:143], v[16:19], v[60:63], v[140:143]
  s_waitcnt lgkmcnt(4)
  v_mfma_f32_16x16x32_bf16 v[144:147], v[20:23], v[48:51], v[144:147]
  ds_read_b64_tr_b16 v[16:17], v13 offset:23552
  ds_read_b64_tr_b16 v[18:19], v13 offset:23808
  v_mfma_f32_16x16x32_bf16 v[148:151], v[20:23], v[52:55], v[148:151]
  v_mfma_f32_16x16x32_bf16 v[152:155], v[20:23], v[56:59], v[152:155]
  v_mfma_f32_16x16x32_bf16 v[156:159], v[20:23], v[60:63], v[156:159]
  v_mfma_f32_16x16x32_bf16 v[68:71], v[20:23], v[64:67], v[68:71]
  s_waitcnt lgkmcnt(4)
  v_mfma_f32_16x16x32_bf16 v[160:163], v[24:27], v[48:51], v[160:163]
  ds_read_b64_tr_b16 v[20:21], v13 offset:28672
  ds_read_b64_tr_b16 v[22:23], v13 offset:28928
  v_mfma_f32_16x16x32_bf16 v[164:167], v[24:27], v[52:55], v[164:167]
  v_mfma_f32_16x16x32_bf16 v[168:171], v[24:27], v[56:59], v[168:171]
  v_mfma_f32_16x16x32_bf16 v[172:175], v[24:27], v[60:63], v[172:175]
  s_waitcnt lgkmcnt(4)
  v_mfma_f32_16x16x32_bf16 v[176:179], v[28:31], v[48:51], v[176:179]
  ds_read_b64_tr_b16 v[24:25], v13 offset:24576
  ds_read_b64_tr_b16 v[26:27], v13 offset:24832
  v_mfma_f32_16x16x32_bf16 v[180:183], v[28:31], v[52:55], v[180:183]
  v_mfma_f32_16x16x32_bf16 v[184:187], v[28:31], v[56:59], v[184:187]
  v_mfma_f32_16x16x32_bf16 v[188:191], v[28:31], v[60:63], v[188:191]
  s_waitcnt lgkmcnt(4)
  v_mfma_f32_16x16x32_bf16 v[192:195], v[16:19], v[48:51], v[192:195]
  ds_read_b64_tr_b16 v[28:29], v13 offset:29696
  ds_read_b64_tr_b16 v[30:31], v13 offset:29952
  v_mfma_f32_16x16x32_bf16 v[196:199], v[16:19], v[52:55], v[196:199]
  v_mfma_f32_16x16x32_bf16 v[200:203], v[16:19], v[56:59], v[200:203]
  v_mfma_f32_16x16x32_bf16 v[204:207], v[16:19], v[60:63], v[204:207]
  s_waitcnt vmcnt(6) lgkmcnt(4)
  s_barrier
  v_mfma_f32_16x16x32_bf16 v[208:211], v[20:23], v[48:51], v[208:211]
  ds_read_b64_tr_b16 v[16:17], v14 offset:0
  ds_read_b64_tr_b16 v[18:19], v14 offset:256
  v_mfma_f32_16x16x32_bf16 v[212:215], v[20:23], v[52:55], v[212:215]
  ds_read_b128 v[32:35], v4 offset:4096
  v_mfma_f32_16x16x32_bf16 v[216:219], v[20:23], v[56:59], v[216:219]
  ds_read_b128 v[36:39], v4 offset:6144
  v_mfma_f32_16x16x32_bf16 v[220:223], v[20:23], v[60:63], v[220:223]
  v_mfma_f32_16x16x32_bf16 v[72:75], v[20:23], v[64:67], v[72:75]
  s_waitcnt lgkmcnt(6)
  v_mfma_f32_16x16x32_bf16 v[224:227], v[24:27], v[48:51], v[224:227]
  ds_read_b64_tr_b16 v[20:21], v14 offset:5120
  ds_read_b64_tr_b16 v[22:23], v14 offset:5376
  s_add_u32 m0, s36, 0
  s_nop 0
  buffer_load_dwordx4 v8, s[16:19], s33 offen lds
  s_add_u32 s33, s33, s43
  v_mfma_f32_16x16x32_bf16 v[228:231], v[24:27], v[52:55], v[228:231]
  ds_read_b128 v[40:43], v5 offset:4096
  v_mfma_f32_16x16x32_bf16 v[232:235], v[24:27], v[56:59], v[232:235]
  ds_read_b128 v[44:47], v5 offset:6144
  v_mfma_f32_16x16x32_bf16 v[236:239], v[24:27], v[60:63], v[236:239]
  s_waitcnt lgkmcnt(8)
  v_mfma_f32_16x16x32_bf16 v[240:243], v[28:31], v[48:51], v[240:243]
  ds_read_b64_tr_b16 v[24:25], v14 offset:1024
  ds_read_b64_tr_b16 v[26:27], v14 offset:1280
  v_mfma_f32_16x16x32_bf16 v[244:247], v[28:31], v[52:55], v[244:247]
  s_add_u32 m0, s37, 0
  s_nop 0
  buffer_load_dwordx4 v9, s[20:23], s34 offen lds
  s_add_u32 s34, s34, s44
  v_mfma_f32_16x16x32_bf16 v[248:251], v[28:31], v[56:59], v[248:251]
  v_mfma_f32_16x16x32_bf16 v[252:255], v[28:31], v[60:63], v[252:255]
  s_waitcnt lgkmcnt(2)
  v_mfma_f32_16x16x32_bf16 v[96:99], v[16:19], v[32:35], v[96:99]
  ds_read_b64_tr_b16 v[28:29], v14 offset:6144
  ds_read_b64_tr_b16 v[30:31], v14 offset:6400
  v_mfma_f32_16x16x32_bf16 v[100:103], v[16:19], v[36:39], v[100:103]
  v_mfma_f32_16x16x32_bf16 v[104:107], v[16:19], v[40:43], v[104:107]
  s_cmp_ge_u32 s28, 4
  s_cbranch_scc1 gemm1_kernel_sk39
  s_add_u32 m0, s38, 0
  s_nop 0
  buffer_load_dwordx4 v10, s[24:27], s35 offen lds
  s_add_u32 s35, s35, s45
  gemm1_kernel_sk39:
  v_mfma_f32_16x16x32_bf16 v[108:111], v[16:19], v[44:47], v[108:111]
  s_waitcnt lgkmcnt(4)
  v_mfma_f32_16x16x32_bf16 v[112:115], v[20:23], v[32:35], v[112:115]
  ds_read_b64_tr_b16 v[16:17], v14 offset:2048
  ds_read_b64_tr_b16 v[18:19], v14 offset:2304
  v_mfma_f32_16x16x32_bf16 v[116:119], v[20:23], v[36:39], v[116:119]
  v_mfma_f32_16x16x32_bf16 v[120:123], v[20:23], v[40:43], v[120:123]
  v_mfma_f32_16x16x32_bf16 v[124:127], v[20:23], v[44:47], v[124:127]
  s_add_u32 m0, s39, 0
  s_nop 0
  buffer_load_dwordx4 v11, s[60:63], s41 offen lds
  s_waitcnt lgkmcnt(4)
  v_mfma_f32_16x16x32_bf16 v[128:131], v[24:27], v[32:35], v[128:131]
  ds_read_b64_tr_b16 v[20:21], v14 offset:7168
  ds_read_b64_tr_b16 v[22:23], v14 offset:7424
  v_mfma_f32_16x16x32_bf16 v[132:135], v[24:27], v[36:39], v[132:135]
  v_mfma_f32_16x16x32_bf16 v[136:139], v[24:27], v[40:43], v[136:139]
  v_mfma_f32_16x16x32_bf16 v[140:143], v[24:27], v[44:47], v[140:143]
  s_waitcnt lgkmcnt(4)
  v_mfma_f32_16x16x32_bf16 v[144:147], v[28:31], v[32:35], v[144:147]
  ds_read_b64_tr_b16 v[24:25], v14 offset:3072
  ds_read_b64_tr_b16 v[26:27], v14 offset:3328
  s_add_u32 m0, s39, 1024
  s_nop 0
  buffer_load_dwordx4 v12, s[60:63], s41 offen lds
  v_mfma_f32_16x16x32_bf16 v[148:151], v[28:31], v[36:39], v[148:151]
  v_mfma_f32_16x16x32_bf16 v[152:155], v[28:31], v[40:43], v[152:155]
  v_mfma_f32_16x16x32_bf16 v[156:159], v[28:31], v[44:47], v[156:159]
  v_mfma_f32_16x16x32_bf16 v[68:71], v[28:31], v[64:67], v[68:71]
  s_waitcnt lgkmcnt(4)
  v_mfma_f32_16x16x32_bf16 v[160:163], v[16:19], v[32:35], v[160:163]
  ds_read_b64_tr_b16 v[28:29], v14 offset:8192
  ds_read_b64_tr_b16 v[30:31], v14 offset:8448
  v_mfma_f32_16x16x32_bf16 v[164:167], v[16:19], v[36:39], v[164:167]
  s_add_u32 m0, s39, 2048
  s_nop 0
  buffer_load_dwordx4 v11, s[60:63], s42 offen lds
  v_mfma_f32_16x16x32_bf16 v[168:171], v[16:19], v[40:43], v[168:171]
  v_mfma_f32_16x16x32_bf16 v[172:175], v[16:19], v[44:47], v[172:175]
  s_waitcnt lgkmcnt(4)
  v_mfma_f32_16x16x32_bf16 v[176:179], v[20:23], v[32:35], v[176:179]
  ds_read_b64_tr_b16 v[16:17], v14 offset:4096
  ds_read_b64_tr_b16 v[18:19], v14 offset:4352
  v_mfma_f32_16x16x32_bf16 v[180:183], v[20:23], v[36:39], v[180:183]
  v_mfma_f32_16x16x32_bf16 v[184:187], v[20:23], v[40:43], v[184:187]
  s_add_u32 m0, s39, 3072
  s_nop 0
  buffer_load_dwordx4 v12, s[60:63], s42 offen lds
  s_add_u32 s41, s41, 128
  s_add_u32 s42, s42, 128
  v_mfma_f32_16x16x32_bf16 v[188:191], v[20:23], v[44:47], v[188:191]
  s_waitcnt lgkmcnt(4)
  v_mfma_f32_16x16x32_bf16 v[192:195], v[24:27], v[32:35], v[192:195]
  ds_read_b64_tr_b16 v[20:21], v14 offset:9216
  ds_read_b64_tr_b16 v[22:23], v14 offset:9472
  v_mfma_f32_16x16x32_bf16 v[196:199], v[24:27], v[36:39], v[196:199]
  v_mfma_f32_16x16x32_bf16 v[200:203], v[24:27], v[40:43], v[200:203]
  v_mfma_f32_16x16x32_bf16 v[204:207], v[24:27], v[44:47], v[204:207]
  s_waitcnt vmcnt(7) lgkmcnt(4)
  s_barrier
  v_mfma_f32_16x16x32_bf16 v[208:211], v[28:31], v[32:35], v[208:211]
  ds_read_b64_tr_b16 v[24:25], v14 offset:20480
  ds_read_b64_tr_b16 v[26:27], v14 offset:20736
  v_mfma_f32_16x16x32_bf16 v[212:215], v[28:31], v[36:39], v[212:215]
  ds_read_b128 v[48:51], v6 offset:4096
  v_mfma_f32_16x16x32_bf16 v[216:219], v[28:31], v[40:43], v[216:219]
  ds_read_b128 v[52:55], v6 offset:6144
  v_mfma_f32_16x16x32_bf16 v[220:223], v[28:31], v[44:47], v[220:223]
  v_mfma_f32_16x16x32_bf16 v[72:75], v[28:31], v[64:67], v[72:75]
  s_waitcnt lgkmcnt(6)
  v_mfma_f32_16x16x32_bf16 v[224:227], v[16:19], v[32:35], v[224:227]
  ds_read_b64_tr_b16 v[28:29], v14 offset:25600
  ds_read_b64_tr_b16 v[30:31], v14 offset:25856
  s_add_u32 m0, s36, 20480
  s_nop 0
  buffer_load_dwordx4 v8, s[16:19], s33 offen lds
  s_add_u32 s33, s33, s43
  v_mfma_f32_16x16x32_bf16 v[228:231], v[16:19], v[36:39], v[228:231]
  ds_read_b128 v[56:59], v7 offset:4096
  v_mfma_f32_16x16x32_bf16 v[232:235], v[16:19], v[40:43], v[232:235]
  ds_read_b128 v[60:63], v7 offset:6144
  v_mfma_f32_16x16x32_bf16 v[236:239], v[16:19], v[44:47], v[236:239]
  s_waitcnt lgkmcnt(8)
  v_mfma_f32_16x16x32_bf16 v[240:243], v[20:23], v[32:35], v[240:243]
  ds_read_b64_tr_b16 v[16:17], v14 offset:21504
  ds_read_b64_tr_b16 v[18:19], v14 offset:21760
  v_mfma_f32_16x16x32_bf16 v[244:247], v[20:23], v[36:39], v[244:247]
  s_add_u32 m0, s37, 20480
  s_nop 0
  buffer_load_dwordx4 v9, s[20:23], s34 offen lds
  s_add_u32 s34, s34, s44
  v_mfma_f32_16x16x32_bf16 v[248:251], v[20:23], v[40:43], v[248:251]
  v_mfma_f32_16x16x32_bf16 v[252:255], v[20:23], v[44:47], v[252:255]
  s_waitcnt lgkmcnt(2)
  v_mfma_f32_16x16x32_bf16 v[96:99], v[24:27], v[48:51], v[96:99]
  ds_read_b64_tr_b16 v[20:21], v14 offset:26624
  ds_read_b64_tr_b16 v[22:23], v14 offset:26880
  v_mfma_f32_16x16x32_bf16 v[100:103], v[24:27], v[52:55], v[100:103]
  v_mfma_f32_16x16x32_bf16 v[104:107], v[24:27], v[56:59], v[104:107]
  s_cmp_ge_u32 s28, 4
  s_cbranch_scc1 gemm1_kernel_sk40
  s_add_u32 m0, s38, 20480
  s_nop 0
  buffer_load_dwordx4 v10, s[24:27], s35 offen lds
  s_add_u32 s35, s35, s45
  gemm1_kernel_sk40:
  v_mfma_f32_16x16x32_bf16 v[108:111], v[24:27], v[60:63], v[108:111]
  s_waitcnt lgkmcnt(4)
  v_mfma_f32_16x16x32_bf16 v[112:115], v[28:31], v[48:51], v[112:115]
  ds_read_b64_tr_b16 v[24:25], v14 offset:22528
  ds_read_b64_tr_b16 v[26:27], v14 offset:22784
  v_mfma_f32_16x16x32_bf16 v[116:119], v[28:31], v[52:55], v[116:119]
  v_mfma_f32_16x16x32_bf16 v[120:123], v[28:31], v[56:59], v[120:123]
  v_mfma_f32_16x16x32_bf16 v[124:127], v[28:31], v[60:63], v[124:127]
  buffer_load_dword v88, v89, s[64:67], s97 offen
  s_add_u32 s97, s97, s98
  s_waitcnt lgkmcnt(4)
  v_mfma_f32_16x16x32_bf16 v[128:131], v[16:19], v[48:51], v[128:131]
  ds_read_b64_tr_b16 v[28:29], v14 offset:27648
  ds_read_b64_tr_b16 v[30:31], v14 offset:27904
  v_mfma_f32_16x16x32_bf16 v[132:135], v[16:19], v[52:55], v[132:135]
  v_mfma_f32_16x16x32_bf16 v[136:139], v[16:19], v[56:59], v[136:139]
  v_mfma_f32_16x16x32_bf16 v[140:143], v[16:19], v[60:63], v[140:143]
  s_waitcnt lgkmcnt(4)
  v_mfma_f32_16x16x32_bf16 v[144:147], v[20:23], v[48:51], v[144:147]
  ds_read_b64_tr_b16 v[16:17], v14 offset:23552
  ds_read_b64_tr_b16 v[18:19], v14 offset:23808
  v_mfma_f32_16x16x32_bf16 v[148:151], v[20:23], v[52:55], v[148:151]
  v_mfma_f32_16x16x32_bf16 v[152:155], v[20:23], v[56:59], v[152:155]
  v_mfma_f32_16x16x32_bf16 v[156:159], v[20:23], v[60:63], v[156:159]
  v_mfma_f32_16x16x32_bf16 v[68:71], v[20:23], v[64:67], v[68:71]
  s_waitcnt lgkmcnt(4)
  v_mfma_f32_16x16x32_bf16 v[160:163], v[24:27], v[48:51], v[160:163]
  ds_read_b64_tr_b16 v[20:21], v14 offset:28672
  ds_read_b64_tr_b16 v[22:23], v14 offset:28928
  v_mfma_f32_16x16x32_bf16 v[164:167], v[24:27], v[52:55], v[164:167]
  v_mfma_f32_16x16x32_bf16 v[168:171], v[24:27], v[56:59], v[168:171]
  v_mfma_f32_16x16x32_bf16 v[172:175], v[24:27], v[60:63], v[172:175]
  s_waitcnt lgkmcnt(4)
  v_mfma_f32_16x16x32_bf16 v[176:179], v[28:31], v[48:51], v[176:179]
  ds_read_b64_tr_b16 v[24:25], v14 offset:24576
  ds_read_b64_tr_b16 v[26:27], v14 offset:24832
  v_mfma_f32_16x16x32_bf16 v[180:183], v[28:31], v[52:55], v[180:183]
  v_mfma_f32_16x16x32_bf16 v[184:187], v[28:31], v[56:59], v[184:187]
  v_mfma_f32_16x16x32_bf16 v[188:191], v[28:31], v[60:63], v[188:191]
  s_waitcnt lgkmcnt(4)
  v_mfma_f32_16x16x32_bf16 v[192:195], v[16:19], v[48:51], v[192:195]
  ds_read_b64_tr_b16 v[28:29], v14 offset:29696
  ds_read_b64_tr_b16 v[30:31], v14 offset:29952
  v_mfma_f32_16x16x32_bf16 v[196:199], v[16:19], v[52:55], v[196:199]
  v_mfma_f32_16x16x32_bf16 v[200:203], v[16:19], v[56:59], v[200:203]
  v_mfma_f32_16x16x32_bf16 v[204:207], v[16:19], v[60:63], v[204:207]
  s_waitcnt vmcnt(3) lgkmcnt(4)
  s_barrier
  v_mfma_f32_16x16x32_bf16 v[208:211], v[20:23], v[48:51], v[208:211]
  ds_read_b64_tr_b16 v[16:17], v13 offset:0
  ds_read_b64_tr_b16 v[18:19], v13 offset:256
  v_mfma_f32_16x16x32_bf16 v[212:215], v[20:23], v[52:55], v[212:215]
  ds_read_b128 v[32:35], v4 offset:0
  v_mfma_f32_16x16x32_bf16 v[216:219], v[20:23], v[56:59], v[216:219]
  ds_read_b128 v[36:39], v4 offset:2048
  v_mfma_f32_16x16x32_bf16 v[220:223], v[20:23], v[60:63], v[220:223]
  v_mfma_f32_16x16x32_bf16 v[72:75], v[20:23], v[64:67], v[72:75]
  s_waitcnt lgkmcnt(6)
  v_mfma_f32_16x16x32_bf16 v[224:227], v[24:27], v[48:51], v[224:227]
  ds_read_b64_tr_b16 v[20:21], v13 offset:5120
  ds_read_b64_tr_b16 v[22:23], v13 offset:5376
  s_add_u32 m0, s36, 40960
  s_nop 0
  buffer_load_dwordx4 v8, s[16:19], s33 offen lds
  s_add_u32 s33, s33, s43
  v_mfma_f32_16x16x32_bf16 v[228:231], v[24:27], v[52:55], v[228:231]
  ds_read_b128 v[40:43], v5 offset:0
  v_mfma_f32_16x16x32_bf16 v[232:235], v[24:27], v[56:59], v[232:235]
  ds_read_b128 v[44:47], v5 offset:2048
  v_mfma_f32_16x16x32_bf16 v[236:239], v[24:27], v[60:63], v[236:239]
  s_waitcnt lgkmcnt(8)
  v_mfma_f32_16x16x32_bf16 v[240:243], v[28:31], v[48:51], v[240:243]
  ds_read_b64_tr_b16 v[24:25], v13 offset:1024
  ds_read_b64_tr_b16 v[26:27], v13 offset:1280
  v_mfma_f32_16x16x32_bf16 v[244:247], v[28:31], v[52:55], v[244:247]
  s_add_u32 m0, s37, 40960
  s_nop 0
  buffer_load_dwordx4 v9, s[20:23], s34 offen lds
  s_add_u32 s34, s34, s44
  v_mfma_f32_16x16x32_bf16 v[248:251], v[28:31], v[56:59], v[248:251]
  v_mfma_f32_16x16x32_bf16 v[252:255], v[28:31], v[60:63], v[252:255]
gemm1_kernel_loop3:
  s_waitcnt lgkmcnt(2)
  v_mfma_f32_16x16x32_bf16 v[96:99], v[16:19], v[32:35], v[96:99]
  ds_read_b64_tr_b16 v[28:29], v13 offset:6144
  ds_read_b64_tr_b16 v[30:31], v13 offset:6400
  v_mfma_f32_16x16x32_bf16 v[100:103], v[16:19], v[36:39], v[100:103]
  v_mfma_f32_16x16x32_bf16 v[104:107], v[16:19], v[40:43], v[104:107]
  s_cmp_ge_u32 s28, 4
  s_cbranch_scc1 gemm1_kernel_sk41
  s_add_u32 m0, s38, 40960
  s_nop 0
  buffer_load_dwordx4 v10, s[24:27], s35 offen lds
  s_add_u32 s35, s35, s45
  gemm1_kernel_sk41:
  v_mfma_f32_16x16x32_bf16 v[108:111], v[16:19], v[44:47], v[108:111]
  s_waitcnt lgkmcnt(4)
  v_mfma_f32_16x16x32_bf16 v[112:115], v[20:23], v[32:35], v[112:115]
  ds_read_b64_tr_b16 v[16:17], v13 offset:2048
  ds_read_b64_tr_b16 v[18:19], v13 offset:2304
  v_mfma_f32_16x16x32_bf16 v[116:119], v[20:23], v[36:39], v[116:119]
  v_mfma_f32_16x16x32_bf16 v[120:123], v[20:23], v[40:43], v[120:123]
  v_mfma_f32_16x16x32_bf16 v[124:127], v[20:23], v[44:47], v[124:127]
  s_add_u32 m0, s39, 4096
  s_nop 0
  buffer_load_dwordx4 v11, s[60:63], s41 offen lds
  s_waitcnt lgkmcnt(4)
  v_mfma_f32_16x16x32_bf16 v[128:131], v[24:27], v[32:35], v[128:131]
  ds_read_b64_tr_b16 v[20:21], v13 offset:7168
  ds_read_b64_tr_b16 v[22:23], v13 offset:7424
  v_mfma_f32_16x16x32_bf16 v[132:135], v[24:27], v[36:39], v[132:135]
  v_mfma_f32_16x16x32_bf16 v[136:139], v[24:27], v[40:43], v[136:139]
  v_mfma_f32_16x16x32_bf16 v[140:143], v[24:27], v[44:47], v[140:143]
  s_waitcnt lgkmcnt(4)
  v_mfma_f32_16x16x32_bf16 v[144:147], v[28:31], v[32:35], v[144:147]
  ds_read_b64_tr_b16 v[24:25], v13 offset:3072
  ds_read_b64_tr_b16 v[26:27], v13 offset:3328
  s_add_u32 m0, s39, 5120
  s_nop 0
  buffer_load_dwordx4 v12, s[60:63], s41 offen lds
  v_mfma_f32_16x16x32_bf16 v[148:151], v[28:31], v[36:39], v[148:151]
  v_mfma_f32_16x16x32_bf16 v[152:155], v[28:31], v[40:43], v[152:155]
  v_mfma_f32_16x16x32_bf16 v[156:159], v[28:31], v[44:47], v[156:159]
  v_mfma_f32_16x16x32_bf16 v[68:71], v[28:31], v[64:67], v[68:71]
  s_waitcnt lgkmcnt(4)
  v_mfma_f32_16x16x32_bf16 v[160:163], v[16:19], v[32:35], v[160:163]
  ds_read_b64_tr_b16 v[28:29], v13 offset:8192
  ds_read_b64_tr_b16 v[30:31], v13 offset:8448
  v_mfma_f32_16x16x32_bf16 v[164:167], v[16:19], v[36:39], v[164:167]
  s_add_u32 m0, s39, 6144
  s_nop 0
  buffer_load_dwordx4 v11, s[60:63], s42 offen lds
  v_mfma_f32_16x16x32_bf16 v[168:171], v[16:19], v[40:43], v[168:171]
  v_mfma_f32_16x16x32_bf16 v[172:175], v[16:19], v[44:47], v[172:175]
  s_waitcnt lgkmcnt(4)
  v_mfma_f32_16x16x32_bf16 v[176:179], v[20:23], v[32:35], v[176:179]
  ds_read_b64_tr_b16 v[16:17], v13 offset:4096
  ds_read_b64_tr_b16 v[18:19], v13 offset:4352
  v_mfma_f32_16x16x32_bf16 v[180:183], v[20:23], v[36:39], v[180:183]
  v_mfma_f32_16x16x32_bf16 v[184:187], v[20:23], v[40:43], v[184:187]
  s_add_u32 m0, s39, 7168
  s_nop 0
  buffer_load_dwordx4 v12, s[60:63], s42 offen lds
  s_add_u32 s41, s41, 128
  s_add_u32 s42, s42, 128
  v_mfma_f32_16x16x32_bf16 v[188:191], v[20:23], v[44:47], v[188:191]
  s_waitcnt lgkmcnt(4)
  v_mfma_f32_16x16x32_bf16 v[192:195], v[24:27], v[32:35], v[192:195]
  ds_read_b64_tr_b16 v[20:21], v13 offset:9216
  ds_read_b64_tr_b16 v[22:23], v13 offset:9472
  v_mfma_f32_16x16x32_bf16 v[196:199], v[24:27], v[36:39], v[196:199]
  v_mfma_f32_16x16x32_bf16 v[200:203], v[24:27], v[40:43], v[200:203]
  v_mfma_f32_16x16x32_bf16 v[204:207], v[24:27], v[44:47], v[204:207]
  s_waitcnt vmcnt(7) lgkmcnt(4)
  s_barrier
  v_mfma_f32_16x16x32_bf16 v[208:211], v[28:31], v[32:35], v[208:211]
  ds_read_b64_tr_b16 v[24:25], v13 offset:20480
  ds_read_b64_tr_b16 v[26:27], v13 offset:20736
  v_mfma_f32_16x16x32_bf16 v[212:215], v[28:31], v[36:39], v[212:215]
  ds_read_b128 v[48:51], v6 offset:0
  v_mfma_f32_16x16x32_bf16 v[216:219], v[28:31], v[40:43], v[216:219]
  ds_read_b128 v[52:55], v6 offset:2048
  v_mfma_f32_16x16x32_bf16 v[220:223], v[28:31], v[44:47], v[220:223]
  v_mfma_f32_16x16x32_bf16 v[72:75], v[28:31], v[64:67], v[72:75]
  s_waitcnt lgkmcnt(6)
  v_mfma_f32_16x16x32_bf16 v[224:227], v[16:19], v[32:35], v[224:227]
  ds_read_b64_tr_b16 v[28:29], v13 offset:25600
  ds_read_b64_tr_b16 v[30:31], v13 offset:25856
  s_add_u32 m0, s36, 61440
  s_nop 0
  buffer_load_dwordx4 v8, s[16:19], s33 offen lds
  s_add_u32 s33, s33, s43
  v_mfma_f32_16x16x32_bf16 v[228:231], v[16:19], v[36:39], v[228:231]
  ds_read_b128 v[56:59], v7 offset:0
  v_mfma_f32_16x16x32_bf16 v[232:235], v[16:19], v[40:43], v[232:235]
  ds_read_b128 v[60:63], v7 offset:2048
  v_mfma_f32_16x16x32_bf16 v[236:239], v[16:19], v[44:47], v[236:239]
  s_waitcnt lgkmcnt(8)
  v_mfma_f32_16x16x32_bf16 v[240:243], v[20:23], v[32:35], v[240:243]
  ds_read_b64_tr_b16 v[16:17], v13 offset:21504
  ds_read_b64_tr_b16 v[18:19], v13 offset:21760
  v_mfma_f32_16x16x32_bf16 v[244:247], v[20:23], v[36:39], v[244:247]
  s_add_u32 m0, s37, 61440
  s_nop 0
  buffer_load_dwordx4 v9, s[20:23], s34 offen lds
  s_add_u32 s34, s34, s44
  v_mfma_f32_16x16x32_bf16 v[248:251], v[20:23], v[40:43], v[248:251]
  v_mfma_f32_16x16x32_bf16 v[252:255], v[20:23], v[44:47], v[252:255]
  s_waitcnt lgkmcnt(2)
  v_mfma_f32_16x16x32_bf16 v[96:99], v[24:27], v[48:51], v[96:99]
  ds_read_b64_tr_b16 v[20:21], v13 offset:26624
  ds_read_b64_tr_b16 v[22:23], v13 offset:26880
  v_mfma_f32_16x16x32_bf16 v[100:103], v[24:27], v[52:55], v[100:103]
  v_mfma_f32_16x16x32_bf16 v[104:107], v[24:27], v[56:59], v[104:107]
  s_cmp_ge_u32 s28, 4
  s_cbranch_scc1 gemm1_kernel_sk42
  s_add_u32 m0, s38, 61440
  s_nop 0
  buffer_load_dwordx4 v10, s[24:27], s35 offen lds
  s_add_u32 s35, s35, s45
  gemm1_kernel_sk42:
  v_mfma_f32_16x16x32_bf16 v[108:111], v[24:27], v[60:63], v[108:111]
  s_waitcnt lgkmcnt(4)
  v_mfma_f32_16x16x32_bf16 v[112:115], v[28:31], v[48:51], v[112:115]
  ds_read_b64_tr_b16 v[24:25], v13 offset:22528
  ds_read_b64_tr_b16 v[26:27], v13 offset:22784
  v_mfma_f32_16x16x32_bf16 v[116:119], v[28:31], v[52:55], v[116:119]
  v_mfma_f32_16x16x32_bf16 v[120:123], v[28:31], v[56:59], v[120:123]
  v_mfma_f32_16x16x32_bf16 v[124:127], v[28:31], v[60:63], v[124:127]
  buffer_load_dword v88, v89, s[64:67], s97 offen
  s_add_u32 s97, s97, s98
  s_waitcnt lgkmcnt(4)
  v_mfma_f32_16x16x32_bf16 v[128:131], v[16:19], v[48:51], v[128:131]
  ds_read_b64_tr_b16 v[28:29], v13 offset:27648
  ds_read_b64_tr_b16 v[30:31], v13 offset:27904
  v_mfma_f32_16x16x32_bf16 v[132:135], v[16:19], v[52:55], v[132:135]
  v_mfma_f32_16x16x32_bf16 v[136:139], v[16:19], v[56:59], v[136:139]
  v_mfma_f32_16x16x32_bf16 v[140:143], v[16:19], v[60:63], v[140:143]
  s_waitcnt lgkmcnt(4)
  v_mfma_f32_16x16x32_bf16 v[144:147], v[20:23], v[48:51], v[144:147]
  ds_read_b64_tr_b16 v[16:17], v13 offset:23552
  ds_read_b64_tr_b16 v[18:19], v13 offset:23808
  v_mfma_f32_16x16x32_bf16 v[148:151], v[20:23], v[52:55], v[148:151]
  v_mfma_f32_16x16x32_bf16 v[152:155], v[20:23], v[56:59], v[152:155]
  v_mfma_f32_16x16x32_bf16 v[156:159], v[20:23], v[60:63], v[156:159]
  v_mfma_f32_16x16x32_bf16 v[68:71], v[20:23], v[64:67], v[68:71]
  s_waitcnt lgkmcnt(4)
  v_mfma_f32_16x16x32_bf16 v[160:163], v[24:27], v[48:51], v[160:163]
  ds_read_b64_tr_b16 v[20:21], v13 offset:28672
  ds_read_b64_tr_b16 v[22:23], v13 offset:28928
  v_mfma_f32_16x16x32_bf16 v[164:167], v[24:27], v[52:55], v[164:167]
  v_mfma_f32_16x16x32_bf16 v[168:171], v[24:27], v[56:59], v[168:171]
  v_mfma_f32_16x16x32_bf16 v[172:175], v[24:27], v[60:63], v[172:175]
  s_waitcnt lgkmcnt(4)
  v_mfma_f32_16x16x32_bf16 v[176:179], v[28:31], v[48:51], v[176:179]
  ds_read_b64_tr_b16 v[24:25], v13 offset:24576
  ds_read_b64_tr_b16 v[26:27], v13 offset:24832
  v_mfma_f32_16x16x32_bf16 v[180:183], v[28:31], v[52:55], v[180:183]
  v_mfma_f32_16x16x32_bf16 v[184:187], v[28:31], v[56:59], v[184:187]
  v_mfma_f32_16x16x32_bf16 v[188:191], v[28:31], v[60:63], v[188:191]
  s_waitcnt lgkmcnt(4)
  v_mfma_f32_16x16x32_bf16 v[192:195], v[16:19], v[48:51], v[192:195]
  ds_read_b64_tr_b16 v[28:29], v13 offset:29696
  ds_read_b64_tr_b16 v[30:31], v13 offset:29952
  v_mfma_f32_16x16x32_bf16 v[196:199], v[16:19], v[52:55], v[196:199]
  v_mfma_f32_16x16x32_bf16 v[200:203], v[16:19], v[56:59], v[200:203]
  v_mfma_f32_16x16x32_bf16 v[204:207], v[16:19], v[60:63], v[204:207]
  s_waitcnt vmcnt(3) lgkmcnt(4)
  s_barrier
  v_mfma_f32_16x16x32_bf16 v[208:211], v[20:23], v[48:51], v[208:211]
  ds_read_b64_tr_b16 v[16:17], v14 offset:0
  ds_read_b64_tr_b16 v[18:19], v14 offset:256
  v_mfma_f32_16x16x32_bf16 v[212:215], v[20:23], v[52:55], v[212:215]
  ds_read_b128 v[32:35], v4 offset:4096
  v_mfma_f32_16x16x32_bf16 v[216:219], v[20:23], v[56:59], v[216:219]
  ds_read_b128 v[36:39], v4 offset:6144
  v_mfma_f32_16x16x32_bf16 v[220:223], v[20:23], v[60:63], v[220:223]
  v_mfma_f32_16x16x32_bf16 v[72:75], v[20:23], v[64:67], v[72:75]
  s_waitcnt lgkmcnt(6)
  v_mfma_f32_16x16x32_bf16 v[224:227], v[24:27], v[48:51], v[224:227]
  ds_read_b64_tr_b16 v[20:21], v14 offset:5120
  ds_read_b64_tr_b16 v[22:23], v14 offset:5376
  s_add_u32 m0, s36, 0
  s_nop 0
  buffer_load_dwordx4 v8, s[16:19], s33 offen lds
  s_add_u32 s33, s33, s43
  v_mfma_f32_16x16x32_bf16 v[228:231], v[24:27], v[52:55], v[228:231]
  ds_read_b128 v[40:43], v5 offset:4096
  v_mfma_f32_16x16x32_bf16 v[232:235], v[24:27], v[56:59], v[232:235]
  ds_read_b128 v[44:47], v5 offset:6144
  v_mfma_f32_16x16x32_bf16 v[236:239], v[24:27], v[60:63], v[236:239]
  s_waitcnt lgkmcnt(8)
  v_mfma_f32_16x16x32_bf16 v[240:243], v[28:31], v[48:51], v[240:243]
  ds_read_b64_tr_b16 v[24:25], v14 offset:1024
  ds_read_b64_tr_b16 v[26:27], v14 offset:1280
  v_mfma_f32_16x16x32_bf16 v[244:247], v[28:31], v[52:55], v[244:247]
  s_add_u32 m0, s37, 0
  s_nop 0
  buffer_load_dwordx4 v9, s[20:23], s34 offen lds
  s_add_u32 s34, s34, s44
  v_mfma_f32_16x16x32_bf16 v[248:251], v[28:31], v[56:59], v[248:251]
  v_mfma_f32_16x16x32_bf16 v[252:255], v[28:31], v[60:63], v[252:255]
  s_waitcnt lgkmcnt(2)
  v_mfma_f32_16x16x32_bf16 v[96:99], v[16:19], v[32:35], v[96:99]
  ds_read_b64_tr_b16 v[28:29], v14 offset:6144
  ds_read_b64_tr_b16 v[30:31], v14 offset:6400
  v_mfma_f32_16x16x32_bf16 v[100:103], v[16:19], v[36:39], v[100:103]
  v_mfma_f32_16x16x32_bf16 v[104:107], v[16:19], v[40:43], v[104:107]
  s_cmp_ge_u32 s28, 4
  s_cbranch_scc1 gemm1_kernel_sk43
  s_add_u32 m0, s38, 0
  s_nop 0
  buffer_load_dwordx4 v10, s[24:27], s35 offen lds
  s_add_u32 s35, s35, s45
  gemm1_kernel_sk43:
  v_mfma_f32_16x16x32_bf16 v[108:111], v[16:19], v[44:47], v[108:111]
  s_waitcnt lgkmcnt(4)
  v_mfma_f32_16x16x32_bf16 v[112:115], v[20:23], v[32:35], v[112:115]
  ds_read_b64_tr_b16 v[16:17], v14 offset:2048
  ds_read_b64_tr_b16 v[18:19], v14 offset:2304
  v_mfma_f32_16x16x32_bf16 v[116:119], v[20:23], v[36:39], v[116:119]
  v_mfma_f32_16x16x32_bf16 v[120:123], v[20:23], v[40:43], v[120:123]
  v_mfma_f32_16x16x32_bf16 v[124:127], v[20:23], v[44:47], v[124:127]
  s_add_u32 m0, s39, 0
  s_nop 0
  buffer_load_dwordx4 v11, s[60:63], s41 offen lds
  s_waitcnt lgkmcnt(4)
  v_mfma_f32_16x16x32_bf16 v[128:131], v[24:27], v[32:35], v[128:131]
  ds_read_b64_tr_b16 v[20:21], v14 offset:7168
  ds_read_b64_tr_b16 v[22:23], v14 offset:7424
  v_mfma_f32_16x16x32_bf16 v[132:135], v[24:27], v[36:39], v[132:135]
  v_mfma_f32_16x16x32_bf16 v[136:139], v[24:27], v[40:43], v[136:139]
  v_mfma_f32_16x16x32_bf16 v[140:143], v[24:27], v[44:47], v[140:143]
  s_waitcnt lgkmcnt(4)
  v_mfma_f32_16x16x32_bf16 v[144:147], v[28:31], v[32:35], v[144:147]
  ds_read_b64_tr_b16 v[24:25], v14 offset:3072
  ds_read_b64_tr_b16 v[26:27], v14 offset:3328
  s_add_u32 m0, s39, 1024
  s_nop 0
  buffer_load_dwordx4 v12, s[60:63], s41 offen lds
  v_mfma_f32_16x16x32_bf16 v[148:151], v[28:31], v[36:39], v[148:151]
  v_mfma_f32_16x16x32_bf16 v[152:155], v[28:31], v[40:43], v[152:155]
  v_mfma_f32_16x16x32_bf16 v[156:159], v[28:31], v[44:47], v[156:159]
  v_mfma_f32_16x16x32_bf16 v[68:71], v[28:31], v[64:67], v[68:71]
  s_waitcnt lgkmcnt(4)
  v_mfma_f32_16x16x32_bf16 v[160:163], v[16:19], v[32:35], v[160:163]
  ds_read_b64_tr_b16 v[28:29], v14 offset:8192
  ds_read_b64_tr_b16 v[30:31], v14 offset:8448
  v_mfma_f32_16x16x32_bf16 v[164:167], v[16:19], v[36:39], v[164:167]
  s_add_u32 m0, s39, 2048
  s_nop 0
  buffer_load_dwordx4 v11, s[60:63], s42 offen lds
  v_mfma_f32_16x16x32_bf16 v[168:171], v[16:19], v[40:43], v[168:171]
  v_mfma_f32_16x16x32_bf16 v[172:175], v[16:19], v[44:47], v[172:175]
  s_waitcnt lgkmcnt(4)
  v_mfma_f32_16x16x32_bf16 v[176:179], v[20:23], v[32:35], v[176:179]
  ds_read_b64_tr_b16 v[16:17], v14 offset:4096
  ds_read_b64_tr_b16 v[18:19], v14 offset:4352
  v_mfma_f32_16x16x32_bf16 v[180:183], v[20:23], v[36:39], v[180:183]
  v_mfma_f32_16x16x32_bf16 v[184:187], v[20:23], v[40:43], v[184:187]
  s_add_u32 m0, s39, 3072
  s_nop 0
  buffer_load_dwordx4 v12, s[60:63], s42 offen lds
  s_add_u32 s41, s41, 128
  s_add_u32 s42, s42, 128
  v_mfma_f32_16x16x32_bf16 v[188:191], v[20:23], v[44:47], v[188:191]
  s_waitcnt lgkmcnt(4)
  v_mfma_f32_16x16x32_bf16 v[192:195], v[24:27], v[32:35], v[192:195]
  ds_read_b64_tr_b16 v[20:21], v14 offset:9216
  ds_read_b64_tr_b16 v[22:23], v14 offset:9472
  v_mfma_f32_16x16x32_bf16 v[196:199], v[24:27], v[36:39], v[196:199]
  v_mfma_f32_16x16x32_bf16 v[200:203], v[24:27], v[40:43], v[200:203]
  v_mfma_f32_16x16x32_bf16 v[204:207], v[24:27], v[44:47], v[204:207]
  s_waitcnt vmcnt(7) lgkmcnt(4)
  s_barrier
  v_mfma_f32_16x16x32_bf16 v[208:211], v[28:31], v[32:35], v[208:211]
  ds_read_b64_tr_b16 v[24:25], v14 offset:20480
  ds_read_b64_tr_b16 v[26:27], v14 offset:20736
  v_mfma_f32_16x16x32_bf16 v[212:215], v[28:31], v[36:39], v[212:215]
  ds_read_b128 v[48:51], v6 offset:4096
  v_mfma_f32_16x16x32_bf16 v[216:219], v[28:31], v[40:43], v[216:219]
  ds_read_b128 v[52:55], v6 offset:6144
  v_mfma_f32_16x16x32_bf16 v[220:223], v[28:31], v[44:47], v[220:223]
  v_mfma_f32_16x16x32_bf16 v[72:75], v[28:31], v[64:67], v[72:75]
  s_waitcnt lgkmcnt(6)
  v_mfma_f32_16x16x32_bf16 v[224:227], v[16:19], v[32:35], v[224:227]
  ds_read_b64_tr_b16 v[28:29], v14 offset:25600
  ds_read_b64_tr_b16 v[30:31], v14 offset:25856
  s_add_u32 m0, s36, 20480
  s_nop 0
  buffer_load_dwordx4 v8, s[16:19], s33 offen lds
  s_add_u32 s33, s33, s43
  v_mfma_f32_16x16x32_bf16 v[228:231], v[16:19], v[36:39], v[228:231]
  ds_read_b128 v[56:59], v7 offset:4096
  v_mfma_f32_16x16x32_bf16 v[232:235], v[16:19], v[40:43], v[232:235]
  ds_read_b128 v[60:63], v7 offset:6144
  v_mfma_f32_16x16x32_bf16 v[236:239], v[16:19], v[44:47], v[236:239]
  s_waitcnt lgkmcnt(8)
  v_mfma_f32_16x16x32_bf16 v[240:243], v[20:23], v[32:35], v[240:243]
  ds_read_b64_tr_b16 v[16:17], v14 offset:21504
  ds_read_b64_tr_b16 v[18:19], v14 offset:21760
  v_mfma_f32_16x16x32_bf16 v[244:247], v[20:23], v[36:39], v[244:247]
  s_add_u32 m0, s37, 20480
  s_nop 0
  buffer_load_dwordx4 v9, s[20:23], s34 offen lds
  s_add_u32 s34, s34, s44
  v_mfma_f32_16x16x32_bf16 v[248:251], v[20:23], v[40:43], v[248:251]
  v_mfma_f32_16x16x32_bf16 v[252:255], v[20:23], v[44:47], v[252:255]
  s_waitcnt lgkmcnt(2)
  v_mfma_f32_16x16x32_bf16 v[96:99], v[24:27], v[48:51], v[96:99]
  ds_read_b64_tr_b16 v[20:21], v14 offset:26624
  ds_read_b64_tr_b16 v[22:23], v14 offset:26880
  v_mfma_f32_16x16x32_bf16 v[100:103], v[24:27], v[52:55], v[100:103]
  v_mfma_f32_16x16x32_bf16 v[104:107], v[24:27], v[56:59], v[104:107]
  s_cmp_ge_u32 s28, 4
  s_cbranch_scc1 gemm1_kernel_sk44
  s_add_u32 m0, s38, 20480
  s_nop 0
  buffer_load_dwordx4 v10, s[24:27], s35 offen lds
  s_add_u32 s35, s35, s45
  gemm1_kernel_sk44:
  v_mfma_f32_16x16x32_bf16 v[108:111], v[24:27], v[60:63], v[108:111]
  s_waitcnt lgkmcnt(4)
  v_mfma_f32_16x16x32_bf16 v[112:115], v[28:31], v[48:51], v[112:115]
  ds_read_b64_tr_b16 v[24:25], v14 offset:22528
  ds_read_b64_tr_b16 v[26:27], v14 offset:22784
  v_mfma_f32_16x16x32_bf16 v[116:119], v[28:31], v[52:55], v[116:119]
  v_mfma_f32_16x16x32_bf16 v[120:123], v[28:31], v[56:59], v[120:123]
  v_mfma_f32_16x16x32_bf16 v[124:127], v[28:31], v[60:63], v[124:127]
  buffer_load_dword v88, v89, s[64:67], s97 offen
  s_add_u32 s97, s97, s98
  s_waitcnt lgkmcnt(4)
  v_mfma_f32_16x16x32_bf16 v[128:131], v[16:19], v[48:51], v[128:131]
  ds_read_b64_tr_b16 v[28:29], v14 offset:27648
  ds_read_b64_tr_b16 v[30:31], v14 offset:27904
  v_mfma_f32_16x16x32_bf16 v[132:135], v[16:19], v[52:55], v[132:135]
  v_mfma_f32_16x16x32_bf16 v[136:139], v[16:19], v[56:59], v[136:139]
  v_mfma_f32_16x16x32_bf16 v[140:143], v[16:19], v[60:63], v[140:143]
  s_waitcnt lgkmcnt(4)
  v_mfma_f32_16x16x32_bf16 v[144:147], v[20:23], v[48:51], v[144:147]
  ds_read_b64_tr_b16 v[16:17], v14 offset:23552
  ds_read_b64_tr_b16 v[18:19], v14 offset:23808
  v_mfma_f32_16x16x32_bf16 v[148:151], v[20:23], v[52:55], v[148:151]
  v_mfma_f32_16x16x32_bf16 v[152:155], v[20:23], v[56:59], v[152:155]
  v_mfma_f32_16x16x32_bf16 v[156:159], v[20:23], v[60:63], v[156:159]
  v_mfma_f32_16x16x32_bf16 v[68:71], v[20:23], v[64:67], v[68:71]
  s_waitcnt lgkmcnt(4)
  v_mfma_f32_16x16x32_bf16 v[160:163], v[24:27], v[48:51], v[160:163]
  ds_read_b64_tr_b16 v[20:21], v14 offset:28672
  ds_read_b64_tr_b16 v[22:23], v14 offset:28928
  v_mfma_f32_16x16x32_bf16 v[164:167], v[24:27], v[52:55], v[164:167]
  v_mfma_f32_16x16x32_bf16 v[168:171], v[24:27], v[56:59], v[168:171]
  v_mfma_f32_16x16x32_bf16 v[172:175], v[24:27], v[60:63], v[172:175]
  s_waitcnt lgkmcnt(4)
  v_mfma_f32_16x16x32_bf16 v[176:179], v[28:31], v[48:51], v[176:179]
  ds_read_b64_tr_b16 v[24:25], v14 offset:24576
  ds_read_b64_tr_b16 v[26:27], v14 offset:24832
  v_mfma_f32_16x16x32_bf16 v[180:183], v[28:31], v[52:55], v[180:183]
  v_mfma_f32_16x16x32_bf16 v[184:187], v[28:31], v[56:59], v[184:187]
  v_mfma_f32_16x16x32_bf16 v[188:191], v[28:31], v[60:63], v[188:191]
  s_waitcnt lgkmcnt(4)
  v_mfma_f32_16x16x32_bf16 v[192:195], v[16:19], v[48:51], v[192:195]
  ds_read_b64_tr_b16 v[28:29], v14 offset:29696
  ds_read_b64_tr_b16 v[30:31], v14 offset:29952
  v_mfma_f32_16x16x32_bf16 v[196:199], v[16:19], v[52:55], v[196:199]
  v_mfma_f32_16x16x32_bf16 v[200:203], v[16:19], v[56:59], v[200:203]
  v_mfma_f32_16x16x32_bf16 v[204:207], v[16:19], v[60:63], v[204:207]
  s_waitcnt vmcnt(3) lgkmcnt(4)
  s_barrier
  v_mfma_f32_16x16x32_bf16 v[208:211], v[20:23], v[48:51], v[208:211]
  ds_read_b64_tr_b16 v[16:17], v13 offset:0
  ds_read_b64_tr_b16 v[18:19], v13 offset:256
  v_mfma_f32_16x16x32_bf16 v[212:215], v[20:23], v[52:55], v[212:215]
  ds_read_b128 v[32:35], v4 offset:0
  v_mfma_f32_16x16x32_bf16 v[216:219], v[20:23], v[56:59], v[216:219]
  ds_read_b128 v[36:39], v4 offset:2048
  v_mfma_f32_16x16x32_bf16 v[220:223], v[20:23], v[60:63], v[220:223]
  v_mfma_f32_16x16x32_bf16 v[72:75], v[20:23], v[64:67], v[72:75]
  s_waitcnt lgkmcnt(6)
  v_mfma_f32_16x16x32_bf16 v[224:227], v[24:27], v[48:51], v[224:227]
  ds_read_b64_tr_b16 v[20:21], v13 offset:5120
  ds_read_b64_tr_b16 v[22:23], v13 offset:5376
  s_add_u32 m0, s36, 40960
  s_nop 0
  buffer_load_dwordx4 v8, s[16:19], s33 offen lds
  s_add_u32 s33, s33, s43
  v_mfma_f32_16x16x32_bf16 v[228:231], v[24:27], v[52:55], v[228:231]
  ds_read_b128 v[40:43], v5 offset:0
  v_mfma_f32_16x16x32_bf16 v[232:235], v[24:27], v[56:59], v[232:235]
  ds_read_b128 v[44:47], v5 offset:2048
  v_mfma_f32_16x16x32_bf16 v[236:239], v[24:27], v[60:63], v[236:239]
  s_waitcnt lgkmcnt(8)
  v_mfma_f32_16x16x32_bf16 v[240:243], v[28:31], v[48:51], v[240:243]
  ds_read_b64_tr_b16 v[24:25], v13 offset:1024
  ds_read_b64_tr_b16 v[26:27], v13 offset:1280
  v_mfma_f32_16x16x32_bf16 v[244:247], v[28:31], v[52:55], v[244:247]
  s_add_u32 m0, s37, 40960
  s_nop 0
  buffer_load_dwordx4 v9, s[20:23], s34 offen lds
  s_add_u32 s34, s34, s44
  v_mfma_f32_16x16x32_bf16 v[248:251], v[28:31], v[56:59], v[248:251]
  v_mfma_f32_16x16x32_bf16 v[252:255], v[28:31], v[60:63], v[252:255]
  s_sub_u32 s40, s40, 1
  s_cmp_lg_u32 s40, 0
  s_cbranch_scc1 gemm1_kernel_loop3
  s_lshl_b32 s55, s32, 2
  buffer_load_dword v1, v15, s[68:71], s55 offen sc1
  s_lshl_b32 s47, s32, 11
  s_lshl_b32 s48, s30, 9
  s_add_u32 s47, s47, s48
  s_lshl_b32 s48, s29, 8
  s_add_u32 s47, s47, s48
  s_add_u32 s47, s47, 41943040
  v_and_b32 v94, 15, v2
  v_lshlrev_b32 v94, 3, v94
  v_add_u32 v94, s47, v94
  v_xor_b32 v95, 256, v94
  s_waitcnt lgkmcnt(2)
  v_mfma_f32_16x16x32_bf16 v[96:99], v[16:19], v[32:35], v[96:99]
  ds_read_b64_tr_b16 v[28:29], v13 offset:6144
  ds_read_b64_tr_b16 v[30:31], v13 offset:6400
  v_mfma_f32_16x16x32_bf16 v[100:103], v[16:19], v[36:39], v[100:103]
  v_mfma_f32_16x16x32_bf16 v[104:107], v[16:19], v[40:43], v[104:107]
  s_cmp_ge_u32 s28, 4
  s_cbranch_scc1 gemm1_kernel_sk45
  s_add_u32 m0, s38, 40960
  s_nop 0
  buffer_load_dwordx4 v10, s[24:27], s35 offen lds
  s_add_u32 s35, s35, s45
  gemm1_kernel_sk45:
  v_mfma_f32_16x16x32_bf16 v[108:111], v[16:19], v[44:47], v[108:111]
  s_waitcnt lgkmcnt(4)
  v_mfma_f32_16x16x32_bf16 v[112:115], v[20:23], v[32:35], v[112:115]
  ds_read_b64_tr_b16 v[16:17], v13 offset:2048
  ds_read_b64_tr_b16 v[18:19], v13 offset:2304
  v_mfma_f32_16x16x32_bf16 v[116:119], v[20:23], v[36:39], v[116:119]
  v_mfma_f32_16x16x32_bf16 v[120:123], v[20:23], v[40:43], v[120:123]
  v_mfma_f32_16x16x32_bf16 v[124:127], v[20:23], v[44:47], v[124:127]
  s_add_u32 m0, s39, 4096
  s_nop 0
  buffer_load_dwordx4 v11, s[60:63], s41 offen lds
  s_waitcnt lgkmcnt(4)
  v_mfma_f32_16x16x32_bf16 v[128:131], v[24:27], v[32:35], v[128:131]
  ds_read_b64_tr_b16 v[20:21], v13 offset:7168
  ds_read_b64_tr_b16 v[22:23], v13 offset:7424
  v_mfma_f32_16x16x32_bf16 v[132:135], v[24:27], v[36:39], v[132:135]
  v_mfma_f32_16x16x32_bf16 v[136:139], v[24:27], v[40:43], v[136:139]
  v_mfma_f32_16x16x32_bf16 v[140:143], v[24:27], v[44:47], v[140:143]
  s_waitcnt lgkmcnt(4)
  v_mfma_f32_16x16x32_bf16 v[144:147], v[28:31], v[32:35], v[144:147]
  ds_read_b64_tr_b16 v[24:25], v13 offset:3072
  ds_read_b64_tr_b16 v[26:27], v13 offset:3328
  s_add_u32 m0, s39, 5120
  s_nop 0
  buffer_load_dwordx4 v12, s[60:63], s41 offen lds
  v_mfma_f32_16x16x32_bf16 v[148:151], v[28:31], v[36:39], v[148:151]
  v_mfma_f32_16x16x32_bf16 v[152:155], v[28:31], v[40:43], v[152:155]
  v_mfma_f32_16x16x32_bf16 v[156:159], v[28:31], v[44:47], v[156:159]
  v_mfma_f32_16x16x32_bf16 v[68:71], v[28:31], v[64:67], v[68:71]
  s_waitcnt lgkmcnt(4)
  v_mfma_f32_16x16x32_bf16 v[160:163], v[16:19], v[32:35], v[160:163]
  ds_read_b64_tr_b16 v[28:29], v13 offset:8192
  ds_read_b64_tr_b16 v[30:31], v13 offset:8448
  v_mfma_f32_16x16x32_bf16 v[164:167], v[16:19], v[36:39], v[164:167]
  s_add_u32 m0, s39, 6144
  s_nop 0
  buffer_load_dwordx4 v11, s[60:63], s42 offen lds
  v_mfma_f32_16x16x32_bf16 v[168:171], v[16:19], v[40:43], v[168:171]
  v_mfma_f32_16x16x32_bf16 v[172:175], v[16:19], v[44:47], v[172:175]
  s_waitcnt lgkmcnt(4)
  v_mfma_f32_16x16x32_bf16 v[176:179], v[20:23], v[32:35], v[176:179]
  ds_read_b64_tr_b16 v[16:17], v13 offset:4096
  ds_read_b64_tr_b16 v[18:19], v13 offset:4352
  v_mfma_f32_16x16x32_bf16 v[180:183], v[20:23], v[36:39], v[180:183]
  v_mfma_f32_16x16x32_bf16 v[184:187], v[20:23], v[40:43], v[184:187]
  s_add_u32 m0, s39, 7168
  s_nop 0
  buffer_load_dwordx4 v12, s[60:63], s42 offen lds
  s_add_u32 s41, s41, 128
  s_add_u32 s42, s42, 128
  v_mfma_f32_16x16x32_bf16 v[188:191], v[20:23], v[44:47], v[188:191]
  s_waitcnt lgkmcnt(4)
  v_mfma_f32_16x16x32_bf16 v[192:195], v[24:27], v[32:35], v[192:195]
  ds_read_b64_tr_b16 v[20:21], v13 offset:9216
  ds_read_b64_tr_b16 v[22:23], v13 offset:9472
  v_mfma_f32_16x16x32_bf16 v[196:199], v[24:27], v[36:39], v[196:199]
  v_mfma_f32_16x16x32_bf16 v[200:203], v[24:27], v[40:43], v[200:203]
  v_mfma_f32_16x16x32_bf16 v[204:207], v[24:27], v[44:47], v[204:207]
  s_waitcnt vmcnt(8) lgkmcnt(4)
  s_barrier
  v_mfma_f32_16x16x32_bf16 v[208:211], v[28:31], v[32:35], v[208:211]
  ds_read_b64_tr_b16 v[24:25], v13 offset:20480
  ds_read_b64_tr_b16 v[26:27], v13 offset:20736
  v_mfma_f32_16x16x32_bf16 v[212:215], v[28:31], v[36:39], v[212:215]
  ds_read_b128 v[48:51], v6 offset:0
  v_mfma_f32_16x16x32_bf16 v[216:219], v[28:31], v[40:43], v[216:219]
  ds_read_b128 v[52:55], v6 offset:2048
  v_mfma_f32_16x16x32_bf16 v[220:223], v[28:31], v[44:47], v[220:223]
  v_mfma_f32_16x16x32_bf16 v[72:75], v[28:31], v[64:67], v[72:75]
  s_waitcnt lgkmcnt(6)
  v_mfma_f32_16x16x32_bf16 v[224:227], v[16:19], v[32:35], v[224:227]
  ds_read_b64_tr_b16 v[28:29], v13 offset:25600
  ds_read_b64_tr_b16 v[30:31], v13 offset:25856
  s_add_u32 m0, s36, 61440
  s_nop 0
  buffer_load_dwordx4 v8, s[16:19], s33 offen lds
  s_add_u32 s33, s33, s43
  v_mfma_f32_16x16x32_bf16 v[228:231], v[16:19], v[36:39], v[228:231]
  ds_read_b128 v[56:59], v7 offset:0
  v_mfma_f32_16x16x32_bf16 v[232:235], v[16:19], v[40:43], v[232:235]
  ds_read_b128 v[60:63], v7 offset:2048
  v_mfma_f32_16x16x32_bf16 v[236:239], v[16:19], v[44:47], v[236:239]
  s_waitcnt lgkmcnt(8)
  v_mfma_f32_16x16x32_bf16 v[240:243], v[20:23], v[32:35], v[240:243]
  ds_read_b64_tr_b16 v[16:17], v13 offset:21504
  ds_read_b64_tr_b16 v[18:19], v13 offset:21760
  v_mfma_f32_16x16x32_bf16 v[244:247], v[20:23], v[36:39], v[244:247]
  s_add_u32 m0, s37, 61440
  s_nop 0
  buffer_load_dwordx4 v9, s[20:23], s34 offen lds
  s_add_u32 s34, s34, s44
  v_mfma_f32_16x16x32_bf16 v[248:251], v[20:23], v[40:43], v[248:251]
  v_mfma_f32_16x16x32_bf16 v[252:255], v[20:23], v[44:47], v[252:255]
  s_waitcnt lgkmcnt(2)
  v_mfma_f32_16x16x32_bf16 v[96:99], v[24:27], v[48:51], v[96:99]
  ds_read_b64_tr_b16 v[20:21], v13 offset:26624
  ds_read_b64_tr_b16 v[22:23], v13 offset:26880
  v_mfma_f32_16x16x32_bf16 v[100:103], v[24:27], v[52:55], v[100:103]
  v_mfma_f32_16x16x32_bf16 v[104:107], v[24:27], v[56:59], v[104:107]
  s_cmp_ge_u32 s28, 4
  s_cbranch_scc1 gemm1_kernel_sk46
  s_add_u32 m0, s38, 61440
  s_nop 0
  buffer_load_dwordx4 v10, s[24:27], s35 offen lds
  s_add_u32 s35, s35, s45
  gemm1_kernel_sk46:
  v_mfma_f32_16x16x32_bf16 v[108:111], v[24:27], v[60:63], v[108:111]
  s_waitcnt lgkmcnt(4)
  v_mfma_f32_16x16x32_bf16 v[112:115], v[28:31], v[48:51], v[112:115]
  ds_read_b64_tr_b16 v[24:25], v13 offset:22528
  ds_read_b64_tr_b16 v[26:27], v13 offset:22784
  v_mfma_f32_16x16x32_bf16 v[116:119], v[28:31], v[52:55], v[116:119]
  v_mfma_f32_16x16x32_bf16 v[120:123], v[28:31], v[56:59], v[120:123]
  v_mfma_f32_16x16x32_bf16 v[124:127], v[28:31], v[60:63], v[124:127]
  s_waitcnt lgkmcnt(4)
  v_mfma_f32_16x16x32_bf16 v[128:131], v[16:19], v[48:51], v[128:131]
  ds_read_b64_tr_b16 v[28:29], v13 offset:27648
  ds_read_b64_tr_b16 v[30:31], v13 offset:27904
  v_mfma_f32_16x16x32_bf16 v[132:135], v[16:19], v[52:55], v[132:135]
  v_mfma_f32_16x16x32_bf16 v[136:139], v[16:19], v[56:59], v[136:139]
  v_mfma_f32_16x16x32_bf16 v[140:143], v[16:19], v[60:63], v[140:143]
  s_waitcnt lgkmcnt(4)
  v_mfma_f32_16x16x32_bf16 v[144:147], v[20:23], v[48:51], v[144:147]
  ds_read_b64_tr_b16 v[16:17], v13 offset:23552
  ds_read_b64_tr_b16 v[18:19], v13 offset:23808
  v_mfma_f32_16x16x32_bf16 v[148:151], v[20:23], v[52:55], v[148:151]
  v_mfma_f32_16x16x32_bf16 v[152:155], v[20:23], v[56:59], v[152:155]
  v_mfma_f32_16x16x32_bf16 v[156:159], v[20:23], v[60:63], v[156:159]
  v_mfma_f32_16x16x32_bf16 v[68:71], v[20:23], v[64:67], v[68:71]
  s_waitcnt lgkmcnt(4)
  v_mfma_f32_16x16x32_bf16 v[160:163], v[24:27], v[48:51], v[160:163]
  ds_read_b64_tr_b16 v[20:21], v13 offset:28672
  ds_read_b64_tr_b16 v[22:23], v13 offset:28928
  v_mfma_f32_16x16x32_bf16 v[164:167], v[24:27], v[52:55], v[164:167]
  v_mfma_f32_16x16x32_bf16 v[168:171], v[24:27], v[56:59], v[168:171]
  v_mfma_f32_16x16x32_bf16 v[172:175], v[24:27], v[60:63], v[172:175]
  s_waitcnt lgkmcnt(4)
  v_mfma_f32_16x16x32_bf16 v[176:179], v[28:31], v[48:51], v[176:179]
  ds_read_b64_tr_b16 v[24:25], v13 offset:24576
  ds_read_b64_tr_b16 v[26:27], v13 offset:24832
  v_mfma_f32_16x16x32_bf16 v[180:183], v[28:31], v[52:55], v[180:183]
  v_mfma_f32_16x16x32_bf16 v[184:187], v[28:31], v[56:59], v[184:187]
  v_mfma_f32_16x16x32_bf16 v[188:191], v[28:31], v[60:63], v[188:191]
  s_waitcnt lgkmcnt(4)
  v_mfma_f32_16x16x32_bf16 v[192:195], v[16:19], v[48:51], v[192:195]
  ds_read_b64_tr_b16 v[28:29], v13 offset:29696
  ds_read_b64_tr_b16 v[30:31], v13 offset:29952
  v_mfma_f32_16x16x32_bf16 v[196:199], v[16:19], v[52:55], v[196:199]
  v_mfma_f32_16x16x32_bf16 v[200:203], v[16:19], v[56:59], v[200:203]
  v_mfma_f32_16x16x32_bf16 v[204:207], v[16:19], v[60:63], v[204:207]
  s_waitcnt vmcnt(2) lgkmcnt(4)
  s_barrier
  v_mfma_f32_16x16x32_bf16 v[208:211], v[20:23], v[48:51], v[208:211]
  ds_read_b64_tr_b16 v[16:17], v14 offset:0
  ds_read_b64_tr_b16 v[18:19], v14 offset:256
  v_mfma_f32_16x16x32_bf16 v[212:215], v[20:23], v[52:55], v[212:215]
  ds_read_b128 v[32:35], v4 offset:4096
  v_mfma_f32_16x16x32_bf16 v[216:219], v[20:23], v[56:59], v[216:219]
  ds_read_b128 v[36:39], v4 offset:6144
  v_mfma_f32_16x16x32_bf16 v[220:223], v[20:23], v[60:63], v[220:223]
  v_mfma_f32_16x16x32_bf16 v[72:75], v[20:23], v[64:67], v[72:75]
  s_waitcnt lgkmcnt(6)
  v_mfma_f32_16x16x32_bf16 v[224:227], v[24:27], v[48:51], v[224:227]
  ds_read_b64_tr_b16 v[20:21], v14 offset:5120
  ds_read_b64_tr_b16 v[22:23], v14 offset:5376
  v_mfma_f32_16x16x32_bf16 v[228:231], v[24:27], v[52:55], v[228:231]
  ds_read_b128 v[40:43], v5 offset:4096
  v_mfma_f32_16x16x32_bf16 v[232:235], v[24:27], v[56:59], v[232:235]
  ds_read_b128 v[44:47], v5 offset:6144
  v_mfma_f32_16x16x32_bf16 v[236:239], v[24:27], v[60:63], v[236:239]
  s_waitcnt lgkmcnt(8)
  v_mfma_f32_16x16x32_bf16 v[240:243], v[28:31], v[48:51], v[240:243]
  ds_read_b64_tr_b16 v[24:25], v14 offset:1024
  ds_read_b64_tr_b16 v[26:27], v14 offset:1280
  v_mfma_f32_16x16x32_bf16 v[244:247], v[28:31], v[52:55], v[244:247]
  v_mfma_f32_16x16x32_bf16 v[248:251], v[28:31], v[56:59], v[248:251]
  v_mfma_f32_16x16x32_bf16 v[252:255], v[28:31], v[60:63], v[252:255]
  s_waitcnt vmcnt(6)
  v_readfirstlane_b32 s58, v1
  buffer_load_dwordx2 v[80:81], v94, s[12:15], 0 offen offset:0 sc1
  buffer_load_dwordx2 v[82:83], v94, s[12:15], 0 offen offset:128 sc1
  buffer_load_dwordx2 v[84:85], v95, s[12:15], 0 offen offset:0 sc1
  buffer_load_dwordx2 v[86:87], v95, s[12:15], 0 offen offset:128 sc1
  s_waitcnt lgkmcnt(2)
  v_mfma_f32_16x16x32_bf16 v[96:99], v[16:19], v[32:35], v[96:99]
  ds_read_b64_tr_b16 v[28:29], v14 offset:6144
  ds_read_b64_tr_b16 v[30:31], v14 offset:6400
  v_mfma_f32_16x16x32_bf16 v[100:103], v[16:19], v[36:39], v[100:103]
  v_mfma_f32_16x16x32_bf16 v[104:107], v[16:19], v[40:43], v[104:107]
  v_mfma_f32_16x16x32_bf16 v[108:111], v[16:19], v[44:47], v[108:111]
  s_waitcnt lgkmcnt(4)
  v_mfma_f32_16x16x32_bf16 v[112:115], v[20:23], v[32:35], v[112:115]
  ds_read_b64_tr_b16 v[16:17], v14 offset:2048
  ds_read_b64_tr_b16 v[18:19], v14 offset:2304
  v_mfma_f32_16x16x32_bf16 v[116:119], v[20:23], v[36:39], v[116:119]
  v_mfma_f32_16x16x32_bf16 v[120:123], v[20:23], v[40:43], v[120:123]
  v_mfma_f32_16x16x32_bf16 v[124:127], v[20:23], v[44:47], v[124:127]
  s_waitcnt lgkmcnt(4)
  v_mfma_f32_16x16x32_bf16 v[128:131], v[24:27], v[32:35], v[128:131]
  ds_read_b64_tr_b16 v[20:21], v14 offset:7168
  ds_read_b64_tr_b16 v[22:23], v14 offset:7424
  v_mfma_f32_16x16x32_bf16 v[132:135], v[24:27], v[36:39], v[132:135]
  v_mfma_f32_16x16x32_bf16 v[136:139], v[24:27], v[40:43], v[136:139]
  v_mfma_f32_16x16x32_bf16 v[140:143], v[24:27], v[44:47], v[140:143]
  s_waitcnt lgkmcnt(4)
  v_mfma_f32_16x16x32_bf16 v[144:147], v[28:31], v[32:35], v[144:147]
  ds_read_b64_tr_b16 v[24:25], v14 offset:3072
  ds_read_b64_tr_b16 v[26:27], v14 offset:3328
  v_mfma_f32_16x16x32_bf16 v[148:151], v[28:31], v[36:39], v[148:151]
  v_mfma_f32_16x16x32_bf16 v[152:155], v[28:31], v[40:43], v[152:155]
  v_mfma_f32_16x16x32_bf16 v[156:159], v[28:31], v[44:47], v[156:159]
  v_mfma_f32_16x16x32_bf16 v[68:71], v[28:31], v[64:67], v[68:71]
  s_waitcnt lgkmcnt(4)
  v_mfma_f32_16x16x32_bf16 v[160:163], v[16:19], v[32:35], v[160:163]
  ds_read_b64_tr_b16 v[28:29], v14 offset:8192
  ds_read_b64_tr_b16 v[30:31], v14 offset:8448
  v_mfma_f32_16x16x32_bf16 v[164:167], v[16:19], v[36:39], v[164:167]
  v_mfma_f32_16x16x32_bf16 v[168:171], v[16:19], v[40:43], v[168:171]
  v_mfma_f32_16x16x32_bf16 v[172:175], v[16:19], v[44:47], v[172:175]
  s_waitcnt lgkmcnt(4)
  v_mfma_f32_16x16x32_bf16 v[176:179], v[20:23], v[32:35], v[176:179]
  ds_read_b64_tr_b16 v[16:17], v14 offset:4096
  ds_read_b64_tr_b16 v[18:19], v14 offset:4352
  v_mfma_f32_16x16x32_bf16 v[180:183], v[20:23], v[36:39], v[180:183]
  v_mfma_f32_16x16x32_bf16 v[184:187], v[20:23], v[40:43], v[184:187]
  v_mfma_f32_16x16x32_bf16 v[188:191], v[20:23], v[44:47], v[188:191]
  s_waitcnt lgkmcnt(4)
  v_mfma_f32_16x16x32_bf16 v[192:195], v[24:27], v[32:35], v[192:195]
  ds_read_b64_tr_b16 v[20:21], v14 offset:9216
  ds_read_b64_tr_b16 v[22:23], v14 offset:9472
  v_mfma_f32_16x16x32_bf16 v[196:199], v[24:27], v[36:39], v[196:199]
  v_mfma_f32_16x16x32_bf16 v[200:203], v[24:27], v[40:43], v[200:203]
  v_mfma_f32_16x16x32_bf16 v[204:207], v[24:27], v[44:47], v[204:207]
  s_waitcnt vmcnt(4) lgkmcnt(4)
  s_barrier
  v_mfma_f32_16x16x32_bf16 v[208:211], v[28:31], v[32:35], v[208:211]
  ds_read_b64_tr_b16 v[24:25], v14 offset:20480
  ds_read_b64_tr_b16 v[26:27], v14 offset:20736
  v_mfma_f32_16x16x32_bf16 v[212:215], v[28:31], v[36:39], v[212:215]
  ds_read_b128 v[48:51], v6 offset:4096
  v_mfma_f32_16x16x32_bf16 v[216:219], v[28:31], v[40:43], v[216:219]
  ds_read_b128 v[52:55], v6 offset:6144
  v_mfma_f32_16x16x32_bf16 v[220:223], v[28:31], v[44:47], v[220:223]
  v_mfma_f32_16x16x32_bf16 v[72:75], v[28:31], v[64:67], v[72:75]
  s_waitcnt lgkmcnt(6)
  v_mfma_f32_16x16x32_bf16 v[224:227], v[16:19], v[32:35], v[224:227]
  ds_read_b64_tr_b16 v[28:29], v14 offset:25600
  ds_read_b64_tr_b16 v[30:31], v14 offset:25856
  v_mfma_f32_16x16x32_bf16 v[228:231], v[16:19], v[36:39], v[228:231]
  ds_read_b128 v[56:59], v7 offset:4096
  v_mfma_f32_16x16x32_bf16 v[232:235], v[16:19], v[40:43], v[232:235]
  ds_read_b128 v[60:63], v7 offset:6144
  v_mfma_f32_16x16x32_bf16 v[236:239], v[16:19], v[44:47], v[236:239]
  s_waitcnt lgkmcnt(8)
  v_mfma_f32_16x16x32_bf16 v[240:243], v[20:23], v[32:35], v[240:243]
  ds_read_b64_tr_b16 v[16:17], v14 offset:21504
  ds_read_b64_tr_b16 v[18:19], v14 offset:21760
  v_mfma_f32_16x16x32_bf16 v[244:247], v[20:23], v[36:39], v[244:247]
  v_mfma_f32_16x16x32_bf16 v[248:251], v[20:23], v[40:43], v[248:251]
  v_mfma_f32_16x16x32_bf16 v[252:255], v[20:23], v[44:47], v[252:255]
  s_waitcnt lgkmcnt(2)
  v_mfma_f32_16x16x32_bf16 v[96:99], v[24:27], v[48:51], v[96:99]
  ds_read_b64_tr_b16 v[20:21], v14 offset:26624
  ds_read_b64_tr_b16 v[22:23], v14 offset:26880
  v_mfma_f32_16x16x32_bf16 v[100:103], v[24:27], v[52:55], v[100:103]
  v_mfma_f32_16x16x32_bf16 v[104:107], v[24:27], v[56:59], v[104:107]
  v_mfma_f32_16x16x32_bf16 v[108:111], v[24:27], v[60:63], v[108:111]
  s_waitcnt lgkmcnt(4)
  v_mfma_f32_16x16x32_bf16 v[112:115], v[28:31], v[48:51], v[112:115]
  ds_read_b64_tr_b16 v[24:25], v14 offset:22528
  ds_read_b64_tr_b16 v[26:27], v14 offset:22784
  v_mfma_f32_16x16x32_bf16 v[116:119], v[28:31], v[52:55], v[116:119]
  v_mfma_f32_16x16x32_bf16 v[120:123], v[28:31], v[56:59], v[120:123]
  v_mfma_f32_16x16x32_bf16 v[124:127], v[28:31], v[60:63], v[124:127]
  s_waitcnt lgkmcnt(4)
  v_mfma_f32_16x16x32_bf16 v[128:131], v[16:19], v[48:51], v[128:131]
  ds_read_b64_tr_b16 v[28:29], v14 offset:27648
  ds_read_b64_tr_b16 v[30:31], v14 offset:27904
  v_mfma_f32_16x16x32_bf16 v[132:135], v[16:19], v[52:55], v[132:135]
  v_mfma_f32_16x16x32_bf16 v[136:139], v[16:19], v[56:59], v[136:139]
  v_mfma_f32_16x16x32_bf16 v[140:143], v[16:19], v[60:63], v[140:143]
  s_waitcnt lgkmcnt(4)
  v_mfma_f32_16x16x32_bf16 v[144:147], v[20:23], v[48:51], v[144:147]
  ds_read_b64_tr_b16 v[16:17], v14 offset:23552
  ds_read_b64_tr_b16 v[18:19], v14 offset:23808
  v_mfma_f32_16x16x32_bf16 v[148:151], v[20:23], v[52:55], v[148:151]
  v_mfma_f32_16x16x32_bf16 v[152:155], v[20:23], v[56:59], v[152:155]
  v_mfma_f32_16x16x32_bf16 v[156:159], v[20:23], v[60:63], v[156:159]
  v_mfma_f32_16x16x32_bf16 v[68:71], v[20:23], v[64:67], v[68:71]
  s_waitcnt lgkmcnt(4)
  v_mfma_f32_16x16x32_bf16 v[160:163], v[24:27], v[48:51], v[160:163]
  ds_read_b64_tr_b16 v[20:21], v14 offset:28672
  ds_read_b64_tr_b16 v[22:23], v14 offset:28928
  v_mfma_f32_16x16x32_bf16 v[164:167], v[24:27], v[52:55], v[164:167]
  v_mfma_f32_16x16x32_bf16 v[168:171], v[24:27], v[56:59], v[168:171]
  v_mfma_f32_16x16x32_bf16 v[172:175], v[24:27], v[60:63], v[172:175]
  s_waitcnt lgkmcnt(4)
  v_mfma_f32_16x16x32_bf16 v[176:179], v[28:31], v[48:51], v[176:179]
  ds_read_b64_tr_b16 v[24:25], v14 offset:24576
  ds_read_b64_tr_b16 v[26:27], v14 offset:24832
  v_mfma_f32_16x16x32_bf16 v[180:183], v[28:31], v[52:55], v[180:183]
  v_mfma_f32_16x16x32_bf16 v[184:187], v[28:31], v[56:59], v[184:187]
  v_mfma_f32_16x16x32_bf16 v[188:191], v[28:31], v[60:63], v[188:191]
  s_waitcnt lgkmcnt(4)
  v_mfma_f32_16x16x32_bf16 v[192:195], v[16:19], v[48:51], v[192:195]
  ds_read_b64_tr_b16 v[28:29], v14 offset:29696
  ds_read_b64_tr_b16 v[30:31], v14 offset:29952
  v_mfma_f32_16x16x32_bf16 v[196:199], v[16:19], v[52:55], v[196:199]
  v_mfma_f32_16x16x32_bf16 v[200:203], v[16:19], v[56:59], v[200:203]
  v_mfma_f32_16x16x32_bf16 v[204:207], v[16:19], v[60:63], v[204:207]
  s_waitcnt lgkmcnt(4)
  v_mfma_f32_16x16x32_bf16 v[208:211], v[20:23], v[48:51], v[208:211]
  v_mfma_f32_16x16x32_bf16 v[212:215], v[20:23], v[52:55], v[212:215]
  v_mfma_f32_16x16x32_bf16 v[216:219], v[20:23], v[56:59], v[216:219]
  v_mfma_f32_16x16x32_bf16 v[220:223], v[20:23], v[60:63], v[220:223]
  v_mfma_f32_16x16x32_bf16 v[72:75], v[20:23], v[64:67], v[72:75]
  s_waitcnt lgkmcnt(2)
  v_mfma_f32_16x16x32_bf16 v[224:227], v[24:27], v[48:51], v[224:227]
  v_mfma_f32_16x16x32_bf16 v[228:231], v[24:27], v[52:55], v[228:231]
  v_mfma_f32_16x16x32_bf16 v[232:235], v[24:27], v[56:59], v[232:235]
  v_mfma_f32_16x16x32_bf16 v[236:239], v[24:27], v[60:63], v[236:239]
  s_waitcnt lgkmcnt(0)
  v_mfma_f32_16x16x32_bf16 v[240:243], v[28:31], v[48:51], v[240:243]
  v_mfma_f32_16x16x32_bf16 v[244:247], v[28:31], v[52:55], v[244:247]
  v_mfma_f32_16x16x32_bf16 v[248:251], v[28:31], v[56:59], v[248:251]
  v_mfma_f32_16x16x32_bf16 v[252:255], v[28:31], v[60:63], v[252:255]
  v_lshrrev_b32 v3, 4, v2
  s_mul_i32 s47, s29, 640
  s_add_u32 s47, s47, 147456
  v_lshlrev_b32 v10, 4, v3
  v_add_u32 v10, s47, v10
  s_nop 7

  ds_write_b128 v10, v[68:71] offset:192
  ds_write_b128 v10, v[72:75] offset:448
gemm1_kernel_epi:
  s_load_dwordx2 s[4:5], s[0:1], 16
  s_load_dwordx2 s[6:7], s[0:1], 48
  v_and_b32 v1, 15, v2
  s_cmp_ge_u32 s58, 32
  s_cbranch_scc1 gemm1_kernel_statok
  s_mov_b32 s40, 20000

gemm1_kernel_spin:
  s_sleep 2
  buffer_load_dword v8, v15, s[68:71], s55 offen sc1
  s_waitcnt vmcnt(0)
  v_readfirstlane_b32 s58, v8
  s_cmp_ge_u32 s58, 32
  s_cbranch_scc1 gemm1_kernel_statld
  s_sub_u32 s40, s40, 1
  s_cmp_lg_u32 s40, 0
  s_cbranch_scc1 gemm1_kernel_spin

  s_lshl_b32 s48, s32, 8
  s_lshl_b32 s49, s30, 6
  s_add_u32 s48, s48, s49
  s_lshl_b32 s48, s48, 11
  s_lshl_b32 s49, s28, 9
  s_add_u32 s49, s49, 149504
  v_lshlrev_b32 v14, 4, v2
  s_mov_b32 s40, 64

gemm1_kernel_fb:
  buffer_load_dwordx4 v[16:19], v14, s[60:63], s48 offen
  buffer_load_dwordx4 v[20:23], v14, s[60:63], s48 offen offset:1024
  s_waitcnt vmcnt(0)

  s_mov_b32 s47, 0xffff0000
  v_lshlrev_b32 v24, 16, v16
  v_and_b32 v25, s47, v16
  v_lshlrev_b32 v26, 16, v17
  v_and_b32 v27, s47, v17
  v_lshlrev_b32 v28, 16, v18
  v_and_b32 v29, s47, v18
  v_lshlrev_b32 v30, 16, v19
  v_and_b32 v31, s47, v19
  v_lshlrev_b32 v32, 16, v20
  v_and_b32 v33, s47, v20
  v_lshlrev_b32 v34, 16, v21
  v_and_b32 v35, s47, v21
  v_lshlrev_b32 v36, 16, v22
  v_and_b32 v37, s47, v22
  v_lshlrev_b32 v38, 16, v23
  v_and_b32 v39, s47, v23
  v_add_f32 v40, v24, v25
  v_add_f32 v41, v26, v27
  v_add_f32 v40, v40, v28
  v_add_f32 v41, v41, v29
  v_add_f32 v40, v40, v30
  v_add_f32 v41, v41, v31
  v_add_f32 v40, v40, v32
  v_add_f32 v41, v41, v33
  v_add_f32 v40, v40, v34
  v_add_f32 v41, v41, v35
  v_add_f32 v40, v40, v36
  v_add_f32 v41, v41, v37
  v_add_f32 v40, v40, v38
  v_add_f32 v41, v41, v39
  v_add_f32 v40, v40, v41
  s_nop 1
  v_add_f32_dpp v40, v40, v40 quad_perm:[1,0,3,2] row_mask:0xf bank_mask:0xf
  s_nop 1
  v_add_f32_dpp v40, v40, v40 quad_perm:[2,3,0,1] row_mask:0xf bank_mask:0xf
  s_nop 1
  v_add_f32_dpp v40, v40, v40 row_half_mirror row_mask:0xf bank_mask:0xf
  s_nop 1
  v_add_f32_dpp v40, v40, v40 row_mirror row_mask:0xf bank_mask:0xf
  v_mov_b32 v42, v40
  s_nop 1
  v_permlane16_swap_b32 v42, v40
  s_nop 0
  v_add_f32 v40, v40, v42
  v_mov_b32 v42, v40
  s_nop 1
  v_permlane32_swap_b32 v42, v40
  s_nop 0
  v_add_f32 v40, v40, v42
  v_mul_f32 v40, 0xba800000, v40
  v_add_f32 v24, v24, v40
  v_add_f32 v25, v25, v40
  v_add_f32 v26, v26, v40
  v_add_f32 v27, v27, v40
  v_add_f32 v28, v28, v40
  v_add_f32 v29, v29, v40
  v_add_f32 v30, v30, v40
  v_add_f32 v31, v31, v40
  v_add_f32 v32, v32, v40
  v_add_f32 v33, v33, v40
  v_add_f32 v34, v34, v40
  v_add_f32 v35, v35, v40
  v_add_f32 v36, v36, v40
  v_add_f32 v37, v37, v40
  v_add_f32 v38, v38, v40
  v_add_f32 v39, v39, v40
  v_mul_f32 v41, v24, v24
  v_mul_f32 v42, v25, v25
  v_fmac_f32 v41, v26, v26
  v_fmac_f32 v42, v27, v27
  v_fmac_f32 v41, v28, v28
  v_fmac_f32 v42, v29, v29
  v_fmac_f32 v41, v30, v30
  v_fmac_f32 v42, v31, v31
  v_fmac_f32 v41, v32, v32
  v_fmac_f32 v42, v33, v33
  v_fmac_f32 v41, v34, v34
  v_fmac_f32 v42, v35, v35
  v_fmac_f32 v41, v36, v36
  v_fmac_f32 v42, v37, v37
  v_fmac_f32 v41, v38, v38
  v_fmac_f32 v42, v39, v39
  v_add_f32 v41, v41, v42
  s_nop 1
  v_add_f32_dpp v41, v41, v41 quad_perm:[1,0,3,2] row_mask:0xf bank_mask:0xf
  s_nop 1
  v_add_f32_dpp v41, v41, v41 quad_perm:[2,3,0,1] row_mask:0xf bank_mask:0xf
  s_nop 1
  v_add_f32_dpp v41, v41, v41 row_half_mirror row_mask:0xf bank_mask:0xf
  s_nop 1
  v_add_f32_dpp v41, v41, v41 row_mirror row_mask:0xf bank_mask:0xf
  v_mov_b32 v42, v41
  s_nop 1
  v_permlane16_swap_b32 v42, v41
  s_nop 0
  v_add_f32 v41, v41, v42
  v_mov_b32 v42, v41
  s_nop 1
  v_permlane32_swap_b32 v42, v41
  s_nop 0
  v_add_f32 v41, v41, v42
  v_mov_b32 v42, 0x3727c5ac
  v_fmac_f32 v42, 0x3a800000, v41
  v_mov_b32 v41, v42
  v_mov_b32 v13, s49
  ds_write_b64 v13, v[40:41]
  s_add_u32 s48, s48, 2048
  s_add_u32 s49, s49, 8
  s_sub_u32 s40, s40, 1
  s_cmp_lg_u32 s40, 0
  s_cbranch_scc1 gemm1_kernel_fb
  s_lshl_b32 s49, s28, 9
  s_lshl_b32 s48, s29, 8
  s_add_u32 s49, s49, s48
  s_add_u32 s49, s49, 149504
  v_lshlrev_b32 v94, 3, v1
  v_add_u32 v94, s49, v94
  v_xor_b32 v95, 256, v94
  s_waitcnt lgkmcnt(0)

  ds_read_b64 v[80:81], v94 offset:0
  ds_read_b64 v[82:83], v94 offset:128
  ds_read_b64 v[84:85], v95 offset:0
  ds_read_b64 v[86:87], v95 offset:128
  s_branch gemm1_kernel_statok
gemm1_kernel_statld:
  buffer_load_dwordx2 v[80:81], v94, s[12:15], 0 offen offset:0 sc1
  buffer_load_dwordx2 v[82:83], v94, s[12:15], 0 offen offset:128 sc1
  buffer_load_dwordx2 v[84:85], v95, s[12:15], 0 offen offset:0 sc1
  buffer_load_dwordx2 v[86:87], v95, s[12:15], 0 offen offset:128 sc1
gemm1_kernel_statok:
  s_waitcnt lgkmcnt(0)
  s_barrier
  ds_read_b128 v[16:19], v10 offset:0
  ds_read_b128 v[20:23], v10 offset:64
  ds_read_b128 v[24:27], v10 offset:128
  ds_read_b128 v[28:31], v10 offset:192
  ds_read_b128 v[32:35], v10 offset:256
  ds_read_b128 v[36:39], v10 offset:320
  ds_read_b128 v[40:43], v10 offset:384
  ds_read_b128 v[44:47], v10 offset:448
  ds_read_b128 v[48:51], v10 offset:512
  ds_read_b128 v[52:55], v10 offset:576
  v_and_b32 v4, 1, v3
  v_lshrrev_b32 v5, 1, v3
  v_lshl_add_u32 v6, v5, 4, v1
  v_lshlrev_b32 v11, 9, v4
  v_lshl_add_u32 v11, v6, 4, v11
  s_lshl_b32 s47, s29, 2
  v_xor_b32 v6, s47, v6
  v_lshlrev_b32 v12, 4, v4
  v_lshl_add_u32 v12, v6, 5, v12
  v_mul_u32_u24 v13, 147456, v5
  v_lshl_add_u32 v13, v4, 8, v13
  v_lshl_add_u32 v13, v1, 4, v13
  s_lshl_b32 s47, s32, 3
  s_lshl_b32 s48, s30, 1
  s_add_u32 s47, s47, s48
  s_add_u32 s50, s47, s29
  s_xor_b32 s51, s50, 1
  s_waitcnt vmcnt(0)

  v_rsq_f32 v56, v81
  v_rsq_f32 v57, v83
  v_rsq_f32 v58, v85
  v_rsq_f32 v59, v87
  s_nop 0
  v_mul_f32 v60, 3216550459, v56
  v_mul_f32 v61, 3216550459, v57
  v_mul_f32 v62, 3216550459, v58
  v_mul_f32 v63, 3216550459, v59
  s_waitcnt lgkmcnt(0)
  s_cmp_gt_u32 s96, 0
  s_cselect_b32 s53, s31, s3
  s_add_u32 s53, s53, 0
  s_cmp_ge_u32 s53, 48
  s_cbranch_scc1 gemm1_kernel_e47
  s_lshl_b32 s54, s53, 18
  s_lshl_b32 s55, s29, 10
  s_add_u32 s54, s54, s55
  s_add_u32 s54, s54, 4194304
  s_lshl_b32 s55, s50, 11
  s_add_u32 s64, s54, s55
  s_lshl_b32 s55, s51, 11
  s_add_u32 s65, s54, s55
  s_add_u32 s66, s64, 131072
  s_add_u32 s67, s65, 131072
  s_cmp_lt_u32 s53, 16
  s_cselect_b32 s55, 1048744942, 1.0
  s_cmp_ge_u32 s53, 32
  s_cselect_b64 vcc, -1, 0

  v_mul_f32 v64, s55, v56
  v_mul_f32 v65, s55, v57
  v_mul_f32 v66, s55, v58
  v_mul_f32 v67, s55, v59
  v_cndmask_b32 v14, v11, v12, vcc
  v_pk_fma_f32 v[96:97], v[80:81], v[16:17], v[96:97] op_sel_hi:[0,1,1]
  v_pk_fma_f32 v[98:99], v[80:81], v[18:19], v[98:99] op_sel_hi:[0,1,1]
  v_pk_mul_f32 v[96:97], v[96:97], v[64:65] op_sel:[0,0] op_sel_hi:[1,0]
  v_pk_mul_f32 v[98:99], v[98:99], v[64:65] op_sel:[0,0] op_sel_hi:[1,0]
  v_cvt_pk_bf16_f32 v68, v96, v97
  v_cvt_pk_bf16_f32 v69, v98, v99
  v_pk_fma_f32 v[100:101], v[82:83], v[16:17], v[100:101] op_sel_hi:[0,1,1]
  v_pk_fma_f32 v[102:103], v[82:83], v[18:19], v[102:103] op_sel_hi:[0,1,1]
  v_pk_mul_f32 v[100:101], v[100:101], v[64:65] op_sel:[0,1] op_sel_hi:[1,1]
  v_pk_mul_f32 v[102:103], v[102:103], v[64:65] op_sel:[0,1] op_sel_hi:[1,1]
  v_cvt_pk_bf16_f32 v70, v100, v101
  v_cvt_pk_bf16_f32 v71, v102, v103
  s_nop 1
  v_permlane32_swap_b32 v68, v70
  v_permlane32_swap_b32 v69, v71
  s_nop 0
  buffer_store_dwordx4 v[68:71], v14, s[12:15], s64 offen sc1
  v_pk_fma_f32 v[104:105], v[84:85], v[16:17], v[104:105] op_sel_hi:[0,1,1]
  v_pk_fma_f32 v[106:107], v[84:85], v[18:19], v[106:107] op_sel_hi:[0,1,1]
  v_pk_mul_f32 v[104:105], v[104:105], v[66:67] op_sel:[0,0] op_sel_hi:[1,0]
  v_pk_mul_f32 v[106:107], v[106:107], v[66:67] op_sel:[0,0] op_sel_hi:[1,0]
  v_cvt_pk_bf16_f32 v72, v104, v105
  v_cvt_pk_bf16_f32 v73, v106, v107
  v_pk_fma_f32 v[108:109], v[86:87], v[16:17], v[108:109] op_sel_hi:[0,1,1]
  v_pk_fma_f32 v[110:111], v[86:87], v[18:19], v[110:111] op_sel_hi:[0,1,1]
  v_pk_mul_f32 v[108:109], v[108:109], v[66:67] op_sel:[0,1] op_sel_hi:[1,1]
  v_pk_mul_f32 v[110:111], v[110:111], v[66:67] op_sel:[0,1] op_sel_hi:[1,1]
  v_cvt_pk_bf16_f32 v74, v108, v109
  v_cvt_pk_bf16_f32 v75, v110, v111
  s_nop 1
  v_permlane32_swap_b32 v72, v74
  v_permlane32_swap_b32 v73, v75
  s_nop 0
  buffer_store_dwordx4 v[72:75], v14, s[12:15], s65 offen sc1
  v_pk_fma_f32 v[112:113], v[80:81], v[20:21], v[112:113] op_sel_hi:[0,1,1]
  v_pk_fma_f32 v[114:115], v[80:81], v[22:23], v[114:115] op_sel_hi:[0,1,1]
  v_pk_mul_f32 v[112:113], v[112:113], v[64:65] op_sel:[0,0] op_sel_hi:[1,0]
  v_pk_mul_f32 v[114:115], v[114:115], v[64:65] op_sel:[0,0] op_sel_hi:[1,0]
  v_cvt_pk_bf16_f32 v76, v112, v113
  v_cvt_pk_bf16_f32 v77, v114, v115
  v_pk_fma_f32 v[116:117], v[82:83], v[20:21], v[116:117] op_sel_hi:[0,1,1]
  v_pk_fma_f32 v[118:119], v[82:83], v[22:23], v[118:119] op_sel_hi:[0,1,1]
  v_pk_mul_f32 v[116:117], v[116:117], v[64:65] op_sel:[0,1] op_sel_hi:[1,1]
  v_pk_mul_f32 v[118:119], v[118:119], v[64:65] op_sel:[0,1] op_sel_hi:[1,1]
  v_cvt_pk_bf16_f32 v78, v116, v117
  v_cvt_pk_bf16_f32 v79, v118, v119
  s_nop 1
  v_permlane32_swap_b32 v76, v78
  v_permlane32_swap_b32 v77, v79
  s_nop 0
  buffer_store_dwordx4 v[76:79], v14, s[12:15], s66 offen sc1
  v_pk_fma_f32 v[120:121], v[84:85], v[20:21], v[120:121] op_sel_hi:[0,1,1]
  v_pk_fma_f32 v[122:123], v[84:85], v[22:23], v[122:123] op_sel_hi:[0,1,1]
  v_pk_mul_f32 v[120:121], v[120:121], v[66:67] op_sel:[0,0] op_sel_hi:[1,0]
  v_pk_mul_f32 v[122:123], v[122:123], v[66:67] op_sel:[0,0] op_sel_hi:[1,0]
  v_cvt_pk_bf16_f32 v68, v120, v121
  v_cvt_pk_bf16_f32 v69, v122, v123
  v_pk_fma_f32 v[124:125], v[86:87], v[20:21], v[124:125] op_sel_hi:[0,1,1]
  v_pk_fma_f32 v[126:127], v[86:87], v[22:23], v[126:127] op_sel_hi:[0,1,1]
  v_pk_mul_f32 v[124:125], v[124:125], v[66:67] op_sel:[0,1] op_sel_hi:[1,1]
  v_pk_mul_f32 v[126:127], v[126:127], v[66:67] op_sel:[0,1] op_sel_hi:[1,1]
  v_cvt_pk_bf16_f32 v70, v124, v125
  v_cvt_pk_bf16_f32 v71, v126, v127
  s_nop 1
  v_permlane32_swap_b32 v68, v70
  v_permlane32_swap_b32 v69, v71
  s_nop 0
  buffer_store_dwordx4 v[68:71], v14, s[12:15], s67 offen sc1
  s_branch gemm1_kernel_e49
gemm1_kernel_e47:
  s_sub_u32 s54, s53, 16
  s_lshl_b32 s54, s54, 10
  s_lshl_b32 s55, s29, 9
  s_add_u32 s54, s54, s55
  s_add_u32 s54, s54, 16777216
  s_mul_i32 s55, s50, 294912
  s_add_u32 s64, s54, s55
  s_mul_i32 s55, s51, 294912
  s_add_u32 s65, s54, s55

  v_pk_fma_f32 v[96:97], v[80:81], v[16:17], v[96:97] op_sel_hi:[0,1,1]
  v_pk_fma_f32 v[98:99], v[80:81], v[18:19], v[98:99] op_sel_hi:[0,1,1]
  v_pk_mul_f32 v[88:89], v[96:97], v[60:61] op_sel:[0,0] op_sel_hi:[1,0]
  v_pk_mul_f32 v[90:91], v[98:99], v[60:61] op_sel:[0,0] op_sel_hi:[1,0]
  v_pk_fma_f32 v[100:101], v[82:83], v[16:17], v[100:101] op_sel_hi:[0,1,1]
  v_pk_fma_f32 v[102:103], v[82:83], v[18:19], v[102:103] op_sel_hi:[0,1,1]
  v_pk_mul_f32 v[92:93], v[100:101], v[60:61] op_sel:[0,1] op_sel_hi:[1,1]
  v_pk_mul_f32 v[94:95], v[102:103], v[60:61] op_sel:[0,1] op_sel_hi:[1,1]
  v_exp_f32 v88, v88
  v_exp_f32 v89, v89
  v_exp_f32 v90, v90
  v_exp_f32 v91, v91
  v_exp_f32 v92, v92
  v_exp_f32 v93, v93
  v_exp_f32 v94, v94
  v_exp_f32 v95, v95
  v_pk_fma_f32 v[112:113], v[80:81], v[20:21], v[112:113] op_sel_hi:[0,1,1]
  v_pk_fma_f32 v[114:115], v[80:81], v[22:23], v[114:115] op_sel_hi:[0,1,1]
  v_pk_fma_f32 v[88:89], v[88:89], v[80:81], v[80:81] op_sel:[0,1,1] op_sel_hi:[1,1,1]
  v_pk_fma_f32 v[90:91], v[90:91], v[80:81], v[80:81] op_sel:[0,1,1] op_sel_hi:[1,1,1]
  v_pk_fma_f32 v[116:117], v[82:83], v[20:21], v[116:117] op_sel_hi:[0,1,1]
  v_pk_fma_f32 v[118:119], v[82:83], v[22:23], v[118:119] op_sel_hi:[0,1,1]
  v_pk_fma_f32 v[92:93], v[92:93], v[82:83], v[82:83] op_sel:[0,1,1] op_sel_hi:[1,1,1]
  v_pk_fma_f32 v[94:95], v[94:95], v[82:83], v[82:83] op_sel:[0,1,1] op_sel_hi:[1,1,1]
  v_rcp_f32 v88, v88
  v_rcp_f32 v89, v89
  v_rcp_f32 v90, v90
  v_rcp_f32 v91, v91
  v_rcp_f32 v92, v92
  v_rcp_f32 v93, v93
  v_rcp_f32 v94, v94
  v_rcp_f32 v95, v95
  v_pk_mul_f32 v[96:97], v[96:97], v[112:113]
  v_pk_mul_f32 v[98:99], v[98:99], v[114:115]
  v_pk_mul_f32 v[100:101], v[100:101], v[116:117]
  v_pk_mul_f32 v[102:103], v[102:103], v[118:119]
  v_pk_mul_f32 v[96:97], v[96:97], v[88:89]
  v_pk_mul_f32 v[98:99], v[98:99], v[90:91]
  v_cvt_pk_bf16_f32 v68, v96, v97
  v_cvt_pk_bf16_f32 v69, v98, v99
  v_pk_mul_f32 v[100:101], v[100:101], v[92:93]
  v_pk_mul_f32 v[102:103], v[102:103], v[94:95]
  v_cvt_pk_bf16_f32 v70, v100, v101
  v_cvt_pk_bf16_f32 v71, v102, v103
  s_nop 1
  v_permlane32_swap_b32 v68, v70
  v_permlane32_swap_b32 v69, v71
  s_nop 0
  buffer_store_dwordx4 v[68:71], v13, s[12:15], s64 offen sc1
  v_pk_fma_f32 v[104:105], v[84:85], v[16:17], v[104:105] op_sel_hi:[0,1,1]
  v_pk_fma_f32 v[106:107], v[84:85], v[18:19], v[106:107] op_sel_hi:[0,1,1]
  v_pk_mul_f32 v[88:89], v[104:105], v[62:63] op_sel:[0,0] op_sel_hi:[1,0]
  v_pk_mul_f32 v[90:91], v[106:107], v[62:63] op_sel:[0,0] op_sel_hi:[1,0]
  v_pk_fma_f32 v[108:109], v[86:87], v[16:17], v[108:109] op_sel_hi:[0,1,1]
  v_pk_fma_f32 v[110:111], v[86:87], v[18:19], v[110:111] op_sel_hi:[0,1,1]
  v_pk_mul_f32 v[92:93], v[108:109], v[62:63] op_sel:[0,1] op_sel_hi:[1,1]
  v_pk_mul_f32 v[94:95], v[110:111], v[62:63] op_sel:[0,1] op_sel_hi:[1,1]
  v_exp_f32 v88, v88
  v_exp_f32 v89, v89
  v_exp_f32 v90, v90
  v_exp_f32 v91, v91
  v_exp_f32 v92, v92
  v_exp_f32 v93, v93
  v_exp_f32 v94, v94
  v_exp_f32 v95, v95
  v_pk_fma_f32 v[120:121], v[84:85], v[20:21], v[120:121] op_sel_hi:[0,1,1]
  v_pk_fma_f32 v[122:123], v[84:85], v[22:23], v[122:123] op_sel_hi:[0,1,1]
  v_pk_fma_f32 v[88:89], v[88:89], v[84:85], v[84:85] op_sel:[0,1,1] op_sel_hi:[1,1,1]
  v_pk_fma_f32 v[90:91], v[90:91], v[84:85], v[84:85] op_sel:[0,1,1] op_sel_hi:[1,1,1]
  v_pk_fma_f32 v[124:125], v[86:87], v[20:21], v[124:125] op_sel_hi:[0,1,1]
  v_pk_fma_f32 v[126:127], v[86:87], v[22:23], v[126:127] op_sel_hi:[0,1,1]
  v_pk_fma_f32 v[92:93], v[92:93], v[86:87], v[86:87] op_sel:[0,1,1] op_sel_hi:[1,1,1]
  v_pk_fma_f32 v[94:95], v[94:95], v[86:87], v[86:87] op_sel:[0,1,1] op_sel_hi:[1,1,1]
  v_rcp_f32 v88, v88
  v_rcp_f32 v89, v89
  v_rcp_f32 v90, v90
  v_rcp_f32 v91, v91
  v_rcp_f32 v92, v92
  v_rcp_f32 v93, v93
  v_rcp_f32 v94, v94
  v_rcp_f32 v95, v95
  v_pk_mul_f32 v[104:105], v[104:105], v[120:121]
  v_pk_mul_f32 v[106:107], v[106:107], v[122:123]
  v_pk_mul_f32 v[108:109], v[108:109], v[124:125]
  v_pk_mul_f32 v[110:111], v[110:111], v[126:127]
  v_pk_mul_f32 v[104:105], v[104:105], v[88:89]
  v_pk_mul_f32 v[106:107], v[106:107], v[90:91]
  v_cvt_pk_bf16_f32 v72, v104, v105
  v_cvt_pk_bf16_f32 v73, v106, v107
  v_pk_mul_f32 v[108:109], v[108:109], v[92:93]
  v_pk_mul_f32 v[110:111], v[110:111], v[94:95]
  v_cvt_pk_bf16_f32 v74, v108, v109
  v_cvt_pk_bf16_f32 v75, v110, v111
  s_nop 1
  v_permlane32_swap_b32 v72, v74
  v_permlane32_swap_b32 v73, v75
  s_nop 0
  buffer_store_dwordx4 v[72:75], v13, s[12:15], s65 offen sc1
gemm1_kernel_e49:
  s_cmp_gt_u32 s96, 1
  s_cselect_b32 s53, s31, s3
  s_add_u32 s53, s53, 1
  s_cmp_ge_u32 s53, 48
  s_cbranch_scc1 gemm1_kernel_e50
  s_lshl_b32 s54, s53, 18
  s_lshl_b32 s55, s29, 10
  s_add_u32 s54, s54, s55
  s_add_u32 s54, s54, 4194304
  s_lshl_b32 s55, s50, 11
  s_add_u32 s64, s54, s55
  s_lshl_b32 s55, s51, 11
  s_add_u32 s65, s54, s55
  s_add_u32 s66, s64, 131072
  s_add_u32 s67, s65, 131072
  s_cmp_lt_u32 s53, 16
  s_cselect_b32 s55, 1048744942, 1.0
  s_cmp_ge_u32 s53, 32
  s_cselect_b64 vcc, -1, 0

  v_mul_f32 v64, s55, v56
  v_mul_f32 v65, s55, v57
  v_mul_f32 v66, s55, v58
  v_mul_f32 v67, s55, v59
  v_cndmask_b32 v14, v11, v12, vcc
  v_pk_fma_f32 v[128:129], v[80:81], v[24:25], v[128:129] op_sel_hi:[0,1,1]
  v_pk_fma_f32 v[130:131], v[80:81], v[26:27], v[130:131] op_sel_hi:[0,1,1]
  v_pk_mul_f32 v[128:129], v[128:129], v[64:65] op_sel:[0,0] op_sel_hi:[1,0]
  v_pk_mul_f32 v[130:131], v[130:131], v[64:65] op_sel:[0,0] op_sel_hi:[1,0]
  v_cvt_pk_bf16_f32 v68, v128, v129
  v_cvt_pk_bf16_f32 v69, v130, v131
  v_pk_fma_f32 v[132:133], v[82:83], v[24:25], v[132:133] op_sel_hi:[0,1,1]
  v_pk_fma_f32 v[134:135], v[82:83], v[26:27], v[134:135] op_sel_hi:[0,1,1]
  v_pk_mul_f32 v[132:133], v[132:133], v[64:65] op_sel:[0,1] op_sel_hi:[1,1]
  v_pk_mul_f32 v[134:135], v[134:135], v[64:65] op_sel:[0,1] op_sel_hi:[1,1]
  v_cvt_pk_bf16_f32 v70, v132, v133
  v_cvt_pk_bf16_f32 v71, v134, v135
  s_nop 1
  v_permlane32_swap_b32 v68, v70
  v_permlane32_swap_b32 v69, v71
  s_nop 0
  buffer_store_dwordx4 v[68:71], v14, s[12:15], s64 offen sc1
  v_pk_fma_f32 v[136:137], v[84:85], v[24:25], v[136:137] op_sel_hi:[0,1,1]
  v_pk_fma_f32 v[138:139], v[84:85], v[26:27], v[138:139] op_sel_hi:[0,1,1]
  v_pk_mul_f32 v[136:137], v[136:137], v[66:67] op_sel:[0,0] op_sel_hi:[1,0]
  v_pk_mul_f32 v[138:139], v[138:139], v[66:67] op_sel:[0,0] op_sel_hi:[1,0]
  v_cvt_pk_bf16_f32 v72, v136, v137
  v_cvt_pk_bf16_f32 v73, v138, v139
  v_pk_fma_f32 v[140:141], v[86:87], v[24:25], v[140:141] op_sel_hi:[0,1,1]
  v_pk_fma_f32 v[142:143], v[86:87], v[26:27], v[142:143] op_sel_hi:[0,1,1]
  v_pk_mul_f32 v[140:141], v[140:141], v[66:67] op_sel:[0,1] op_sel_hi:[1,1]
  v_pk_mul_f32 v[142:143], v[142:143], v[66:67] op_sel:[0,1] op_sel_hi:[1,1]
  v_cvt_pk_bf16_f32 v74, v140, v141
  v_cvt_pk_bf16_f32 v75, v142, v143
  s_nop 1
  v_permlane32_swap_b32 v72, v74
  v_permlane32_swap_b32 v73, v75
  s_nop 0
  buffer_store_dwordx4 v[72:75], v14, s[12:15], s65 offen sc1
  v_pk_fma_f32 v[144:145], v[80:81], v[28:29], v[144:145] op_sel_hi:[0,1,1]
  v_pk_fma_f32 v[146:147], v[80:81], v[30:31], v[146:147] op_sel_hi:[0,1,1]
  v_pk_mul_f32 v[144:145], v[144:145], v[64:65] op_sel:[0,0] op_sel_hi:[1,0]
  v_pk_mul_f32 v[146:147], v[146:147], v[64:65] op_sel:[0,0] op_sel_hi:[1,0]
  v_cvt_pk_bf16_f32 v76, v144, v145
  v_cvt_pk_bf16_f32 v77, v146, v147
  v_pk_fma_f32 v[148:149], v[82:83], v[28:29], v[148:149] op_sel_hi:[0,1,1]
  v_pk_fma_f32 v[150:151], v[82:83], v[30:31], v[150:151] op_sel_hi:[0,1,1]
  v_pk_mul_f32 v[148:149], v[148:149], v[64:65] op_sel:[0,1] op_sel_hi:[1,1]
  v_pk_mul_f32 v[150:151], v[150:151], v[64:65] op_sel:[0,1] op_sel_hi:[1,1]
  v_cvt_pk_bf16_f32 v78, v148, v149
  v_cvt_pk_bf16_f32 v79, v150, v151
  s_nop 1
  v_permlane32_swap_b32 v76, v78
  v_permlane32_swap_b32 v77, v79
  s_nop 0
  buffer_store_dwordx4 v[76:79], v14, s[12:15], s66 offen sc1
  v_pk_fma_f32 v[152:153], v[84:85], v[28:29], v[152:153] op_sel_hi:[0,1,1]
  v_pk_fma_f32 v[154:155], v[84:85], v[30:31], v[154:155] op_sel_hi:[0,1,1]
  v_pk_mul_f32 v[152:153], v[152:153], v[66:67] op_sel:[0,0] op_sel_hi:[1,0]
  v_pk_mul_f32 v[154:155], v[154:155], v[66:67] op_sel:[0,0] op_sel_hi:[1,0]
  v_cvt_pk_bf16_f32 v68, v152, v153
  v_cvt_pk_bf16_f32 v69, v154, v155
  v_pk_fma_f32 v[156:157], v[86:87], v[28:29], v[156:157] op_sel_hi:[0,1,1]
  v_pk_fma_f32 v[158:159], v[86:87], v[30:31], v[158:159] op_sel_hi:[0,1,1]
  v_pk_mul_f32 v[156:157], v[156:157], v[66:67] op_sel:[0,1] op_sel_hi:[1,1]
  v_pk_mul_f32 v[158:159], v[158:159], v[66:67] op_sel:[0,1] op_sel_hi:[1,1]
  v_cvt_pk_bf16_f32 v70, v156, v157
  v_cvt_pk_bf16_f32 v71, v158, v159
  s_nop 1
  v_permlane32_swap_b32 v68, v70
  v_permlane32_swap_b32 v69, v71
  s_nop 0
  buffer_store_dwordx4 v[68:71], v14, s[12:15], s67 offen sc1
  s_branch gemm1_kernel_e52
gemm1_kernel_e50:
  s_sub_u32 s54, s53, 16
  s_lshl_b32 s54, s54, 10
  s_lshl_b32 s55, s29, 9
  s_add_u32 s54, s54, s55
  s_add_u32 s54, s54, 16777216
  s_mul_i32 s55, s50, 294912
  s_add_u32 s64, s54, s55
  s_mul_i32 s55, s51, 294912
  s_add_u32 s65, s54, s55

  v_pk_fma_f32 v[128:129], v[80:81], v[24:25], v[128:129] op_sel_hi:[0,1,1]
  v_pk_fma_f32 v[130:131], v[80:81], v[26:27], v[130:131] op_sel_hi:[0,1,1]
  v_pk_mul_f32 v[88:89], v[128:129], v[60:61] op_sel:[0,0] op_sel_hi:[1,0]
  v_pk_mul_f32 v[90:91], v[130:131], v[60:61] op_sel:[0,0] op_sel_hi:[1,0]
  v_pk_fma_f32 v[132:133], v[82:83], v[24:25], v[132:133] op_sel_hi:[0,1,1]
  v_pk_fma_f32 v[134:135], v[82:83], v[26:27], v[134:135] op_sel_hi:[0,1,1]
  v_pk_mul_f32 v[92:93], v[132:133], v[60:61] op_sel:[0,1] op_sel_hi:[1,1]
  v_pk_mul_f32 v[94:95], v[134:135], v[60:61] op_sel:[0,1] op_sel_hi:[1,1]
  v_exp_f32 v88, v88
  v_exp_f32 v89, v89
  v_exp_f32 v90, v90
  v_exp_f32 v91, v91
  v_exp_f32 v92, v92
  v_exp_f32 v93, v93
  v_exp_f32 v94, v94
  v_exp_f32 v95, v95
  v_pk_fma_f32 v[144:145], v[80:81], v[28:29], v[144:145] op_sel_hi:[0,1,1]
  v_pk_fma_f32 v[146:147], v[80:81], v[30:31], v[146:147] op_sel_hi:[0,1,1]
  v_pk_fma_f32 v[88:89], v[88:89], v[80:81], v[80:81] op_sel:[0,1,1] op_sel_hi:[1,1,1]
  v_pk_fma_f32 v[90:91], v[90:91], v[80:81], v[80:81] op_sel:[0,1,1] op_sel_hi:[1,1,1]
  v_pk_fma_f32 v[148:149], v[82:83], v[28:29], v[148:149] op_sel_hi:[0,1,1]
  v_pk_fma_f32 v[150:151], v[82:83], v[30:31], v[150:151] op_sel_hi:[0,1,1]
  v_pk_fma_f32 v[92:93], v[92:93], v[82:83], v[82:83] op_sel:[0,1,1] op_sel_hi:[1,1,1]
  v_pk_fma_f32 v[94:95], v[94:95], v[82:83], v[82:83] op_sel:[0,1,1] op_sel_hi:[1,1,1]
  v_rcp_f32 v88, v88
  v_rcp_f32 v89, v89
  v_rcp_f32 v90, v90
  v_rcp_f32 v91, v91
  v_rcp_f32 v92, v92
  v_rcp_f32 v93, v93
  v_rcp_f32 v94, v94
  v_rcp_f32 v95, v95
  v_pk_mul_f32 v[128:129], v[128:129], v[144:145]
  v_pk_mul_f32 v[130:131], v[130:131], v[146:147]
  v_pk_mul_f32 v[132:133], v[132:133], v[148:149]
  v_pk_mul_f32 v[134:135], v[134:135], v[150:151]
  v_pk_mul_f32 v[128:129], v[128:129], v[88:89]
  v_pk_mul_f32 v[130:131], v[130:131], v[90:91]
  v_cvt_pk_bf16_f32 v68, v128, v129
  v_cvt_pk_bf16_f32 v69, v130, v131
  v_pk_mul_f32 v[132:133], v[132:133], v[92:93]
  v_pk_mul_f32 v[134:135], v[134:135], v[94:95]
  v_cvt_pk_bf16_f32 v70, v132, v133
  v_cvt_pk_bf16_f32 v71, v134, v135
  s_nop 1
  v_permlane32_swap_b32 v68, v70
  v_permlane32_swap_b32 v69, v71
  s_nop 0
  buffer_store_dwordx4 v[68:71], v13, s[12:15], s64 offen sc1
  v_pk_fma_f32 v[136:137], v[84:85], v[24:25], v[136:137] op_sel_hi:[0,1,1]
  v_pk_fma_f32 v[138:139], v[84:85], v[26:27], v[138:139] op_sel_hi:[0,1,1]
  v_pk_mul_f32 v[88:89], v[136:137], v[62:63] op_sel:[0,0] op_sel_hi:[1,0]
  v_pk_mul_f32 v[90:91], v[138:139], v[62:63] op_sel:[0,0] op_sel_hi:[1,0]
  v_pk_fma_f32 v[140:141], v[86:87], v[24:25], v[140:141] op_sel_hi:[0,1,1]
  v_pk_fma_f32 v[142:143], v[86:87], v[26:27], v[142:143] op_sel_hi:[0,1,1]
  v_pk_mul_f32 v[92:93], v[140:141], v[62:63] op_sel:[0,1] op_sel_hi:[1,1]
  v_pk_mul_f32 v[94:95], v[142:143], v[62:63] op_sel:[0,1] op_sel_hi:[1,1]
  v_exp_f32 v88, v88
  v_exp_f32 v89, v89
  v_exp_f32 v90, v90
  v_exp_f32 v91, v91
  v_exp_f32 v92, v92
  v_exp_f32 v93, v93
  v_exp_f32 v94, v94
  v_exp_f32 v95, v95
  v_pk_fma_f32 v[152:153], v[84:85], v[28:29], v[152:153] op_sel_hi:[0,1,1]
  v_pk_fma_f32 v[154:155], v[84:85], v[30:31], v[154:155] op_sel_hi:[0,1,1]
  v_pk_fma_f32 v[88:89], v[88:89], v[84:85], v[84:85] op_sel:[0,1,1] op_sel_hi:[1,1,1]
  v_pk_fma_f32 v[90:91], v[90:91], v[84:85], v[84:85] op_sel:[0,1,1] op_sel_hi:[1,1,1]
  v_pk_fma_f32 v[156:157], v[86:87], v[28:29], v[156:157] op_sel_hi:[0,1,1]
  v_pk_fma_f32 v[158:159], v[86:87], v[30:31], v[158:159] op_sel_hi:[0,1,1]
  v_pk_fma_f32 v[92:93], v[92:93], v[86:87], v[86:87] op_sel:[0,1,1] op_sel_hi:[1,1,1]
  v_pk_fma_f32 v[94:95], v[94:95], v[86:87], v[86:87] op_sel:[0,1,1] op_sel_hi:[1,1,1]
  v_rcp_f32 v88, v88
  v_rcp_f32 v89, v89
  v_rcp_f32 v90, v90
  v_rcp_f32 v91, v91
  v_rcp_f32 v92, v92
  v_rcp_f32 v93, v93
  v_rcp_f32 v94, v94
  v_rcp_f32 v95, v95
  v_pk_mul_f32 v[136:137], v[136:137], v[152:153]
  v_pk_mul_f32 v[138:139], v[138:139], v[154:155]
  v_pk_mul_f32 v[140:141], v[140:141], v[156:157]
  v_pk_mul_f32 v[142:143], v[142:143], v[158:159]
  v_pk_mul_f32 v[136:137], v[136:137], v[88:89]
  v_pk_mul_f32 v[138:139], v[138:139], v[90:91]
  v_cvt_pk_bf16_f32 v72, v136, v137
  v_cvt_pk_bf16_f32 v73, v138, v139
  v_pk_mul_f32 v[140:141], v[140:141], v[92:93]
  v_pk_mul_f32 v[142:143], v[142:143], v[94:95]
  v_cvt_pk_bf16_f32 v74, v140, v141
  v_cvt_pk_bf16_f32 v75, v142, v143
  s_nop 1
  v_permlane32_swap_b32 v72, v74
  v_permlane32_swap_b32 v73, v75
  s_nop 0
  buffer_store_dwordx4 v[72:75], v13, s[12:15], s65 offen sc1
gemm1_kernel_e52:
  s_cmp_gt_u32 s96, 2
  s_cselect_b32 s53, s31, s3
  s_add_u32 s53, s53, 2
  s_cmp_ge_u32 s53, 48
  s_cbranch_scc1 gemm1_kernel_e53
  s_lshl_b32 s54, s53, 18
  s_lshl_b32 s55, s29, 10
  s_add_u32 s54, s54, s55
  s_add_u32 s54, s54, 4194304
  s_lshl_b32 s55, s50, 11
  s_add_u32 s64, s54, s55
  s_lshl_b32 s55, s51, 11
  s_add_u32 s65, s54, s55
  s_add_u32 s66, s64, 131072
  s_add_u32 s67, s65, 131072
  s_cmp_lt_u32 s53, 16
  s_cselect_b32 s55, 1048744942, 1.0
  s_cmp_ge_u32 s53, 32
  s_cselect_b64 vcc, -1, 0

  v_mul_f32 v64, s55, v56
  v_mul_f32 v65, s55, v57
  v_mul_f32 v66, s55, v58
  v_mul_f32 v67, s55, v59
  v_cndmask_b32 v14, v11, v12, vcc
  v_pk_fma_f32 v[160:161], v[80:81], v[32:33], v[160:161] op_sel_hi:[0,1,1]
  v_pk_fma_f32 v[162:163], v[80:81], v[34:35], v[162:163] op_sel_hi:[0,1,1]
  v_pk_mul_f32 v[160:161], v[160:161], v[64:65] op_sel:[0,0] op_sel_hi:[1,0]
  v_pk_mul_f32 v[162:163], v[162:163], v[64:65] op_sel:[0,0] op_sel_hi:[1,0]
  v_cvt_pk_bf16_f32 v68, v160, v161
  v_cvt_pk_bf16_f32 v69, v162, v163
  v_pk_fma_f32 v[164:165], v[82:83], v[32:33], v[164:165] op_sel_hi:[0,1,1]
  v_pk_fma_f32 v[166:167], v[82:83], v[34:35], v[166:167] op_sel_hi:[0,1,1]
  v_pk_mul_f32 v[164:165], v[164:165], v[64:65] op_sel:[0,1] op_sel_hi:[1,1]
  v_pk_mul_f32 v[166:167], v[166:167], v[64:65] op_sel:[0,1] op_sel_hi:[1,1]
  v_cvt_pk_bf16_f32 v70, v164, v165
  v_cvt_pk_bf16_f32 v71, v166, v167
  s_nop 1
  v_permlane32_swap_b32 v68, v70
  v_permlane32_swap_b32 v69, v71
  s_nop 0
  buffer_store_dwordx4 v[68:71], v14, s[12:15], s64 offen sc1
  v_pk_fma_f32 v[168:169], v[84:85], v[32:33], v[168:169] op_sel_hi:[0,1,1]
  v_pk_fma_f32 v[170:171], v[84:85], v[34:35], v[170:171] op_sel_hi:[0,1,1]
  v_pk_mul_f32 v[168:169], v[168:169], v[66:67] op_sel:[0,0] op_sel_hi:[1,0]
  v_pk_mul_f32 v[170:171], v[170:171], v[66:67] op_sel:[0,0] op_sel_hi:[1,0]
  v_cvt_pk_bf16_f32 v72, v168, v169
  v_cvt_pk_bf16_f32 v73, v170, v171
  v_pk_fma_f32 v[172:173], v[86:87], v[32:33], v[172:173] op_sel_hi:[0,1,1]
  v_pk_fma_f32 v[174:175], v[86:87], v[34:35], v[174:175] op_sel_hi:[0,1,1]
  v_pk_mul_f32 v[172:173], v[172:173], v[66:67] op_sel:[0,1] op_sel_hi:[1,1]
  v_pk_mul_f32 v[174:175], v[174:175], v[66:67] op_sel:[0,1] op_sel_hi:[1,1]
  v_cvt_pk_bf16_f32 v74, v172, v173
  v_cvt_pk_bf16_f32 v75, v174, v175
  s_nop 1
  v_permlane32_swap_b32 v72, v74
  v_permlane32_swap_b32 v73, v75
  s_nop 0
  buffer_store_dwordx4 v[72:75], v14, s[12:15], s65 offen sc1
  v_pk_fma_f32 v[176:177], v[80:81], v[36:37], v[176:177] op_sel_hi:[0,1,1]
  v_pk_fma_f32 v[178:179], v[80:81], v[38:39], v[178:179] op_sel_hi:[0,1,1]
  v_pk_mul_f32 v[176:177], v[176:177], v[64:65] op_sel:[0,0] op_sel_hi:[1,0]
  v_pk_mul_f32 v[178:179], v[178:179], v[64:65] op_sel:[0,0] op_sel_hi:[1,0]
  v_cvt_pk_bf16_f32 v76, v176, v177
  v_cvt_pk_bf16_f32 v77, v178, v179
  v_pk_fma_f32 v[180:181], v[82:83], v[36:37], v[180:181] op_sel_hi:[0,1,1]
  v_pk_fma_f32 v[182:183], v[82:83], v[38:39], v[182:183] op_sel_hi:[0,1,1]
  v_pk_mul_f32 v[180:181], v[180:181], v[64:65] op_sel:[0,1] op_sel_hi:[1,1]
  v_pk_mul_f32 v[182:183], v[182:183], v[64:65] op_sel:[0,1] op_sel_hi:[1,1]
  v_cvt_pk_bf16_f32 v78, v180, v181
  v_cvt_pk_bf16_f32 v79, v182, v183
  s_nop 1
  v_permlane32_swap_b32 v76, v78
  v_permlane32_swap_b32 v77, v79
  s_nop 0
  buffer_store_dwordx4 v[76:79], v14, s[12:15], s66 offen sc1
  v_pk_fma_f32 v[184:185], v[84:85], v[36:37], v[184:185] op_sel_hi:[0,1,1]
  v_pk_fma_f32 v[186:187], v[84:85], v[38:39], v[186:187] op_sel_hi:[0,1,1]
  v_pk_mul_f32 v[184:185], v[184:185], v[66:67] op_sel:[0,0] op_sel_hi:[1,0]
  v_pk_mul_f32 v[186:187], v[186:187], v[66:67] op_sel:[0,0] op_sel_hi:[1,0]
  v_cvt_pk_bf16_f32 v68, v184, v185
  v_cvt_pk_bf16_f32 v69, v186, v187
  v_pk_fma_f32 v[188:189], v[86:87], v[36:37], v[188:189] op_sel_hi:[0,1,1]
  v_pk_fma_f32 v[190:191], v[86:87], v[38:39], v[190:191] op_sel_hi:[0,1,1]
  v_pk_mul_f32 v[188:189], v[188:189], v[66:67] op_sel:[0,1] op_sel_hi:[1,1]
  v_pk_mul_f32 v[190:191], v[190:191], v[66:67] op_sel:[0,1] op_sel_hi:[1,1]
  v_cvt_pk_bf16_f32 v70, v188, v189
  v_cvt_pk_bf16_f32 v71, v190, v191
  s_nop 1
  v_permlane32_swap_b32 v68, v70
  v_permlane32_swap_b32 v69, v71
  s_nop 0
  buffer_store_dwordx4 v[68:71], v14, s[12:15], s67 offen sc1
  s_branch gemm1_kernel_e55
gemm1_kernel_e53:
  s_sub_u32 s54, s53, 16
  s_lshl_b32 s54, s54, 10
  s_lshl_b32 s55, s29, 9
  s_add_u32 s54, s54, s55
  s_add_u32 s54, s54, 16777216
  s_mul_i32 s55, s50, 294912
  s_add_u32 s64, s54, s55
  s_mul_i32 s55, s51, 294912
  s_add_u32 s65, s54, s55

  v_pk_fma_f32 v[160:161], v[80:81], v[32:33], v[160:161] op_sel_hi:[0,1,1]
  v_pk_fma_f32 v[162:163], v[80:81], v[34:35], v[162:163] op_sel_hi:[0,1,1]
  v_pk_mul_f32 v[88:89], v[160:161], v[60:61] op_sel:[0,0] op_sel_hi:[1,0]
  v_pk_mul_f32 v[90:91], v[162:163], v[60:61] op_sel:[0,0] op_sel_hi:[1,0]
  v_pk_fma_f32 v[164:165], v[82:83], v[32:33], v[164:165] op_sel_hi:[0,1,1]
  v_pk_fma_f32 v[166:167], v[82:83], v[34:35], v[166:167] op_sel_hi:[0,1,1]
  v_pk_mul_f32 v[92:93], v[164:165], v[60:61] op_sel:[0,1] op_sel_hi:[1,1]
  v_pk_mul_f32 v[94:95], v[166:167], v[60:61] op_sel:[0,1] op_sel_hi:[1,1]
  v_exp_f32 v88, v88
  v_exp_f32 v89, v89
  v_exp_f32 v90, v90
  v_exp_f32 v91, v91
  v_exp_f32 v92, v92
  v_exp_f32 v93, v93
  v_exp_f32 v94, v94
  v_exp_f32 v95, v95
  v_pk_fma_f32 v[176:177], v[80:81], v[36:37], v[176:177] op_sel_hi:[0,1,1]
  v_pk_fma_f32 v[178:179], v[80:81], v[38:39], v[178:179] op_sel_hi:[0,1,1]
  v_pk_fma_f32 v[88:89], v[88:89], v[80:81], v[80:81] op_sel:[0,1,1] op_sel_hi:[1,1,1]
  v_pk_fma_f32 v[90:91], v[90:91], v[80:81], v[80:81] op_sel:[0,1,1] op_sel_hi:[1,1,1]
  v_pk_fma_f32 v[180:181], v[82:83], v[36:37], v[180:181] op_sel_hi:[0,1,1]
  v_pk_fma_f32 v[182:183], v[82:83], v[38:39], v[182:183] op_sel_hi:[0,1,1]
  v_pk_fma_f32 v[92:93], v[92:93], v[82:83], v[82:83] op_sel:[0,1,1] op_sel_hi:[1,1,1]
  v_pk_fma_f32 v[94:95], v[94:95], v[82:83], v[82:83] op_sel:[0,1,1] op_sel_hi:[1,1,1]
  v_rcp_f32 v88, v88
  v_rcp_f32 v89, v89
  v_rcp_f32 v90, v90
  v_rcp_f32 v91, v91
  v_rcp_f32 v92, v92
  v_rcp_f32 v93, v93
  v_rcp_f32 v94, v94
  v_rcp_f32 v95, v95
  v_pk_mul_f32 v[160:161], v[160:161], v[176:177]
  v_pk_mul_f32 v[162:163], v[162:163], v[178:179]
  v_pk_mul_f32 v[164:165], v[164:165], v[180:181]
  v_pk_mul_f32 v[166:167], v[166:167], v[182:183]
  v_pk_mul_f32 v[160:161], v[160:161], v[88:89]
  v_pk_mul_f32 v[162:163], v[162:163], v[90:91]
  v_cvt_pk_bf16_f32 v68, v160, v161
  v_cvt_pk_bf16_f32 v69, v162, v163
  v_pk_mul_f32 v[164:165], v[164:165], v[92:93]
  v_pk_mul_f32 v[166:167], v[166:167], v[94:95]
  v_cvt_pk_bf16_f32 v70, v164, v165
  v_cvt_pk_bf16_f32 v71, v166, v167
  s_nop 1
  v_permlane32_swap_b32 v68, v70
  v_permlane32_swap_b32 v69, v71
  s_nop 0
  buffer_store_dwordx4 v[68:71], v13, s[12:15], s64 offen sc1
  v_pk_fma_f32 v[168:169], v[84:85], v[32:33], v[168:169] op_sel_hi:[0,1,1]
  v_pk_fma_f32 v[170:171], v[84:85], v[34:35], v[170:171] op_sel_hi:[0,1,1]
  v_pk_mul_f32 v[88:89], v[168:169], v[62:63] op_sel:[0,0] op_sel_hi:[1,0]
  v_pk_mul_f32 v[90:91], v[170:171], v[62:63] op_sel:[0,0] op_sel_hi:[1,0]
  v_pk_fma_f32 v[172:173], v[86:87], v[32:33], v[172:173] op_sel_hi:[0,1,1]
  v_pk_fma_f32 v[174:175], v[86:87], v[34:35], v[174:175] op_sel_hi:[0,1,1]
  v_pk_mul_f32 v[92:93], v[172:173], v[62:63] op_sel:[0,1] op_sel_hi:[1,1]
  v_pk_mul_f32 v[94:95], v[174:175], v[62:63] op_sel:[0,1] op_sel_hi:[1,1]
  v_exp_f32 v88, v88
  v_exp_f32 v89, v89
  v_exp_f32 v90, v90
  v_exp_f32 v91, v91
  v_exp_f32 v92, v92
  v_exp_f32 v93, v93
  v_exp_f32 v94, v94
  v_exp_f32 v95, v95
  v_pk_fma_f32 v[184:185], v[84:85], v[36:37], v[184:185] op_sel_hi:[0,1,1]
  v_pk_fma_f32 v[186:187], v[84:85], v[38:39], v[186:187] op_sel_hi:[0,1,1]
  v_pk_fma_f32 v[88:89], v[88:89], v[84:85], v[84:85] op_sel:[0,1,1] op_sel_hi:[1,1,1]
  v_pk_fma_f32 v[90:91], v[90:91], v[84:85], v[84:85] op_sel:[0,1,1] op_sel_hi:[1,1,1]
  v_pk_fma_f32 v[188:189], v[86:87], v[36:37], v[188:189] op_sel_hi:[0,1,1]
  v_pk_fma_f32 v[190:191], v[86:87], v[38:39], v[190:191] op_sel_hi:[0,1,1]
  v_pk_fma_f32 v[92:93], v[92:93], v[86:87], v[86:87] op_sel:[0,1,1] op_sel_hi:[1,1,1]
  v_pk_fma_f32 v[94:95], v[94:95], v[86:87], v[86:87] op_sel:[0,1,1] op_sel_hi:[1,1,1]
  v_rcp_f32 v88, v88
  v_rcp_f32 v89, v89
  v_rcp_f32 v90, v90
  v_rcp_f32 v91, v91
  v_rcp_f32 v92, v92
  v_rcp_f32 v93, v93
  v_rcp_f32 v94, v94
  v_rcp_f32 v95, v95
  v_pk_mul_f32 v[168:169], v[168:169], v[184:185]
  v_pk_mul_f32 v[170:171], v[170:171], v[186:187]
  v_pk_mul_f32 v[172:173], v[172:173], v[188:189]
  v_pk_mul_f32 v[174:175], v[174:175], v[190:191]
  v_pk_mul_f32 v[168:169], v[168:169], v[88:89]
  v_pk_mul_f32 v[170:171], v[170:171], v[90:91]
  v_cvt_pk_bf16_f32 v72, v168, v169
  v_cvt_pk_bf16_f32 v73, v170, v171
  v_pk_mul_f32 v[172:173], v[172:173], v[92:93]
  v_pk_mul_f32 v[174:175], v[174:175], v[94:95]
  v_cvt_pk_bf16_f32 v74, v172, v173
  v_cvt_pk_bf16_f32 v75, v174, v175
  s_nop 1
  v_permlane32_swap_b32 v72, v74
  v_permlane32_swap_b32 v73, v75
  s_nop 0
  buffer_store_dwordx4 v[72:75], v13, s[12:15], s65 offen sc1
gemm1_kernel_e55:
  s_cmp_gt_u32 s96, 3
  s_cselect_b32 s53, s31, s3
  s_add_u32 s53, s53, 3
  s_cmp_ge_u32 s53, 48
  s_cbranch_scc1 gemm1_kernel_e56
  s_lshl_b32 s54, s53, 18
  s_lshl_b32 s55, s29, 10
  s_add_u32 s54, s54, s55
  s_add_u32 s54, s54, 4194304
  s_lshl_b32 s55, s50, 11
  s_add_u32 s64, s54, s55
  s_lshl_b32 s55, s51, 11
  s_add_u32 s65, s54, s55
  s_add_u32 s66, s64, 131072
  s_add_u32 s67, s65, 131072
  s_cmp_lt_u32 s53, 16
  s_cselect_b32 s55, 1048744942, 1.0
  s_cmp_ge_u32 s53, 32
  s_cselect_b64 vcc, -1, 0

  v_mul_f32 v64, s55, v56
  v_mul_f32 v65, s55, v57
  v_mul_f32 v66, s55, v58
  v_mul_f32 v67, s55, v59
  v_cndmask_b32 v14, v11, v12, vcc
  v_pk_fma_f32 v[192:193], v[80:81], v[40:41], v[192:193] op_sel_hi:[0,1,1]
  v_pk_fma_f32 v[194:195], v[80:81], v[42:43], v[194:195] op_sel_hi:[0,1,1]
  v_pk_mul_f32 v[192:193], v[192:193], v[64:65] op_sel:[0,0] op_sel_hi:[1,0]
  v_pk_mul_f32 v[194:195], v[194:195], v[64:65] op_sel:[0,0] op_sel_hi:[1,0]
  v_cvt_pk_bf16_f32 v68, v192, v193
  v_cvt_pk_bf16_f32 v69, v194, v195
  v_pk_fma_f32 v[196:197], v[82:83], v[40:41], v[196:197] op_sel_hi:[0,1,1]
  v_pk_fma_f32 v[198:199], v[82:83], v[42:43], v[198:199] op_sel_hi:[0,1,1]
  v_pk_mul_f32 v[196:197], v[196:197], v[64:65] op_sel:[0,1] op_sel_hi:[1,1]
  v_pk_mul_f32 v[198:199], v[198:199], v[64:65] op_sel:[0,1] op_sel_hi:[1,1]
  v_cvt_pk_bf16_f32 v70, v196, v197
  v_cvt_pk_bf16_f32 v71, v198, v199
  s_nop 1
  v_permlane32_swap_b32 v68, v70
  v_permlane32_swap_b32 v69, v71
  s_nop 0
  buffer_store_dwordx4 v[68:71], v14, s[12:15], s64 offen sc1
  v_pk_fma_f32 v[200:201], v[84:85], v[40:41], v[200:201] op_sel_hi:[0,1,1]
  v_pk_fma_f32 v[202:203], v[84:85], v[42:43], v[202:203] op_sel_hi:[0,1,1]
  v_pk_mul_f32 v[200:201], v[200:201], v[66:67] op_sel:[0,0] op_sel_hi:[1,0]
  v_pk_mul_f32 v[202:203], v[202:203], v[66:67] op_sel:[0,0] op_sel_hi:[1,0]
  v_cvt_pk_bf16_f32 v72, v200, v201
  v_cvt_pk_bf16_f32 v73, v202, v203
  v_pk_fma_f32 v[204:205], v[86:87], v[40:41], v[204:205] op_sel_hi:[0,1,1]
  v_pk_fma_f32 v[206:207], v[86:87], v[42:43], v[206:207] op_sel_hi:[0,1,1]
  v_pk_mul_f32 v[204:205], v[204:205], v[66:67] op_sel:[0,1] op_sel_hi:[1,1]
  v_pk_mul_f32 v[206:207], v[206:207], v[66:67] op_sel:[0,1] op_sel_hi:[1,1]
  v_cvt_pk_bf16_f32 v74, v204, v205
  v_cvt_pk_bf16_f32 v75, v206, v207
  s_nop 1
  v_permlane32_swap_b32 v72, v74
  v_permlane32_swap_b32 v73, v75
  s_nop 0
  buffer_store_dwordx4 v[72:75], v14, s[12:15], s65 offen sc1
  v_pk_fma_f32 v[208:209], v[80:81], v[44:45], v[208:209] op_sel_hi:[0,1,1]
  v_pk_fma_f32 v[210:211], v[80:81], v[46:47], v[210:211] op_sel_hi:[0,1,1]
  v_pk_mul_f32 v[208:209], v[208:209], v[64:65] op_sel:[0,0] op_sel_hi:[1,0]
  v_pk_mul_f32 v[210:211], v[210:211], v[64:65] op_sel:[0,0] op_sel_hi:[1,0]
  v_cvt_pk_bf16_f32 v76, v208, v209
  v_cvt_pk_bf16_f32 v77, v210, v211
  v_pk_fma_f32 v[212:213], v[82:83], v[44:45], v[212:213] op_sel_hi:[0,1,1]
  v_pk_fma_f32 v[214:215], v[82:83], v[46:47], v[214:215] op_sel_hi:[0,1,1]
  v_pk_mul_f32 v[212:213], v[212:213], v[64:65] op_sel:[0,1] op_sel_hi:[1,1]
  v_pk_mul_f32 v[214:215], v[214:215], v[64:65] op_sel:[0,1] op_sel_hi:[1,1]
  v_cvt_pk_bf16_f32 v78, v212, v213
  v_cvt_pk_bf16_f32 v79, v214, v215
  s_nop 1
  v_permlane32_swap_b32 v76, v78
  v_permlane32_swap_b32 v77, v79
  s_nop 0
  buffer_store_dwordx4 v[76:79], v14, s[12:15], s66 offen sc1
  v_pk_fma_f32 v[216:217], v[84:85], v[44:45], v[216:217] op_sel_hi:[0,1,1]
  v_pk_fma_f32 v[218:219], v[84:85], v[46:47], v[218:219] op_sel_hi:[0,1,1]
  v_pk_mul_f32 v[216:217], v[216:217], v[66:67] op_sel:[0,0] op_sel_hi:[1,0]
  v_pk_mul_f32 v[218:219], v[218:219], v[66:67] op_sel:[0,0] op_sel_hi:[1,0]
  v_cvt_pk_bf16_f32 v68, v216, v217
  v_cvt_pk_bf16_f32 v69, v218, v219
  v_pk_fma_f32 v[220:221], v[86:87], v[44:45], v[220:221] op_sel_hi:[0,1,1]
  v_pk_fma_f32 v[222:223], v[86:87], v[46:47], v[222:223] op_sel_hi:[0,1,1]
  v_pk_mul_f32 v[220:221], v[220:221], v[66:67] op_sel:[0,1] op_sel_hi:[1,1]
  v_pk_mul_f32 v[222:223], v[222:223], v[66:67] op_sel:[0,1] op_sel_hi:[1,1]
  v_cvt_pk_bf16_f32 v70, v220, v221
  v_cvt_pk_bf16_f32 v71, v222, v223
  s_nop 1
  v_permlane32_swap_b32 v68, v70
  v_permlane32_swap_b32 v69, v71
  s_nop 0
  buffer_store_dwordx4 v[68:71], v14, s[12:15], s67 offen sc1
  s_branch gemm1_kernel_e58
gemm1_kernel_e56:
  s_sub_u32 s54, s53, 16
  s_lshl_b32 s54, s54, 10
  s_lshl_b32 s55, s29, 9
  s_add_u32 s54, s54, s55
  s_add_u32 s54, s54, 16777216
  s_mul_i32 s55, s50, 294912
  s_add_u32 s64, s54, s55
  s_mul_i32 s55, s51, 294912
  s_add_u32 s65, s54, s55

  v_pk_fma_f32 v[192:193], v[80:81], v[40:41], v[192:193] op_sel_hi:[0,1,1]
  v_pk_fma_f32 v[194:195], v[80:81], v[42:43], v[194:195] op_sel_hi:[0,1,1]
  v_pk_mul_f32 v[88:89], v[192:193], v[60:61] op_sel:[0,0] op_sel_hi:[1,0]
  v_pk_mul_f32 v[90:91], v[194:195], v[60:61] op_sel:[0,0] op_sel_hi:[1,0]
  v_pk_fma_f32 v[196:197], v[82:83], v[40:41], v[196:197] op_sel_hi:[0,1,1]
  v_pk_fma_f32 v[198:199], v[82:83], v[42:43], v[198:199] op_sel_hi:[0,1,1]
  v_pk_mul_f32 v[92:93], v[196:197], v[60:61] op_sel:[0,1] op_sel_hi:[1,1]
  v_pk_mul_f32 v[94:95], v[198:199], v[60:61] op_sel:[0,1] op_sel_hi:[1,1]
  v_exp_f32 v88, v88
  v_exp_f32 v89, v89
  v_exp_f32 v90, v90
  v_exp_f32 v91, v91
  v_exp_f32 v92, v92
  v_exp_f32 v93, v93
  v_exp_f32 v94, v94
  v_exp_f32 v95, v95
  v_pk_fma_f32 v[208:209], v[80:81], v[44:45], v[208:209] op_sel_hi:[0,1,1]
  v_pk_fma_f32 v[210:211], v[80:81], v[46:47], v[210:211] op_sel_hi:[0,1,1]
  v_pk_fma_f32 v[88:89], v[88:89], v[80:81], v[80:81] op_sel:[0,1,1] op_sel_hi:[1,1,1]
  v_pk_fma_f32 v[90:91], v[90:91], v[80:81], v[80:81] op_sel:[0,1,1] op_sel_hi:[1,1,1]
  v_pk_fma_f32 v[212:213], v[82:83], v[44:45], v[212:213] op_sel_hi:[0,1,1]
  v_pk_fma_f32 v[214:215], v[82:83], v[46:47], v[214:215] op_sel_hi:[0,1,1]
  v_pk_fma_f32 v[92:93], v[92:93], v[82:83], v[82:83] op_sel:[0,1,1] op_sel_hi:[1,1,1]
  v_pk_fma_f32 v[94:95], v[94:95], v[82:83], v[82:83] op_sel:[0,1,1] op_sel_hi:[1,1,1]
  v_rcp_f32 v88, v88
  v_rcp_f32 v89, v89
  v_rcp_f32 v90, v90
  v_rcp_f32 v91, v91
  v_rcp_f32 v92, v92
  v_rcp_f32 v93, v93
  v_rcp_f32 v94, v94
  v_rcp_f32 v95, v95
  v_pk_mul_f32 v[192:193], v[192:193], v[208:209]
  v_pk_mul_f32 v[194:195], v[194:195], v[210:211]
  v_pk_mul_f32 v[196:197], v[196:197], v[212:213]
  v_pk_mul_f32 v[198:199], v[198:199], v[214:215]
  v_pk_mul_f32 v[192:193], v[192:193], v[88:89]
  v_pk_mul_f32 v[194:195], v[194:195], v[90:91]
  v_cvt_pk_bf16_f32 v68, v192, v193
  v_cvt_pk_bf16_f32 v69, v194, v195
  v_pk_mul_f32 v[196:197], v[196:197], v[92:93]
  v_pk_mul_f32 v[198:199], v[198:199], v[94:95]
  v_cvt_pk_bf16_f32 v70, v196, v197
  v_cvt_pk_bf16_f32 v71, v198, v199
  s_nop 1
  v_permlane32_swap_b32 v68, v70
  v_permlane32_swap_b32 v69, v71
  s_nop 0
  buffer_store_dwordx4 v[68:71], v13, s[12:15], s64 offen sc1
  v_pk_fma_f32 v[200:201], v[84:85], v[40:41], v[200:201] op_sel_hi:[0,1,1]
  v_pk_fma_f32 v[202:203], v[84:85], v[42:43], v[202:203] op_sel_hi:[0,1,1]
  v_pk_mul_f32 v[88:89], v[200:201], v[62:63] op_sel:[0,0] op_sel_hi:[1,0]
  v_pk_mul_f32 v[90:91], v[202:203], v[62:63] op_sel:[0,0] op_sel_hi:[1,0]
  v_pk_fma_f32 v[204:205], v[86:87], v[40:41], v[204:205] op_sel_hi:[0,1,1]
  v_pk_fma_f32 v[206:207], v[86:87], v[42:43], v[206:207] op_sel_hi:[0,1,1]
  v_pk_mul_f32 v[92:93], v[204:205], v[62:63] op_sel:[0,1] op_sel_hi:[1,1]
  v_pk_mul_f32 v[94:95], v[206:207], v[62:63] op_sel:[0,1] op_sel_hi:[1,1]
  v_exp_f32 v88, v88
  v_exp_f32 v89, v89
  v_exp_f32 v90, v90
  v_exp_f32 v91, v91
  v_exp_f32 v92, v92
  v_exp_f32 v93, v93
  v_exp_f32 v94, v94
  v_exp_f32 v95, v95
  v_pk_fma_f32 v[216:217], v[84:85], v[44:45], v[216:217] op_sel_hi:[0,1,1]
  v_pk_fma_f32 v[218:219], v[84:85], v[46:47], v[218:219] op_sel_hi:[0,1,1]
  v_pk_fma_f32 v[88:89], v[88:89], v[84:85], v[84:85] op_sel:[0,1,1] op_sel_hi:[1,1,1]
  v_pk_fma_f32 v[90:91], v[90:91], v[84:85], v[84:85] op_sel:[0,1,1] op_sel_hi:[1,1,1]
  v_pk_fma_f32 v[220:221], v[86:87], v[44:45], v[220:221] op_sel_hi:[0,1,1]
  v_pk_fma_f32 v[222:223], v[86:87], v[46:47], v[222:223] op_sel_hi:[0,1,1]
  v_pk_fma_f32 v[92:93], v[92:93], v[86:87], v[86:87] op_sel:[0,1,1] op_sel_hi:[1,1,1]
  v_pk_fma_f32 v[94:95], v[94:95], v[86:87], v[86:87] op_sel:[0,1,1] op_sel_hi:[1,1,1]
  v_rcp_f32 v88, v88
  v_rcp_f32 v89, v89
  v_rcp_f32 v90, v90
  v_rcp_f32 v91, v91
  v_rcp_f32 v92, v92
  v_rcp_f32 v93, v93
  v_rcp_f32 v94, v94
  v_rcp_f32 v95, v95
  v_pk_mul_f32 v[200:201], v[200:201], v[216:217]
  v_pk_mul_f32 v[202:203], v[202:203], v[218:219]
  v_pk_mul_f32 v[204:205], v[204:205], v[220:221]
  v_pk_mul_f32 v[206:207], v[206:207], v[222:223]
  v_pk_mul_f32 v[200:201], v[200:201], v[88:89]
  v_pk_mul_f32 v[202:203], v[202:203], v[90:91]
  v_cvt_pk_bf16_f32 v72, v200, v201
  v_cvt_pk_bf16_f32 v73, v202, v203
  v_pk_mul_f32 v[204:205], v[204:205], v[92:93]
  v_pk_mul_f32 v[206:207], v[206:207], v[94:95]
  v_cvt_pk_bf16_f32 v74, v204, v205
  v_cvt_pk_bf16_f32 v75, v206, v207
  s_nop 1
  v_permlane32_swap_b32 v72, v74
  v_permlane32_swap_b32 v73, v75
  s_nop 0
  buffer_store_dwordx4 v[72:75], v13, s[12:15], s65 offen sc1
gemm1_kernel_e58:
  s_cmp_gt_u32 s96, 4
  s_cselect_b32 s53, s31, s3
  s_add_u32 s53, s53, 4
  s_cmp_ge_u32 s53, 48
  s_cbranch_scc1 gemm1_kernel_e59
  s_lshl_b32 s54, s53, 18
  s_lshl_b32 s55, s29, 10
  s_add_u32 s54, s54, s55
  s_add_u32 s54, s54, 4194304
  s_lshl_b32 s55, s50, 11
  s_add_u32 s64, s54, s55
  s_lshl_b32 s55, s51, 11
  s_add_u32 s65, s54, s55
  s_add_u32 s66, s64, 131072
  s_add_u32 s67, s65, 131072
  s_cmp_lt_u32 s53, 16
  s_cselect_b32 s55, 1048744942, 1.0
  s_cmp_ge_u32 s53, 32
  s_cselect_b64 vcc, -1, 0

  v_mul_f32 v64, s55, v56
  v_mul_f32 v65, s55, v57
  v_mul_f32 v66, s55, v58
  v_mul_f32 v67, s55, v59
  v_cndmask_b32 v14, v11, v12, vcc
  v_pk_fma_f32 v[224:225], v[80:81], v[48:49], v[224:225] op_sel_hi:[0,1,1]
  v_pk_fma_f32 v[226:227], v[80:81], v[50:51], v[226:227] op_sel_hi:[0,1,1]
  v_pk_mul_f32 v[224:225], v[224:225], v[64:65] op_sel:[0,0] op_sel_hi:[1,0]
  v_pk_mul_f32 v[226:227], v[226:227], v[64:65] op_sel:[0,0] op_sel_hi:[1,0]
  v_cvt_pk_bf16_f32 v68, v224, v225
  v_cvt_pk_bf16_f32 v69, v226, v227
  v_pk_fma_f32 v[228:229], v[82:83], v[48:49], v[228:229] op_sel_hi:[0,1,1]
  v_pk_fma_f32 v[230:231], v[82:83], v[50:51], v[230:231] op_sel_hi:[0,1,1]
  v_pk_mul_f32 v[228:229], v[228:229], v[64:65] op_sel:[0,1] op_sel_hi:[1,1]
  v_pk_mul_f32 v[230:231], v[230:231], v[64:65] op_sel:[0,1] op_sel_hi:[1,1]
  v_cvt_pk_bf16_f32 v70, v228, v229
  v_cvt_pk_bf16_f32 v71, v230, v231
  s_nop 1
  v_permlane32_swap_b32 v68, v70
  v_permlane32_swap_b32 v69, v71
  s_nop 0
  buffer_store_dwordx4 v[68:71], v14, s[12:15], s64 offen sc1
  v_pk_fma_f32 v[232:233], v[84:85], v[48:49], v[232:233] op_sel_hi:[0,1,1]
  v_pk_fma_f32 v[234:235], v[84:85], v[50:51], v[234:235] op_sel_hi:[0,1,1]
  v_pk_mul_f32 v[232:233], v[232:233], v[66:67] op_sel:[0,0] op_sel_hi:[1,0]
  v_pk_mul_f32 v[234:235], v[234:235], v[66:67] op_sel:[0,0] op_sel_hi:[1,0]
  v_cvt_pk_bf16_f32 v72, v232, v233
  v_cvt_pk_bf16_f32 v73, v234, v235
  v_pk_fma_f32 v[236:237], v[86:87], v[48:49], v[236:237] op_sel_hi:[0,1,1]
  v_pk_fma_f32 v[238:239], v[86:87], v[50:51], v[238:239] op_sel_hi:[0,1,1]
  v_pk_mul_f32 v[236:237], v[236:237], v[66:67] op_sel:[0,1] op_sel_hi:[1,1]
  v_pk_mul_f32 v[238:239], v[238:239], v[66:67] op_sel:[0,1] op_sel_hi:[1,1]
  v_cvt_pk_bf16_f32 v74, v236, v237
  v_cvt_pk_bf16_f32 v75, v238, v239
  s_nop 1
  v_permlane32_swap_b32 v72, v74
  v_permlane32_swap_b32 v73, v75
  s_nop 0
  buffer_store_dwordx4 v[72:75], v14, s[12:15], s65 offen sc1
  v_pk_fma_f32 v[240:241], v[80:81], v[52:53], v[240:241] op_sel_hi:[0,1,1]
  v_pk_fma_f32 v[242:243], v[80:81], v[54:55], v[242:243] op_sel_hi:[0,1,1]
  v_pk_mul_f32 v[240:241], v[240:241], v[64:65] op_sel:[0,0] op_sel_hi:[1,0]
  v_pk_mul_f32 v[242:243], v[242:243], v[64:65] op_sel:[0,0] op_sel_hi:[1,0]
  v_cvt_pk_bf16_f32 v76, v240, v241
  v_cvt_pk_bf16_f32 v77, v242, v243
  v_pk_fma_f32 v[244:245], v[82:83], v[52:53], v[244:245] op_sel_hi:[0,1,1]
  v_pk_fma_f32 v[246:247], v[82:83], v[54:55], v[246:247] op_sel_hi:[0,1,1]
  v_pk_mul_f32 v[244:245], v[244:245], v[64:65] op_sel:[0,1] op_sel_hi:[1,1]
  v_pk_mul_f32 v[246:247], v[246:247], v[64:65] op_sel:[0,1] op_sel_hi:[1,1]
  v_cvt_pk_bf16_f32 v78, v244, v245
  v_cvt_pk_bf16_f32 v79, v246, v247
  s_nop 1
  v_permlane32_swap_b32 v76, v78
  v_permlane32_swap_b32 v77, v79
  s_nop 0
  buffer_store_dwordx4 v[76:79], v14, s[12:15], s66 offen sc1
  v_pk_fma_f32 v[248:249], v[84:85], v[52:53], v[248:249] op_sel_hi:[0,1,1]
  v_pk_fma_f32 v[250:251], v[84:85], v[54:55], v[250:251] op_sel_hi:[0,1,1]
  v_pk_mul_f32 v[248:249], v[248:249], v[66:67] op_sel:[0,0] op_sel_hi:[1,0]
  v_pk_mul_f32 v[250:251], v[250:251], v[66:67] op_sel:[0,0] op_sel_hi:[1,0]
  v_cvt_pk_bf16_f32 v68, v248, v249
  v_cvt_pk_bf16_f32 v69, v250, v251
  v_pk_fma_f32 v[252:253], v[86:87], v[52:53], v[252:253] op_sel_hi:[0,1,1]
  v_pk_fma_f32 v[254:255], v[86:87], v[54:55], v[254:255] op_sel_hi:[0,1,1]
  v_pk_mul_f32 v[252:253], v[252:253], v[66:67] op_sel:[0,1] op_sel_hi:[1,1]
  v_pk_mul_f32 v[254:255], v[254:255], v[66:67] op_sel:[0,1] op_sel_hi:[1,1]
  v_cvt_pk_bf16_f32 v70, v252, v253
  v_cvt_pk_bf16_f32 v71, v254, v255
  s_nop 1
  v_permlane32_swap_b32 v68, v70
  v_permlane32_swap_b32 v69, v71
  s_nop 0
  buffer_store_dwordx4 v[68:71], v14, s[12:15], s67 offen sc1
  s_branch gemm1_kernel_e61
gemm1_kernel_e59:
  s_sub_u32 s54, s53, 16
  s_lshl_b32 s54, s54, 10
  s_lshl_b32 s55, s29, 9
  s_add_u32 s54, s54, s55
  s_add_u32 s54, s54, 16777216
  s_mul_i32 s55, s50, 294912
  s_add_u32 s64, s54, s55
  s_mul_i32 s55, s51, 294912
  s_add_u32 s65, s54, s55

  v_pk_fma_f32 v[224:225], v[80:81], v[48:49], v[224:225] op_sel_hi:[0,1,1]
  v_pk_fma_f32 v[226:227], v[80:81], v[50:51], v[226:227] op_sel_hi:[0,1,1]
  v_pk_mul_f32 v[88:89], v[224:225], v[60:61] op_sel:[0,0] op_sel_hi:[1,0]
  v_pk_mul_f32 v[90:91], v[226:227], v[60:61] op_sel:[0,0] op_sel_hi:[1,0]
  v_pk_fma_f32 v[228:229], v[82:83], v[48:49], v[228:229] op_sel_hi:[0,1,1]
  v_pk_fma_f32 v[230:231], v[82:83], v[50:51], v[230:231] op_sel_hi:[0,1,1]
  v_pk_mul_f32 v[92:93], v[228:229], v[60:61] op_sel:[0,1] op_sel_hi:[1,1]
  v_pk_mul_f32 v[94:95], v[230:231], v[60:61] op_sel:[0,1] op_sel_hi:[1,1]
  v_exp_f32 v88, v88
  v_exp_f32 v89, v89
  v_exp_f32 v90, v90
  v_exp_f32 v91, v91
  v_exp_f32 v92, v92
  v_exp_f32 v93, v93
  v_exp_f32 v94, v94
  v_exp_f32 v95, v95
  v_pk_fma_f32 v[240:241], v[80:81], v[52:53], v[240:241] op_sel_hi:[0,1,1]
  v_pk_fma_f32 v[242:243], v[80:81], v[54:55], v[242:243] op_sel_hi:[0,1,1]
  v_pk_fma_f32 v[88:89], v[88:89], v[80:81], v[80:81] op_sel:[0,1,1] op_sel_hi:[1,1,1]
  v_pk_fma_f32 v[90:91], v[90:91], v[80:81], v[80:81] op_sel:[0,1,1] op_sel_hi:[1,1,1]
  v_pk_fma_f32 v[244:245], v[82:83], v[52:53], v[244:245] op_sel_hi:[0,1,1]
  v_pk_fma_f32 v[246:247], v[82:83], v[54:55], v[246:247] op_sel_hi:[0,1,1]
  v_pk_fma_f32 v[92:93], v[92:93], v[82:83], v[82:83] op_sel:[0,1,1] op_sel_hi:[1,1,1]
  v_pk_fma_f32 v[94:95], v[94:95], v[82:83], v[82:83] op_sel:[0,1,1] op_sel_hi:[1,1,1]
  v_rcp_f32 v88, v88
  v_rcp_f32 v89, v89
  v_rcp_f32 v90, v90
  v_rcp_f32 v91, v91
  v_rcp_f32 v92, v92
  v_rcp_f32 v93, v93
  v_rcp_f32 v94, v94
  v_rcp_f32 v95, v95
  v_pk_mul_f32 v[224:225], v[224:225], v[240:241]
  v_pk_mul_f32 v[226:227], v[226:227], v[242:243]
  v_pk_mul_f32 v[228:229], v[228:229], v[244:245]
  v_pk_mul_f32 v[230:231], v[230:231], v[246:247]
  v_pk_mul_f32 v[224:225], v[224:225], v[88:89]
  v_pk_mul_f32 v[226:227], v[226:227], v[90:91]
  v_cvt_pk_bf16_f32 v68, v224, v225
  v_cvt_pk_bf16_f32 v69, v226, v227
  v_pk_mul_f32 v[228:229], v[228:229], v[92:93]
  v_pk_mul_f32 v[230:231], v[230:231], v[94:95]
  v_cvt_pk_bf16_f32 v70, v228, v229
  v_cvt_pk_bf16_f32 v71, v230, v231
  s_nop 1
  v_permlane32_swap_b32 v68, v70
  v_permlane32_swap_b32 v69, v71
  s_nop 0
  buffer_store_dwordx4 v[68:71], v13, s[12:15], s64 offen sc1
  v_pk_fma_f32 v[232:233], v[84:85], v[48:49], v[232:233] op_sel_hi:[0,1,1]
  v_pk_fma_f32 v[234:235], v[84:85], v[50:51], v[234:235] op_sel_hi:[0,1,1]
  v_pk_mul_f32 v[88:89], v[232:233], v[62:63] op_sel:[0,0] op_sel_hi:[1,0]
  v_pk_mul_f32 v[90:91], v[234:235], v[62:63] op_sel:[0,0] op_sel_hi:[1,0]
  v_pk_fma_f32 v[236:237], v[86:87], v[48:49], v[236:237] op_sel_hi:[0,1,1]
  v_pk_fma_f32 v[238:239], v[86:87], v[50:51], v[238:239] op_sel_hi:[0,1,1]
  v_pk_mul_f32 v[92:93], v[236:237], v[62:63] op_sel:[0,1] op_sel_hi:[1,1]
  v_pk_mul_f32 v[94:95], v[238:239], v[62:63] op_sel:[0,1] op_sel_hi:[1,1]
  v_exp_f32 v88, v88
  v_exp_f32 v89, v89
  v_exp_f32 v90, v90
  v_exp_f32 v91, v91
  v_exp_f32 v92, v92
  v_exp_f32 v93, v93
  v_exp_f32 v94, v94
  v_exp_f32 v95, v95
  v_pk_fma_f32 v[248:249], v[84:85], v[52:53], v[248:249] op_sel_hi:[0,1,1]
  v_pk_fma_f32 v[250:251], v[84:85], v[54:55], v[250:251] op_sel_hi:[0,1,1]
  v_pk_fma_f32 v[88:89], v[88:89], v[84:85], v[84:85] op_sel:[0,1,1] op_sel_hi:[1,1,1]
  v_pk_fma_f32 v[90:91], v[90:91], v[84:85], v[84:85] op_sel:[0,1,1] op_sel_hi:[1,1,1]
  v_pk_fma_f32 v[252:253], v[86:87], v[52:53], v[252:253] op_sel_hi:[0,1,1]
  v_pk_fma_f32 v[254:255], v[86:87], v[54:55], v[254:255] op_sel_hi:[0,1,1]
  v_pk_fma_f32 v[92:93], v[92:93], v[86:87], v[86:87] op_sel:[0,1,1] op_sel_hi:[1,1,1]
  v_pk_fma_f32 v[94:95], v[94:95], v[86:87], v[86:87] op_sel:[0,1,1] op_sel_hi:[1,1,1]
  v_rcp_f32 v88, v88
  v_rcp_f32 v89, v89
  v_rcp_f32 v90, v90
  v_rcp_f32 v91, v91
  v_rcp_f32 v92, v92
  v_rcp_f32 v93, v93
  v_rcp_f32 v94, v94
  v_rcp_f32 v95, v95
  v_pk_mul_f32 v[232:233], v[232:233], v[248:249]
  v_pk_mul_f32 v[234:235], v[234:235], v[250:251]
  v_pk_mul_f32 v[236:237], v[236:237], v[252:253]
  v_pk_mul_f32 v[238:239], v[238:239], v[254:255]
  v_pk_mul_f32 v[232:233], v[232:233], v[88:89]
  v_pk_mul_f32 v[234:235], v[234:235], v[90:91]
  v_cvt_pk_bf16_f32 v72, v232, v233
  v_cvt_pk_bf16_f32 v73, v234, v235
  v_pk_mul_f32 v[236:237], v[236:237], v[92:93]
  v_pk_mul_f32 v[238:239], v[238:239], v[94:95]
  v_cvt_pk_bf16_f32 v74, v236, v237
  v_cvt_pk_bf16_f32 v75, v238, v239
  s_nop 1
  v_permlane32_swap_b32 v72, v74
  v_permlane32_swap_b32 v73, v75
  s_nop 0
  buffer_store_dwordx4 v[72:75], v13, s[12:15], s65 offen sc1
gemm1_kernel_e61:
gemm1_kernel_end:
  s_endpgm
.globl fused_kernel
.p2align 8
.type fused_kernel,@function
fused_kernel:
  s_cmp_ge_u32 s2, 256
  s_cbranch_scc1 fused_kernel_end
  s_load_dwordx2 s[12:13], s[0:1], 72
  s_load_dwordx2 s[20:21], s[0:1], 48
  s_load_dwordx2 s[60:61], s[0:1], 0
  s_load_dwordx2 s[16:17], s[0:1], 16
  s_load_dwordx2 s[24:25], s[0:1], 56
  v_lshrrev_b32 v1, 6, v0
  v_and_b32 v0, 63, v0
  v_readfirstlane_b32 s28, v1
  s_mov_b32 s14, 268435456
  s_mov_b32 s15, 0x20000
  s_mov_b32 s18, 2097152
  s_mov_b32 s19, 0x20000
  s_mov_b32 s22, 7340032
  s_mov_b32 s23, 0x20000
  s_mov_b32 s26, 4194304
  s_mov_b32 s27, 0x20000
  s_mov_b32 s62, 4194304
  s_mov_b32 s63, 0x20000
  s_cmp_ge_u32 s2, 256
  s_cbranch_scc1 fused_kernel_end
  s_cmp_ge_u32 s28, 8
  s_cbranch_scc1 fused_kernel_gemm
  s_and_b32 s31, s2, 7
  s_lshl_b32 s31, s31, 2
  s_bfe_u32 s47, s2, 0x20003
  s_add_u32 s31, s31, s47
  s_lshr_b32 s32, s2, 5
  s_lshr_b32 s29, s28, 2
  s_and_b32 s30, s28, 3
  s_mov_b32 s35, 0

  s_lshl_b32 s47, s29, 12
  v_lshlrev_b32 v1, 4, v0
  v_add_u32 v1, s47, v1

  s_lshl_b32 s47, s31, 17
  s_lshl_b32 s48, s29, 12
  s_sub_u32 s47, s47, s48
  s_add_u32 s37, s47, 8388608
  s_lshl_b32 s48, s32, 14
  s_lshl_b32 s49, s30, 12
  s_add_u32 s48, s48, s49
  s_add_u32 s36, s47, s48
  s_add_u32 s36, s36, 4194304
  s_lshl_b32 s34, s28, 10
  s_lshl_b32 s48, s29, 16
  s_add_u32 s38, s37, s48
  s_and_b32 s48, s30, 1
  s_lshl_b32 s48, s48, 10
  s_add_u32 s48, s48, s38
  s_add_u32 s49, s48, 4194304
  s_add_u32 s48, s48, 2048
  s_cmp_lt_u32 s30, 2
  s_cselect_b32 s39, s48, s49
  s_waitcnt lgkmcnt(0)

  buffer_load_dwordx4 v[4:7], v1, s[12:15], s36 offen offset:0
  buffer_load_dwordx4 v[8:11], v1, s[12:15], s36 offen offset:1024
  buffer_load_dwordx4 v[12:15], v1, s[12:15], s36 offen offset:2048
  buffer_load_dwordx4 v[16:19], v1, s[12:15], s36 offen offset:3072
  buffer_load_dwordx4 v[108:111], v1, s[12:15], s37 offen offset:0
  buffer_load_dwordx4 v[112:115], v1, s[12:15], s37 offen offset:1024
  v_mov_b32 v3, 73728
  v_mov_b32 v84, 0
  ds_write_b32 v3, v84
fused_kernel_start:
  buffer_load_dwordx4 v[100:103], v1, s[12:15], s38 offen offset:0
  buffer_load_dwordx4 v[104:107], v1, s[12:15], s38 offen offset:1024
  s_mov_b32 s33, s39
  s_add_u32 m0, s34, 24576
  s_nop 0
  buffer_load_dwordx4 v1, s[12:15], s33 offen lds
  s_add_u32 s33, s33, 2048
  s_add_u32 m0, s34, 0
  s_nop 0
  buffer_load_dwordx4 v1, s[12:15], s33 offen lds
  s_add_u32 s33, s33, 2048
  s_add_u32 m0, s34, 8192
  s_nop 0
  buffer_load_dwordx4 v1, s[12:15], s33 offen lds
  s_add_u32 s33, s33, 2048
  s_lshl_b32 s47, s29, 12
  v_bfe_u32 v2, v0, 2, 2
  v_lshrrev_b32 v85, 5, v0
  v_lshl_add_u32 v2, v85, 2, v2
  v_bfe_u32 v85, v0, 4, 1
  v_lshlrev_b32 v86, 2, v85
  v_xor_b32 v2, v2, v86
  v_lshlrev_b32 v2, 5, v2
  v_lshl_add_u32 v2, v85, 10, v2
  v_and_b32 v85, 1, v0
  v_lshl_add_u32 v2, v85, 4, v2
  v_bfe_u32 v85, v0, 1, 1
  v_lshl_add_u32 v2, v85, 3, v2
  s_add_u32 s47, s47, 2048
  v_add_u32 v2, s47, v2
  v_lshrrev_b32 v85, 2, v0
  v_xor_b32 v85, v85, v0
  v_and_b32 v85, 4, v85
  v_and_b32 v86, 3, v0
  v_or_b32 v85, v85, v86
  v_mov_b32 v86, 0x3f803f80
  v_cmp_eq_u32 vcc, 0, v85
  v_cndmask_b32 v120, 0, v86, vcc
  v_cmp_eq_u32 vcc, 1, v85
  v_cndmask_b32 v124, 0, v86, vcc

  v_mov_b32 v121, v120
  v_mov_b32 v125, v124
  v_mov_b32 v122, v120
  v_mov_b32 v126, v124
  v_mov_b32 v123, v120
  v_mov_b32 v127, v124
  v_mov_b32 v20, 0
  v_mov_b32 v21, 0
  v_mov_b32 v22, 0
  v_mov_b32 v23, 0
  v_mov_b32 v24, 0
  v_mov_b32 v25, 0
  v_mov_b32 v26, 0
  v_mov_b32 v27, 0
  v_mov_b32 v28, 0
  v_mov_b32 v29, 0
  v_mov_b32 v30, 0
  v_mov_b32 v31, 0
  v_mov_b32 v32, 0
  v_mov_b32 v33, 0
  v_mov_b32 v34, 0
  v_mov_b32 v35, 0
  v_mov_b32 v36, 0
  v_mov_b32 v37, 0
  v_mov_b32 v38, 0
  v_mov_b32 v39, 0
  v_mov_b32 v40, 0
  v_mov_b32 v41, 0
  v_mov_b32 v42, 0
  v_mov_b32 v43, 0
  v_mov_b32 v44, 0
  v_mov_b32 v45, 0
  v_mov_b32 v46, 0
  v_mov_b32 v47, 0
  v_mov_b32 v48, 0
  v_mov_b32 v49, 0
  v_mov_b32 v50, 0
  v_mov_b32 v51, 0
  v_mov_b32 v116, 0
  v_mov_b32 v117, 0
  v_mov_b32 v118, 0
  v_mov_b32 v119, 0
  s_cmp_lg_u32 s35, 0
  s_cbranch_scc1 fused_kernel_havem
  s_waitcnt vmcnt(5)
  v_mfma_f32_32x32x16_bf16 v[52:67], v[108:111], v[4:7], 0
  v_mfma_f32_32x32x16_bf16 v[52:67], v[112:115], v[8:11], v[52:67]
  v_mfma_f32_32x32x16_bf16 v[68:83], v[108:111], v[12:15], 0
  v_mfma_f32_32x32x16_bf16 v[68:83], v[112:115], v[16:19], v[68:83]
  s_nop 7
  s_nop 5
  v_max3_f32 v84, v52, v53, v54
  v_max3_f32 v84, v84, v55, v56
  v_max3_f32 v84, v84, v57, v58
  v_max3_f32 v84, v84, v59, v60
  v_max3_f32 v84, v84, v61, v62
  v_max3_f32 v84, v84, v63, v64
  v_max3_f32 v84, v84, v65, v66
  v_max3_f32 v84, v84, v67, v68
  v_max3_f32 v84, v84, v69, v70
  v_max3_f32 v84, v84, v71, v72
  v_max3_f32 v84, v84, v73, v74
  v_max3_f32 v84, v84, v75, v76
  v_max3_f32 v84, v84, v77, v78
  v_max3_f32 v84, v84, v79, v80
  v_max3_f32 v84, v84, v81, v82
  v_max_f32 v84, v84, v83
fused_kernel_havem:
  v_mov_b32 v85, v84
  s_nop 1
  v_permlane32_swap_b32 v85, v84
  s_nop 0
  v_max_f32 v84, v84, v85
  v_mul_f32 v84, -1.0, v84

  v_mov_b32 v85, v84
  v_mov_b32 v86, v84
  v_mov_b32 v87, v84
  v_mov_b32 v88, v84
  v_mov_b32 v89, v84
  v_mov_b32 v90, v84
  v_mov_b32 v91, v84
  v_mov_b32 v92, v84
  v_mov_b32 v93, v84
  v_mov_b32 v94, v84
  v_mov_b32 v95, v84
  v_mov_b32 v96, v84
  v_mov_b32 v97, v84
  v_mov_b32 v98, v84
  v_mov_b32 v99, v84
  s_waitcnt vmcnt(3)
  s_nop 0
  v_mfma_f32_32x32x16_bf16 v[52:67], v[100:103], v[4:7], v[84:99]
  v_mfma_f32_32x32x16_bf16 v[52:67], v[104:107], v[8:11], v[52:67]
  v_mfma_f32_32x32x16_bf16 v[68:83], v[100:103], v[12:15], v[84:99]
  v_mfma_f32_32x32x16_bf16 v[68:83], v[104:107], v[16:19], v[68:83]
  s_nop 7
  s_nop 1
  s_waitcnt vmcnt(2) lgkmcnt(0)
  s_barrier
  ds_read_b64_tr_b16 v[108:109], v2 offset:24576
  ds_read_b64_tr_b16 v[110:111], v2 offset:24832
  ds_read_b64_tr_b16 v[112:113], v2 offset:25088
  ds_read_b64_tr_b16 v[114:115], v2 offset:25344
  v_exp_f32 v52, v52
  v_exp_f32 v53, v53
  v_exp_f32 v54, v54
  v_exp_f32 v55, v55
  v_exp_f32 v56, v56
  ds_read_b128 v[100:103], v1 offset:24576
  v_exp_f32 v57, v57
  ds_read_b128 v[104:107], v1 offset:25600
  v_exp_f32 v58, v58
  s_add_u32 m0, s34, 16384
  s_nop 0
  buffer_load_dwordx4 v1, s[12:15], s33 offen lds
  s_add_u32 s33, s33, 2048
  v_exp_f32 v59, v59
  v_exp_f32 v60, v60
  v_exp_f32 v61, v61
  v_exp_f32 v62, v62
  v_exp_f32 v63, v63
  v_exp_f32 v64, v64
  v_exp_f32 v65, v65
  v_exp_f32 v66, v66
  v_exp_f32 v67, v67
  v_cvt_pk_bf16_f32 v52, v52, v53
  v_cvt_pk_bf16_f32 v53, v54, v55
  v_cvt_pk_bf16_f32 v54, v56, v57
  v_cvt_pk_bf16_f32 v55, v58, v59
  v_cvt_pk_bf16_f32 v56, v60, v61
  v_cvt_pk_bf16_f32 v57, v62, v63
  v_cvt_pk_bf16_f32 v58, v64, v65
  v_cvt_pk_bf16_f32 v59, v66, v67
  s_mov_b32 s40, 7
fused_kernel_loop:
  s_waitcnt lgkmcnt(2)
  v_mfma_f32_32x32x16_bf16 v[20:35], v[108:111], v[52:55], v[20:35]
  v_exp_f32 v68, v68
  v_exp_f32 v69, v69
  v_exp_f32 v70, v70
  v_mfma_f32_32x32x16_bf16 v[20:35], v[112:115], v[56:59], v[20:35]
  v_exp_f32 v71, v71
  v_exp_f32 v72, v72
  v_exp_f32 v73, v73
  v_mfma_f32_16x16x32_bf16 v[116:119], v[120:123], v[52:55], v[116:119]
  v_exp_f32 v74, v74
  v_mfma_f32_16x16x32_bf16 v[116:119], v[120:123], v[56:59], v[116:119]
  v_exp_f32 v75, v75
  s_waitcnt lgkmcnt(0)
  v_mfma_f32_32x32x16_bf16 v[52:67], v[100:103], v[4:7], v[84:99]
  v_exp_f32 v76, v76
  v_exp_f32 v77, v77
  v_exp_f32 v78, v78
  v_mfma_f32_32x32x16_bf16 v[52:67], v[104:107], v[8:11], v[52:67]
  v_exp_f32 v79, v79
  v_exp_f32 v80, v80
  v_exp_f32 v81, v81
  v_exp_f32 v82, v82
  v_exp_f32 v83, v83
  v_cvt_pk_bf16_f32 v68, v68, v69
  v_cvt_pk_bf16_f32 v69, v70, v71
  v_cvt_pk_bf16_f32 v70, v72, v73
  v_cvt_pk_bf16_f32 v71, v74, v75
  v_cvt_pk_bf16_f32 v72, v76, v77
  v_cvt_pk_bf16_f32 v73, v78, v79
  v_cvt_pk_bf16_f32 v74, v80, v81
  v_cvt_pk_bf16_f32 v75, v82, v83
  v_mfma_f32_32x32x16_bf16 v[36:51], v[108:111], v[68:71], v[36:51]
  v_exp_f32 v52, v52
  v_exp_f32 v53, v53
  v_exp_f32 v54, v54
  v_mfma_f32_32x32x16_bf16 v[36:51], v[112:115], v[72:75], v[36:51]
  v_exp_f32 v55, v55
  v_exp_f32 v56, v56
  v_exp_f32 v57, v57
  v_mfma_f32_16x16x32_bf16 v[116:119], v[124:127], v[68:71], v[116:119]
  v_exp_f32 v58, v58
  v_mfma_f32_16x16x32_bf16 v[116:119], v[124:127], v[72:75], v[116:119]
  v_exp_f32 v59, v59
  v_mfma_f32_32x32x16_bf16 v[68:83], v[100:103], v[12:15], v[84:99]
  s_waitcnt vmcnt(2)
  s_barrier
  ds_read_b64_tr_b16 v[108:109], v2 offset:0
  ds_read_b64_tr_b16 v[110:111], v2 offset:256
  ds_read_b64_tr_b16 v[112:113], v2 offset:512
  ds_read_b64_tr_b16 v[114:115], v2 offset:768
  v_exp_f32 v60, v60
  v_exp_f32 v61, v61
  v_exp_f32 v62, v62
  v_mfma_f32_32x32x16_bf16 v[68:83], v[104:107], v[16:19], v[68:83]
  v_exp_f32 v63, v63
  v_exp_f32 v64, v64
  ds_read_b128 v[100:103], v1 offset:0
  v_exp_f32 v65, v65
  ds_read_b128 v[104:107], v1 offset:1024
  v_exp_f32 v66, v66
  s_add_u32 m0, s34, 24576
  s_nop 0
  buffer_load_dwordx4 v1, s[12:15], s33 offen lds
  s_add_u32 s33, s33, 2048
  v_exp_f32 v67, v67
  v_cvt_pk_bf16_f32 v52, v52, v53
  v_cvt_pk_bf16_f32 v53, v54, v55
  v_cvt_pk_bf16_f32 v54, v56, v57
  v_cvt_pk_bf16_f32 v55, v58, v59
  v_cvt_pk_bf16_f32 v56, v60, v61
  v_cvt_pk_bf16_f32 v57, v62, v63
  v_cvt_pk_bf16_f32 v58, v64, v65
  v_cvt_pk_bf16_f32 v59, v66, v67
  s_waitcnt lgkmcnt(2)
  v_mfma_f32_32x32x16_bf16 v[20:35], v[108:111], v[52:55], v[20:35]
  v_exp_f32 v68, v68
  v_exp_f32 v69, v69
  v_exp_f32 v70, v70
  v_mfma_f32_32x32x16_bf16 v[20:35], v[112:115], v[56:59], v[20:35]
  v_exp_f32 v71, v71
  v_exp_f32 v72, v72
  v_exp_f32 v73, v73
  v_mfma_f32_16x16x32_bf16 v[116:119], v[120:123], v[52:55], v[116:119]
  v_exp_f32 v74, v74
  v_mfma_f32_16x16x32_bf16 v[116:119], v[120:123], v[56:59], v[116:119]
  v_exp_f32 v75, v75
  s_waitcnt lgkmcnt(0)
  v_mfma_f32_32x32x16_bf16 v[52:67], v[100:103], v[4:7], v[84:99]
  v_exp_f32 v76, v76
  v_exp_f32 v77, v77
  v_exp_f32 v78, v78
  v_mfma_f32_32x32x16_bf16 v[52:67], v[104:107], v[8:11], v[52:67]
  v_exp_f32 v79, v79
  v_exp_f32 v80, v80
  v_exp_f32 v81, v81
  v_exp_f32 v82, v82
  v_exp_f32 v83, v83
  v_cvt_pk_bf16_f32 v68, v68, v69
  v_cvt_pk_bf16_f32 v69, v70, v71
  v_cvt_pk_bf16_f32 v70, v72, v73
  v_cvt_pk_bf16_f32 v71, v74, v75
  v_cvt_pk_bf16_f32 v72, v76, v77
  v_cvt_pk_bf16_f32 v73, v78, v79
  v_cvt_pk_bf16_f32 v74, v80, v81
  v_cvt_pk_bf16_f32 v75, v82, v83
  v_mfma_f32_32x32x16_bf16 v[36:51], v[108:111], v[68:71], v[36:51]
  v_exp_f32 v52, v52
  v_exp_f32 v53, v53
  v_exp_f32 v54, v54
  v_mfma_f32_32x32x16_bf16 v[36:51], v[112:115], v[72:75], v[36:51]
  v_exp_f32 v55, v55
  v_exp_f32 v56, v56
  v_exp_f32 v57, v57
  v_mfma_f32_16x16x32_bf16 v[116:119], v[124:127], v[68:71], v[116:119]
  v_exp_f32 v58, v58
  v_mfma_f32_16x16x32_bf16 v[116:119], v[124:127], v[72:75], v[116:119]
  v_exp_f32 v59, v59
  v_mfma_f32_32x32x16_bf16 v[68:83], v[100:103], v[12:15], v[84:99]
  s_waitcnt vmcnt(2)
  s_barrier
  ds_read_b64_tr_b16 v[108:109], v2 offset:8192
  ds_read_b64_tr_b16 v[110:111], v2 offset:8448
  ds_read_b64_tr_b16 v[112:113], v2 offset:8704
  ds_read_b64_tr_b16 v[114:115], v2 offset:8960
  v_exp_f32 v60, v60
  v_exp_f32 v61, v61
  v_exp_f32 v62, v62
  v_mfma_f32_32x32x16_bf16 v[68:83], v[104:107], v[16:19], v[68:83]
  v_exp_f32 v63, v63
  v_exp_f32 v64, v64
  ds_read_b128 v[100:103], v1 offset:8192
  v_exp_f32 v65, v65
  ds_read_b128 v[104:107], v1 offset:9216
  v_exp_f32 v66, v66
  s_add_u32 m0, s34, 0
  s_nop 0
  buffer_load_dwordx4 v1, s[12:15], s33 offen lds
  s_add_u32 s33, s33, 2048
  v_exp_f32 v67, v67
  v_cvt_pk_bf16_f32 v52, v52, v53
  v_cvt_pk_bf16_f32 v53, v54, v55
  v_cvt_pk_bf16_f32 v54, v56, v57
  v_cvt_pk_bf16_f32 v55, v58, v59
  v_cvt_pk_bf16_f32 v56, v60, v61
  v_cvt_pk_bf16_f32 v57, v62, v63
  v_cvt_pk_bf16_f32 v58, v64, v65
  v_cvt_pk_bf16_f32 v59, v66, v67
  s_waitcnt lgkmcnt(2)
  v_mfma_f32_32x32x16_bf16 v[20:35], v[108:111], v[52:55], v[20:35]
  v_exp_f32 v68, v68
  v_exp_f32 v69, v69
  v_exp_f32 v70, v70
  v_mfma_f32_32x32x16_bf16 v[20:35], v[112:115], v[56:59], v[20:35]
  v_exp_f32 v71, v71
  v_exp_f32 v72, v72
  v_exp_f32 v73, v73
  v_mfma_f32_16x16x32_bf16 v[116:119], v[120:123], v[52:55], v[116:119]
  v_exp_f32 v74, v74
  v_mfma_f32_16x16x32_bf16 v[116:119], v[120:123], v[56:59], v[116:119]
  v_exp_f32 v75, v75
  s_waitcnt lgkmcnt(0)
  v_mfma_f32_32x32x16_bf16 v[52:67], v[100:103], v[4:7], v[84:99]
  v_exp_f32 v76, v76
  v_exp_f32 v77, v77
  v_exp_f32 v78, v78
  v_mfma_f32_32x32x16_bf16 v[52:67], v[104:107], v[8:11], v[52:67]
  v_exp_f32 v79, v79
  v_exp_f32 v80, v80
  v_exp_f32 v81, v81
  v_exp_f32 v82, v82
  v_exp_f32 v83, v83
  v_cvt_pk_bf16_f32 v68, v68, v69
  v_cvt_pk_bf16_f32 v69, v70, v71
  v_cvt_pk_bf16_f32 v70, v72, v73
  v_cvt_pk_bf16_f32 v71, v74, v75
  v_cvt_pk_bf16_f32 v72, v76, v77
  v_cvt_pk_bf16_f32 v73, v78, v79
  v_cvt_pk_bf16_f32 v74, v80, v81
  v_cvt_pk_bf16_f32 v75, v82, v83
  v_mfma_f32_32x32x16_bf16 v[36:51], v[108:111], v[68:71], v[36:51]
  v_exp_f32 v52, v52
  v_exp_f32 v53, v53
  v_exp_f32 v54, v54
  v_mfma_f32_32x32x16_bf16 v[36:51], v[112:115], v[72:75], v[36:51]
  v_exp_f32 v55, v55
  v_exp_f32 v56, v56
  v_exp_f32 v57, v57
  v_mfma_f32_16x16x32_bf16 v[116:119], v[124:127], v[68:71], v[116:119]
  v_exp_f32 v58, v58
  v_mfma_f32_16x16x32_bf16 v[116:119], v[124:127], v[72:75], v[116:119]
  v_exp_f32 v59, v59
  v_mfma_f32_32x32x16_bf16 v[68:83], v[100:103], v[12:15], v[84:99]
  s_waitcnt vmcnt(2)
  s_barrier
  ds_read_b64_tr_b16 v[108:109], v2 offset:16384
  ds_read_b64_tr_b16 v[110:111], v2 offset:16640
  ds_read_b64_tr_b16 v[112:113], v2 offset:16896
  ds_read_b64_tr_b16 v[114:115], v2 offset:17152
  v_exp_f32 v60, v60
  v_exp_f32 v61, v61
  v_exp_f32 v62, v62
  v_mfma_f32_32x32x16_bf16 v[68:83], v[104:107], v[16:19], v[68:83]
  v_exp_f32 v63, v63
  v_exp_f32 v64, v64
  ds_read_b128 v[100:103], v1 offset:16384
  v_exp_f32 v65, v65
  ds_read_b128 v[104:107], v1 offset:17408
  v_exp_f32 v66, v66
  s_add_u32 m0, s34, 8192
  s_nop 0
  buffer_load_dwordx4 v1, s[12:15], s33 offen lds
  s_add_u32 s33, s33, 2048
  v_exp_f32 v67, v67
  v_cvt_pk_bf16_f32 v52, v52, v53
  v_cvt_pk_bf16_f32 v53, v54, v55
  v_cvt_pk_bf16_f32 v54, v56, v57
  v_cvt_pk_bf16_f32 v55, v58, v59
  v_cvt_pk_bf16_f32 v56, v60, v61
  v_cvt_pk_bf16_f32 v57, v62, v63
  v_cvt_pk_bf16_f32 v58, v64, v65
  v_cvt_pk_bf16_f32 v59, v66, v67
  s_waitcnt lgkmcnt(2)
  v_mfma_f32_32x32x16_bf16 v[20:35], v[108:111], v[52:55], v[20:35]
  v_exp_f32 v68, v68
  v_exp_f32 v69, v69
  v_exp_f32 v70, v70
  v_mfma_f32_32x32x16_bf16 v[20:35], v[112:115], v[56:59], v[20:35]
  v_exp_f32 v71, v71
  v_exp_f32 v72, v72
  v_exp_f32 v73, v73
  v_mfma_f32_16x16x32_bf16 v[116:119], v[120:123], v[52:55], v[116:119]
  v_exp_f32 v74, v74
  v_mfma_f32_16x16x32_bf16 v[116:119], v[120:123], v[56:59], v[116:119]
  v_exp_f32 v75, v75
  s_waitcnt lgkmcnt(0)
  v_mfma_f32_32x32x16_bf16 v[52:67], v[100:103], v[4:7], v[84:99]
  v_exp_f32 v76, v76
  v_exp_f32 v77, v77
  v_exp_f32 v78, v78
  v_mfma_f32_32x32x16_bf16 v[52:67], v[104:107], v[8:11], v[52:67]
  v_exp_f32 v79, v79
  v_exp_f32 v80, v80
  v_exp_f32 v81, v81
  v_exp_f32 v82, v82
  v_exp_f32 v83, v83
  v_cvt_pk_bf16_f32 v68, v68, v69
  v_cvt_pk_bf16_f32 v69, v70, v71
  v_cvt_pk_bf16_f32 v70, v72, v73
  v_cvt_pk_bf16_f32 v71, v74, v75
  v_cvt_pk_bf16_f32 v72, v76, v77
  v_cvt_pk_bf16_f32 v73, v78, v79
  v_cvt_pk_bf16_f32 v74, v80, v81
  v_cvt_pk_bf16_f32 v75, v82, v83
  v_mfma_f32_32x32x16_bf16 v[36:51], v[108:111], v[68:71], v[36:51]
  v_exp_f32 v52, v52
  v_exp_f32 v53, v53
  v_exp_f32 v54, v54
  v_mfma_f32_32x32x16_bf16 v[36:51], v[112:115], v[72:75], v[36:51]
  v_exp_f32 v55, v55
  v_exp_f32 v56, v56
  v_exp_f32 v57, v57
  v_mfma_f32_16x16x32_bf16 v[116:119], v[124:127], v[68:71], v[116:119]
  v_exp_f32 v58, v58
  v_mfma_f32_16x16x32_bf16 v[116:119], v[124:127], v[72:75], v[116:119]
  v_exp_f32 v59, v59
  v_mfma_f32_32x32x16_bf16 v[68:83], v[100:103], v[12:15], v[84:99]
  s_waitcnt vmcnt(2)
  s_barrier
  ds_read_b64_tr_b16 v[108:109], v2 offset:24576
  ds_read_b64_tr_b16 v[110:111], v2 offset:24832
  ds_read_b64_tr_b16 v[112:113], v2 offset:25088
  ds_read_b64_tr_b16 v[114:115], v2 offset:25344
  v_exp_f32 v60, v60
  v_exp_f32 v61, v61
  v_exp_f32 v62, v62
  v_mfma_f32_32x32x16_bf16 v[68:83], v[104:107], v[16:19], v[68:83]
  v_exp_f32 v63, v63
  v_exp_f32 v64, v64
  ds_read_b128 v[100:103], v1 offset:24576
  v_exp_f32 v65, v65
  ds_read_b128 v[104:107], v1 offset:25600
  v_exp_f32 v66, v66
  s_add_u32 m0, s34, 16384
  s_nop 0
  buffer_load_dwordx4 v1, s[12:15], s33 offen lds
  s_add_u32 s33, s33, 2048
  v_exp_f32 v67, v67
  v_cvt_pk_bf16_f32 v52, v52, v53
  v_cvt_pk_bf16_f32 v53, v54, v55
  v_cvt_pk_bf16_f32 v54, v56, v57
  v_cvt_pk_bf16_f32 v55, v58, v59
  v_cvt_pk_bf16_f32 v56, v60, v61
  v_cvt_pk_bf16_f32 v57, v62, v63
  v_cvt_pk_bf16_f32 v58, v64, v65
  v_cvt_pk_bf16_f32 v59, v66, v67
  s_sub_u32 s40, s40, 1
  s_cmp_lg_u32 s40, 0
  s_cbranch_scc1 fused_kernel_loop
  s_waitcnt lgkmcnt(2)
  v_mfma_f32_32x32x16_bf16 v[20:35], v[108:111], v[52:55], v[20:35]
  v_exp_f32 v68, v68
  v_exp_f32 v69, v69
  v_exp_f32 v70, v70
  v_mfma_f32_32x32x16_bf16 v[20:35], v[112:115], v[56:59], v[20:35]
  v_exp_f32 v71, v71
  v_exp_f32 v72, v72
  v_exp_f32 v73, v73
  v_mfma_f32_16x16x32_bf16 v[116:119], v[120:123], v[52:55], v[116:119]
  v_exp_f32 v74, v74
  v_mfma_f32_16x16x32_bf16 v[116:119], v[120:123], v[56:59], v[116:119]
  v_exp_f32 v75, v75
  s_waitcnt lgkmcnt(0)
  v_mfma_f32_32x32x16_bf16 v[52:67], v[100:103], v[4:7], v[84:99]
  v_exp_f32 v76, v76
  v_exp_f32 v77, v77
  v_exp_f32 v78, v78
  v_mfma_f32_32x32x16_bf16 v[52:67], v[104:107], v[8:11], v[52:67]
  v_exp_f32 v79, v79
  v_exp_f32 v80, v80
  v_exp_f32 v81, v81
  v_exp_f32 v82, v82
  v_exp_f32 v83, v83
  v_cvt_pk_bf16_f32 v68, v68, v69
  v_cvt_pk_bf16_f32 v69, v70, v71
  v_cvt_pk_bf16_f32 v70, v72, v73
  v_cvt_pk_bf16_f32 v71, v74, v75
  v_cvt_pk_bf16_f32 v72, v76, v77
  v_cvt_pk_bf16_f32 v73, v78, v79
  v_cvt_pk_bf16_f32 v74, v80, v81
  v_cvt_pk_bf16_f32 v75, v82, v83
  v_mfma_f32_32x32x16_bf16 v[36:51], v[108:111], v[68:71], v[36:51]
  v_exp_f32 v52, v52
  v_exp_f32 v53, v53
  v_exp_f32 v54, v54
  v_mfma_f32_32x32x16_bf16 v[36:51], v[112:115], v[72:75], v[36:51]
  v_exp_f32 v55, v55
  v_exp_f32 v56, v56
  v_exp_f32 v57, v57
  v_mfma_f32_16x16x32_bf16 v[116:119], v[124:127], v[68:71], v[116:119]
  v_exp_f32 v58, v58
  v_mfma_f32_16x16x32_bf16 v[116:119], v[124:127], v[72:75], v[116:119]
  v_exp_f32 v59, v59
  v_mfma_f32_32x32x16_bf16 v[68:83], v[100:103], v[12:15], v[84:99]
  s_waitcnt vmcnt(2)
  s_barrier
  ds_read_b64_tr_b16 v[108:109], v2 offset:0
  ds_read_b64_tr_b16 v[110:111], v2 offset:256
  ds_read_b64_tr_b16 v[112:113], v2 offset:512
  ds_read_b64_tr_b16 v[114:115], v2 offset:768
  v_exp_f32 v60, v60
  v_exp_f32 v61, v61
  v_exp_f32 v62, v62
  v_mfma_f32_32x32x16_bf16 v[68:83], v[104:107], v[16:19], v[68:83]
  v_exp_f32 v63, v63
  v_exp_f32 v64, v64
  ds_read_b128 v[100:103], v1 offset:0
  v_exp_f32 v65, v65
  ds_read_b128 v[104:107], v1 offset:1024
  v_exp_f32 v66, v66
  v_exp_f32 v67, v67
  v_cvt_pk_bf16_f32 v52, v52, v53
  v_cvt_pk_bf16_f32 v53, v54, v55
  v_cvt_pk_bf16_f32 v54, v56, v57
  v_cvt_pk_bf16_f32 v55, v58, v59
  v_cvt_pk_bf16_f32 v56, v60, v61
  v_cvt_pk_bf16_f32 v57, v62, v63
  v_cvt_pk_bf16_f32 v58, v64, v65
  v_cvt_pk_bf16_f32 v59, v66, v67
  s_waitcnt lgkmcnt(2)
  v_mfma_f32_32x32x16_bf16 v[20:35], v[108:111], v[52:55], v[20:35]
  v_exp_f32 v68, v68
  v_exp_f32 v69, v69
  v_exp_f32 v70, v70
  v_mfma_f32_32x32x16_bf16 v[20:35], v[112:115], v[56:59], v[20:35]
  v_exp_f32 v71, v71
  v_exp_f32 v72, v72
  v_exp_f32 v73, v73
  v_mfma_f32_16x16x32_bf16 v[116:119], v[120:123], v[52:55], v[116:119]
  v_exp_f32 v74, v74
  v_mfma_f32_16x16x32_bf16 v[116:119], v[120:123], v[56:59], v[116:119]
  v_exp_f32 v75, v75
  s_waitcnt lgkmcnt(0)
  v_mfma_f32_32x32x16_bf16 v[52:67], v[100:103], v[4:7], v[84:99]
  v_exp_f32 v76, v76
  v_exp_f32 v77, v77
  v_exp_f32 v78, v78
  v_mfma_f32_32x32x16_bf16 v[52:67], v[104:107], v[8:11], v[52:67]
  v_exp_f32 v79, v79
  v_exp_f32 v80, v80
  v_exp_f32 v81, v81
  v_exp_f32 v82, v82
  v_exp_f32 v83, v83
  v_cvt_pk_bf16_f32 v68, v68, v69
  v_cvt_pk_bf16_f32 v69, v70, v71
  v_cvt_pk_bf16_f32 v70, v72, v73
  v_cvt_pk_bf16_f32 v71, v74, v75
  v_cvt_pk_bf16_f32 v72, v76, v77
  v_cvt_pk_bf16_f32 v73, v78, v79
  v_cvt_pk_bf16_f32 v74, v80, v81
  v_cvt_pk_bf16_f32 v75, v82, v83
  v_mfma_f32_32x32x16_bf16 v[36:51], v[108:111], v[68:71], v[36:51]
  v_exp_f32 v52, v52
  v_exp_f32 v53, v53
  v_exp_f32 v54, v54
  v_mfma_f32_32x32x16_bf16 v[36:51], v[112:115], v[72:75], v[36:51]
  v_exp_f32 v55, v55
  v_exp_f32 v56, v56
  v_exp_f32 v57, v57
  v_mfma_f32_16x16x32_bf16 v[116:119], v[124:127], v[68:71], v[116:119]
  v_exp_f32 v58, v58
  v_mfma_f32_16x16x32_bf16 v[116:119], v[124:127], v[72:75], v[116:119]
  v_exp_f32 v59, v59
  v_mfma_f32_32x32x16_bf16 v[68:83], v[100:103], v[12:15], v[84:99]
  s_waitcnt vmcnt(1)
  s_barrier
  ds_read_b64_tr_b16 v[108:109], v2 offset:8192
  ds_read_b64_tr_b16 v[110:111], v2 offset:8448
  ds_read_b64_tr_b16 v[112:113], v2 offset:8704
  ds_read_b64_tr_b16 v[114:115], v2 offset:8960
  v_exp_f32 v60, v60
  v_exp_f32 v61, v61
  v_exp_f32 v62, v62
  v_mfma_f32_32x32x16_bf16 v[68:83], v[104:107], v[16:19], v[68:83]
  v_exp_f32 v63, v63
  v_exp_f32 v64, v64
  ds_read_b128 v[100:103], v1 offset:8192
  v_exp_f32 v65, v65
  ds_read_b128 v[104:107], v1 offset:9216
  v_exp_f32 v66, v66
  v_exp_f32 v67, v67
  v_cvt_pk_bf16_f32 v52, v52, v53
  v_cvt_pk_bf16_f32 v53, v54, v55
  v_cvt_pk_bf16_f32 v54, v56, v57
  v_cvt_pk_bf16_f32 v55, v58, v59
  v_cvt_pk_bf16_f32 v56, v60, v61
  v_cvt_pk_bf16_f32 v57, v62, v63
  v_cvt_pk_bf16_f32 v58, v64, v65
  v_cvt_pk_bf16_f32 v59, v66, v67
  s_waitcnt lgkmcnt(2)
  v_mfma_f32_32x32x16_bf16 v[20:35], v[108:111], v[52:55], v[20:35]
  v_exp_f32 v68, v68
  v_exp_f32 v69, v69
  v_exp_f32 v70, v70
  v_mfma_f32_32x32x16_bf16 v[20:35], v[112:115], v[56:59], v[20:35]
  v_exp_f32 v71, v71
  v_exp_f32 v72, v72
  v_exp_f32 v73, v73
  v_mfma_f32_16x16x32_bf16 v[116:119], v[120:123], v[52:55], v[116:119]
  v_exp_f32 v74, v74
  v_mfma_f32_16x16x32_bf16 v[116:119], v[120:123], v[56:59], v[116:119]
  v_exp_f32 v75, v75
  s_waitcnt lgkmcnt(0)
  v_mfma_f32_32x32x16_bf16 v[52:67], v[100:103], v[4:7], v[84:99]
  v_exp_f32 v76, v76
  v_exp_f32 v77, v77
  v_exp_f32 v78, v78
  v_mfma_f32_32x32x16_bf16 v[52:67], v[104:107], v[8:11], v[52:67]
  v_exp_f32 v79, v79
  v_exp_f32 v80, v80
  v_exp_f32 v81, v81
  v_exp_f32 v82, v82
  v_exp_f32 v83, v83
  v_cvt_pk_bf16_f32 v68, v68, v69
  v_cvt_pk_bf16_f32 v69, v70, v71
  v_cvt_pk_bf16_f32 v70, v72, v73
  v_cvt_pk_bf16_f32 v71, v74, v75
  v_cvt_pk_bf16_f32 v72, v76, v77
  v_cvt_pk_bf16_f32 v73, v78, v79
  v_cvt_pk_bf16_f32 v74, v80, v81
  v_cvt_pk_bf16_f32 v75, v82, v83
  v_mfma_f32_32x32x16_bf16 v[36:51], v[108:111], v[68:71], v[36:51]
  v_exp_f32 v52, v52
  v_exp_f32 v53, v53
  v_exp_f32 v54, v54
  v_mfma_f32_32x32x16_bf16 v[36:51], v[112:115], v[72:75], v[36:51]
  v_exp_f32 v55, v55
  v_exp_f32 v56, v56
  v_exp_f32 v57, v57
  v_mfma_f32_16x16x32_bf16 v[116:119], v[124:127], v[68:71], v[116:119]
  v_exp_f32 v58, v58
  v_mfma_f32_16x16x32_bf16 v[116:119], v[124:127], v[72:75], v[116:119]
  v_exp_f32 v59, v59
  v_mfma_f32_32x32x16_bf16 v[68:83], v[100:103], v[12:15], v[84:99]
  s_waitcnt vmcnt(0)
  s_barrier
  ds_read_b64_tr_b16 v[108:109], v2 offset:16384
  ds_read_b64_tr_b16 v[110:111], v2 offset:16640
  ds_read_b64_tr_b16 v[112:113], v2 offset:16896
  ds_read_b64_tr_b16 v[114:115], v2 offset:17152
  v_exp_f32 v60, v60
  v_exp_f32 v61, v61
  v_exp_f32 v62, v62
  v_mfma_f32_32x32x16_bf16 v[68:83], v[104:107], v[16:19], v[68:83]
  v_exp_f32 v63, v63
  v_exp_f32 v64, v64
  ds_read_b128 v[100:103], v1 offset:16384
  v_exp_f32 v65, v65
  ds_read_b128 v[104:107], v1 offset:17408
  v_exp_f32 v66, v66
  v_exp_f32 v67, v67
  v_cvt_pk_bf16_f32 v52, v52, v53
  v_cvt_pk_bf16_f32 v53, v54, v55
  v_cvt_pk_bf16_f32 v54, v56, v57
  v_cvt_pk_bf16_f32 v55, v58, v59
  v_cvt_pk_bf16_f32 v56, v60, v61
  v_cvt_pk_bf16_f32 v57, v62, v63
  v_cvt_pk_bf16_f32 v58, v64, v65
  v_cvt_pk_bf16_f32 v59, v66, v67
  s_waitcnt lgkmcnt(0)
  v_mfma_f32_32x32x16_bf16 v[20:35], v[108:111], v[52:55], v[20:35]
  v_exp_f32 v68, v68
  v_exp_f32 v69, v69
  v_exp_f32 v70, v70
  v_mfma_f32_32x32x16_bf16 v[20:35], v[112:115], v[56:59], v[20:35]
  v_exp_f32 v71, v71
  v_exp_f32 v72, v72
  v_exp_f32 v73, v73
  v_mfma_f32_16x16x32_bf16 v[116:119], v[120:123], v[52:55], v[116:119]
  v_exp_f32 v74, v74
  v_mfma_f32_16x16x32_bf16 v[116:119], v[120:123], v[56:59], v[116:119]
  v_exp_f32 v75, v75
  v_exp_f32 v76, v76
  v_exp_f32 v77, v77
  v_exp_f32 v78, v78
  v_exp_f32 v79, v79
  v_exp_f32 v80, v80
  v_exp_f32 v81, v81
  v_exp_f32 v82, v82
  v_exp_f32 v83, v83
  v_cvt_pk_bf16_f32 v68, v68, v69
  v_cvt_pk_bf16_f32 v69, v70, v71
  v_cvt_pk_bf16_f32 v70, v72, v73
  v_cvt_pk_bf16_f32 v71, v74, v75
  v_cvt_pk_bf16_f32 v72, v76, v77
  v_cvt_pk_bf16_f32 v73, v78, v79
  v_cvt_pk_bf16_f32 v74, v80, v81
  v_cvt_pk_bf16_f32 v75, v82, v83
  s_nop 1
  v_mfma_f32_32x32x16_bf16 v[36:51], v[108:111], v[68:71], v[36:51]
  v_mfma_f32_32x32x16_bf16 v[36:51], v[112:115], v[72:75], v[36:51]
  v_mfma_f32_16x16x32_bf16 v[116:119], v[124:127], v[68:71], v[116:119]
  v_mfma_f32_16x16x32_bf16 v[116:119], v[124:127], v[72:75], v[116:119]
  s_mul_i32 s47, s28, 5120
  s_add_u32 s47, s47, 32768
  s_xor_b32 s48, s28, 4
  s_mul_i32 s48, s48, 5120
  s_add_u32 s48, s48, 32768
  v_lshlrev_b32 v3, 4, v0
  v_add_u32 v100, s47, v3
  v_add_u32 v101, s48, v3
  s_lshl_b32 s47, s32, 4
  s_lshl_b32 s48, s30, 2
  s_add_u32 s47, s47, s48
  s_lshl_b32 s48, s29, 1
  s_add_u32 s47, s47, s48
  s_mul_i32 s47, s47, 147456
  s_lshl_b32 s48, s31, 10
  s_add_u32 s47, s47, s48
  s_add_u32 s47, s47, 16777216
  v_bfe_u32 v3, v0, 4, 1
  v_mul_u32_u24 v102, 147456, v3
  v_lshrrev_b32 v3, 5, v0
  v_lshl_add_u32 v102, v3, 8, v102
  v_and_b32 v3, 15, v0
  v_lshl_add_u32 v102, v3, 4, v102
  s_cmp_eq_u32 s29, 1
  s_cbranch_scc1 fused_kernel_x1

  ds_write_b128 v100, v[36:39] offset:0
  ds_write_b128 v100, v[40:43] offset:1024
  ds_write_b128 v100, v[44:47] offset:2048
  ds_write_b128 v100, v[48:51] offset:3072
  ds_write_b32 v100, v117 offset:4096
  s_waitcnt lgkmcnt(0)
  s_barrier
  ds_read_b32 v68, v101 offset:4096
  ds_read_b128 v[52:55], v101 offset:0
  ds_read_b128 v[56:59], v101 offset:1024
  ds_read_b128 v[60:63], v101 offset:2048
  ds_read_b128 v[64:67], v101 offset:3072
  s_waitcnt lgkmcnt(4)
  v_add_f32 v68, v68, v116
  v_rcp_f32 v69, v68
  s_waitcnt lgkmcnt(0)
  v_add_f32 v52, v52, v20
  v_add_f32 v53, v53, v21
  v_add_f32 v54, v54, v22
  v_add_f32 v55, v55, v23
  v_add_f32 v56, v56, v24
  v_add_f32 v57, v57, v25
  v_add_f32 v58, v58, v26
  v_add_f32 v59, v59, v27
  v_add_f32 v60, v60, v28
  v_add_f32 v61, v61, v29
  v_add_f32 v62, v62, v30
  v_add_f32 v63, v63, v31
  v_add_f32 v64, v64, v32
  v_add_f32 v65, v65, v33
  v_add_f32 v66, v66, v34
  v_add_f32 v67, v67, v35
  s_branch fused_kernel_fin
fused_kernel_x1:
  ds_write_b128 v100, v[20:23] offset:0
  ds_write_b128 v100, v[24:27] offset:1024
  ds_write_b128 v100, v[28:31] offset:2048
  ds_write_b128 v100, v[32:35] offset:3072
  ds_write_b32 v100, v116 offset:4096
  s_waitcnt lgkmcnt(0)
  s_barrier
  ds_read_b32 v68, v101 offset:4096
  ds_read_b128 v[52:55], v101 offset:0
  ds_read_b128 v[56:59], v101 offset:1024
  ds_read_b128 v[60:63], v101 offset:2048
  ds_read_b128 v[64:67], v101 offset:3072
  s_waitcnt lgkmcnt(4)
  v_add_f32 v68, v68, v117
  v_rcp_f32 v69, v68
  s_waitcnt lgkmcnt(0)
  v_add_f32 v52, v52, v36
  v_add_f32 v53, v53, v37
  v_add_f32 v54, v54, v38
  v_add_f32 v55, v55, v39
  v_add_f32 v56, v56, v40
  v_add_f32 v57, v57, v41
  v_add_f32 v58, v58, v42
  v_add_f32 v59, v59, v43
  v_add_f32 v60, v60, v44
  v_add_f32 v61, v61, v45
  v_add_f32 v62, v62, v46
  v_add_f32 v63, v63, v47
  v_add_f32 v64, v64, v48
  v_add_f32 v65, v65, v49
  v_add_f32 v66, v66, v50
  v_add_f32 v67, v67, v51
fused_kernel_fin:
  v_mul_f32 v52, v52, v69
  v_mul_f32 v53, v53, v69
  v_mul_f32 v54, v54, v69
  v_mul_f32 v55, v55, v69
  v_mul_f32 v56, v56, v69
  v_mul_f32 v57, v57, v69
  v_mul_f32 v58, v58, v69
  v_mul_f32 v59, v59, v69
  v_mul_f32 v60, v60, v69
  v_mul_f32 v61, v61, v69
  v_mul_f32 v62, v62, v69
  v_mul_f32 v63, v63, v69
  v_mul_f32 v64, v64, v69
  v_mul_f32 v65, v65, v69
  v_mul_f32 v66, v66, v69
  v_mul_f32 v67, v67, v69
  v_cvt_pk_bf16_f32 v52, v52, v53
  v_cvt_pk_bf16_f32 v53, v54, v55
  v_cvt_pk_bf16_f32 v54, v56, v57
  v_cvt_pk_bf16_f32 v55, v58, v59
  v_cvt_pk_bf16_f32 v56, v60, v61
  v_cvt_pk_bf16_f32 v57, v62, v63
  v_cvt_pk_bf16_f32 v58, v64, v65
  v_cvt_pk_bf16_f32 v59, v66, v67
  s_add_u32 s48, s29, 1
  s_cmp_eq_u32 s35, 0
  s_cselect_b32 s48, 0, s48
  s_cmp_lg_u32 s48, s35
  s_cbranch_scc1 fused_kernel_nost
  buffer_store_dwordx4 v[52:55], v102, s[12:15], s47 offen sc1
  buffer_store_dwordx4 v[56:59], v102, s[12:15], s47 offen offset:512 sc1
  fused_kernel_nost:
  s_cmp_eq_u32 s35, 2
  s_cbranch_scc1 fused_kernel_done2
  s_cmp_eq_u32 s35, 1
  s_cbranch_scc1 fused_kernel_slow
  v_cmp_le_f32 vcc, 0x1f800000, v68
  s_mov_b64 s[48:49], vcc
  v_cmp_ge_f32 vcc, 0x5f800000, v68
  s_and_b64 vcc, vcc, s[48:49]
  v_mov_b32 v3, 73728
  s_cmp_eq_u64 vcc, -1
  s_cbranch_scc1 fused_kernel_okw
  ds_write_b32 v3, v3
  fused_kernel_okw:
  s_waitcnt vmcnt(0) lgkmcnt(0)
  s_barrier
  ds_read_b32 v3, v3
  s_waitcnt lgkmcnt(0)
  v_readfirstlane_b32 s48, v3
  s_cmp_eq_u32 s48, 0
  s_cbranch_scc1 fused_kernel_done

fused_kernel_slow:
  s_lshl_b32 s48, s35, 11
  s_add_u32 s48, s48, s36

  buffer_load_dwordx4 v[4:7], v1, s[12:15], s48 offen offset:0
  buffer_load_dwordx4 v[8:11], v1, s[12:15], s48 offen offset:1024
  buffer_load_dwordx4 v[12:15], v1, s[12:15], s48 offen offset:0
  buffer_load_dwordx4 v[16:19], v1, s[12:15], s48 offen offset:1024
  s_mov_b32 s48, s37
  s_mov_b32 s40, 64
  v_mov_b32 v84, 0xff800000

fused_kernel_mx:
  buffer_load_dwordx4 v[108:111], v1, s[12:15], s48 offen offset:0
  buffer_load_dwordx4 v[112:115], v1, s[12:15], s48 offen offset:1024
  s_waitcnt vmcnt(0)
  v_mfma_f32_32x32x16_bf16 v[52:67], v[108:111], v[4:7], 0
  v_mfma_f32_32x32x16_bf16 v[52:67], v[112:115], v[8:11], v[52:67]
  s_nop 7
  s_nop 5
  v_max3_f32 v84, v84, v52, v53
  v_max3_f32 v84, v84, v54, v55
  v_max3_f32 v84, v84, v56, v57
  v_max3_f32 v84, v84, v58, v59
  v_max3_f32 v84, v84, v60, v61
  v_max3_f32 v84, v84, v62, v63
  v_max3_f32 v84, v84, v64, v65
  v_max3_f32 v84, v84, v66, v67
  s_add_u32 s48, s48, 2048
  s_sub_u32 s40, s40, 1
  s_cmp_lg_u32 s40, 0
  s_cbranch_scc1 fused_kernel_mx
  s_add_u32 s35, s35, 1
  s_barrier
  s_branch fused_kernel_start

fused_kernel_done2:
  s_waitcnt vmcnt(0)
  s_barrier
fused_kernel_done:
  s_cmp_lg_u32 s28, 0
  s_cbranch_scc1 fused_kernel_adone
  s_lshl_b32 s47, s32, 7
  s_lshl_b32 s48, s31, 2
  s_add_u32 s47, s47, s48
  s_add_u32 s47, s47, 42008576
  v_mov_b32 v3, 0
  v_mov_b32 v4, 1
  s_mov_b64 exec, 1
  buffer_store_dword v4, v3, s[12:15], s47 offen sc1
  s_mov_b64 exec, -1

fused_kernel_adone:
  s_endpgm
fused_kernel_gemm:
  s_sub_u32 s28, s28, 8
  s_and_b32 s31, s2, 3
  s_lshl_b32 s31, s31, 2
  s_bfe_u32 s47, s2, 0x20003
  s_add_u32 s31, s31, s47
  s_bfe_u32 s32, s2, 0x10002
  s_lshl_b32 s32, s32, 3
  s_bfe_u32 s47, s2, 0x30005
  s_add_u32 s32, s32, s47
  s_and_b32 s29, s28, 1
  s_lshr_b32 s30, s28, 1
  v_lshrrev_b32 v2, 3, v0
  v_lshlrev_b32 v1, 11, v2
  v_and_b32 v2, 6, v2
  v_and_b32 v3, 7, v0
  v_xor_b32 v2, v2, v3
  v_lshl_add_u32 v1, v2, 4, v1
  s_lshl_b32 s36, s28, 15
  s_lshl_b32 s47, s32, 7
  s_add_u32 s36, s36, s47
  s_mov_b32 s33, s36
  s_lshl_b32 s34, s28, 11
  s_lshl_b32 s37, s30, 10
  s_add_u32 s37, s37, 16777216
  s_add_u32 s35, s37, 32768
  s_lshl_b32 s47, s31, 3
  s_lshl_b32 s48, s29, 2
  s_add_u32 s47, s47, s48
  v_lshlrev_b32 v2, 4, v0

  s_add_u32 s48, s30, 0
  s_and_b32 s48, s48, 3
  s_add_u32 s48, s48, s47
  s_mul_i32 s48, s48, 147456
  v_add_u32 v4, s48, v2
  s_add_u32 s48, s30, 1
  s_and_b32 s48, s48, 3
  s_add_u32 s48, s48, s47
  s_mul_i32 s48, s48, 147456
  v_add_u32 v5, s48, v2
  s_add_u32 s48, s30, 2
  s_and_b32 s48, s48, 3
  s_add_u32 s48, s48, s47
  s_mul_i32 s48, s48, 147456
  v_add_u32 v6, s48, v2
  s_add_u32 s48, s30, 3
  s_and_b32 s48, s48, 3
  s_add_u32 s48, s48, s47
  s_mul_i32 s48, s48, 147456
  v_add_u32 v7, s48, v2
  s_waitcnt lgkmcnt(0)
  s_add_u32 m0, s34, 75776
  s_nop 0
  buffer_load_dwordx4 v1, s[20:23], s33 offen lds
  s_add_u32 s33, s33, 16384
  s_add_u32 m0, s34, 76800
  s_nop 0
  buffer_load_dwordx4 v1, s[20:23], s33 offen lds
  s_add_u32 s33, s33, 245760
  buffer_load_dwordx4 v[36:39], v5, s[12:15], s35 offen
  buffer_load_dwordx4 v[40:43], v6, s[12:15], s35 offen
  buffer_load_dwordx4 v[44:47], v7, s[12:15], s35 offen
  buffer_load_dwordx4 v[32:35], v4, s[12:15], s35 offen
  s_add_u32 s35, s35, 4096
  s_lshl_b32 s39, s31, 3
  s_lshl_b32 s48, s29, 2
  s_add_u32 s39, s39, s48
  s_add_u32 s39, s39, s30
  s_lshl_b32 s39, s39, 15
  s_lshl_b32 s48, s32, 7
  s_add_u32 s39, s39, s48
  v_and_b32 v2, 15, v0
  v_lshlrev_b32 v2, 11, v2
  v_lshrrev_b32 v3, 4, v0
  v_lshl_add_u32 v2, v3, 3, v2

  buffer_load_dwordx2 v[16:17], v2, s[60:63], s39 offen offset:0
  buffer_load_dwordx2 v[18:19], v2, s[60:63], s39 offen offset:32
  buffer_load_dwordx2 v[20:21], v2, s[60:63], s39 offen offset:64
  buffer_load_dwordx2 v[22:23], v2, s[60:63], s39 offen offset:96
  s_add_u32 s38, s36, 1048576
  v_lshrrev_b32 v2, 5, v0
  v_lshlrev_b32 v2, 4, v2
  v_bfe_u32 v3, v0, 2, 3
  v_add_u32 v2, v2, v3
  v_lshlrev_b32 v2, 7, v2
  v_and_b32 v8, 3, v0
  v_lshl_add_u32 v2, v8, 3, v2
  v_lshrrev_b32 v3, 1, v3
  v_lshl_add_u32 v2, v3, 5, v2
  s_lshl_b32 s47, s30, 12
  v_add_u32 v12, s47, v2
  v_xor_b32 v13, 32, v12
  v_xor_b32 v14, 64, v12
  v_xor_b32 v15, 96, v12
  s_lshr_b32 s47, s31, 1
  s_lshl_b32 s47, s47, 7
  s_add_u32 s47, s47, 42008576
  s_mov_b32 s48, 0xffff0000

  v_add_u32 v8, 75776, v12
  v_add_u32 v9, 75776, v13
  v_add_u32 v10, 75776, v14
  v_add_u32 v11, 75776, v15
  s_barrier
  s_add_u32 m0, s34, 92160
  s_nop 0
  buffer_load_dwordx4 v1, s[20:23], s33 offen lds
  s_add_u32 s33, s33, 16384
  s_add_u32 m0, s34, 93184
  s_nop 0
  buffer_load_dwordx4 v1, s[20:23], s33 offen lds
  s_add_u32 s33, s33, 245760
  buffer_load_dwordx4 v[52:55], v5, s[12:15], s35 offen
  buffer_load_dwordx4 v[56:59], v6, s[12:15], s35 offen
  buffer_load_dwordx4 v[60:63], v7, s[12:15], s35 offen
  buffer_load_dwordx4 v[48:51], v4, s[12:15], s35 offen
  s_add_u32 s35, s35, 4096
  s_add_u32 m0, s34, 108544
  s_nop 0
  buffer_load_dwordx4 v1, s[20:23], s33 offen lds
  s_add_u32 s33, s33, 16384
  s_add_u32 m0, s34, 109568
  s_nop 0
  buffer_load_dwordx4 v1, s[20:23], s33 offen lds
  s_add_u32 s33, s33, 245760
  s_add_u32 m0, s34, 124928
  s_nop 0
  buffer_load_dwordx4 v1, s[20:23], s33 offen lds
  s_add_u32 s33, s33, 16384
  s_add_u32 m0, s34, 125952
  s_nop 0
  buffer_load_dwordx4 v1, s[20:23], s33 offen lds
  s_add_u32 s33, s33, 245760
  s_waitcnt vmcnt(10)
  v_lshlrev_b32 v64, 16, v16
  v_and_b32 v65, s48, v16
  v_lshlrev_b32 v66, 16, v17
  v_and_b32 v67, s48, v17
  v_lshlrev_b32 v68, 16, v18
  v_and_b32 v69, s48, v18
  v_lshlrev_b32 v70, 16, v19
  v_and_b32 v71, s48, v19
  v_lshlrev_b32 v72, 16, v20
  v_and_b32 v73, s48, v20
  v_lshlrev_b32 v74, 16, v21
  v_and_b32 v75, s48, v21
  v_lshlrev_b32 v76, 16, v22
  v_and_b32 v77, s48, v22
  v_lshlrev_b32 v78, 16, v23
  v_and_b32 v79, s48, v23
  s_waitcnt vmcnt(18)
  s_barrier
  ds_read_b64_tr_b16 v[16:17], v8 offset:0
  ds_read_b64_tr_b16 v[18:19], v8 offset:1024
  ds_read_b64_tr_b16 v[20:21], v9 offset:0
  ds_read_b64_tr_b16 v[22:23], v9 offset:1024
  ds_read_b64_tr_b16 v[24:25], v10 offset:0
  ds_read_b64_tr_b16 v[26:27], v10 offset:1024
  ds_read_b64_tr_b16 v[28:29], v11 offset:0
  ds_read_b64_tr_b16 v[30:31], v11 offset:1024
  s_waitcnt vmcnt(17)
  s_waitcnt lgkmcnt(6)
  v_mfma_f32_16x16x32_bf16 v[80:83], v[16:19], v[36:39], 0
  s_waitcnt lgkmcnt(4)
  v_mfma_f32_16x16x32_bf16 v[84:87], v[20:23], v[36:39], 0
  s_waitcnt lgkmcnt(2)
  v_mfma_f32_16x16x32_bf16 v[88:91], v[24:27], v[36:39], 0
  s_waitcnt lgkmcnt(0)
  v_mfma_f32_16x16x32_bf16 v[92:95], v[28:31], v[36:39], 0
  buffer_load_dwordx4 v[36:39], v5, s[12:15], s35 offen
  s_waitcnt vmcnt(17)
  v_mfma_f32_16x16x32_bf16 v[96:99], v[16:19], v[40:43], 0
  v_mfma_f32_16x16x32_bf16 v[100:103], v[20:23], v[40:43], 0
  v_mfma_f32_16x16x32_bf16 v[104:107], v[24:27], v[40:43], 0
  v_mfma_f32_16x16x32_bf16 v[108:111], v[28:31], v[40:43], 0
  buffer_load_dwordx4 v[40:43], v6, s[12:15], s35 offen
  s_waitcnt vmcnt(17)
  v_mfma_f32_16x16x32_bf16 v[112:115], v[16:19], v[44:47], 0
  v_mfma_f32_16x16x32_bf16 v[116:119], v[20:23], v[44:47], 0
  v_mfma_f32_16x16x32_bf16 v[120:123], v[24:27], v[44:47], 0
  v_mfma_f32_16x16x32_bf16 v[124:127], v[28:31], v[44:47], 0
  buffer_load_dwordx4 v[44:47], v7, s[12:15], s35 offen
  s_waitcnt vmcnt(11)
  s_barrier
  s_add_u32 m0, s34, 75776
  s_nop 0
  buffer_load_dwordx4 v1, s[20:23], s33 offen lds
  s_add_u32 s33, s33, 16384
  s_add_u32 m0, s34, 76800
  s_nop 0
  buffer_load_dwordx4 v1, s[20:23], s33 offen lds
  s_add_u32 s33, s33, 245760
  s_waitcnt vmcnt(19)
  v_mfma_f32_16x16x32_bf16 v[64:67], v[16:19], v[32:35], v[64:67]
  v_mfma_f32_16x16x32_bf16 v[68:71], v[20:23], v[32:35], v[68:71]
  ds_read_b64_tr_b16 v[16:17], v8 offset:16384
  ds_read_b64_tr_b16 v[18:19], v8 offset:17408
  v_mfma_f32_16x16x32_bf16 v[72:75], v[24:27], v[32:35], v[72:75]
  ds_read_b64_tr_b16 v[20:21], v9 offset:16384
  ds_read_b64_tr_b16 v[22:23], v9 offset:17408
  v_mfma_f32_16x16x32_bf16 v[76:79], v[28:31], v[32:35], v[76:79]
  ds_read_b64_tr_b16 v[24:25], v10 offset:16384
  ds_read_b64_tr_b16 v[26:27], v10 offset:17408
  buffer_load_dwordx4 v[32:35], v4, s[12:15], s35 offen
  s_add_u32 s35, s35, 4096
  s_nop 3
  ds_read_b64_tr_b16 v[28:29], v11 offset:16384
  ds_read_b64_tr_b16 v[30:31], v11 offset:17408
  s_waitcnt vmcnt(13)
  s_waitcnt lgkmcnt(6)
  v_mfma_f32_16x16x32_bf16 v[80:83], v[16:19], v[52:55], v[80:83]
  s_waitcnt lgkmcnt(4)
  v_mfma_f32_16x16x32_bf16 v[84:87], v[20:23], v[52:55], v[84:87]
  s_waitcnt lgkmcnt(2)
  v_mfma_f32_16x16x32_bf16 v[88:91], v[24:27], v[52:55], v[88:91]
  s_waitcnt lgkmcnt(0)
  v_mfma_f32_16x16x32_bf16 v[92:95], v[28:31], v[52:55], v[92:95]
  buffer_load_dwordx4 v[52:55], v5, s[12:15], s35 offen
  s_waitcnt vmcnt(13)
  v_mfma_f32_16x16x32_bf16 v[96:99], v[16:19], v[56:59], v[96:99]
  v_mfma_f32_16x16x32_bf16 v[100:103], v[20:23], v[56:59], v[100:103]
  v_mfma_f32_16x16x32_bf16 v[104:107], v[24:27], v[56:59], v[104:107]
  v_mfma_f32_16x16x32_bf16 v[108:111], v[28:31], v[56:59], v[108:111]
  buffer_load_dwordx4 v[56:59], v6, s[12:15], s35 offen
  s_waitcnt vmcnt(10)
  s_barrier
  s_add_u32 m0, s34, 92160
  s_nop 0
  buffer_load_dwordx4 v1, s[20:23], s33 offen lds
  s_add_u32 s33, s33, 16384
  s_add_u32 m0, s34, 93184
  s_nop 0
  buffer_load_dwordx4 v1, s[20:23], s33 offen lds
  s_add_u32 s33, s33, 245760
  s_waitcnt vmcnt(15)
  v_mfma_f32_16x16x32_bf16 v[112:115], v[16:19], v[60:63], v[112:115]
  v_mfma_f32_16x16x32_bf16 v[116:119], v[20:23], v[60:63], v[116:119]
  v_mfma_f32_16x16x32_bf16 v[120:123], v[24:27], v[60:63], v[120:123]
  v_mfma_f32_16x16x32_bf16 v[124:127], v[28:31], v[60:63], v[124:127]
  buffer_load_dwordx4 v[60:63], v7, s[12:15], s35 offen
  s_waitcnt vmcnt(15)
  v_mfma_f32_16x16x32_bf16 v[64:67], v[16:19], v[48:51], v[64:67]
  v_mfma_f32_16x16x32_bf16 v[68:71], v[20:23], v[48:51], v[68:71]
  ds_read_b64_tr_b16 v[16:17], v8 offset:32768
  ds_read_b64_tr_b16 v[18:19], v8 offset:33792
  v_mfma_f32_16x16x32_bf16 v[72:75], v[24:27], v[48:51], v[72:75]
  ds_read_b64_tr_b16 v[20:21], v9 offset:32768
  ds_read_b64_tr_b16 v[22:23], v9 offset:33792
  v_mfma_f32_16x16x32_bf16 v[76:79], v[28:31], v[48:51], v[76:79]
  ds_read_b64_tr_b16 v[24:25], v10 offset:32768
  ds_read_b64_tr_b16 v[26:27], v10 offset:33792
  buffer_load_dwordx4 v[48:51], v4, s[12:15], s35 offen
  s_add_u32 s35, s35, 4096
  s_nop 3
  ds_read_b64_tr_b16 v[28:29], v11 offset:32768
  ds_read_b64_tr_b16 v[30:31], v11 offset:33792
  s_waitcnt vmcnt(11)
  s_waitcnt lgkmcnt(6)
  v_mfma_f32_16x16x32_bf16 v[80:83], v[16:19], v[36:39], v[80:83]
  s_waitcnt lgkmcnt(4)
  v_mfma_f32_16x16x32_bf16 v[84:87], v[20:23], v[36:39], v[84:87]
  s_waitcnt lgkmcnt(2)
  v_mfma_f32_16x16x32_bf16 v[88:91], v[24:27], v[36:39], v[88:91]
  s_waitcnt lgkmcnt(0)
  v_mfma_f32_16x16x32_bf16 v[92:95], v[28:31], v[36:39], v[92:95]
  buffer_load_dwordx4 v[36:39], v5, s[12:15], s35 offen
  s_waitcnt vmcnt(13)
  s_barrier
  s_add_u32 m0, s34, 108544
  s_nop 0
  buffer_load_dwordx4 v1, s[20:23], s33 offen lds
  s_add_u32 s33, s33, 16384
  s_add_u32 m0, s34, 109568
  s_nop 0
  buffer_load_dwordx4 v1, s[20:23], s33 offen lds
  s_add_u32 s33, s33, 245760
  s_waitcnt vmcnt(13)
  v_mfma_f32_16x16x32_bf16 v[96:99], v[16:19], v[40:43], v[96:99]
  v_mfma_f32_16x16x32_bf16 v[100:103], v[20:23], v[40:43], v[100:103]
  v_mfma_f32_16x16x32_bf16 v[104:107], v[24:27], v[40:43], v[104:107]
  v_mfma_f32_16x16x32_bf16 v[108:111], v[28:31], v[40:43], v[108:111]
  buffer_load_dwordx4 v[40:43], v6, s[12:15], s35 offen
  s_waitcnt vmcnt(13)
  v_mfma_f32_16x16x32_bf16 v[112:115], v[16:19], v[44:47], v[112:115]
  v_mfma_f32_16x16x32_bf16 v[116:119], v[20:23], v[44:47], v[116:119]
  v_mfma_f32_16x16x32_bf16 v[120:123], v[24:27], v[44:47], v[120:123]
  v_mfma_f32_16x16x32_bf16 v[124:127], v[28:31], v[44:47], v[124:127]
  buffer_load_dwordx4 v[44:47], v7, s[12:15], s35 offen
  s_waitcnt vmcnt(11)
  v_mfma_f32_16x16x32_bf16 v[64:67], v[16:19], v[32:35], v[64:67]
  v_mfma_f32_16x16x32_bf16 v[68:71], v[20:23], v[32:35], v[68:71]
  ds_read_b64_tr_b16 v[16:17], v8 offset:49152
  ds_read_b64_tr_b16 v[18:19], v8 offset:50176
  v_mfma_f32_16x16x32_bf16 v[72:75], v[24:27], v[32:35], v[72:75]
  ds_read_b64_tr_b16 v[20:21], v9 offset:49152
  ds_read_b64_tr_b16 v[22:23], v9 offset:50176
  v_mfma_f32_16x16x32_bf16 v[76:79], v[28:31], v[32:35], v[76:79]
  ds_read_b64_tr_b16 v[24:25], v10 offset:49152
  ds_read_b64_tr_b16 v[26:27], v10 offset:50176
  buffer_load_dwordx4 v[32:35], v4, s[12:15], s35 offen
  s_add_u32 s35, s35, 4096
  s_nop 3
  ds_read_b64_tr_b16 v[28:29], v11 offset:49152
  ds_read_b64_tr_b16 v[30:31], v11 offset:50176
  s_barrier
  s_waitcnt vmcnt(11)
  s_waitcnt lgkmcnt(6)
  v_mfma_f32_16x16x32_bf16 v[80:83], v[16:19], v[52:55], v[80:83]
  s_waitcnt lgkmcnt(4)
  v_mfma_f32_16x16x32_bf16 v[84:87], v[20:23], v[52:55], v[84:87]
  s_waitcnt lgkmcnt(2)
  v_mfma_f32_16x16x32_bf16 v[88:91], v[24:27], v[52:55], v[88:91]
  s_waitcnt lgkmcnt(0)
  v_mfma_f32_16x16x32_bf16 v[92:95], v[28:31], v[52:55], v[92:95]
  buffer_load_dwordx4 v[52:55], v5, s[12:15], s35 offen
  s_waitcnt vmcnt(11)
  v_mfma_f32_16x16x32_bf16 v[96:99], v[16:19], v[56:59], v[96:99]
  v_mfma_f32_16x16x32_bf16 v[100:103], v[20:23], v[56:59], v[100:103]
  v_mfma_f32_16x16x32_bf16 v[104:107], v[24:27], v[56:59], v[104:107]
  v_mfma_f32_16x16x32_bf16 v[108:111], v[28:31], v[56:59], v[108:111]
  buffer_load_dwordx4 v[56:59], v6, s[12:15], s35 offen
  s_waitcnt vmcnt(9)
  v_mfma_f32_16x16x32_bf16 v[112:115], v[16:19], v[60:63], v[112:115]
  v_mfma_f32_16x16x32_bf16 v[116:119], v[20:23], v[60:63], v[116:119]
  v_mfma_f32_16x16x32_bf16 v[120:123], v[24:27], v[60:63], v[120:123]
  v_mfma_f32_16x16x32_bf16 v[124:127], v[28:31], v[60:63], v[124:127]
  buffer_load_dwordx4 v[60:63], v7, s[12:15], s35 offen
  s_waitcnt vmcnt(16)
  s_barrier
  s_add_u32 m0, s34, 124928
  s_nop 0
  buffer_load_dwordx4 v1, s[20:23], s33 offen lds
  s_add_u32 s33, s33, 16384
  s_add_u32 m0, s34, 125952
  s_nop 0
  buffer_load_dwordx4 v1, s[20:23], s33 offen lds
  s_add_u32 s33, s33, 245760
  s_waitcnt vmcnt(11)
  v_mfma_f32_16x16x32_bf16 v[64:67], v[16:19], v[48:51], v[64:67]
  v_mfma_f32_16x16x32_bf16 v[68:71], v[20:23], v[48:51], v[68:71]
  ds_read_b64_tr_b16 v[16:17], v8 offset:0
  ds_read_b64_tr_b16 v[18:19], v8 offset:1024
  v_mfma_f32_16x16x32_bf16 v[72:75], v[24:27], v[48:51], v[72:75]
  ds_read_b64_tr_b16 v[20:21], v9 offset:0
  ds_read_b64_tr_b16 v[22:23], v9 offset:1024
  v_mfma_f32_16x16x32_bf16 v[76:79], v[28:31], v[48:51], v[76:79]
  ds_read_b64_tr_b16 v[24:25], v10 offset:0
  ds_read_b64_tr_b16 v[26:27], v10 offset:1024
  buffer_load_dwordx4 v[48:51], v4, s[12:15], s35 offen
  s_add_u32 s35, s35, 4096
  s_nop 3
  ds_read_b64_tr_b16 v[28:29], v11 offset:0
  ds_read_b64_tr_b16 v[30:31], v11 offset:1024
  s_waitcnt vmcnt(11)
  s_waitcnt lgkmcnt(6)
  v_mfma_f32_16x16x32_bf16 v[80:83], v[16:19], v[36:39], v[80:83]
  s_waitcnt lgkmcnt(4)
  v_mfma_f32_16x16x32_bf16 v[84:87], v[20:23], v[36:39], v[84:87]
  s_waitcnt lgkmcnt(2)
  v_mfma_f32_16x16x32_bf16 v[88:91], v[24:27], v[36:39], v[88:91]
  s_waitcnt lgkmcnt(0)
  v_mfma_f32_16x16x32_bf16 v[92:95], v[28:31], v[36:39], v[92:95]
  buffer_load_dwordx4 v[36:39], v5, s[12:15], s35 offen
  s_waitcnt vmcnt(9)
  v_mfma_f32_16x16x32_bf16 v[96:99], v[16:19], v[40:43], v[96:99]
  v_mfma_f32_16x16x32_bf16 v[100:103], v[20:23], v[40:43], v[100:103]
  v_mfma_f32_16x16x32_bf16 v[104:107], v[24:27], v[40:43], v[104:107]
  v_mfma_f32_16x16x32_bf16 v[108:111], v[28:31], v[40:43], v[108:111]
  buffer_load_dwordx4 v[40:43], v6, s[12:15], s35 offen
  s_waitcnt vmcnt(16)
  s_barrier
  s_add_u32 m0, s34, 75776
  s_nop 0
  buffer_load_dwordx4 v1, s[20:23], s33 offen lds
  s_add_u32 s33, s33, 16384
  s_add_u32 m0, s34, 76800
  s_nop 0
  buffer_load_dwordx4 v1, s[20:23], s33 offen lds
  s_add_u32 s33, s33, 245760
  s_waitcnt vmcnt(11)
  v_mfma_f32_16x16x32_bf16 v[112:115], v[16:19], v[44:47], v[112:115]
  v_mfma_f32_16x16x32_bf16 v[116:119], v[20:23], v[44:47], v[116:119]
  v_mfma_f32_16x16x32_bf16 v[120:123], v[24:27], v[44:47], v[120:123]
  v_mfma_f32_16x16x32_bf16 v[124:127], v[28:31], v[44:47], v[124:127]
  buffer_load_dwordx4 v[44:47], v7, s[12:15], s35 offen
  s_waitcnt vmcnt(11)
  v_mfma_f32_16x16x32_bf16 v[64:67], v[16:19], v[32:35], v[64:67]
  v_mfma_f32_16x16x32_bf16 v[68:71], v[20:23], v[32:35], v[68:71]
  ds_read_b64_tr_b16 v[16:17], v8 offset:16384
  ds_read_b64_tr_b16 v[18:19], v8 offset:17408
  v_mfma_f32_16x16x32_bf16 v[72:75], v[24:27], v[32:35], v[72:75]
  ds_read_b64_tr_b16 v[20:21], v9 offset:16384
  ds_read_b64_tr_b16 v[22:23], v9 offset:17408
  v_mfma_f32_16x16x32_bf16 v[76:79], v[28:31], v[32:35], v[76:79]
  ds_read_b64_tr_b16 v[24:25], v10 offset:16384
  ds_read_b64_tr_b16 v[26:27], v10 offset:17408
  buffer_load_dwordx4 v[32:35], v4, s[12:15], s35 offen
  s_add_u32 s35, s35, 4096
  s_nop 3
  ds_read_b64_tr_b16 v[28:29], v11 offset:16384
  ds_read_b64_tr_b16 v[30:31], v11 offset:17408
  s_waitcnt vmcnt(11)
  s_waitcnt lgkmcnt(6)
  v_mfma_f32_16x16x32_bf16 v[80:83], v[16:19], v[52:55], v[80:83]
  s_waitcnt lgkmcnt(4)
  v_mfma_f32_16x16x32_bf16 v[84:87], v[20:23], v[52:55], v[84:87]
  s_waitcnt lgkmcnt(2)
  v_mfma_f32_16x16x32_bf16 v[88:91], v[24:27], v[52:55], v[88:91]
  s_waitcnt lgkmcnt(0)
  v_mfma_f32_16x16x32_bf16 v[92:95], v[28:31], v[52:55], v[92:95]
  buffer_load_dwordx4 v[52:55], v5, s[12:15], s35 offen
  s_waitcnt vmcnt(16)
  s_barrier
  s_add_u32 m0, s34, 92160
  s_nop 0
  buffer_load_dwordx4 v1, s[20:23], s33 offen lds
  s_add_u32 s33, s33, 16384
  s_add_u32 m0, s34, 93184
  s_nop 0
  buffer_load_dwordx4 v1, s[20:23], s33 offen lds
  s_add_u32 s33, s33, 245760
  s_waitcnt vmcnt(13)
  v_mfma_f32_16x16x32_bf16 v[96:99], v[16:19], v[56:59], v[96:99]
  v_mfma_f32_16x16x32_bf16 v[100:103], v[20:23], v[56:59], v[100:103]
  v_mfma_f32_16x16x32_bf16 v[104:107], v[24:27], v[56:59], v[104:107]
  v_mfma_f32_16x16x32_bf16 v[108:111], v[28:31], v[56:59], v[108:111]
  buffer_load_dwordx4 v[56:59], v6, s[12:15], s35 offen
  s_waitcnt vmcnt(13)
  v_mfma_f32_16x16x32_bf16 v[112:115], v[16:19], v[60:63], v[112:115]
  v_mfma_f32_16x16x32_bf16 v[116:119], v[20:23], v[60:63], v[116:119]
  v_mfma_f32_16x16x32_bf16 v[120:123], v[24:27], v[60:63], v[120:123]
  v_mfma_f32_16x16x32_bf16 v[124:127], v[28:31], v[60:63], v[124:127]
  buffer_load_dwordx4 v[60:63], v7, s[12:15], s35 offen
  s_waitcnt vmcnt(11)
  v_mfma_f32_16x16x32_bf16 v[64:67], v[16:19], v[48:51], v[64:67]
  v_mfma_f32_16x16x32_bf16 v[68:71], v[20:23], v[48:51], v[68:71]
  ds_read_b64_tr_b16 v[16:17], v8 offset:32768
  ds_read_b64_tr_b16 v[18:19], v8 offset:33792
  v_mfma_f32_16x16x32_bf16 v[72:75], v[24:27], v[48:51], v[72:75]
  ds_read_b64_tr_b16 v[20:21], v9 offset:32768
  ds_read_b64_tr_b16 v[22:23], v9 offset:33792
  v_mfma_f32_16x16x32_bf16 v[76:79], v[28:31], v[48:51], v[76:79]
  ds_read_b64_tr_b16 v[24:25], v10 offset:32768
  ds_read_b64_tr_b16 v[26:27], v10 offset:33792
  buffer_load_dwordx4 v[48:51], v4, s[12:15], s35 offen
  s_add_u32 s35, s35, 4096
  s_nop 3
  ds_read_b64_tr_b16 v[28:29], v11 offset:32768
  ds_read_b64_tr_b16 v[30:31], v11 offset:33792
  s_barrier
  s_waitcnt vmcnt(11)
  s_waitcnt lgkmcnt(6)
  v_mfma_f32_16x16x32_bf16 v[80:83], v[16:19], v[36:39], v[80:83]
  s_waitcnt lgkmcnt(4)
  v_mfma_f32_16x16x32_bf16 v[84:87], v[20:23], v[36:39], v[84:87]
  s_waitcnt lgkmcnt(2)
  v_mfma_f32_16x16x32_bf16 v[88:91], v[24:27], v[36:39], v[88:91]
  s_waitcnt lgkmcnt(0)
  v_mfma_f32_16x16x32_bf16 v[92:95], v[28:31], v[36:39], v[92:95]
  buffer_load_dwordx4 v[36:39], v5, s[12:15], s35 offen
  s_waitcnt vmcnt(11)
  v_mfma_f32_16x16x32_bf16 v[96:99], v[16:19], v[40:43], v[96:99]
  v_mfma_f32_16x16x32_bf16 v[100:103], v[20:23], v[40:43], v[100:103]
  v_mfma_f32_16x16x32_bf16 v[104:107], v[24:27], v[40:43], v[104:107]
  v_mfma_f32_16x16x32_bf16 v[108:111], v[28:31], v[40:43], v[108:111]
  buffer_load_dwordx4 v[40:43], v6, s[12:15], s35 offen
  s_waitcnt vmcnt(9)
  v_mfma_f32_16x16x32_bf16 v[112:115], v[16:19], v[44:47], v[112:115]
  v_mfma_f32_16x16x32_bf16 v[116:119], v[20:23], v[44:47], v[116:119]
  v_mfma_f32_16x16x32_bf16 v[120:123], v[24:27], v[44:47], v[120:123]
  v_mfma_f32_16x16x32_bf16 v[124:127], v[28:31], v[44:47], v[124:127]
  buffer_load_dwordx4 v[44:47], v7, s[12:15], s35 offen
  s_waitcnt vmcnt(16)
  s_barrier
  s_add_u32 m0, s34, 108544
  s_nop 0
  buffer_load_dwordx4 v1, s[20:23], s33 offen lds
  s_add_u32 s33, s33, 16384
  s_add_u32 m0, s34, 109568
  s_nop 0
  buffer_load_dwordx4 v1, s[20:23], s33 offen lds
  s_add_u32 s33, s33, 245760
  s_waitcnt vmcnt(11)
  v_mfma_f32_16x16x32_bf16 v[64:67], v[16:19], v[32:35], v[64:67]
  v_mfma_f32_16x16x32_bf16 v[68:71], v[20:23], v[32:35], v[68:71]
  ds_read_b64_tr_b16 v[16:17], v8 offset:49152
  ds_read_b64_tr_b16 v[18:19], v8 offset:50176
  v_mfma_f32_16x16x32_bf16 v[72:75], v[24:27], v[32:35], v[72:75]
  ds_read_b64_tr_b16 v[20:21], v9 offset:49152
  ds_read_b64_tr_b16 v[22:23], v9 offset:50176
  v_mfma_f32_16x16x32_bf16 v[76:79], v[28:31], v[32:35], v[76:79]
  ds_read_b64_tr_b16 v[24:25], v10 offset:49152
  ds_read_b64_tr_b16 v[26:27], v10 offset:50176
  buffer_load_dwordx4 v[32:35], v4, s[12:15], s35 offen
  s_add_u32 s35, s35, 4096
  s_nop 3
  ds_read_b64_tr_b16 v[28:29], v11 offset:49152
  ds_read_b64_tr_b16 v[30:31], v11 offset:50176
  s_waitcnt vmcnt(11)
  s_waitcnt lgkmcnt(6)
  v_mfma_f32_16x16x32_bf16 v[80:83], v[16:19], v[52:55], v[80:83]
  s_waitcnt lgkmcnt(4)
  v_mfma_f32_16x16x32_bf16 v[84:87], v[20:23], v[52:55], v[84:87]
  s_waitcnt lgkmcnt(2)
  v_mfma_f32_16x16x32_bf16 v[88:91], v[24:27], v[52:55], v[88:91]
  s_waitcnt lgkmcnt(0)
  v_mfma_f32_16x16x32_bf16 v[92:95], v[28:31], v[52:55], v[92:95]
  buffer_load_dwordx4 v[52:55], v5, s[12:15], s35 offen
  s_waitcnt vmcnt(9)
  v_mfma_f32_16x16x32_bf16 v[96:99], v[16:19], v[56:59], v[96:99]
  v_mfma_f32_16x16x32_bf16 v[100:103], v[20:23], v[56:59], v[100:103]
  v_mfma_f32_16x16x32_bf16 v[104:107], v[24:27], v[56:59], v[104:107]
  v_mfma_f32_16x16x32_bf16 v[108:111], v[28:31], v[56:59], v[108:111]
  buffer_load_dwordx4 v[56:59], v6, s[12:15], s35 offen
  s_waitcnt vmcnt(16)
  s_barrier
  s_add_u32 m0, s34, 124928
  s_nop 0
  buffer_load_dwordx4 v1, s[20:23], s33 offen lds
  s_add_u32 s33, s33, 16384
  s_add_u32 m0, s34, 125952
  s_nop 0
  buffer_load_dwordx4 v1, s[20:23], s33 offen lds
  s_add_u32 s33, s33, 245760
  s_waitcnt vmcnt(11)
  v_mfma_f32_16x16x32_bf16 v[112:115], v[16:19], v[60:63], v[112:115]
  v_mfma_f32_16x16x32_bf16 v[116:119], v[20:23], v[60:63], v[116:119]
  v_mfma_f32_16x16x32_bf16 v[120:123], v[24:27], v[60:63], v[120:123]
  v_mfma_f32_16x16x32_bf16 v[124:127], v[28:31], v[60:63], v[124:127]
  buffer_load_dwordx4 v[60:63], v7, s[12:15], s35 offen
  s_waitcnt vmcnt(11)
  v_mfma_f32_16x16x32_bf16 v[64:67], v[16:19], v[48:51], v[64:67]
  v_mfma_f32_16x16x32_bf16 v[68:71], v[20:23], v[48:51], v[68:71]
  ds_read_b64_tr_b16 v[16:17], v8 offset:0
  ds_read_b64_tr_b16 v[18:19], v8 offset:1024
  v_mfma_f32_16x16x32_bf16 v[72:75], v[24:27], v[48:51], v[72:75]
  ds_read_b64_tr_b16 v[20:21], v9 offset:0
  ds_read_b64_tr_b16 v[22:23], v9 offset:1024
  v_mfma_f32_16x16x32_bf16 v[76:79], v[28:31], v[48:51], v[76:79]
  ds_read_b64_tr_b16 v[24:25], v10 offset:0
  ds_read_b64_tr_b16 v[26:27], v10 offset:1024
  buffer_load_dwordx4 v[48:51], v4, s[12:15], s35 offen
  s_add_u32 s35, s35, 4096
  s_nop 3
  ds_read_b64_tr_b16 v[28:29], v11 offset:0
  ds_read_b64_tr_b16 v[30:31], v11 offset:1024
  s_waitcnt vmcnt(11)
  s_waitcnt lgkmcnt(6)
  v_mfma_f32_16x16x32_bf16 v[80:83], v[16:19], v[36:39], v[80:83]
  s_waitcnt lgkmcnt(4)
  v_mfma_f32_16x16x32_bf16 v[84:87], v[20:23], v[36:39], v[84:87]
  s_waitcnt lgkmcnt(2)
  v_mfma_f32_16x16x32_bf16 v[88:91], v[24:27], v[36:39], v[88:91]
  s_waitcnt lgkmcnt(0)
  v_mfma_f32_16x16x32_bf16 v[92:95], v[28:31], v[36:39], v[92:95]
  buffer_load_dwordx4 v[36:39], v5, s[12:15], s35 offen
  s_waitcnt vmcnt(16)
  s_barrier
  s_add_u32 m0, s34, 75776
  s_nop 0
  buffer_load_dwordx4 v1, s[20:23], s33 offen lds
  s_add_u32 s33, s33, 16384
  s_add_u32 m0, s34, 76800
  s_nop 0
  buffer_load_dwordx4 v1, s[20:23], s33 offen lds
  s_add_u32 s33, s33, 245760
  s_waitcnt vmcnt(13)
  v_mfma_f32_16x16x32_bf16 v[96:99], v[16:19], v[40:43], v[96:99]
  v_mfma_f32_16x16x32_bf16 v[100:103], v[20:23], v[40:43], v[100:103]
  v_mfma_f32_16x16x32_bf16 v[104:107], v[24:27], v[40:43], v[104:107]
  v_mfma_f32_16x16x32_bf16 v[108:111], v[28:31], v[40:43], v[108:111]
  buffer_load_dwordx4 v[40:43], v6, s[12:15], s35 offen
  s_waitcnt vmcnt(13)
  v_mfma_f32_16x16x32_bf16 v[112:115], v[16:19], v[44:47], v[112:115]
  v_mfma_f32_16x16x32_bf16 v[116:119], v[20:23], v[44:47], v[116:119]
  v_mfma_f32_16x16x32_bf16 v[120:123], v[24:27], v[44:47], v[120:123]
  v_mfma_f32_16x16x32_bf16 v[124:127], v[28:31], v[44:47], v[124:127]
  buffer_load_dwordx4 v[44:47], v7, s[12:15], s35 offen
  s_waitcnt vmcnt(11)
  v_mfma_f32_16x16x32_bf16 v[64:67], v[16:19], v[32:35], v[64:67]
  v_mfma_f32_16x16x32_bf16 v[68:71], v[20:23], v[32:35], v[68:71]
  ds_read_b64_tr_b16 v[16:17], v8 offset:16384
  ds_read_b64_tr_b16 v[18:19], v8 offset:17408
  v_mfma_f32_16x16x32_bf16 v[72:75], v[24:27], v[32:35], v[72:75]
  ds_read_b64_tr_b16 v[20:21], v9 offset:16384
  ds_read_b64_tr_b16 v[22:23], v9 offset:17408
  v_mfma_f32_16x16x32_bf16 v[76:79], v[28:31], v[32:35], v[76:79]
  ds_read_b64_tr_b16 v[24:25], v10 offset:16384
  ds_read_b64_tr_b16 v[26:27], v10 offset:17408
  buffer_load_dwordx4 v[32:35], v4, s[12:15], s35 offen
  s_add_u32 s35, s35, 4096
  s_nop 3
  ds_read_b64_tr_b16 v[28:29], v11 offset:16384
  ds_read_b64_tr_b16 v[30:31], v11 offset:17408
  s_barrier
  s_waitcnt vmcnt(11)
  s_waitcnt lgkmcnt(6)
  v_mfma_f32_16x16x32_bf16 v[80:83], v[16:19], v[52:55], v[80:83]
  s_waitcnt lgkmcnt(4)
  v_mfma_f32_16x16x32_bf16 v[84:87], v[20:23], v[52:55], v[84:87]
  s_waitcnt lgkmcnt(2)
  v_mfma_f32_16x16x32_bf16 v[88:91], v[24:27], v[52:55], v[88:91]
  s_waitcnt lgkmcnt(0)
  v_mfma_f32_16x16x32_bf16 v[92:95], v[28:31], v[52:55], v[92:95]
  buffer_load_dwordx4 v[52:55], v5, s[12:15], s35 offen
  s_waitcnt vmcnt(11)
  v_mfma_f32_16x16x32_bf16 v[96:99], v[16:19], v[56:59], v[96:99]
  v_mfma_f32_16x16x32_bf16 v[100:103], v[20:23], v[56:59], v[100:103]
  v_mfma_f32_16x16x32_bf16 v[104:107], v[24:27], v[56:59], v[104:107]
  v_mfma_f32_16x16x32_bf16 v[108:111], v[28:31], v[56:59], v[108:111]
  buffer_load_dwordx4 v[56:59], v6, s[12:15], s35 offen
  s_waitcnt vmcnt(9)
  v_mfma_f32_16x16x32_bf16 v[112:115], v[16:19], v[60:63], v[112:115]
  v_mfma_f32_16x16x32_bf16 v[116:119], v[20:23], v[60:63], v[116:119]
  v_mfma_f32_16x16x32_bf16 v[120:123], v[24:27], v[60:63], v[120:123]
  v_mfma_f32_16x16x32_bf16 v[124:127], v[28:31], v[60:63], v[124:127]
  buffer_load_dwordx4 v[60:63], v7, s[12:15], s35 offen
  s_waitcnt vmcnt(16)
  s_barrier
  s_add_u32 m0, s34, 92160
  s_nop 0
  buffer_load_dwordx4 v1, s[20:23], s33 offen lds
  s_add_u32 s33, s33, 16384
  s_add_u32 m0, s34, 93184
  s_nop 0
  buffer_load_dwordx4 v1, s[20:23], s33 offen lds
  s_add_u32 s33, s33, 245760
  s_waitcnt vmcnt(11)
  v_mfma_f32_16x16x32_bf16 v[64:67], v[16:19], v[48:51], v[64:67]
  v_mfma_f32_16x16x32_bf16 v[68:71], v[20:23], v[48:51], v[68:71]
  ds_read_b64_tr_b16 v[16:17], v8 offset:32768
  ds_read_b64_tr_b16 v[18:19], v8 offset:33792
  v_mfma_f32_16x16x32_bf16 v[72:75], v[24:27], v[48:51], v[72:75]
  ds_read_b64_tr_b16 v[20:21], v9 offset:32768
  ds_read_b64_tr_b16 v[22:23], v9 offset:33792
  v_mfma_f32_16x16x32_bf16 v[76:79], v[28:31], v[48:51], v[76:79]
  ds_read_b64_tr_b16 v[24:25], v10 offset:32768
  ds_read_b64_tr_b16 v[26:27], v10 offset:33792
  buffer_load_dwordx4 v[48:51], v4, s[12:15], s35 offen
  s_add_u32 s35, s35, 4096
  s_nop 3
  ds_read_b64_tr_b16 v[28:29], v11 offset:32768
  ds_read_b64_tr_b16 v[30:31], v11 offset:33792
  s_waitcnt vmcnt(11)
  s_waitcnt lgkmcnt(6)
  v_mfma_f32_16x16x32_bf16 v[80:83], v[16:19], v[36:39], v[80:83]
  s_waitcnt lgkmcnt(4)
  v_mfma_f32_16x16x32_bf16 v[84:87], v[20:23], v[36:39], v[84:87]
  s_waitcnt lgkmcnt(2)
  v_mfma_f32_16x16x32_bf16 v[88:91], v[24:27], v[36:39], v[88:91]
  s_waitcnt lgkmcnt(0)
  v_mfma_f32_16x16x32_bf16 v[92:95], v[28:31], v[36:39], v[92:95]
  buffer_load_dwordx4 v[36:39], v5, s[12:15], s35 offen
  s_waitcnt vmcnt(9)
  v_mfma_f32_16x16x32_bf16 v[96:99], v[16:19], v[40:43], v[96:99]
  v_mfma_f32_16x16x32_bf16 v[100:103], v[20:23], v[40:43], v[100:103]
  v_mfma_f32_16x16x32_bf16 v[104:107], v[24:27], v[40:43], v[104:107]
  v_mfma_f32_16x16x32_bf16 v[108:111], v[28:31], v[40:43], v[108:111]
  buffer_load_dwordx4 v[40:43], v6, s[12:15], s35 offen
  s_waitcnt vmcnt(16)
  s_barrier
  s_add_u32 m0, s34, 108544
  s_nop 0
  buffer_load_dwordx4 v1, s[20:23], s33 offen lds
  s_add_u32 s33, s33, 16384
  s_add_u32 m0, s34, 109568
  s_nop 0
  buffer_load_dwordx4 v1, s[20:23], s33 offen lds
  s_add_u32 s33, s33, 245760
  s_waitcnt vmcnt(11)
  v_mfma_f32_16x16x32_bf16 v[112:115], v[16:19], v[44:47], v[112:115]
  v_mfma_f32_16x16x32_bf16 v[116:119], v[20:23], v[44:47], v[116:119]
  v_mfma_f32_16x16x32_bf16 v[120:123], v[24:27], v[44:47], v[120:123]
  v_mfma_f32_16x16x32_bf16 v[124:127], v[28:31], v[44:47], v[124:127]
  buffer_load_dwordx4 v[44:47], v7, s[12:15], s35 offen
  s_waitcnt vmcnt(11)
  v_mfma_f32_16x16x32_bf16 v[64:67], v[16:19], v[32:35], v[64:67]
  v_mfma_f32_16x16x32_bf16 v[68:71], v[20:23], v[32:35], v[68:71]
  ds_read_b64_tr_b16 v[16:17], v8 offset:49152
  ds_read_b64_tr_b16 v[18:19], v8 offset:50176
  v_mfma_f32_16x16x32_bf16 v[72:75], v[24:27], v[32:35], v[72:75]
  ds_read_b64_tr_b16 v[20:21], v9 offset:49152
  ds_read_b64_tr_b16 v[22:23], v9 offset:50176
  v_mfma_f32_16x16x32_bf16 v[76:79], v[28:31], v[32:35], v[76:79]
  ds_read_b64_tr_b16 v[24:25], v10 offset:49152
  ds_read_b64_tr_b16 v[26:27], v10 offset:50176
  buffer_load_dwordx4 v[32:35], v4, s[12:15], s35 offen
  s_add_u32 s35, s35, 4096
  s_nop 3
  ds_read_b64_tr_b16 v[28:29], v11 offset:49152
  ds_read_b64_tr_b16 v[30:31], v11 offset:50176
  s_waitcnt vmcnt(11)
  s_waitcnt lgkmcnt(6)
  v_mfma_f32_16x16x32_bf16 v[80:83], v[16:19], v[52:55], v[80:83]
  s_waitcnt lgkmcnt(4)
  v_mfma_f32_16x16x32_bf16 v[84:87], v[20:23], v[52:55], v[84:87]
  s_waitcnt lgkmcnt(2)
  v_mfma_f32_16x16x32_bf16 v[88:91], v[24:27], v[52:55], v[88:91]
  s_waitcnt lgkmcnt(0)
  v_mfma_f32_16x16x32_bf16 v[92:95], v[28:31], v[52:55], v[92:95]
  buffer_load_dwordx4 v[52:55], v5, s[12:15], s35 offen
  s_waitcnt vmcnt(16)
  s_barrier
  s_add_u32 m0, s34, 124928
  s_nop 0
  buffer_load_dwordx4 v1, s[20:23], s33 offen lds
  s_add_u32 s33, s33, 16384
  s_add_u32 m0, s34, 125952
  s_nop 0
  buffer_load_dwordx4 v1, s[20:23], s33 offen lds
  s_add_u32 s33, s33, 245760
  s_waitcnt vmcnt(13)
  v_mfma_f32_16x16x32_bf16 v[96:99], v[16:19], v[56:59], v[96:99]
  v_mfma_f32_16x16x32_bf16 v[100:103], v[20:23], v[56:59], v[100:103]
  v_mfma_f32_16x16x32_bf16 v[104:107], v[24:27], v[56:59], v[104:107]
  v_mfma_f32_16x16x32_bf16 v[108:111], v[28:31], v[56:59], v[108:111]
  buffer_load_dwordx4 v[56:59], v6, s[12:15], s35 offen
  s_waitcnt vmcnt(13)
  v_mfma_f32_16x16x32_bf16 v[112:115], v[16:19], v[60:63], v[112:115]
  v_mfma_f32_16x16x32_bf16 v[116:119], v[20:23], v[60:63], v[116:119]
  v_mfma_f32_16x16x32_bf16 v[120:123], v[24:27], v[60:63], v[120:123]
  v_mfma_f32_16x16x32_bf16 v[124:127], v[28:31], v[60:63], v[124:127]
  buffer_load_dwordx4 v[60:63], v7, s[12:15], s35 offen
  s_waitcnt vmcnt(11)
  v_mfma_f32_16x16x32_bf16 v[64:67], v[16:19], v[48:51], v[64:67]
  v_mfma_f32_16x16x32_bf16 v[68:71], v[20:23], v[48:51], v[68:71]
  ds_read_b64_tr_b16 v[16:17], v8 offset:0
  ds_read_b64_tr_b16 v[18:19], v8 offset:1024
  v_mfma_f32_16x16x32_bf16 v[72:75], v[24:27], v[48:51], v[72:75]
  ds_read_b64_tr_b16 v[20:21], v9 offset:0
  ds_read_b64_tr_b16 v[22:23], v9 offset:1024
  v_mfma_f32_16x16x32_bf16 v[76:79], v[28:31], v[48:51], v[76:79]
  ds_read_b64_tr_b16 v[24:25], v10 offset:0
  ds_read_b64_tr_b16 v[26:27], v10 offset:1024
  buffer_load_dwordx4 v[48:51], v4, s[12:15], s35 offen
  s_add_u32 s35, s35, 4096
  s_nop 3
  ds_read_b64_tr_b16 v[28:29], v11 offset:0
  ds_read_b64_tr_b16 v[30:31], v11 offset:1024
  s_barrier
  s_waitcnt vmcnt(11)
  s_waitcnt lgkmcnt(6)
  v_mfma_f32_16x16x32_bf16 v[80:83], v[16:19], v[36:39], v[80:83]
  s_waitcnt lgkmcnt(4)
  v_mfma_f32_16x16x32_bf16 v[84:87], v[20:23], v[36:39], v[84:87]
  s_waitcnt lgkmcnt(2)
  v_mfma_f32_16x16x32_bf16 v[88:91], v[24:27], v[36:39], v[88:91]
  s_waitcnt lgkmcnt(0)
  v_mfma_f32_16x16x32_bf16 v[92:95], v[28:31], v[36:39], v[92:95]
  buffer_load_dwordx4 v[36:39], v5, s[12:15], s35 offen
  s_waitcnt vmcnt(11)
  v_mfma_f32_16x16x32_bf16 v[96:99], v[16:19], v[40:43], v[96:99]
  v_mfma_f32_16x16x32_bf16 v[100:103], v[20:23], v[40:43], v[100:103]
  v_mfma_f32_16x16x32_bf16 v[104:107], v[24:27], v[40:43], v[104:107]
  v_mfma_f32_16x16x32_bf16 v[108:111], v[28:31], v[40:43], v[108:111]
  buffer_load_dwordx4 v[40:43], v6, s[12:15], s35 offen
  s_waitcnt vmcnt(9)
  v_mfma_f32_16x16x32_bf16 v[112:115], v[16:19], v[44:47], v[112:115]
  v_mfma_f32_16x16x32_bf16 v[116:119], v[20:23], v[44:47], v[116:119]
  v_mfma_f32_16x16x32_bf16 v[120:123], v[24:27], v[44:47], v[120:123]
  v_mfma_f32_16x16x32_bf16 v[124:127], v[28:31], v[44:47], v[124:127]
  buffer_load_dwordx4 v[44:47], v7, s[12:15], s35 offen
  s_waitcnt vmcnt(16)
  s_barrier
  s_add_u32 m0, s34, 75776
  s_nop 0
  buffer_load_dwordx4 v1, s[20:23], s33 offen lds
  s_add_u32 s33, s33, 16384
  s_add_u32 m0, s34, 76800
  s_nop 0
  buffer_load_dwordx4 v1, s[20:23], s33 offen lds
  s_add_u32 s33, s33, 245760
  s_waitcnt vmcnt(11)
  v_mfma_f32_16x16x32_bf16 v[64:67], v[16:19], v[32:35], v[64:67]
  v_mfma_f32_16x16x32_bf16 v[68:71], v[20:23], v[32:35], v[68:71]
  ds_read_b64_tr_b16 v[16:17], v8 offset:16384
  ds_read_b64_tr_b16 v[18:19], v8 offset:17408
  v_mfma_f32_16x16x32_bf16 v[72:75], v[24:27], v[32:35], v[72:75]
  ds_read_b64_tr_b16 v[20:21], v9 offset:16384
  ds_read_b64_tr_b16 v[22:23], v9 offset:17408
  v_mfma_f32_16x16x32_bf16 v[76:79], v[28:31], v[32:35], v[76:79]
  ds_read_b64_tr_b16 v[24:25], v10 offset:16384
  ds_read_b64_tr_b16 v[26:27], v10 offset:17408
  buffer_load_dwordx4 v[32:35], v4, s[12:15], s35 offen
  s_add_u32 s35, s35, 4096
  s_nop 3
  ds_read_b64_tr_b16 v[28:29], v11 offset:16384
  ds_read_b64_tr_b16 v[30:31], v11 offset:17408
  s_waitcnt vmcnt(11)
  s_waitcnt lgkmcnt(6)
  v_mfma_f32_16x16x32_bf16 v[80:83], v[16:19], v[52:55], v[80:83]
  s_waitcnt lgkmcnt(4)
  v_mfma_f32_16x16x32_bf16 v[84:87], v[20:23], v[52:55], v[84:87]
  s_waitcnt lgkmcnt(2)
  v_mfma_f32_16x16x32_bf16 v[88:91], v[24:27], v[52:55], v[88:91]
  s_waitcnt lgkmcnt(0)
  v_mfma_f32_16x16x32_bf16 v[92:95], v[28:31], v[52:55], v[92:95]
  buffer_load_dwordx4 v[52:55], v5, s[12:15], s35 offen
  s_waitcnt vmcnt(9)
  v_mfma_f32_16x16x32_bf16 v[96:99], v[16:19], v[56:59], v[96:99]
  v_mfma_f32_16x16x32_bf16 v[100:103], v[20:23], v[56:59], v[100:103]
  v_mfma_f32_16x16x32_bf16 v[104:107], v[24:27], v[56:59], v[104:107]
  v_mfma_f32_16x16x32_bf16 v[108:111], v[28:31], v[56:59], v[108:111]
  buffer_load_dwordx4 v[56:59], v6, s[12:15], s35 offen
  s_waitcnt vmcnt(16)
  s_barrier
  s_add_u32 m0, s34, 92160
  s_nop 0
  buffer_load_dwordx4 v1, s[20:23], s33 offen lds
  s_add_u32 s33, s33, 16384
  s_add_u32 m0, s34, 93184
  s_nop 0
  buffer_load_dwordx4 v1, s[20:23], s33 offen lds
  s_add_u32 s33, s33, 245760
  s_waitcnt vmcnt(11)
  v_mfma_f32_16x16x32_bf16 v[112:115], v[16:19], v[60:63], v[112:115]
  v_mfma_f32_16x16x32_bf16 v[116:119], v[20:23], v[60:63], v[116:119]
  v_mfma_f32_16x16x32_bf16 v[120:123], v[24:27], v[60:63], v[120:123]
  v_mfma_f32_16x16x32_bf16 v[124:127], v[28:31], v[60:63], v[124:127]
  buffer_load_dwordx4 v[60:63], v7, s[12:15], s35 offen
  s_waitcnt vmcnt(11)
  v_mfma_f32_16x16x32_bf16 v[64:67], v[16:19], v[48:51], v[64:67]
  v_mfma_f32_16x16x32_bf16 v[68:71], v[20:23], v[48:51], v[68:71]
  ds_read_b64_tr_b16 v[16:17], v8 offset:32768
  ds_read_b64_tr_b16 v[18:19], v8 offset:33792
  v_mfma_f32_16x16x32_bf16 v[72:75], v[24:27], v[48:51], v[72:75]
  ds_read_b64_tr_b16 v[20:21], v9 offset:32768
  ds_read_b64_tr_b16 v[22:23], v9 offset:33792
  v_mfma_f32_16x16x32_bf16 v[76:79], v[28:31], v[48:51], v[76:79]
  ds_read_b64_tr_b16 v[24:25], v10 offset:32768
  ds_read_b64_tr_b16 v[26:27], v10 offset:33792
  buffer_load_dwordx4 v[48:51], v4, s[12:15], s35 offen
  s_add_u32 s35, s35, 4096
  s_nop 3
  ds_read_b64_tr_b16 v[28:29], v11 offset:32768
  ds_read_b64_tr_b16 v[30:31], v11 offset:33792
  s_waitcnt vmcnt(11)
  s_waitcnt lgkmcnt(6)
  v_mfma_f32_16x16x32_bf16 v[80:83], v[16:19], v[36:39], v[80:83]
  s_waitcnt lgkmcnt(4)
  v_mfma_f32_16x16x32_bf16 v[84:87], v[20:23], v[36:39], v[84:87]
  s_waitcnt lgkmcnt(2)
  v_mfma_f32_16x16x32_bf16 v[88:91], v[24:27], v[36:39], v[88:91]
  s_waitcnt lgkmcnt(0)
  v_mfma_f32_16x16x32_bf16 v[92:95], v[28:31], v[36:39], v[92:95]
  buffer_load_dwordx4 v[36:39], v5, s[12:15], s35 offen
  s_waitcnt vmcnt(16)
  s_barrier
  s_add_u32 m0, s34, 108544
  s_nop 0
  buffer_load_dwordx4 v1, s[20:23], s33 offen lds
  s_add_u32 s33, s33, 16384
  s_add_u32 m0, s34, 109568
  s_nop 0
  buffer_load_dwordx4 v1, s[20:23], s33 offen lds
  s_add_u32 s33, s33, 245760
  s_waitcnt vmcnt(13)
  v_mfma_f32_16x16x32_bf16 v[96:99], v[16:19], v[40:43], v[96:99]
  v_mfma_f32_16x16x32_bf16 v[100:103], v[20:23], v[40:43], v[100:103]
  v_mfma_f32_16x16x32_bf16 v[104:107], v[24:27], v[40:43], v[104:107]
  v_mfma_f32_16x16x32_bf16 v[108:111], v[28:31], v[40:43], v[108:111]
  buffer_load_dwordx4 v[40:43], v6, s[12:15], s35 offen
  s_waitcnt vmcnt(13)
  v_mfma_f32_16x16x32_bf16 v[112:115], v[16:19], v[44:47], v[112:115]
  v_mfma_f32_16x16x32_bf16 v[116:119], v[20:23], v[44:47], v[116:119]
  v_mfma_f32_16x16x32_bf16 v[120:123], v[24:27], v[44:47], v[120:123]
  v_mfma_f32_16x16x32_bf16 v[124:127], v[28:31], v[44:47], v[124:127]
  buffer_load_dwordx4 v[44:47], v7, s[12:15], s35 offen
  s_waitcnt vmcnt(11)
  v_mfma_f32_16x16x32_bf16 v[64:67], v[16:19], v[32:35], v[64:67]
  v_mfma_f32_16x16x32_bf16 v[68:71], v[20:23], v[32:35], v[68:71]
  ds_read_b64_tr_b16 v[16:17], v8 offset:49152
  ds_read_b64_tr_b16 v[18:19], v8 offset:50176
  v_mfma_f32_16x16x32_bf16 v[72:75], v[24:27], v[32:35], v[72:75]
  ds_read_b64_tr_b16 v[20:21], v9 offset:49152
  ds_read_b64_tr_b16 v[22:23], v9 offset:50176
  v_mfma_f32_16x16x32_bf16 v[76:79], v[28:31], v[32:35], v[76:79]
  ds_read_b64_tr_b16 v[24:25], v10 offset:49152
  ds_read_b64_tr_b16 v[26:27], v10 offset:50176
  buffer_load_dwordx4 v[32:35], v4, s[12:15], s35 offen
  s_add_u32 s35, s35, 4096
  s_nop 3
  ds_read_b64_tr_b16 v[28:29], v11 offset:49152
  ds_read_b64_tr_b16 v[30:31], v11 offset:50176
  s_barrier
  s_waitcnt vmcnt(11)
  s_waitcnt lgkmcnt(6)
  v_mfma_f32_16x16x32_bf16 v[80:83], v[16:19], v[52:55], v[80:83]
  s_waitcnt lgkmcnt(4)
  v_mfma_f32_16x16x32_bf16 v[84:87], v[20:23], v[52:55], v[84:87]
  s_waitcnt lgkmcnt(2)
  v_mfma_f32_16x16x32_bf16 v[88:91], v[24:27], v[52:55], v[88:91]
  s_waitcnt lgkmcnt(0)
  v_mfma_f32_16x16x32_bf16 v[92:95], v[28:31], v[52:55], v[92:95]
  buffer_load_dwordx4 v[52:55], v5, s[12:15], s35 offen
  s_waitcnt vmcnt(11)
  v_mfma_f32_16x16x32_bf16 v[96:99], v[16:19], v[56:59], v[96:99]
  v_mfma_f32_16x16x32_bf16 v[100:103], v[20:23], v[56:59], v[100:103]
  v_mfma_f32_16x16x32_bf16 v[104:107], v[24:27], v[56:59], v[104:107]
  v_mfma_f32_16x16x32_bf16 v[108:111], v[28:31], v[56:59], v[108:111]
  buffer_load_dwordx4 v[56:59], v6, s[12:15], s35 offen
  s_waitcnt vmcnt(9)
  v_mfma_f32_16x16x32_bf16 v[112:115], v[16:19], v[60:63], v[112:115]
  v_mfma_f32_16x16x32_bf16 v[116:119], v[20:23], v[60:63], v[116:119]
  v_mfma_f32_16x16x32_bf16 v[120:123], v[24:27], v[60:63], v[120:123]
  v_mfma_f32_16x16x32_bf16 v[124:127], v[28:31], v[60:63], v[124:127]
  buffer_load_dwordx4 v[60:63], v7, s[12:15], s35 offen
  s_waitcnt vmcnt(16)
  s_barrier
  s_add_u32 m0, s34, 124928
  s_nop 0
  buffer_load_dwordx4 v1, s[20:23], s33 offen lds
  s_add_u32 s33, s33, 16384
  s_add_u32 m0, s34, 125952
  s_nop 0
  buffer_load_dwordx4 v1, s[20:23], s33 offen lds
  s_add_u32 s33, s33, 245760
  s_waitcnt vmcnt(11)
  v_mfma_f32_16x16x32_bf16 v[64:67], v[16:19], v[48:51], v[64:67]
  v_mfma_f32_16x16x32_bf16 v[68:71], v[20:23], v[48:51], v[68:71]
  ds_read_b64_tr_b16 v[16:17], v8 offset:0
  ds_read_b64_tr_b16 v[18:19], v8 offset:1024
  v_mfma_f32_16x16x32_bf16 v[72:75], v[24:27], v[48:51], v[72:75]
  ds_read_b64_tr_b16 v[20:21], v9 offset:0
  ds_read_b64_tr_b16 v[22:23], v9 offset:1024
  v_mfma_f32_16x16x32_bf16 v[76:79], v[28:31], v[48:51], v[76:79]
  ds_read_b64_tr_b16 v[24:25], v10 offset:0
  ds_read_b64_tr_b16 v[26:27], v10 offset:1024
  buffer_load_dwordx4 v[48:51], v4, s[12:15], s35 offen
  s_add_u32 s35, s35, 4096
  s_nop 3
  ds_read_b64_tr_b16 v[28:29], v11 offset:0
  ds_read_b64_tr_b16 v[30:31], v11 offset:1024
  s_waitcnt vmcnt(11)
  s_waitcnt lgkmcnt(6)
  v_mfma_f32_16x16x32_bf16 v[80:83], v[16:19], v[36:39], v[80:83]
  s_waitcnt lgkmcnt(4)
  v_mfma_f32_16x16x32_bf16 v[84:87], v[20:23], v[36:39], v[84:87]
  s_waitcnt lgkmcnt(2)
  v_mfma_f32_16x16x32_bf16 v[88:91], v[24:27], v[36:39], v[88:91]
  s_waitcnt lgkmcnt(0)
  v_mfma_f32_16x16x32_bf16 v[92:95], v[28:31], v[36:39], v[92:95]
  buffer_load_dwordx4 v[36:39], v5, s[12:15], s35 offen
  s_waitcnt vmcnt(9)
  v_mfma_f32_16x16x32_bf16 v[96:99], v[16:19], v[40:43], v[96:99]
  v_mfma_f32_16x16x32_bf16 v[100:103], v[20:23], v[40:43], v[100:103]
  v_mfma_f32_16x16x32_bf16 v[104:107], v[24:27], v[40:43], v[104:107]
  v_mfma_f32_16x16x32_bf16 v[108:111], v[28:31], v[40:43], v[108:111]
  buffer_load_dwordx4 v[40:43], v6, s[12:15], s35 offen
  s_waitcnt vmcnt(16)
  s_barrier
  s_add_u32 m0, s34, 75776
  s_nop 0
  buffer_load_dwordx4 v1, s[20:23], s33 offen lds
  s_add_u32 s33, s33, 16384
  s_add_u32 m0, s34, 76800
  s_nop 0
  buffer_load_dwordx4 v1, s[20:23], s33 offen lds
  s_add_u32 s33, s33, 245760
  s_waitcnt vmcnt(11)
  v_mfma_f32_16x16x32_bf16 v[112:115], v[16:19], v[44:47], v[112:115]
  v_mfma_f32_16x16x32_bf16 v[116:119], v[20:23], v[44:47], v[116:119]
  v_mfma_f32_16x16x32_bf16 v[120:123], v[24:27], v[44:47], v[120:123]
  v_mfma_f32_16x16x32_bf16 v[124:127], v[28:31], v[44:47], v[124:127]
  buffer_load_dwordx4 v[44:47], v7, s[12:15], s35 offen
  s_waitcnt vmcnt(11)
  v_mfma_f32_16x16x32_bf16 v[64:67], v[16:19], v[32:35], v[64:67]
  v_mfma_f32_16x16x32_bf16 v[68:71], v[20:23], v[32:35], v[68:71]
  ds_read_b64_tr_b16 v[16:17], v8 offset:16384
  ds_read_b64_tr_b16 v[18:19], v8 offset:17408
  v_mfma_f32_16x16x32_bf16 v[72:75], v[24:27], v[32:35], v[72:75]
  ds_read_b64_tr_b16 v[20:21], v9 offset:16384
  ds_read_b64_tr_b16 v[22:23], v9 offset:17408
  v_mfma_f32_16x16x32_bf16 v[76:79], v[28:31], v[32:35], v[76:79]
  ds_read_b64_tr_b16 v[24:25], v10 offset:16384
  ds_read_b64_tr_b16 v[26:27], v10 offset:17408
  buffer_load_dwordx4 v[32:35], v4, s[12:15], s35 offen
  s_add_u32 s35, s35, 4096
  s_nop 3
  ds_read_b64_tr_b16 v[28:29], v11 offset:16384
  ds_read_b64_tr_b16 v[30:31], v11 offset:17408
  s_waitcnt vmcnt(11)
  s_waitcnt lgkmcnt(6)
  v_mfma_f32_16x16x32_bf16 v[80:83], v[16:19], v[52:55], v[80:83]
  s_waitcnt lgkmcnt(4)
  v_mfma_f32_16x16x32_bf16 v[84:87], v[20:23], v[52:55], v[84:87]
  s_waitcnt lgkmcnt(2)
  v_mfma_f32_16x16x32_bf16 v[88:91], v[24:27], v[52:55], v[88:91]
  s_waitcnt lgkmcnt(0)
  v_mfma_f32_16x16x32_bf16 v[92:95], v[28:31], v[52:55], v[92:95]
  buffer_load_dwordx4 v[52:55], v5, s[12:15], s35 offen
  s_waitcnt vmcnt(16)
  s_barrier
  s_add_u32 m0, s34, 92160
  s_nop 0
  buffer_load_dwordx4 v1, s[20:23], s33 offen lds
  s_add_u32 s33, s33, 16384
  s_add_u32 m0, s34, 93184
  s_nop 0
  buffer_load_dwordx4 v1, s[20:23], s33 offen lds
  s_add_u32 s33, s33, 245760
  s_waitcnt vmcnt(13)
  v_mfma_f32_16x16x32_bf16 v[96:99], v[16:19], v[56:59], v[96:99]
  v_mfma_f32_16x16x32_bf16 v[100:103], v[20:23], v[56:59], v[100:103]
  v_mfma_f32_16x16x32_bf16 v[104:107], v[24:27], v[56:59], v[104:107]
  v_mfma_f32_16x16x32_bf16 v[108:111], v[28:31], v[56:59], v[108:111]
  buffer_load_dwordx4 v[56:59], v6, s[12:15], s35 offen
  s_waitcnt vmcnt(13)
  v_mfma_f32_16x16x32_bf16 v[112:115], v[16:19], v[60:63], v[112:115]
  v_mfma_f32_16x16x32_bf16 v[116:119], v[20:23], v[60:63], v[116:119]
  v_mfma_f32_16x16x32_bf16 v[120:123], v[24:27], v[60:63], v[120:123]
  v_mfma_f32_16x16x32_bf16 v[124:127], v[28:31], v[60:63], v[124:127]
  buffer_load_dwordx4 v[60:63], v7, s[12:15], s35 offen
  s_waitcnt vmcnt(11)
  v_mfma_f32_16x16x32_bf16 v[64:67], v[16:19], v[48:51], v[64:67]
  v_mfma_f32_16x16x32_bf16 v[68:71], v[20:23], v[48:51], v[68:71]
  ds_read_b64_tr_b16 v[16:17], v8 offset:32768
  ds_read_b64_tr_b16 v[18:19], v8 offset:33792
  v_mfma_f32_16x16x32_bf16 v[72:75], v[24:27], v[48:51], v[72:75]
  ds_read_b64_tr_b16 v[20:21], v9 offset:32768
  ds_read_b64_tr_b16 v[22:23], v9 offset:33792
  v_mfma_f32_16x16x32_bf16 v[76:79], v[28:31], v[48:51], v[76:79]
  ds_read_b64_tr_b16 v[24:25], v10 offset:32768
  ds_read_b64_tr_b16 v[26:27], v10 offset:33792
  buffer_load_dwordx4 v[48:51], v4, s[12:15], s35 offen
  s_add_u32 s35, s35, 4096
  s_nop 3
  ds_read_b64_tr_b16 v[28:29], v11 offset:32768
  ds_read_b64_tr_b16 v[30:31], v11 offset:33792
  s_barrier
  s_waitcnt vmcnt(11)
  s_waitcnt lgkmcnt(6)
  v_mfma_f32_16x16x32_bf16 v[80:83], v[16:19], v[36:39], v[80:83]
  s_waitcnt lgkmcnt(4)
  v_mfma_f32_16x16x32_bf16 v[84:87], v[20:23], v[36:39], v[84:87]
  s_waitcnt lgkmcnt(2)
  v_mfma_f32_16x16x32_bf16 v[88:91], v[24:27], v[36:39], v[88:91]
  s_waitcnt lgkmcnt(0)
  v_mfma_f32_16x16x32_bf16 v[92:95], v[28:31], v[36:39], v[92:95]
  buffer_load_dwordx4 v[36:39], v5, s[12:15], s35 offen
  s_waitcnt vmcnt(11)
  v_mfma_f32_16x16x32_bf16 v[96:99], v[16:19], v[40:43], v[96:99]
  v_mfma_f32_16x16x32_bf16 v[100:103], v[20:23], v[40:43], v[100:103]
  v_mfma_f32_16x16x32_bf16 v[104:107], v[24:27], v[40:43], v[104:107]
  v_mfma_f32_16x16x32_bf16 v[108:111], v[28:31], v[40:43], v[108:111]
  buffer_load_dwordx4 v[40:43], v6, s[12:15], s35 offen
  s_waitcnt vmcnt(9)
  v_mfma_f32_16x16x32_bf16 v[112:115], v[16:19], v[44:47], v[112:115]
  v_mfma_f32_16x16x32_bf16 v[116:119], v[20:23], v[44:47], v[116:119]
  v_mfma_f32_16x16x32_bf16 v[120:123], v[24:27], v[44:47], v[120:123]
  v_mfma_f32_16x16x32_bf16 v[124:127], v[28:31], v[44:47], v[124:127]
  buffer_load_dwordx4 v[44:47], v7, s[12:15], s35 offen
  s_waitcnt vmcnt(16)
  s_barrier
  s_add_u32 m0, s34, 108544
  s_nop 0
  buffer_load_dwordx4 v1, s[20:23], s33 offen lds
  s_add_u32 s33, s33, 16384
  s_add_u32 m0, s34, 109568
  s_nop 0
  buffer_load_dwordx4 v1, s[20:23], s33 offen lds
  s_add_u32 s33, s33, 245760
  s_waitcnt vmcnt(11)
  v_mfma_f32_16x16x32_bf16 v[64:67], v[16:19], v[32:35], v[64:67]
  v_mfma_f32_16x16x32_bf16 v[68:71], v[20:23], v[32:35], v[68:71]
  ds_read_b64_tr_b16 v[16:17], v8 offset:49152
  ds_read_b64_tr_b16 v[18:19], v8 offset:50176
  v_mfma_f32_16x16x32_bf16 v[72:75], v[24:27], v[32:35], v[72:75]
  ds_read_b64_tr_b16 v[20:21], v9 offset:49152
  ds_read_b64_tr_b16 v[22:23], v9 offset:50176
  v_mfma_f32_16x16x32_bf16 v[76:79], v[28:31], v[32:35], v[76:79]
  ds_read_b64_tr_b16 v[24:25], v10 offset:49152
  ds_read_b64_tr_b16 v[26:27], v10 offset:50176
  buffer_load_dwordx4 v[32:35], v4, s[12:15], s35 offen
  s_add_u32 s35, s35, 4096
  s_nop 3
  ds_read_b64_tr_b16 v[28:29], v11 offset:49152
  ds_read_b64_tr_b16 v[30:31], v11 offset:50176
  s_waitcnt vmcnt(11)
  s_waitcnt lgkmcnt(6)
  v_mfma_f32_16x16x32_bf16 v[80:83], v[16:19], v[52:55], v[80:83]
  s_waitcnt lgkmcnt(4)
  v_mfma_f32_16x16x32_bf16 v[84:87], v[20:23], v[52:55], v[84:87]
  s_waitcnt lgkmcnt(2)
  v_mfma_f32_16x16x32_bf16 v[88:91], v[24:27], v[52:55], v[88:91]
  s_waitcnt lgkmcnt(0)
  v_mfma_f32_16x16x32_bf16 v[92:95], v[28:31], v[52:55], v[92:95]
  buffer_load_dwordx4 v[52:55], v5, s[12:15], s35 offen
  s_waitcnt vmcnt(9)
  v_mfma_f32_16x16x32_bf16 v[96:99], v[16:19], v[56:59], v[96:99]
  v_mfma_f32_16x16x32_bf16 v[100:103], v[20:23], v[56:59], v[100:103]
  v_mfma_f32_16x16x32_bf16 v[104:107], v[24:27], v[56:59], v[104:107]
  v_mfma_f32_16x16x32_bf16 v[108:111], v[28:31], v[56:59], v[108:111]
  buffer_load_dwordx4 v[56:59], v6, s[12:15], s35 offen
  s_waitcnt vmcnt(16)
  s_barrier
  s_add_u32 m0, s34, 124928
  s_nop 0
  buffer_load_dwordx4 v1, s[20:23], s33 offen lds
  s_add_u32 s33, s33, 16384
  s_add_u32 m0, s34, 125952
  s_nop 0
  buffer_load_dwordx4 v1, s[20:23], s33 offen lds
  s_add_u32 s33, s33, 245760
  s_waitcnt vmcnt(11)
  v_mfma_f32_16x16x32_bf16 v[112:115], v[16:19], v[60:63], v[112:115]
  v_mfma_f32_16x16x32_bf16 v[116:119], v[20:23], v[60:63], v[116:119]
  v_mfma_f32_16x16x32_bf16 v[120:123], v[24:27], v[60:63], v[120:123]
  v_mfma_f32_16x16x32_bf16 v[124:127], v[28:31], v[60:63], v[124:127]
  buffer_load_dwordx4 v[60:63], v7, s[12:15], s35 offen
  s_waitcnt vmcnt(11)
  v_mfma_f32_16x16x32_bf16 v[64:67], v[16:19], v[48:51], v[64:67]
  v_mfma_f32_16x16x32_bf16 v[68:71], v[20:23], v[48:51], v[68:71]
  ds_read_b64_tr_b16 v[16:17], v8 offset:0
  ds_read_b64_tr_b16 v[18:19], v8 offset:1024
  v_mfma_f32_16x16x32_bf16 v[72:75], v[24:27], v[48:51], v[72:75]
  ds_read_b64_tr_b16 v[20:21], v9 offset:0
  ds_read_b64_tr_b16 v[22:23], v9 offset:1024
  v_mfma_f32_16x16x32_bf16 v[76:79], v[28:31], v[48:51], v[76:79]
  ds_read_b64_tr_b16 v[24:25], v10 offset:0
  ds_read_b64_tr_b16 v[26:27], v10 offset:1024
  buffer_load_dwordx4 v[48:51], v4, s[12:15], s35 offen
  s_add_u32 s35, s35, 4096
  s_nop 3
  ds_read_b64_tr_b16 v[28:29], v11 offset:0
  ds_read_b64_tr_b16 v[30:31], v11 offset:1024
  s_waitcnt vmcnt(11)
  s_waitcnt lgkmcnt(6)
  v_mfma_f32_16x16x32_bf16 v[80:83], v[16:19], v[36:39], v[80:83]
  s_waitcnt lgkmcnt(4)
  v_mfma_f32_16x16x32_bf16 v[84:87], v[20:23], v[36:39], v[84:87]
  s_waitcnt lgkmcnt(2)
  v_mfma_f32_16x16x32_bf16 v[88:91], v[24:27], v[36:39], v[88:91]
  s_waitcnt lgkmcnt(0)
  v_mfma_f32_16x16x32_bf16 v[92:95], v[28:31], v[36:39], v[92:95]
  buffer_load_dwordx4 v[36:39], v5, s[12:15], s35 offen
  s_waitcnt vmcnt(16)
  s_barrier
  s_add_u32 m0, s34, 75776
  s_nop 0
  buffer_load_dwordx4 v1, s[20:23], s33 offen lds
  s_add_u32 s33, s33, 16384
  s_add_u32 m0, s34, 76800
  s_nop 0
  buffer_load_dwordx4 v1, s[20:23], s33 offen lds
  s_add_u32 s33, s33, 245760
  s_waitcnt vmcnt(13)
  v_mfma_f32_16x16x32_bf16 v[96:99], v[16:19], v[40:43], v[96:99]
  v_mfma_f32_16x16x32_bf16 v[100:103], v[20:23], v[40:43], v[100:103]
  v_mfma_f32_16x16x32_bf16 v[104:107], v[24:27], v[40:43], v[104:107]
  v_mfma_f32_16x16x32_bf16 v[108:111], v[28:31], v[40:43], v[108:111]
  buffer_load_dwordx4 v[40:43], v6, s[12:15], s35 offen
  s_waitcnt vmcnt(13)
  v_mfma_f32_16x16x32_bf16 v[112:115], v[16:19], v[44:47], v[112:115]
  v_mfma_f32_16x16x32_bf16 v[116:119], v[20:23], v[44:47], v[116:119]
  v_mfma_f32_16x16x32_bf16 v[120:123], v[24:27], v[44:47], v[120:123]
  v_mfma_f32_16x16x32_bf16 v[124:127], v[28:31], v[44:47], v[124:127]
  buffer_load_dwordx4 v[44:47], v7, s[12:15], s35 offen
  s_waitcnt vmcnt(11)
  v_mfma_f32_16x16x32_bf16 v[64:67], v[16:19], v[32:35], v[64:67]
  v_mfma_f32_16x16x32_bf16 v[68:71], v[20:23], v[32:35], v[68:71]
  ds_read_b64_tr_b16 v[16:17], v8 offset:16384
  ds_read_b64_tr_b16 v[18:19], v8 offset:17408
  v_mfma_f32_16x16x32_bf16 v[72:75], v[24:27], v[32:35], v[72:75]
  ds_read_b64_tr_b16 v[20:21], v9 offset:16384
  ds_read_b64_tr_b16 v[22:23], v9 offset:17408
  v_mfma_f32_16x16x32_bf16 v[76:79], v[28:31], v[32:35], v[76:79]
  ds_read_b64_tr_b16 v[24:25], v10 offset:16384
  ds_read_b64_tr_b16 v[26:27], v10 offset:17408
  buffer_load_dwordx4 v[32:35], v4, s[12:15], s35 offen
  s_add_u32 s35, s35, 4096
  s_nop 3
  ds_read_b64_tr_b16 v[28:29], v11 offset:16384
  ds_read_b64_tr_b16 v[30:31], v11 offset:17408
  s_barrier
  s_waitcnt vmcnt(11)
  s_waitcnt lgkmcnt(6)
  v_mfma_f32_16x16x32_bf16 v[80:83], v[16:19], v[52:55], v[80:83]
  s_waitcnt lgkmcnt(4)
  v_mfma_f32_16x16x32_bf16 v[84:87], v[20:23], v[52:55], v[84:87]
  s_waitcnt lgkmcnt(2)
  v_mfma_f32_16x16x32_bf16 v[88:91], v[24:27], v[52:55], v[88:91]
  s_waitcnt lgkmcnt(0)
  v_mfma_f32_16x16x32_bf16 v[92:95], v[28:31], v[52:55], v[92:95]
  buffer_load_dwordx4 v[52:55], v5, s[12:15], s35 offen
  s_waitcnt vmcnt(11)
  v_mfma_f32_16x16x32_bf16 v[96:99], v[16:19], v[56:59], v[96:99]
  v_mfma_f32_16x16x32_bf16 v[100:103], v[20:23], v[56:59], v[100:103]
  v_mfma_f32_16x16x32_bf16 v[104:107], v[24:27], v[56:59], v[104:107]
  v_mfma_f32_16x16x32_bf16 v[108:111], v[28:31], v[56:59], v[108:111]
  buffer_load_dwordx4 v[56:59], v6, s[12:15], s35 offen
  s_waitcnt vmcnt(9)
  v_mfma_f32_16x16x32_bf16 v[112:115], v[16:19], v[60:63], v[112:115]
  v_mfma_f32_16x16x32_bf16 v[116:119], v[20:23], v[60:63], v[116:119]
  v_mfma_f32_16x16x32_bf16 v[120:123], v[24:27], v[60:63], v[120:123]
  v_mfma_f32_16x16x32_bf16 v[124:127], v[28:31], v[60:63], v[124:127]
  buffer_load_dwordx4 v[60:63], v7, s[12:15], s35 offen
  s_waitcnt vmcnt(16)
  s_barrier
  s_add_u32 m0, s34, 92160
  s_nop 0
  buffer_load_dwordx4 v1, s[20:23], s33 offen lds
  s_add_u32 s33, s33, 16384
  s_add_u32 m0, s34, 93184
  s_nop 0
  buffer_load_dwordx4 v1, s[20:23], s33 offen lds
  s_add_u32 s33, s33, 245760
  s_waitcnt vmcnt(11)
  v_mfma_f32_16x16x32_bf16 v[64:67], v[16:19], v[48:51], v[64:67]
  v_mfma_f32_16x16x32_bf16 v[68:71], v[20:23], v[48:51], v[68:71]
  ds_read_b64_tr_b16 v[16:17], v8 offset:32768
  ds_read_b64_tr_b16 v[18:19], v8 offset:33792
  v_mfma_f32_16x16x32_bf16 v[72:75], v[24:27], v[48:51], v[72:75]
  ds_read_b64_tr_b16 v[20:21], v9 offset:32768
  ds_read_b64_tr_b16 v[22:23], v9 offset:33792
  v_mfma_f32_16x16x32_bf16 v[76:79], v[28:31], v[48:51], v[76:79]
  ds_read_b64_tr_b16 v[24:25], v10 offset:32768
  ds_read_b64_tr_b16 v[26:27], v10 offset:33792
  buffer_load_dwordx4 v[48:51], v4, s[12:15], s35 offen
  s_add_u32 s35, s35, 4096
  s_nop 3
  ds_read_b64_tr_b16 v[28:29], v11 offset:32768
  ds_read_b64_tr_b16 v[30:31], v11 offset:33792
  s_waitcnt vmcnt(11)
  s_waitcnt lgkmcnt(6)
  v_mfma_f32_16x16x32_bf16 v[80:83], v[16:19], v[36:39], v[80:83]
  s_waitcnt lgkmcnt(4)
  v_mfma_f32_16x16x32_bf16 v[84:87], v[20:23], v[36:39], v[84:87]
  s_waitcnt lgkmcnt(2)
  v_mfma_f32_16x16x32_bf16 v[88:91], v[24:27], v[36:39], v[88:91]
  s_waitcnt lgkmcnt(0)
  v_mfma_f32_16x16x32_bf16 v[92:95], v[28:31], v[36:39], v[92:95]
  buffer_load_dwordx4 v[36:39], v5, s[12:15], s35 offen
  s_waitcnt vmcnt(9)
  v_mfma_f32_16x16x32_bf16 v[96:99], v[16:19], v[40:43], v[96:99]
  v_mfma_f32_16x16x32_bf16 v[100:103], v[20:23], v[40:43], v[100:103]
  v_mfma_f32_16x16x32_bf16 v[104:107], v[24:27], v[40:43], v[104:107]
  v_mfma_f32_16x16x32_bf16 v[108:111], v[28:31], v[40:43], v[108:111]
  buffer_load_dwordx4 v[40:43], v6, s[12:15], s35 offen
  s_waitcnt vmcnt(16)
  s_barrier
  s_add_u32 m0, s34, 108544
  s_nop 0
  buffer_load_dwordx4 v1, s[20:23], s33 offen lds
  s_add_u32 s33, s33, 16384
  s_add_u32 m0, s34, 109568
  s_nop 0
  buffer_load_dwordx4 v1, s[20:23], s33 offen lds
  s_add_u32 s33, s33, 245760
  v_and_b32 v2, 31, v0
  v_lshlrev_b32 v2, 2, v2
  s_waitcnt vmcnt(11)
  v_mfma_f32_16x16x32_bf16 v[112:115], v[16:19], v[44:47], v[112:115]
  v_mfma_f32_16x16x32_bf16 v[116:119], v[20:23], v[44:47], v[116:119]
  v_mfma_f32_16x16x32_bf16 v[120:123], v[24:27], v[44:47], v[120:123]
  v_mfma_f32_16x16x32_bf16 v[124:127], v[28:31], v[44:47], v[124:127]
  buffer_load_dwordx4 v[44:47], v7, s[12:15], s35 offen
  s_waitcnt vmcnt(11)
  v_mfma_f32_16x16x32_bf16 v[64:67], v[16:19], v[32:35], v[64:67]
  v_mfma_f32_16x16x32_bf16 v[68:71], v[20:23], v[32:35], v[68:71]
  ds_read_b64_tr_b16 v[16:17], v8 offset:49152
  ds_read_b64_tr_b16 v[18:19], v8 offset:50176
  v_mfma_f32_16x16x32_bf16 v[72:75], v[24:27], v[32:35], v[72:75]
  ds_read_b64_tr_b16 v[20:21], v9 offset:49152
  ds_read_b64_tr_b16 v[22:23], v9 offset:50176
  v_mfma_f32_16x16x32_bf16 v[76:79], v[28:31], v[32:35], v[76:79]
  ds_read_b64_tr_b16 v[24:25], v10 offset:49152
  ds_read_b64_tr_b16 v[26:27], v10 offset:50176
  buffer_load_dwordx4 v[32:35], v4, s[12:15], s35 offen
  s_add_u32 s35, s35, 4096
  s_nop 3
  ds_read_b64_tr_b16 v[28:29], v11 offset:49152
  ds_read_b64_tr_b16 v[30:31], v11 offset:50176
  s_waitcnt vmcnt(11)
  s_waitcnt lgkmcnt(6)
  v_mfma_f32_16x16x32_bf16 v[80:83], v[16:19], v[52:55], v[80:83]
  s_waitcnt lgkmcnt(4)
  v_mfma_f32_16x16x32_bf16 v[84:87], v[20:23], v[52:55], v[84:87]
  s_waitcnt lgkmcnt(2)
  v_mfma_f32_16x16x32_bf16 v[88:91], v[24:27], v[52:55], v[88:91]
  s_waitcnt lgkmcnt(0)
  v_mfma_f32_16x16x32_bf16 v[92:95], v[28:31], v[52:55], v[92:95]
  buffer_load_dwordx4 v[52:55], v5, s[12:15], s35 offen
  s_waitcnt vmcnt(11)
  v_mfma_f32_16x16x32_bf16 v[96:99], v[16:19], v[56:59], v[96:99]
  v_mfma_f32_16x16x32_bf16 v[100:103], v[20:23], v[56:59], v[100:103]
  v_mfma_f32_16x16x32_bf16 v[104:107], v[24:27], v[56:59], v[104:107]
  v_mfma_f32_16x16x32_bf16 v[108:111], v[28:31], v[56:59], v[108:111]
  buffer_load_dwordx4 v[56:59], v6, s[12:15], s35 offen
  s_waitcnt vmcnt(17)
  s_barrier
  s_add_u32 m0, s34, 124928
  s_nop 0
  buffer_load_dwordx4 v1, s[20:23], s33 offen lds
  s_add_u32 s33, s33, 16384
  s_add_u32 m0, s34, 125952
  s_nop 0
  buffer_load_dwordx4 v1, s[20:23], s33 offen lds
  s_add_u32 s33, s33, 245760
  s_waitcnt vmcnt(13)
  v_mfma_f32_16x16x32_bf16 v[112:115], v[16:19], v[60:63], v[112:115]
  v_mfma_f32_16x16x32_bf16 v[116:119], v[20:23], v[60:63], v[116:119]
  v_mfma_f32_16x16x32_bf16 v[120:123], v[24:27], v[60:63], v[120:123]
  v_mfma_f32_16x16x32_bf16 v[124:127], v[28:31], v[60:63], v[124:127]
  buffer_load_dwordx4 v[60:63], v7, s[12:15], s35 offen
  s_waitcnt vmcnt(11)
  v_mfma_f32_16x16x32_bf16 v[64:67], v[16:19], v[48:51], v[64:67]
  v_mfma_f32_16x16x32_bf16 v[68:71], v[20:23], v[48:51], v[68:71]
  ds_read_b64_tr_b16 v[16:17], v8 offset:0
  ds_read_b64_tr_b16 v[18:19], v8 offset:1024
  v_mfma_f32_16x16x32_bf16 v[72:75], v[24:27], v[48:51], v[72:75]
  ds_read_b64_tr_b16 v[20:21], v9 offset:0
  ds_read_b64_tr_b16 v[22:23], v9 offset:1024
  v_mfma_f32_16x16x32_bf16 v[76:79], v[28:31], v[48:51], v[76:79]
  ds_read_b64_tr_b16 v[24:25], v10 offset:0
  ds_read_b64_tr_b16 v[26:27], v10 offset:1024
  buffer_load_dwordx4 v[48:51], v4, s[12:15], s35 offen
  s_add_u32 s35, s35, 4096
  s_nop 3
  ds_read_b64_tr_b16 v[28:29], v11 offset:0
  ds_read_b64_tr_b16 v[30:31], v11 offset:1024
  s_waitcnt vmcnt(11)
  s_waitcnt lgkmcnt(6)
  v_mfma_f32_16x16x32_bf16 v[80:83], v[16:19], v[36:39], v[80:83]
  s_waitcnt lgkmcnt(4)
  v_mfma_f32_16x16x32_bf16 v[84:87], v[20:23], v[36:39], v[84:87]
  s_waitcnt lgkmcnt(2)
  v_mfma_f32_16x16x32_bf16 v[88:91], v[24:27], v[36:39], v[88:91]
  s_waitcnt lgkmcnt(0)
  v_mfma_f32_16x16x32_bf16 v[92:95], v[28:31], v[36:39], v[92:95]
  buffer_load_dwordx4 v[36:39], v5, s[12:15], s35 offen
  s_waitcnt vmcnt(11)
  v_mfma_f32_16x16x32_bf16 v[96:99], v[16:19], v[40:43], v[96:99]
  v_mfma_f32_16x16x32_bf16 v[100:103], v[20:23], v[40:43], v[100:103]
  v_mfma_f32_16x16x32_bf16 v[104:107], v[24:27], v[40:43], v[104:107]
  v_mfma_f32_16x16x32_bf16 v[108:111], v[28:31], v[40:43], v[108:111]
  buffer_load_dwordx4 v[40:43], v6, s[12:15], s35 offen
  s_barrier
  v_mov_b32 v3, 73728
  ds_read_b32 v3, v3
  s_waitcnt lgkmcnt(0)
  v_readfirstlane_b32 s48, v3
  s_cmp_eq_u32 s48, 0
  s_cbranch_scc1 fused_kernel_gok
  s_mov_b32 s40, 69
  fused_kernel_gbar:
  s_barrier
  s_sub_u32 s40, s40, 1
  s_cmp_lg_u32 s40, 0
  s_cbranch_scc1 fused_kernel_gbar
  fused_kernel_gok:

  s_mov_b32 s33, s36
  s_add_u32 m0, s34, 75776
  s_nop 0
  buffer_load_dwordx4 v1, s[16:19], s33 offen lds
  s_add_u32 s33, s33, 16384
  s_add_u32 m0, s34, 76800
  s_nop 0
  buffer_load_dwordx4 v1, s[16:19], s33 offen lds
  s_add_u32 s33, s33, 245760
  s_add_u32 m0, s34, 0
  s_nop 0
  buffer_load_dwordx4 v1, s[16:19], s38 offen lds
  s_add_u32 s38, s38, 16384
  s_add_u32 m0, s34, 1024
  s_nop 0
  buffer_load_dwordx4 v1, s[16:19], s38 offen lds
  s_add_u32 s38, s38, 245760
  s_add_u32 m0, s34, 16384
  s_nop 0
  buffer_load_dwordx4 v1, s[16:19], s38 offen lds
  s_add_u32 s38, s38, 16384
  s_add_u32 m0, s34, 17408
  s_nop 0
  buffer_load_dwordx4 v1, s[16:19], s38 offen lds
  s_add_u32 s38, s38, 245760
  s_add_u32 m0, s34, 32768
  s_nop 0
  buffer_load_dwordx4 v1, s[16:19], s38 offen lds
  s_add_u32 s38, s38, 16384
  s_add_u32 m0, s34, 33792
  s_nop 0
  buffer_load_dwordx4 v1, s[16:19], s38 offen lds
  s_add_u32 s38, s38, 245760
  s_add_u32 m0, s34, 49152
  s_nop 0
  buffer_load_dwordx4 v1, s[16:19], s38 offen lds
  s_add_u32 s38, s38, 16384
  s_add_u32 m0, s34, 50176
  s_nop 0
  buffer_load_dwordx4 v1, s[16:19], s38 offen lds
  s_add_u32 s38, s38, 245760
  s_waitcnt vmcnt(19)
  v_mfma_f32_16x16x32_bf16 v[112:115], v[16:19], v[44:47], v[112:115]
  v_mfma_f32_16x16x32_bf16 v[116:119], v[20:23], v[44:47], v[116:119]
  v_mfma_f32_16x16x32_bf16 v[120:123], v[24:27], v[44:47], v[120:123]
  v_mfma_f32_16x16x32_bf16 v[124:127], v[28:31], v[44:47], v[124:127]
  buffer_load_dwordx4 v[44:47], v7, s[12:15], s35 offen
  s_waitcnt vmcnt(26)
  s_barrier
  s_waitcnt vmcnt(19)
  v_mfma_f32_16x16x32_bf16 v[64:67], v[16:19], v[32:35], v[64:67]
  v_mfma_f32_16x16x32_bf16 v[68:71], v[20:23], v[32:35], v[68:71]
  ds_read_b64_tr_b16 v[16:17], v8 offset:16384
  ds_read_b64_tr_b16 v[18:19], v8 offset:17408
  v_mfma_f32_16x16x32_bf16 v[72:75], v[24:27], v[32:35], v[72:75]
  ds_read_b64_tr_b16 v[20:21], v9 offset:16384
  ds_read_b64_tr_b16 v[22:23], v9 offset:17408
  v_mfma_f32_16x16x32_bf16 v[76:79], v[28:31], v[32:35], v[76:79]
  ds_read_b64_tr_b16 v[24:25], v10 offset:16384
  ds_read_b64_tr_b16 v[26:27], v10 offset:17408
  buffer_load_dwordx4 v[32:35], v4, s[12:15], s35 offen
  s_add_u32 s35, s35, 4096
  s_nop 3
  ds_read_b64_tr_b16 v[28:29], v11 offset:16384
  ds_read_b64_tr_b16 v[30:31], v11 offset:17408
  buffer_load_dword v3, v2, s[12:15], s47 offen sc1
  s_waitcnt vmcnt(20)
  s_waitcnt lgkmcnt(6)
  v_mfma_f32_16x16x32_bf16 v[80:83], v[16:19], v[52:55], v[80:83]
  s_waitcnt lgkmcnt(4)
  v_mfma_f32_16x16x32_bf16 v[84:87], v[20:23], v[52:55], v[84:87]
  s_waitcnt lgkmcnt(2)
  v_mfma_f32_16x16x32_bf16 v[88:91], v[24:27], v[52:55], v[88:91]
  s_waitcnt lgkmcnt(0)
  v_mfma_f32_16x16x32_bf16 v[92:95], v[28:31], v[52:55], v[92:95]
  buffer_load_dwordx4 v[52:55], v5, s[12:15], s35 offen
  s_waitcnt vmcnt(20)
  v_mfma_f32_16x16x32_bf16 v[96:99], v[16:19], v[56:59], v[96:99]
  v_mfma_f32_16x16x32_bf16 v[100:103], v[20:23], v[56:59], v[100:103]
  v_mfma_f32_16x16x32_bf16 v[104:107], v[24:27], v[56:59], v[104:107]
  v_mfma_f32_16x16x32_bf16 v[108:111], v[28:31], v[56:59], v[108:111]
  buffer_load_dwordx4 v[56:59], v6, s[12:15], s35 offen
  s_waitcnt vmcnt(18)
  v_mfma_f32_16x16x32_bf16 v[112:115], v[16:19], v[60:63], v[112:115]
  v_mfma_f32_16x16x32_bf16 v[116:119], v[20:23], v[60:63], v[116:119]
  v_mfma_f32_16x16x32_bf16 v[120:123], v[24:27], v[60:63], v[120:123]
  v_mfma_f32_16x16x32_bf16 v[124:127], v[28:31], v[60:63], v[124:127]
  buffer_load_dwordx4 v[60:63], v7, s[12:15], s35 offen
  s_waitcnt vmcnt(26)
  s_barrier
  s_add_u32 m0, s34, 92160
  s_nop 0
  buffer_load_dwordx4 v1, s[16:19], s33 offen lds
  s_add_u32 s33, s33, 16384
  s_add_u32 m0, s34, 93184
  s_nop 0
  buffer_load_dwordx4 v1, s[16:19], s33 offen lds
  s_add_u32 s33, s33, 245760
  s_waitcnt vmcnt(20)
  v_mfma_f32_16x16x32_bf16 v[64:67], v[16:19], v[48:51], v[64:67]
  v_mfma_f32_16x16x32_bf16 v[68:71], v[20:23], v[48:51], v[68:71]
  ds_read_b64_tr_b16 v[16:17], v8 offset:32768
  ds_read_b64_tr_b16 v[18:19], v8 offset:33792
  v_mfma_f32_16x16x32_bf16 v[72:75], v[24:27], v[48:51], v[72:75]
  ds_read_b64_tr_b16 v[20:21], v9 offset:32768
  ds_read_b64_tr_b16 v[22:23], v9 offset:33792
  v_mfma_f32_16x16x32_bf16 v[76:79], v[28:31], v[48:51], v[76:79]
  ds_read_b64_tr_b16 v[24:25], v10 offset:32768
  ds_read_b64_tr_b16 v[26:27], v10 offset:33792
  buffer_load_dwordx4 v[48:51], v4, s[12:15], s35 offen
  s_add_u32 s35, s35, 4096
  s_nop 3
  ds_read_b64_tr_b16 v[28:29], v11 offset:32768
  ds_read_b64_tr_b16 v[30:31], v11 offset:33792
  s_mov_b32 s40, 0x200000
  s_waitcnt vmcnt(6)
  fused_kernel_poll:
  v_cmp_eq_u32 vcc, 1, v3
  s_cmp_eq_u64 vcc, -1
  s_cbranch_scc1 fused_kernel_go
  buffer_load_dword v3, v2, s[12:15], s47 offen sc1
  s_sub_u32 s40, s40, 1
  s_cmp_lg_u32 s40, 0
  s_waitcnt vmcnt(0)
  s_cbranch_scc1 fused_kernel_poll
  fused_kernel_go:

  s_waitcnt vmcnt(20)
  s_waitcnt lgkmcnt(6)
  v_mfma_f32_16x16x32_bf16 v[80:83], v[16:19], v[36:39], v[80:83]
  s_waitcnt lgkmcnt(4)
  v_mfma_f32_16x16x32_bf16 v[84:87], v[20:23], v[36:39], v[84:87]
  s_waitcnt lgkmcnt(2)
  v_mfma_f32_16x16x32_bf16 v[88:91], v[24:27], v[36:39], v[88:91]
  s_waitcnt lgkmcnt(0)
  v_mfma_f32_16x16x32_bf16 v[92:95], v[28:31], v[36:39], v[92:95]
  s_mov_b32 s35, s37
  buffer_load_dwordx4 v[36:39], v5, s[12:15], s35 offen sc1
  s_waitcnt vmcnt(20)
  v_mfma_f32_16x16x32_bf16 v[96:99], v[16:19], v[40:43], v[96:99]
  v_mfma_f32_16x16x32_bf16 v[100:103], v[20:23], v[40:43], v[100:103]
  v_mfma_f32_16x16x32_bf16 v[104:107], v[24:27], v[40:43], v[104:107]
  v_mfma_f32_16x16x32_bf16 v[108:111], v[28:31], v[40:43], v[108:111]
  buffer_load_dwordx4 v[40:43], v6, s[12:15], s35 offen sc1
  s_waitcnt vmcnt(10)
  v_mfma_f32_16x16x32_bf16 v[112:115], v[16:19], v[44:47], v[112:115]
  v_mfma_f32_16x16x32_bf16 v[116:119], v[20:23], v[44:47], v[116:119]
  v_mfma_f32_16x16x32_bf16 v[120:123], v[24:27], v[44:47], v[120:123]
  v_mfma_f32_16x16x32_bf16 v[124:127], v[28:31], v[44:47], v[124:127]
  buffer_load_dwordx4 v[44:47], v7, s[12:15], s35 offen sc1
  s_waitcnt vmcnt(26)
  s_barrier
  s_add_u32 m0, s34, 108544
  s_nop 0
  buffer_load_dwordx4 v1, s[16:19], s33 offen lds
  s_add_u32 s33, s33, 16384
  s_add_u32 m0, s34, 109568
  s_nop 0
  buffer_load_dwordx4 v1, s[16:19], s33 offen lds
  s_add_u32 s33, s33, 245760
  s_waitcnt vmcnt(12)
  v_mfma_f32_16x16x32_bf16 v[64:67], v[16:19], v[32:35], v[64:67]
  v_mfma_f32_16x16x32_bf16 v[68:71], v[20:23], v[32:35], v[68:71]
  ds_read_b64_tr_b16 v[16:17], v8 offset:49152
  ds_read_b64_tr_b16 v[18:19], v8 offset:50176
  v_mfma_f32_16x16x32_bf16 v[72:75], v[24:27], v[32:35], v[72:75]
  ds_read_b64_tr_b16 v[20:21], v9 offset:49152
  ds_read_b64_tr_b16 v[22:23], v9 offset:50176
  v_mfma_f32_16x16x32_bf16 v[76:79], v[28:31], v[32:35], v[76:79]
  ds_read_b64_tr_b16 v[24:25], v10 offset:49152
  ds_read_b64_tr_b16 v[26:27], v10 offset:50176
  buffer_load_dwordx4 v[32:35], v4, s[12:15], s35 offen sc1
  s_add_u32 s35, s35, 4096
  s_nop 3
  ds_read_b64_tr_b16 v[28:29], v11 offset:49152
  ds_read_b64_tr_b16 v[30:31], v11 offset:50176
  s_waitcnt vmcnt(11)
  s_waitcnt lgkmcnt(6)
  v_mfma_f32_16x16x32_bf16 v[80:83], v[16:19], v[52:55], v[80:83]
  s_waitcnt lgkmcnt(4)
  v_mfma_f32_16x16x32_bf16 v[84:87], v[20:23], v[52:55], v[84:87]
  s_waitcnt lgkmcnt(2)
  v_mfma_f32_16x16x32_bf16 v[88:91], v[24:27], v[52:55], v[88:91]
  s_waitcnt lgkmcnt(0)
  v_mfma_f32_16x16x32_bf16 v[92:95], v[28:31], v[52:55], v[92:95]
  buffer_load_dwordx4 v[52:55], v5, s[12:15], s35 offen sc1
  s_waitcnt vmcnt(11)
  v_mfma_f32_16x16x32_bf16 v[96:99], v[16:19], v[56:59], v[96:99]
  v_mfma_f32_16x16x32_bf16 v[100:103], v[20:23], v[56:59], v[100:103]
  v_mfma_f32_16x16x32_bf16 v[104:107], v[24:27], v[56:59], v[104:107]
  v_mfma_f32_16x16x32_bf16 v[108:111], v[28:31], v[56:59], v[108:111]
  buffer_load_dwordx4 v[56:59], v6, s[12:15], s35 offen sc1
  s_waitcnt vmcnt(11)
  v_mfma_f32_16x16x32_bf16 v[112:115], v[16:19], v[60:63], v[112:115]
  v_mfma_f32_16x16x32_bf16 v[116:119], v[20:23], v[60:63], v[116:119]
  v_mfma_f32_16x16x32_bf16 v[120:123], v[24:27], v[60:63], v[120:123]
  v_mfma_f32_16x16x32_bf16 v[124:127], v[28:31], v[60:63], v[124:127]
  buffer_load_dwordx4 v[60:63], v7, s[12:15], s35 offen sc1
  s_waitcnt vmcnt(26)
  s_barrier
  s_add_u32 m0, s34, 124928
  s_nop 0
  buffer_load_dwordx4 v1, s[16:19], s33 offen lds
  s_add_u32 s33, s33, 16384
  s_add_u32 m0, s34, 125952
  s_nop 0
  buffer_load_dwordx4 v1, s[16:19], s33 offen lds
  s_add_u32 s33, s33, 245760
  s_waitcnt vmcnt(11)
  v_mfma_f32_16x16x32_bf16 v[64:67], v[16:19], v[48:51], v[64:67]
  v_mfma_f32_16x16x32_bf16 v[68:71], v[20:23], v[48:51], v[68:71]
  ds_read_b64_tr_b16 v[16:17], v8 offset:0
  ds_read_b64_tr_b16 v[18:19], v8 offset:1024
  v_mfma_f32_16x16x32_bf16 v[72:75], v[24:27], v[48:51], v[72:75]
  ds_read_b64_tr_b16 v[20:21], v9 offset:0
  ds_read_b64_tr_b16 v[22:23], v9 offset:1024
  v_mfma_f32_16x16x32_bf16 v[76:79], v[28:31], v[48:51], v[76:79]
  ds_read_b64_tr_b16 v[24:25], v10 offset:0
  ds_read_b64_tr_b16 v[26:27], v10 offset:1024
  buffer_load_dwordx4 v[48:51], v4, s[12:15], s35 offen sc1
  s_add_u32 s35, s35, 4096
  s_nop 3
  ds_read_b64_tr_b16 v[28:29], v11 offset:0
  ds_read_b64_tr_b16 v[30:31], v11 offset:1024
  s_waitcnt vmcnt(11)
  s_waitcnt lgkmcnt(6)
  v_mfma_f32_16x16x32_bf16 v[80:83], v[16:19], v[36:39], v[80:83]
  s_waitcnt lgkmcnt(4)
  v_mfma_f32_16x16x32_bf16 v[84:87], v[20:23], v[36:39], v[84:87]
  s_waitcnt lgkmcnt(2)
  v_mfma_f32_16x16x32_bf16 v[88:91], v[24:27], v[36:39], v[88:91]
  s_waitcnt lgkmcnt(0)
  v_mfma_f32_16x16x32_bf16 v[92:95], v[28:31], v[36:39], v[92:95]
  buffer_load_dwordx4 v[36:39], v5, s[12:15], s35 offen sc1
  s_waitcnt vmcnt(11)
  v_mfma_f32_16x16x32_bf16 v[96:99], v[16:19], v[40:43], v[96:99]
  v_mfma_f32_16x16x32_bf16 v[100:103], v[20:23], v[40:43], v[100:103]
  v_mfma_f32_16x16x32_bf16 v[104:107], v[24:27], v[40:43], v[104:107]
  v_mfma_f32_16x16x32_bf16 v[108:111], v[28:31], v[40:43], v[108:111]
  buffer_load_dwordx4 v[40:43], v6, s[12:15], s35 offen sc1
  s_waitcnt vmcnt(11)
  v_mfma_f32_16x16x32_bf16 v[112:115], v[16:19], v[44:47], v[112:115]
  v_mfma_f32_16x16x32_bf16 v[116:119], v[20:23], v[44:47], v[116:119]
  v_mfma_f32_16x16x32_bf16 v[120:123], v[24:27], v[44:47], v[120:123]
  v_mfma_f32_16x16x32_bf16 v[124:127], v[28:31], v[44:47], v[124:127]
  buffer_load_dwordx4 v[44:47], v7, s[12:15], s35 offen sc1
  s_waitcnt vmcnt(16)
  s_barrier
  s_waitcnt vmcnt(9)
  v_mfma_f32_16x16x32_bf16 v[64:67], v[16:19], v[32:35], v[64:67]
  v_mfma_f32_16x16x32_bf16 v[68:71], v[20:23], v[32:35], v[68:71]
  ds_read_b64_tr_b16 v[16:17], v8 offset:16384
  ds_read_b64_tr_b16 v[18:19], v8 offset:17408
  v_mfma_f32_16x16x32_bf16 v[72:75], v[24:27], v[32:35], v[72:75]
  ds_read_b64_tr_b16 v[20:21], v9 offset:16384
  ds_read_b64_tr_b16 v[22:23], v9 offset:17408
  v_mfma_f32_16x16x32_bf16 v[76:79], v[28:31], v[32:35], v[76:79]
  ds_read_b64_tr_b16 v[24:25], v10 offset:16384
  ds_read_b64_tr_b16 v[26:27], v10 offset:17408
  buffer_load_dwordx4 v[32:35], v4, s[12:15], s35 offen sc1
  s_add_u32 s35, s35, 4096
  s_nop 3
  ds_read_b64_tr_b16 v[28:29], v11 offset:16384
  ds_read_b64_tr_b16 v[30:31], v11 offset:17408
  s_waitcnt vmcnt(9)
  s_waitcnt lgkmcnt(6)
  v_mfma_f32_16x16x32_bf16 v[80:83], v[16:19], v[52:55], v[80:83]
  s_waitcnt lgkmcnt(4)
  v_mfma_f32_16x16x32_bf16 v[84:87], v[20:23], v[52:55], v[84:87]
  s_waitcnt lgkmcnt(2)
  v_mfma_f32_16x16x32_bf16 v[88:91], v[24:27], v[52:55], v[88:91]
  s_waitcnt lgkmcnt(0)
  v_mfma_f32_16x16x32_bf16 v[92:95], v[28:31], v[52:55], v[92:95]
  buffer_load_dwordx4 v[52:55], v5, s[12:15], s35 offen sc1
  s_waitcnt vmcnt(9)
  v_mfma_f32_16x16x32_bf16 v[96:99], v[16:19], v[56:59], v[96:99]
  v_mfma_f32_16x16x32_bf16 v[100:103], v[20:23], v[56:59], v[100:103]
  v_mfma_f32_16x16x32_bf16 v[104:107], v[24:27], v[56:59], v[104:107]
  v_mfma_f32_16x16x32_bf16 v[108:111], v[28:31], v[56:59], v[108:111]
  buffer_load_dwordx4 v[56:59], v6, s[12:15], s35 offen sc1
  s_waitcnt vmcnt(9)
  v_mfma_f32_16x16x32_bf16 v[112:115], v[16:19], v[60:63], v[112:115]
  v_mfma_f32_16x16x32_bf16 v[116:119], v[20:23], v[60:63], v[116:119]
  v_mfma_f32_16x16x32_bf16 v[120:123], v[24:27], v[60:63], v[120:123]
  v_mfma_f32_16x16x32_bf16 v[124:127], v[28:31], v[60:63], v[124:127]
  buffer_load_dwordx4 v[60:63], v7, s[12:15], s35 offen sc1
  s_waitcnt vmcnt(14)
  s_barrier
  s_waitcnt vmcnt(7)
  v_mfma_f32_16x16x32_bf16 v[64:67], v[16:19], v[48:51], v[64:67]
  v_mfma_f32_16x16x32_bf16 v[68:71], v[20:23], v[48:51], v[68:71]
  ds_read_b64_tr_b16 v[16:17], v8 offset:32768
  ds_read_b64_tr_b16 v[18:19], v8 offset:33792
  v_mfma_f32_16x16x32_bf16 v[72:75], v[24:27], v[48:51], v[72:75]
  ds_read_b64_tr_b16 v[20:21], v9 offset:32768
  ds_read_b64_tr_b16 v[22:23], v9 offset:33792
  v_mfma_f32_16x16x32_bf16 v[76:79], v[28:31], v[48:51], v[76:79]
  ds_read_b64_tr_b16 v[24:25], v10 offset:32768
  ds_read_b64_tr_b16 v[26:27], v10 offset:33792
  buffer_load_dwordx4 v[48:51], v4, s[12:15], s35 offen sc1
  s_add_u32 s35, s35, 4096
  s_nop 3
  ds_read_b64_tr_b16 v[28:29], v11 offset:32768
  ds_read_b64_tr_b16 v[30:31], v11 offset:33792
  s_waitcnt vmcnt(7)
  s_waitcnt lgkmcnt(6)
  v_mfma_f32_16x16x32_bf16 v[80:83], v[16:19], v[36:39], v[80:83]
  s_waitcnt lgkmcnt(4)
  v_mfma_f32_16x16x32_bf16 v[84:87], v[20:23], v[36:39], v[84:87]
  s_waitcnt lgkmcnt(2)
  v_mfma_f32_16x16x32_bf16 v[88:91], v[24:27], v[36:39], v[88:91]
  s_waitcnt lgkmcnt(0)
  v_mfma_f32_16x16x32_bf16 v[92:95], v[28:31], v[36:39], v[92:95]
  buffer_load_dwordx4 v[36:39], v5, s[12:15], s35 offen sc1
  s_waitcnt vmcnt(7)
  v_mfma_f32_16x16x32_bf16 v[96:99], v[16:19], v[40:43], v[96:99]
  v_mfma_f32_16x16x32_bf16 v[100:103], v[20:23], v[40:43], v[100:103]
  v_mfma_f32_16x16x32_bf16 v[104:107], v[24:27], v[40:43], v[104:107]
  v_mfma_f32_16x16x32_bf16 v[108:111], v[28:31], v[40:43], v[108:111]
  buffer_load_dwordx4 v[40:43], v6, s[12:15], s35 offen sc1
  s_waitcnt vmcnt(7)
  v_mfma_f32_16x16x32_bf16 v[112:115], v[16:19], v[44:47], v[112:115]
  v_mfma_f32_16x16x32_bf16 v[116:119], v[20:23], v[44:47], v[116:119]
  v_mfma_f32_16x16x32_bf16 v[120:123], v[24:27], v[44:47], v[120:123]
  v_mfma_f32_16x16x32_bf16 v[124:127], v[28:31], v[44:47], v[124:127]
  buffer_load_dwordx4 v[44:47], v7, s[12:15], s35 offen sc1
  s_waitcnt vmcnt(12)
  s_barrier
  s_waitcnt vmcnt(7)
  v_mfma_f32_16x16x32_bf16 v[64:67], v[16:19], v[32:35], v[64:67]
  v_mfma_f32_16x16x32_bf16 v[68:71], v[20:23], v[32:35], v[68:71]
  ds_read_b64_tr_b16 v[16:17], v8 offset:49152
  ds_read_b64_tr_b16 v[18:19], v8 offset:50176
  v_mfma_f32_16x16x32_bf16 v[72:75], v[24:27], v[32:35], v[72:75]
  ds_read_b64_tr_b16 v[20:21], v9 offset:49152
  ds_read_b64_tr_b16 v[22:23], v9 offset:50176
  v_mfma_f32_16x16x32_bf16 v[76:79], v[28:31], v[32:35], v[76:79]
  ds_read_b64_tr_b16 v[24:25], v10 offset:49152
  ds_read_b64_tr_b16 v[26:27], v10 offset:50176
  buffer_load_dwordx4 v[32:35], v4, s[12:15], s35 offen sc1
  s_add_u32 s35, s35, 4096
  s_nop 3
  ds_read_b64_tr_b16 v[28:29], v11 offset:49152
  ds_read_b64_tr_b16 v[30:31], v11 offset:50176
  s_waitcnt vmcnt(7)
  s_waitcnt lgkmcnt(6)
  v_mfma_f32_16x16x32_bf16 v[80:83], v[16:19], v[52:55], v[80:83]
  s_waitcnt lgkmcnt(4)
  v_mfma_f32_16x16x32_bf16 v[84:87], v[20:23], v[52:55], v[84:87]
  s_waitcnt lgkmcnt(2)
  v_mfma_f32_16x16x32_bf16 v[88:91], v[24:27], v[52:55], v[88:91]
  s_waitcnt lgkmcnt(0)
  v_mfma_f32_16x16x32_bf16 v[92:95], v[28:31], v[52:55], v[92:95]
  buffer_load_dwordx4 v[52:55], v5, s[12:15], s35 offen sc1
  s_waitcnt vmcnt(7)
  v_mfma_f32_16x16x32_bf16 v[96:99], v[16:19], v[56:59], v[96:99]
  v_mfma_f32_16x16x32_bf16 v[100:103], v[20:23], v[56:59], v[100:103]
  v_mfma_f32_16x16x32_bf16 v[104:107], v[24:27], v[56:59], v[104:107]
  v_mfma_f32_16x16x32_bf16 v[108:111], v[28:31], v[56:59], v[108:111]
  buffer_load_dwordx4 v[56:59], v6, s[12:15], s35 offen sc1
  s_waitcnt vmcnt(7)
  v_mfma_f32_16x16x32_bf16 v[112:115], v[16:19], v[60:63], v[112:115]
  v_mfma_f32_16x16x32_bf16 v[116:119], v[20:23], v[60:63], v[116:119]
  v_mfma_f32_16x16x32_bf16 v[120:123], v[24:27], v[60:63], v[120:123]
  v_mfma_f32_16x16x32_bf16 v[124:127], v[28:31], v[60:63], v[124:127]
  buffer_load_dwordx4 v[60:63], v7, s[12:15], s35 offen sc1
  s_waitcnt vmcnt(7)
  v_mfma_f32_16x16x32_bf16 v[64:67], v[16:19], v[48:51], v[64:67]
  v_mfma_f32_16x16x32_bf16 v[68:71], v[20:23], v[48:51], v[68:71]
  ds_read_b64_tr_b16 v[16:17], v12 offset:0
  ds_read_b64_tr_b16 v[18:19], v12 offset:1024
  v_mfma_f32_16x16x32_bf16 v[72:75], v[24:27], v[48:51], v[72:75]
  ds_read_b64_tr_b16 v[20:21], v13 offset:0
  ds_read_b64_tr_b16 v[22:23], v13 offset:1024
  v_mfma_f32_16x16x32_bf16 v[76:79], v[28:31], v[48:51], v[76:79]
  ds_read_b64_tr_b16 v[24:25], v14 offset:0
  ds_read_b64_tr_b16 v[26:27], v14 offset:1024
  buffer_load_dwordx4 v[48:51], v4, s[12:15], s35 offen sc1
  s_add_u32 s35, s35, 4096
  s_nop 3
  ds_read_b64_tr_b16 v[28:29], v15 offset:0
  ds_read_b64_tr_b16 v[30:31], v15 offset:1024
  s_waitcnt vmcnt(7)
  s_waitcnt lgkmcnt(6)
  v_mfma_f32_16x16x32_bf16 v[80:83], v[16:19], v[36:39], v[80:83]
  s_waitcnt lgkmcnt(4)
  v_mfma_f32_16x16x32_bf16 v[84:87], v[20:23], v[36:39], v[84:87]
  s_waitcnt lgkmcnt(2)
  v_mfma_f32_16x16x32_bf16 v[88:91], v[24:27], v[36:39], v[88:91]
  s_waitcnt lgkmcnt(0)
  v_mfma_f32_16x16x32_bf16 v[92:95], v[28:31], v[36:39], v[92:95]
  buffer_load_dwordx4 v[36:39], v5, s[12:15], s35 offen sc1
  s_waitcnt vmcnt(7)
  v_mfma_f32_16x16x32_bf16 v[96:99], v[16:19], v[40:43], v[96:99]
  v_mfma_f32_16x16x32_bf16 v[100:103], v[20:23], v[40:43], v[100:103]
  v_mfma_f32_16x16x32_bf16 v[104:107], v[24:27], v[40:43], v[104:107]
  v_mfma_f32_16x16x32_bf16 v[108:111], v[28:31], v[40:43], v[108:111]
  buffer_load_dwordx4 v[40:43], v6, s[12:15], s35 offen sc1
  s_waitcnt vmcnt(7)
  v_mfma_f32_16x16x32_bf16 v[112:115], v[16:19], v[44:47], v[112:115]
  v_mfma_f32_16x16x32_bf16 v[116:119], v[20:23], v[44:47], v[116:119]
  v_mfma_f32_16x16x32_bf16 v[120:123], v[24:27], v[44:47], v[120:123]
  v_mfma_f32_16x16x32_bf16 v[124:127], v[28:31], v[44:47], v[124:127]
  buffer_load_dwordx4 v[44:47], v7, s[12:15], s35 offen sc1
  s_waitcnt vmcnt(7)
  v_mfma_f32_16x16x32_bf16 v[64:67], v[16:19], v[32:35], v[64:67]
  v_mfma_f32_16x16x32_bf16 v[68:71], v[20:23], v[32:35], v[68:71]
  ds_read_b64_tr_b16 v[16:17], v12 offset:16384
  ds_read_b64_tr_b16 v[18:19], v12 offset:17408
  v_mfma_f32_16x16x32_bf16 v[72:75], v[24:27], v[32:35], v[72:75]
  ds_read_b64_tr_b16 v[20:21], v13 offset:16384
  ds_read_b64_tr_b16 v[22:23], v13 offset:17408
  v_mfma_f32_16x16x32_bf16 v[76:79], v[28:31], v[32:35], v[76:79]
  ds_read_b64_tr_b16 v[24:25], v14 offset:16384
  ds_read_b64_tr_b16 v[26:27], v14 offset:17408
  buffer_load_dwordx4 v[32:35], v4, s[12:15], s35 offen sc1
  s_add_u32 s35, s35, 4096
  s_nop 3
  ds_read_b64_tr_b16 v[28:29], v15 offset:16384
  ds_read_b64_tr_b16 v[30:31], v15 offset:17408
  s_waitcnt vmcnt(41)
  s_barrier
  s_waitcnt vmcnt(7)
  s_waitcnt lgkmcnt(6)
  v_mfma_f32_16x16x32_bf16 v[80:83], v[16:19], v[52:55], v[80:83]
  s_waitcnt lgkmcnt(4)
  v_mfma_f32_16x16x32_bf16 v[84:87], v[20:23], v[52:55], v[84:87]
  s_waitcnt lgkmcnt(2)
  v_mfma_f32_16x16x32_bf16 v[88:91], v[24:27], v[52:55], v[88:91]
  s_waitcnt lgkmcnt(0)
  v_mfma_f32_16x16x32_bf16 v[92:95], v[28:31], v[52:55], v[92:95]
  buffer_load_dwordx4 v[52:55], v5, s[12:15], s35 offen sc1
  s_waitcnt vmcnt(7)
  v_mfma_f32_16x16x32_bf16 v[96:99], v[16:19], v[56:59], v[96:99]
  v_mfma_f32_16x16x32_bf16 v[100:103], v[20:23], v[56:59], v[100:103]
  v_mfma_f32_16x16x32_bf16 v[104:107], v[24:27], v[56:59], v[104:107]
  v_mfma_f32_16x16x32_bf16 v[108:111], v[28:31], v[56:59], v[108:111]
  buffer_load_dwordx4 v[56:59], v6, s[12:15], s35 offen sc1
  s_waitcnt vmcnt(7)
  v_mfma_f32_16x16x32_bf16 v[112:115], v[16:19], v[60:63], v[112:115]
  v_mfma_f32_16x16x32_bf16 v[116:119], v[20:23], v[60:63], v[116:119]
  v_mfma_f32_16x16x32_bf16 v[120:123], v[24:27], v[60:63], v[120:123]
  v_mfma_f32_16x16x32_bf16 v[124:127], v[28:31], v[60:63], v[124:127]
  buffer_load_dwordx4 v[60:63], v7, s[12:15], s35 offen sc1
  s_waitcnt vmcnt(7)
  v_mfma_f32_16x16x32_bf16 v[64:67], v[16:19], v[48:51], v[64:67]
  v_mfma_f32_16x16x32_bf16 v[68:71], v[20:23], v[48:51], v[68:71]
  ds_read_b64_tr_b16 v[16:17], v12 offset:32768
  ds_read_b64_tr_b16 v[18:19], v12 offset:33792
  v_mfma_f32_16x16x32_bf16 v[72:75], v[24:27], v[48:51], v[72:75]
  ds_read_b64_tr_b16 v[20:21], v13 offset:32768
  ds_read_b64_tr_b16 v[22:23], v13 offset:33792
  v_mfma_f32_16x16x32_bf16 v[76:79], v[28:31], v[48:51], v[76:79]
  ds_read_b64_tr_b16 v[24:25], v14 offset:32768
  ds_read_b64_tr_b16 v[26:27], v14 offset:33792
  buffer_load_dwordx4 v[48:51], v4, s[12:15], s35 offen sc1
  s_add_u32 s35, s35, 4096
  s_nop 3
  ds_read_b64_tr_b16 v[28:29], v15 offset:32768
  ds_read_b64_tr_b16 v[30:31], v15 offset:33792
  s_lshl_b32 s39, s31, 3
  s_lshl_b32 s48, s29, 2
  s_add_u32 s39, s39, s48
  s_add_u32 s39, s39, s30
  s_lshl_b32 s39, s39, 15
  s_lshl_b32 s48, s32, 7
  s_add_u32 s39, s39, s48
  v_and_b32 v2, 15, v0
  v_lshlrev_b32 v2, 11, v2
  v_lshrrev_b32 v3, 4, v0
  v_lshl_add_u32 v2, v3, 3, v2

  v_lshlrev_b32 v3, 4, v0
  s_lshl_b32 s49, s29, 2
  s_add_u32 s48, s30, 0
  s_and_b32 s48, s48, 3
  s_add_u32 s48, s48, s49
  s_mul_i32 s48, s48, 12288
  s_add_u32 s48, s48, 65536
  v_add_u32 v4, s48, v3
  s_add_u32 s48, s30, 1
  s_and_b32 s48, s48, 3
  s_add_u32 s48, s48, s49
  s_mul_i32 s48, s48, 12288
  s_add_u32 s48, s48, 65536
  v_add_u32 v5, s48, v3
  s_add_u32 s48, s30, 2
  s_and_b32 s48, s48, 3
  s_add_u32 s48, s48, s49
  s_mul_i32 s48, s48, 12288
  s_add_u32 s48, s48, 65536
  v_add_u32 v6, s48, v3
  s_add_u32 s48, s30, 3
  s_and_b32 s48, s48, 3
  s_add_u32 s48, s48, s49
  s_mul_i32 s48, s48, 12288
  s_add_u32 s48, s48, 65536
  v_add_u32 v7, s48, v3
  s_waitcnt vmcnt(7)
  s_waitcnt lgkmcnt(6)
  v_mfma_f32_16x16x32_bf16 v[80:83], v[16:19], v[36:39], v[80:83]
  s_waitcnt lgkmcnt(4)
  v_mfma_f32_16x16x32_bf16 v[84:87], v[20:23], v[36:39], v[84:87]
  s_waitcnt lgkmcnt(2)
  v_mfma_f32_16x16x32_bf16 v[88:91], v[24:27], v[36:39], v[88:91]
  s_waitcnt lgkmcnt(0)
  v_mfma_f32_16x16x32_bf16 v[92:95], v[28:31], v[36:39], v[92:95]
  s_waitcnt vmcnt(6)
  v_mfma_f32_16x16x32_bf16 v[96:99], v[16:19], v[40:43], v[96:99]
  v_mfma_f32_16x16x32_bf16 v[100:103], v[20:23], v[40:43], v[100:103]
  v_mfma_f32_16x16x32_bf16 v[104:107], v[24:27], v[40:43], v[104:107]
  v_mfma_f32_16x16x32_bf16 v[108:111], v[28:31], v[40:43], v[108:111]
  s_waitcnt vmcnt(5)
  v_mfma_f32_16x16x32_bf16 v[112:115], v[16:19], v[44:47], v[112:115]
  v_mfma_f32_16x16x32_bf16 v[116:119], v[20:23], v[44:47], v[116:119]
  v_mfma_f32_16x16x32_bf16 v[120:123], v[24:27], v[44:47], v[120:123]
  v_mfma_f32_16x16x32_bf16 v[124:127], v[28:31], v[44:47], v[124:127]
  s_waitcnt vmcnt(4)
  v_mfma_f32_16x16x32_bf16 v[64:67], v[16:19], v[32:35], v[64:67]
  v_mfma_f32_16x16x32_bf16 v[68:71], v[20:23], v[32:35], v[68:71]
  ds_read_b64_tr_b16 v[16:17], v12 offset:49152
  ds_read_b64_tr_b16 v[18:19], v12 offset:50176
  v_mfma_f32_16x16x32_bf16 v[72:75], v[24:27], v[32:35], v[72:75]
  ds_read_b64_tr_b16 v[20:21], v13 offset:49152
  ds_read_b64_tr_b16 v[22:23], v13 offset:50176
  v_mfma_f32_16x16x32_bf16 v[76:79], v[28:31], v[32:35], v[76:79]
  ds_read_b64_tr_b16 v[24:25], v14 offset:49152
  ds_read_b64_tr_b16 v[26:27], v14 offset:50176
  s_nop 3
  ds_read_b64_tr_b16 v[28:29], v15 offset:49152
  ds_read_b64_tr_b16 v[30:31], v15 offset:50176
  s_waitcnt vmcnt(3)
  s_waitcnt lgkmcnt(6)
  v_mfma_f32_16x16x32_bf16 v[80:83], v[16:19], v[52:55], v[80:83]
  s_waitcnt lgkmcnt(4)
  v_mfma_f32_16x16x32_bf16 v[84:87], v[20:23], v[52:55], v[84:87]
  s_waitcnt lgkmcnt(2)
  v_mfma_f32_16x16x32_bf16 v[88:91], v[24:27], v[52:55], v[88:91]
  s_waitcnt lgkmcnt(0)
  v_mfma_f32_16x16x32_bf16 v[92:95], v[28:31], v[52:55], v[92:95]
  s_nop 7
  ds_write_b128 v5, v[80:83] offset:0
  ds_write_b128 v5, v[84:87] offset:1024
  ds_write_b128 v5, v[88:91] offset:2048
  ds_write_b128 v5, v[92:95] offset:3072
  s_waitcnt vmcnt(2)
  v_mfma_f32_16x16x32_bf16 v[96:99], v[16:19], v[56:59], v[96:99]
  v_mfma_f32_16x16x32_bf16 v[100:103], v[20:23], v[56:59], v[100:103]
  v_mfma_f32_16x16x32_bf16 v[104:107], v[24:27], v[56:59], v[104:107]
  v_mfma_f32_16x16x32_bf16 v[108:111], v[28:31], v[56:59], v[108:111]
  s_nop 7
  ds_write_b128 v6, v[96:99] offset:4096
  ds_write_b128 v6, v[100:103] offset:5120
  ds_write_b128 v6, v[104:107] offset:6144
  ds_write_b128 v6, v[108:111] offset:7168
  s_waitcnt vmcnt(1)
  v_mfma_f32_16x16x32_bf16 v[112:115], v[16:19], v[60:63], v[112:115]
  v_mfma_f32_16x16x32_bf16 v[116:119], v[20:23], v[60:63], v[116:119]
  v_mfma_f32_16x16x32_bf16 v[120:123], v[24:27], v[60:63], v[120:123]
  v_mfma_f32_16x16x32_bf16 v[124:127], v[28:31], v[60:63], v[124:127]
  s_nop 7
  ds_write_b128 v7, v[112:115] offset:8192
  ds_write_b128 v7, v[116:119] offset:9216
  ds_write_b128 v7, v[120:123] offset:10240
  ds_write_b128 v7, v[124:127] offset:11264
  s_waitcnt lgkmcnt(0)
  s_barrier
  ds_read_b128 v[80:83], v4 offset:0
  ds_read_b128 v[96:99], v4 offset:4096
  ds_read_b128 v[112:115], v4 offset:8192
  ds_read_b128 v[84:87], v4 offset:1024
  ds_read_b128 v[100:103], v4 offset:5120
  ds_read_b128 v[116:119], v4 offset:9216
  ds_read_b128 v[88:91], v4 offset:2048
  ds_read_b128 v[104:107], v4 offset:6144
  ds_read_b128 v[120:123], v4 offset:10240
  ds_read_b128 v[92:95], v4 offset:3072
  ds_read_b128 v[108:111], v4 offset:7168
  ds_read_b128 v[124:127], v4 offset:11264
  s_waitcnt vmcnt(0)
  v_mfma_f32_16x16x32_bf16 v[64:67], v[16:19], v[48:51], v[64:67]
  v_mfma_f32_16x16x32_bf16 v[68:71], v[20:23], v[48:51], v[68:71]
  v_mfma_f32_16x16x32_bf16 v[72:75], v[24:27], v[48:51], v[72:75]
  v_mfma_f32_16x16x32_bf16 v[76:79], v[28:31], v[48:51], v[76:79]
  s_waitcnt lgkmcnt(9)
  v_add_f32 v80, v80, v96
  v_add_f32 v81, v81, v97
  v_add_f32 v82, v82, v98
  v_add_f32 v83, v83, v99
  v_add_f32 v80, v80, v112
  v_add_f32 v81, v81, v113
  v_add_f32 v82, v82, v114
  v_add_f32 v83, v83, v115
  v_add_f32 v64, v64, v80
  v_add_f32 v65, v65, v81
  v_add_f32 v66, v66, v82
  v_add_f32 v67, v67, v83
  v_cvt_pk_bf16_f32 v8, v64, v65
  v_cvt_pk_bf16_f32 v9, v66, v67
  buffer_store_dwordx2 v[8:9], v2, s[24:27], s39 offen offset:0
  s_waitcnt lgkmcnt(6)
  v_add_f32 v84, v84, v100
  v_add_f32 v85, v85, v101
  v_add_f32 v86, v86, v102
  v_add_f32 v87, v87, v103
  v_add_f32 v84, v84, v116
  v_add_f32 v85, v85, v117
  v_add_f32 v86, v86, v118
  v_add_f32 v87, v87, v119
  v_add_f32 v68, v68, v84
  v_add_f32 v69, v69, v85
  v_add_f32 v70, v70, v86
  v_add_f32 v71, v71, v87
  v_cvt_pk_bf16_f32 v10, v68, v69
  v_cvt_pk_bf16_f32 v11, v70, v71
  buffer_store_dwordx2 v[10:11], v2, s[24:27], s39 offen offset:32
  s_waitcnt lgkmcnt(3)
  v_add_f32 v88, v88, v104
  v_add_f32 v89, v89, v105
  v_add_f32 v90, v90, v106
  v_add_f32 v91, v91, v107
  v_add_f32 v88, v88, v120
  v_add_f32 v89, v89, v121
  v_add_f32 v90, v90, v122
  v_add_f32 v91, v91, v123
  v_add_f32 v72, v72, v88
  v_add_f32 v73, v73, v89
  v_add_f32 v74, v74, v90
  v_add_f32 v75, v75, v91
  v_cvt_pk_bf16_f32 v12, v72, v73
  v_cvt_pk_bf16_f32 v13, v74, v75
  buffer_store_dwordx2 v[12:13], v2, s[24:27], s39 offen offset:64
  s_waitcnt lgkmcnt(0)
  v_add_f32 v92, v92, v108
  v_add_f32 v93, v93, v109
  v_add_f32 v94, v94, v110
  v_add_f32 v95, v95, v111
  v_add_f32 v92, v92, v124
  v_add_f32 v93, v93, v125
  v_add_f32 v94, v94, v126
  v_add_f32 v95, v95, v127
  v_add_f32 v76, v76, v92
  v_add_f32 v77, v77, v93
  v_add_f32 v78, v78, v94
  v_add_f32 v79, v79, v95
  v_cvt_pk_bf16_f32 v14, v76, v77
  v_cvt_pk_bf16_f32 v15, v78, v79
  buffer_store_dwordx2 v[14:15], v2, s[24:27], s39 offen offset:96
fused_kernel_end:
  s_waitcnt lgkmcnt(0)
  s_endpgm
.section .rodata,"a"
.p2align 6
.amdhsa_kernel gemm1_kernel
  .amdhsa_next_free_vgpr 256
  .amdhsa_next_free_sgpr 102
  .amdhsa_accum_offset 256
  .amdhsa_group_segment_fixed_size 0
  .amdhsa_kernarg_size 80
  .amdhsa_user_sgpr_count 2
  .amdhsa_user_sgpr_kernarg_segment_ptr 1
  .amdhsa_system_sgpr_workgroup_id_x 1
.end_amdhsa_kernel
.p2align 6
.amdhsa_kernel fused_kernel
  .amdhsa_next_free_vgpr 128
  .amdhsa_next_free_sgpr 96
  .amdhsa_accum_offset 128
  .amdhsa_group_segment_fixed_size 0
  .amdhsa_kernarg_size 80
  .amdhsa_user_sgpr_count 2
  .amdhsa_user_sgpr_kernarg_segment_ptr 1
  .amdhsa_system_sgpr_workgroup_id_x 1
.end_amdhsa_kernel
```
